```python
import torch

def _softmax(x, axis=-1):
    return torch.softmax(x, dim=axis)

def _gelu(x):
    return torch.nn.functional.gelu(x, approximate='tanh')

def _silu(x):
    return torch.nn.functional.silu(x)

def _sigmoid(x):
    return torch.sigmoid(x)

def _layernorm(x, axis=-1, eps=1e-05):
    m = x.mean(dim=axis, keepdim=True)
    v = x.var(dim=axis, keepdim=True, unbiased=False)
    return (x - m) / torch.sqrt(v + eps)

def _scatter_add(tgt, idx, src, axis=0):
    return tgt.clone().index_add_(axis, idx, src)

def _segment_sum(src, seg, n):
    out = torch.zeros((n,) + src.shape[1:], dtype=src.dtype)
    return out.index_add_(0, seg, src)

def _pad(x, pw):
    flat = tuple((v for pair in reversed(pw) for v in pair))
    return torch.nn.functional.pad(x, flat)
kernel_name = 'gated_mix__memory_aug_recurrent_mem_tr__ssm_conv_s5__prompt'

def setup_inputs():

    _w = lambda a: (lambda t: t.to(torch.bfloat16) if t.is_floating_point() else t)(torch.as_tensor(a))

    def _A_setup():
        B, S, Dm = (1, 2048, 640)
        H, Dh = (32, 192)
        M, seg = (8, 32)
        seg = min(seg, S)
        S = S // seg * seg
        return {'x': _w((lambda *s: torch.randn(*s, dtype=torch.bfloat16) * 0.05)(B, S, Dm)), 'mem0': _w((lambda *s: torch.randn(*s, dtype=torch.bfloat16) * 0.8)(B, M, Dm)), 'Wq': _w((lambda *s: torch.randn(*s, dtype=torch.bfloat16) * 1.6)(Dm, H, Dh) * Dm ** (-0.5)), 'Wk': _w((lambda *s: torch.randn(*s, dtype=torch.bfloat16) * 1.6)(Dm, H, Dh) * Dm ** (-0.5)), 'Wv': _w((lambda *s: torch.randn(*s, dtype=torch.bfloat16) * 0.8)(Dm, H, Dh) * Dm ** (-0.5)), 'Wo': _w((lambda *s: torch.randn(*s, dtype=torch.bfloat16) * 0.8)(H, Dh, Dm) * (H * Dh) ** (-0.5)), 'seg_len': seg}
    _A_in = _A_setup()

    def _B_setup():
        B, S, D = (1, 2048, 640)
        P = D
        Lambda_re = -0.5 * (lambda _x: torch.exp(torch.as_tensor(_x)))((lambda *s: torch.randn(*s, dtype=torch.bfloat16) * 0.8)(P))
        Lambda_im = (lambda *s: torch.randn(*s, dtype=torch.bfloat16) * 0.8)(P) * 1.0
        B_re = (lambda *s: torch.randn(*s, dtype=torch.bfloat16) * 0.8)(P, D) * D ** (-0.5)
        B_im = (lambda *s: torch.randn(*s, dtype=torch.bfloat16) * 0.8)(P, D) * D ** (-0.5)
        C_re = (lambda *s: torch.randn(*s, dtype=torch.bfloat16) * 0.8)(D, P) * P ** (-0.5)
        C_im = (lambda *s: torch.randn(*s, dtype=torch.bfloat16) * 0.8)(D, P) * P ** (-0.5)
        log_dt = (lambda *s: torch.randn(*s, dtype=torch.bfloat16) * 0.8)(P) * 0.3 - 2.0
        Dskip = (lambda *s: torch.randn(*s, dtype=torch.bfloat16) * 0.8)(D)
        return {'x': _w((lambda *s: torch.randn(*s, dtype=torch.bfloat16) * 0.05)(B, S, D)), 'Lambda_re': _w(Lambda_re), 'Lambda_im': _w(Lambda_im), 'B_re': _w(B_re), 'B_im': _w(B_im), 'C_re': _w(C_re), 'C_im': _w(C_im), 'log_dt': _w(log_dt), 'Dskip': _w(Dskip)}
    _B_in = _B_setup()
    return {'A_x': _A_in['x'], 'A_mem0': _A_in['mem0'], 'A_Wq': _A_in['Wq'], 'A_Wk': _A_in['Wk'], 'A_Wv': _A_in['Wv'], 'A_Wo': _A_in['Wo'], 'A_seg_len': _A_in['seg_len'], 'B_x': _B_in['x'], 'B_Lambda_re': _B_in['Lambda_re'], 'B_Lambda_im': _B_in['Lambda_im'], 'B_B_re': _B_in['B_re'], 'B_B_im': _B_in['B_im'], 'B_C_re': _B_in['C_re'], 'B_C_im': _B_in['C_im'], 'B_log_dt': _B_in['log_dt'], 'B_Dskip': _B_in['Dskip'], 'gate_w': _w((lambda *s: torch.randn(*s, dtype=torch.bfloat16) * 0.05)(640) * 16.0)}

def reference(A_x, A_mem0, A_Wq, A_Wk, A_Wv, A_Wo, A_seg_len, B_x, B_Lambda_re, B_Lambda_im, B_B_re, B_B_im, B_C_re, B_C_im, B_log_dt, B_Dskip, gate_w):

    def _A_ref(x, mem0, Wq, Wk, Wv, Wo, seg_len):
        B, S, Dm = x.shape
        H, Dh = (Wq.shape[1], Wq.shape[2])
        M = mem0.shape[1]
        scale = Dh ** (-0.5)
        n_seg = S // seg_len
        L = M + seg_len
        idx = torch.arange(L)
        mask = (idx[:, None] < M) | (idx[:, None] >= idx[None, :])
        mem = mem0
        outs = []
        for s in range(n_seg):
            xs = x[:, s * seg_len:(s + 1) * seg_len, :].clone()
            h = torch.concatenate([mem, xs], axis=1)
            q = torch.einsum('btd,dhe->bhte', h, Wq)
            k = torch.einsum('btd,dhe->bhte', h, Wk)
            v = torch.einsum('btd,dhe->bhte', h, Wv)
            scores = torch.einsum('bhqe,bhke->bhqk', q, k) * scale
            scores = torch.where(mask[None, None], scores, -1000000000.0)
            p = _softmax(scores, axis=-1)
            o = torch.einsum('bhqk,bhke->bhqe', p, v)
            o = torch.einsum('bhte,hed->btd', o, Wo)
            mem = o[:, :M, :].clone()
            outs.append(o[:, M:, :])
        return torch.concatenate(outs, axis=1)

    def _B_ref(x, Lambda_re, Lambda_im, B_re, B_im, C_re, C_im, log_dt, Dskip):
        Bsz, L, H = x.shape
        Lam = Lambda_re + 1j * Lambda_im
        Bmat = B_re + 1j * B_im
        Cmat = C_re + 1j * C_im
        dt = torch.exp(log_dt)
        Lam_bar = torch.exp(dt * Lam)
        B_bar = ((Lam_bar - 1.0) / Lam)[:, None] * Bmat
        Bu = torch.einsum('bld,pd->blp', x + 0j, B_bar)
        h = torch.zeros_like(Bu[:, 0, :])
        hs = []
        for t in range(L):
            h = Lam_bar[None, :] * h + Bu[:, t, :]
            hs.append(h)
        hseq = torch.stack(hs, 1)
        y = 2.0 * torch.einsum('blp,dp->bld', hseq, Cmat).real + x * Dskip[None, None, :]
        return y
    x = A_x
    g = _sigmoid((x * gate_w).sum(-1, keepdims=True))
    a = _A_ref(x, A_mem0, A_Wq, A_Wk, A_Wv, A_Wo, A_seg_len)
    b = _B_ref(x, B_Lambda_re, B_Lambda_im, B_B_re, B_B_im, B_C_re, B_C_im, B_log_dt, B_Dskip)
    return g * a + (1 - g) * b
```

```asm
; @launch grid=(256,1,1) block=(256,1,1) lds=163840
.amdgcn_target "amdgcn-amd-amdhsa--gfx950"
.text
.globl gated_mix__memory_aug_recurrent_mem_tr__ssm_conv_s5__prompt_kernel
.p2align 8
.type gated_mix__memory_aug_recurrent_mem_tr__ssm_conv_s5__prompt_kernel,@function
gated_mix__memory_aug_recurrent_mem_tr__ssm_conv_s5__prompt_kernel:
    s_cmp_ge_u32 s2, 256
    s_cbranch_scc1 L_end
    s_load_dwordx2 s[8:9], s[0:1], 152
    s_load_dwordx2 s[24:25], s[0:1], 144
    s_mov_b32 s10, 268435456
    s_mov_b32 s11, 0x20000
    s_mov_b32 s26, 256
    s_mov_b32 s27, 0x20000
    v_and_b32 v1, 63, v0
    v_lshrrev_b32 v2, 6, v0
    s_nop 0
    v_readfirstlane_b32 s3, v2
    s_getreg_b32 s40, hwreg(HW_REG_XCC_ID)
    s_and_b32 s40, s40, 7
    v_mov_b32 v4, 0
    s_cmp_lg_u32 s3, 0
    s_waitcnt lgkmcnt(0)
    s_cbranch_scc1 L_tk
    s_lshl_b32 s30, s40, 4
    s_add_u32 s30, s30, 64
    v_mov_b32 v2, s30
    v_mov_b32 v3, 1
    s_mov_b64 exec, 1
    buffer_atomic_add v3, v2, s[24:27], 0 offen sc0 sc1
    s_mov_b64 exec, -1
    s_waitcnt vmcnt(0)
    v_readfirstlane_b32 s41, v3
    s_nop 0
    s_cmp_lt_u32 s41, 32
    s_nop 1
    s_cbranch_scc1 L_tk_ok
    v_mov_b32 v2, 20
    v_mov_b32 v3, 1
    s_mov_b64 exec, 1
    buffer_atomic_add v3, v2, s[24:27], 0 offen sc0 sc1
    s_mov_b64 exec, -1
    s_waitcnt vmcnt(0)
    v_readfirstlane_b32 s42, v3
    v_and_b32 v2, 7, v1
    v_lshlrev_b32 v2, 4, v2
    s_mov_b32 s31, 0
    s_nop 1
L_tk_all:
    buffer_load_dword v3, v2, s[24:27], 0 offen offset:64 sc1
    s_add_u32 s31, s31, 1
    s_cmp_gt_u32 s31, 400000
    s_cbranch_scc1 L_tk_bad
    s_waitcnt vmcnt(0)
    v_mov_b32 v5, v3
    s_nop 1
    v_add_u32_dpp v5, v5, v5 row_ror:4 row_mask:0xf bank_mask:0xf
    s_nop 1
    v_add_u32_dpp v5, v5, v5 row_ror:2 row_mask:0xf bank_mask:0xf
    s_nop 1
    v_add_u32_dpp v5, v5, v5 row_ror:1 row_mask:0xf bank_mask:0xf
    s_nop 0
    v_readfirstlane_b32 s30, v5
    s_nop 0
    s_cmp_lt_u32 s30, 256
    s_nop 1
    s_cbranch_scc1 L_tk_all
    s_mov_b32 s40, 0
L_tk_hole:
    v_readlane_b32 s41, v3, s40
    s_nop 0
    s_min_u32 s41, s41, 32
    s_add_u32 s41, s41, s42
    s_cmp_lt_u32 s41, 32
    s_cbranch_scc1 L_tk_ok
    s_sub_u32 s42, s41, 32
    s_add_u32 s40, s40, 1
    s_cmp_lt_u32 s40, 8
    s_cbranch_scc1 L_tk_hole
L_tk_bad:
    s_waitcnt vmcnt(0)
    s_mov_b32 s41, 64
L_tk_ok:
    s_lshl_b32 s41, s41, 2
    s_and_b32 s30, s40, 3
    s_add_u32 s41, s41, s30
    s_and_b32 s30, s40, 4
    s_lshl_b32 s30, s30, 5
    s_add_u32 s41, s41, s30
    v_mov_b32 v3, s41
    ds_write_b32 v4, v3
    s_waitcnt lgkmcnt(0)
L_tk:
    s_barrier
    ds_read_b32 v3, v4
    s_waitcnt lgkmcnt(0)
    v_readfirstlane_b32 s30, v3
    s_barrier
    s_cmp_gt_u32 s30, 255
    s_nop 1
    s_cbranch_scc1 L_end
    s_mov_b32 s2, s30
    s_mov_b32 s6, s2
    s_waitcnt lgkmcnt(0)
    s_cmp_lt_u32 s2, 32
    s_cbranch_scc1 L_role_c
    s_cmp_lt_u32 s2, 64
    s_cbranch_scc1 L_role_b
    s_cmp_lt_u32 s2, 104
    s_cbranch_scc1 L_role_r
    s_cmp_lt_u32 s2, 128
    s_cbranch_scc1 L_role_sp
    s_cmp_lt_u32 s2, 200
    s_cbranch_scc1 L_role_pj
    s_cmp_lt_u32 s2, 232
    s_cbranch_scc1 L_role_vo
    s_cmp_lt_u32 s2, 242
    s_cbranch_scc1 L_role_s5a
    s_cmp_lt_u32 s2, 252
    s_cbranch_scc1 L_role_s5b
    s_branch L_role_sp
.p2align 6
L_role_c:
    s_mov_b32 s4, s2
    s_load_dwordx2 s[12:13], s[0:1], 16
    s_mov_b32 s14, 7864320
    s_mov_b32 s15, 0x20000
    s_load_dwordx2 s[16:17], s[0:1], 24
    s_mov_b32 s18, 7864320
    s_mov_b32 s19, 0x20000
    s_waitcnt lgkmcnt(0)
    s_lshr_b32 s31, s4, 3
    s_lshr_b32 s30, s31, 1
    s_add_u32 s30, s30, 24
    s_lshl_b32 s30, s30, 16
    s_and_b32 s43, s31, 1
    s_lshl_b32 s43, s43, 14
    s_add_u32 s43, s43, s30
    s_and_b32 s30, s4, 7
    s_mul_i32 s30, s30, 768
    s_add_u32 s43, s43, s30
    s_cmp_lg_u32 s3, 0
    s_cbranch_scc1 Lar0_1
    v_mov_b32 v24, -1
    v_mov_b32 v25, -1
    v_mov_b32 v26, -1
    v_mov_b32 v27, -1
    v_lshl_add_u32 v22, v1, 4, s43
    s_mov_b32 exec_hi, 0xff
    s_mov_b32 s30, 0
    buffer_store_dwordx4 v[24:27], v22, s[8:11], s30 offen sc1
    s_mov_b32 s30, 8192
    buffer_store_dwordx4 v[24:27], v22, s[8:11], s30 offen sc1
    s_mov_b32 s30, 32768
    buffer_store_dwordx4 v[24:27], v22, s[8:11], s30 offen sc1
    s_mov_b32 s30, 40960
    buffer_store_dwordx4 v[24:27], v22, s[8:11], s30 offen sc1
    s_mov_b64 exec, -1
    v_mov_b32 v20, 0
    v_lshlrev_b32 v21, 2, v1
    s_lshl_b32 s30, s2, 7
    s_add_u32 s30, s30, 246415360
    s_mov_b64 exec, 0xffffffff
    buffer_store_dword v20, v21, s[8:11], s30 offen sc1
    s_mov_b64 exec, -1
    s_waitcnt vmcnt(0)
    s_cmp_eq_u32 s3, 0
    s_cselect_b32 s30, 0, 2146435072
    v_mov_b32 v20, 0
    v_mov_b32 v21, 1
    s_mov_b64 exec, 1
    buffer_atomic_add v21, v20, s[24:27], s30 offen sc1
    s_mov_b64 exec, -1
Lar0_1:
    s_mul_i32 s41, s4, 384
    s_lshl_b32 s56, s4, 7
    s_cmp_eq_u32 s3, 1
    s_cselect_b32 s30, 4096, 0
    s_add_u32 s56, s56, s30
    s_add_u32 s56, s56, 246448128
    s_lshr_b32 s30, s3, 1
    s_and_b32 s31, s3, 1
    s_lshl_b32 s30, s30, 4
    s_lshl_b32 s31, s31, 2
    s_add_u32 s30, s30, s31
    s_mov_b32 s32, 12288
    v_add_u32 v2, 0, v1
    v_mul_u32_u24 v3, 2731, v2
    v_lshrrev_b32 v3, 16, v3
    v_mul_u32_u24 v4, 24, v3
    v_sub_u32 v2, v2, v4
    v_lshrrev_b32 v4, 1, v3
    v_lshlrev_b32 v4, 1, v4
    v_xor_b32 v2, v2, v4
    v_and_b32 v4, 4, v3
    v_add_u32 v3, v3, v4
    v_add_u32 v3, s30, v3
    v_mul_lo_u32 v3, v3, s32
    v_lshl_add_u32 v6, v2, 4, v3
    v_add_u32 v2, 64, v1
    v_mul_u32_u24 v3, 2731, v2
    v_lshrrev_b32 v3, 16, v3
    v_mul_u32_u24 v4, 24, v3
    v_sub_u32 v2, v2, v4
    v_lshrrev_b32 v4, 1, v3
    v_lshlrev_b32 v4, 1, v4
    v_xor_b32 v2, v2, v4
    v_and_b32 v4, 4, v3
    v_add_u32 v3, v3, v4
    v_add_u32 v3, s30, v3
    v_mul_lo_u32 v3, v3, s32
    v_lshl_add_u32 v7, v2, 4, v3
    v_add_u32 v2, 128, v1
    v_mul_u32_u24 v3, 2731, v2
    v_lshrrev_b32 v3, 16, v3
    v_mul_u32_u24 v4, 24, v3
    v_sub_u32 v2, v2, v4
    v_lshrrev_b32 v4, 1, v3
    v_lshlrev_b32 v4, 1, v4
    v_xor_b32 v2, v2, v4
    v_and_b32 v4, 4, v3
    v_add_u32 v3, v3, v4
    v_add_u32 v3, s30, v3
    v_mul_lo_u32 v3, v3, s32
    v_lshl_add_u32 v8, v2, 4, v3
    v_bfe_u32 v2, v1, 2, 3
    v_lshrrev_b32 v10, 1, v2
    v_mul_u32_u24 v9, 384, v2
    v_lshrrev_b32 v2, 5, v1
    v_mul_u32_u24 v2, 6144, v2
    v_add_u32 v9, v9, v2
    v_and_b32 v2, 3, v1
    v_lshl_add_u32 v9, v2, 3, v9
    s_lshr_b32 s30, s3, 1
    s_and_b32 s31, s3, 1
    s_lshl_b32 s30, s30, 4
    s_lshl_b32 s31, s31, 2
    s_add_u32 s30, s30, s31
    s_mov_b32 s32, 12288
    v_add_u32 v2, 0, v1
    v_mul_u32_u24 v3, 2731, v2
    v_lshrrev_b32 v3, 16, v3
    v_mul_u32_u24 v4, 24, v3
    v_sub_u32 v2, v2, v4
    v_lshrrev_b32 v4, 1, v3
    v_lshlrev_b32 v4, 1, v4
    v_xor_b32 v2, v2, v4
    v_and_b32 v4, 4, v3
    v_add_u32 v3, v3, v4
    v_add_u32 v3, s30, v3
    v_mul_lo_u32 v3, v3, s32
    v_lshl_add_u32 v11, v2, 4, v3
    v_add_u32 v2, 64, v1
    v_mul_u32_u24 v3, 2731, v2
    v_lshrrev_b32 v3, 16, v3
    v_mul_u32_u24 v4, 24, v3
    v_sub_u32 v2, v2, v4
    v_lshrrev_b32 v4, 1, v3
    v_lshlrev_b32 v4, 1, v4
    v_xor_b32 v2, v2, v4
    v_and_b32 v4, 4, v3
    v_add_u32 v3, v3, v4
    v_add_u32 v3, s30, v3
    v_mul_lo_u32 v3, v3, s32
    v_lshl_add_u32 v12, v2, 4, v3
    v_add_u32 v2, 128, v1
    v_mul_u32_u24 v3, 2731, v2
    v_lshrrev_b32 v3, 16, v3
    v_mul_u32_u24 v4, 24, v3
    v_sub_u32 v2, v2, v4
    v_lshrrev_b32 v4, 1, v3
    v_lshlrev_b32 v4, 1, v4
    v_xor_b32 v2, v2, v4
    v_and_b32 v4, 4, v3
    v_add_u32 v3, v3, v4
    v_add_u32 v3, s30, v3
    v_mul_lo_u32 v3, v3, s32
    v_lshl_add_u32 v13, v2, 4, v3
    v_bfe_u32 v2, v1, 2, 3
    v_lshrrev_b32 v15, 1, v2
    v_mul_u32_u24 v14, 384, v2
    v_lshrrev_b32 v2, 5, v1
    v_mul_u32_u24 v2, 6144, v2
    v_add_u32 v14, v14, v2
    v_and_b32 v2, 3, v1
    v_lshl_add_u32 v14, v2, 3, v14
    s_mul_i32 s33, s3, 3072
    s_add_u32 s34, s41, 0
    s_add_u32 m0, s33, 0
    s_nop 0
    buffer_load_dwordx4 v6, s[12:15], s34 offen nt lds
    s_add_u32 m0, s33, 1024
    s_nop 0
    buffer_load_dwordx4 v7, s[12:15], s34 offen nt lds
    s_add_u32 m0, s33, 2048
    s_nop 0
    buffer_load_dwordx4 v8, s[12:15], s34 offen nt lds
    s_add_u32 s34, s41, 393216
    s_add_u32 m0, s33, 12288
    s_nop 0
    buffer_load_dwordx4 v6, s[12:15], s34 offen nt lds
    s_add_u32 m0, s33, 13312
    s_nop 0
    buffer_load_dwordx4 v7, s[12:15], s34 offen nt lds
    s_add_u32 m0, s33, 14336
    s_nop 0
    buffer_load_dwordx4 v8, s[12:15], s34 offen nt lds
    s_mul_i32 s33, s3, 3072
    s_add_u32 s34, s41, 786432
    s_add_u32 m0, s33, 24576
    s_nop 0
    buffer_load_dwordx4 v6, s[12:15], s34 offen nt lds
    s_add_u32 m0, s33, 25600
    s_nop 0
    buffer_load_dwordx4 v7, s[12:15], s34 offen nt lds
    s_add_u32 m0, s33, 26624
    s_nop 0
    buffer_load_dwordx4 v8, s[12:15], s34 offen nt lds
    s_add_u32 s34, s41, 1179648
    s_add_u32 m0, s33, 36864
    s_nop 0
    buffer_load_dwordx4 v6, s[12:15], s34 offen nt lds
    s_add_u32 m0, s33, 37888
    s_nop 0
    buffer_load_dwordx4 v7, s[12:15], s34 offen nt lds
    s_add_u32 m0, s33, 38912
    s_nop 0
    buffer_load_dwordx4 v8, s[12:15], s34 offen nt lds
    s_mul_i32 s33, s3, 3072
    s_add_u32 s34, s41, 1572864
    s_add_u32 m0, s33, 49152
    s_nop 0
    buffer_load_dwordx4 v6, s[12:15], s34 offen nt lds
    s_add_u32 m0, s33, 50176
    s_nop 0
    buffer_load_dwordx4 v7, s[12:15], s34 offen nt lds
    s_add_u32 m0, s33, 51200
    s_nop 0
    buffer_load_dwordx4 v8, s[12:15], s34 offen nt lds
    s_add_u32 s34, s41, 1966080
    s_add_u32 m0, s33, 61440
    s_nop 0
    buffer_load_dwordx4 v6, s[12:15], s34 offen nt lds
    s_add_u32 m0, s33, 62464
    s_nop 0
    buffer_load_dwordx4 v7, s[12:15], s34 offen nt lds
    s_add_u32 m0, s33, 63488
    s_nop 0
    buffer_load_dwordx4 v8, s[12:15], s34 offen nt lds
    s_mul_i32 s33, s3, 3072
    s_add_u32 s34, s41, 2359296
    s_add_u32 m0, s33, 73728
    s_nop 0
    buffer_load_dwordx4 v6, s[12:15], s34 offen nt lds
    s_add_u32 m0, s33, 74752
    s_nop 0
    buffer_load_dwordx4 v7, s[12:15], s34 offen nt lds
    s_add_u32 m0, s33, 75776
    s_nop 0
    buffer_load_dwordx4 v8, s[12:15], s34 offen nt lds
    s_add_u32 s34, s41, 2752512
    s_add_u32 m0, s33, 86016
    s_nop 0
    buffer_load_dwordx4 v6, s[12:15], s34 offen nt lds
    s_add_u32 m0, s33, 87040
    s_nop 0
    buffer_load_dwordx4 v7, s[12:15], s34 offen nt lds
    s_add_u32 m0, s33, 88064
    s_nop 0
    buffer_load_dwordx4 v8, s[12:15], s34 offen nt lds
    s_mul_i32 s33, s3, 3072
    s_add_u32 s34, s41, 3145728
    s_add_u32 m0, s33, 98304
    s_nop 0
    buffer_load_dwordx4 v6, s[12:15], s34 offen nt lds
    s_add_u32 m0, s33, 99328
    s_nop 0
    buffer_load_dwordx4 v7, s[12:15], s34 offen nt lds
    s_add_u32 m0, s33, 100352
    s_nop 0
    buffer_load_dwordx4 v8, s[12:15], s34 offen nt lds
    s_add_u32 s34, s41, 3538944
    s_add_u32 m0, s33, 110592
    s_nop 0
    buffer_load_dwordx4 v6, s[12:15], s34 offen nt lds
    s_add_u32 m0, s33, 111616
    s_nop 0
    buffer_load_dwordx4 v7, s[12:15], s34 offen nt lds
    s_add_u32 m0, s33, 112640
    s_nop 0
    buffer_load_dwordx4 v8, s[12:15], s34 offen nt lds
    s_mul_i32 s33, s3, 3072
    s_add_u32 s34, s41, 3932160
    s_add_u32 m0, s33, 122880
    s_nop 0
    buffer_load_dwordx4 v6, s[12:15], s34 offen nt lds
    s_add_u32 m0, s33, 123904
    s_nop 0
    buffer_load_dwordx4 v7, s[12:15], s34 offen nt lds
    s_add_u32 m0, s33, 124928
    s_nop 0
    buffer_load_dwordx4 v8, s[12:15], s34 offen nt lds
    s_add_u32 s34, s41, 4325376
    s_add_u32 m0, s33, 135168
    s_nop 0
    buffer_load_dwordx4 v6, s[12:15], s34 offen nt lds
    s_add_u32 m0, s33, 136192
    s_nop 0
    buffer_load_dwordx4 v7, s[12:15], s34 offen nt lds
    s_add_u32 m0, s33, 137216
    s_nop 0
    buffer_load_dwordx4 v8, s[12:15], s34 offen nt lds
    s_waitcnt vmcnt(30) lgkmcnt(0)
    s_barrier
    v_add_u32 v4, 0, v9
    s_lshl_b32 s35, s3, 1
    v_xor_b32 v2, s35, v10
    v_lshl_add_u32 v2, v2, 5, v4
    ds_read_b64_tr_b16 a[0:1], v2 offset:0
    ds_read_b64_tr_b16 a[2:3], v2 offset:3072
    ds_read_b64_tr_b16 a[4:5], v2 offset:12288
    ds_read_b64_tr_b16 a[6:7], v2 offset:15360
    s_lshl_b32 s35, s3, 1
    s_add_u32 s35, s35, 1
    v_xor_b32 v3, s35, v10
    v_lshl_add_u32 v3, v3, 5, v4
    ds_read_b64_tr_b16 v[32:33], v3 offset:0
    ds_read_b64_tr_b16 v[34:35], v3 offset:3072
    ds_read_b64_tr_b16 v[36:37], v3 offset:12288
    ds_read_b64_tr_b16 v[38:39], v3 offset:15360
    s_add_u32 s35, s3, 8
    v_xor_b32 v2, s35, v10
    v_lshl_add_u32 v2, v2, 5, v4
    ds_read_b64_tr_b16 a[8:9], v2 offset:0
    ds_read_b64_tr_b16 a[10:11], v2 offset:3072
    ds_read_b64_tr_b16 a[12:13], v2 offset:12288
    ds_read_b64_tr_b16 a[14:15], v2 offset:15360
    s_waitcnt vmcnt(24) lgkmcnt(0)
    s_barrier
    s_mul_i32 s33, s3, 3072
    s_add_u32 s34, s41, 4718592
    s_add_u32 m0, s33, 0
    s_nop 0
    buffer_load_dwordx4 v6, s[12:15], s34 offen nt lds
    s_add_u32 m0, s33, 1024
    s_nop 0
    buffer_load_dwordx4 v7, s[12:15], s34 offen nt lds
    s_add_u32 m0, s33, 2048
    s_nop 0
    buffer_load_dwordx4 v8, s[12:15], s34 offen nt lds
    s_add_u32 s34, s41, 5111808
    s_add_u32 m0, s33, 12288
    s_nop 0
    buffer_load_dwordx4 v6, s[12:15], s34 offen nt lds
    s_add_u32 m0, s33, 13312
    s_nop 0
    buffer_load_dwordx4 v7, s[12:15], s34 offen nt lds
    s_add_u32 m0, s33, 14336
    s_nop 0
    buffer_load_dwordx4 v8, s[12:15], s34 offen nt lds
    v_add_u32 v4, 24576, v9
    s_lshl_b32 s35, s3, 1
    v_xor_b32 v2, s35, v10
    v_lshl_add_u32 v2, v2, 5, v4
    ds_read_b64_tr_b16 a[16:17], v2 offset:0
    ds_read_b64_tr_b16 a[18:19], v2 offset:3072
    ds_read_b64_tr_b16 a[20:21], v2 offset:12288
    ds_read_b64_tr_b16 a[22:23], v2 offset:15360
    s_lshl_b32 s35, s3, 1
    s_add_u32 s35, s35, 1
    v_xor_b32 v3, s35, v10
    v_lshl_add_u32 v3, v3, 5, v4
    ds_read_b64_tr_b16 a[24:25], v3 offset:0
    ds_read_b64_tr_b16 a[26:27], v3 offset:3072
    ds_read_b64_tr_b16 a[28:29], v3 offset:12288
    ds_read_b64_tr_b16 a[30:31], v3 offset:15360
    s_add_u32 s35, s3, 8
    v_xor_b32 v2, s35, v10
    v_lshl_add_u32 v2, v2, 5, v4
    ds_read_b64_tr_b16 a[32:33], v2 offset:0
    ds_read_b64_tr_b16 a[34:35], v2 offset:3072
    ds_read_b64_tr_b16 a[36:37], v2 offset:12288
    ds_read_b64_tr_b16 a[38:39], v2 offset:15360
    s_waitcnt vmcnt(24) lgkmcnt(0)
    s_barrier
    s_mul_i32 s33, s3, 3072
    s_add_u32 s34, s41, 5505024
    s_add_u32 m0, s33, 24576
    s_nop 0
    buffer_load_dwordx4 v6, s[12:15], s34 offen nt lds
    s_add_u32 m0, s33, 25600
    s_nop 0
    buffer_load_dwordx4 v7, s[12:15], s34 offen nt lds
    s_add_u32 m0, s33, 26624
    s_nop 0
    buffer_load_dwordx4 v8, s[12:15], s34 offen nt lds
    s_add_u32 s34, s41, 5898240
    s_add_u32 m0, s33, 36864
    s_nop 0
    buffer_load_dwordx4 v6, s[12:15], s34 offen nt lds
    s_add_u32 m0, s33, 37888
    s_nop 0
    buffer_load_dwordx4 v7, s[12:15], s34 offen nt lds
    s_add_u32 m0, s33, 38912
    s_nop 0
    buffer_load_dwordx4 v8, s[12:15], s34 offen nt lds
    v_add_u32 v4, 49152, v9
    s_lshl_b32 s35, s3, 1
    v_xor_b32 v2, s35, v10
    v_lshl_add_u32 v2, v2, 5, v4
    ds_read_b64_tr_b16 a[40:41], v2 offset:0
    ds_read_b64_tr_b16 a[42:43], v2 offset:3072
    ds_read_b64_tr_b16 a[44:45], v2 offset:12288
    ds_read_b64_tr_b16 a[46:47], v2 offset:15360
    s_lshl_b32 s35, s3, 1
    s_add_u32 s35, s35, 1
    v_xor_b32 v3, s35, v10
    v_lshl_add_u32 v3, v3, 5, v4
    ds_read_b64_tr_b16 v[40:41], v3 offset:0
    ds_read_b64_tr_b16 v[42:43], v3 offset:3072
    ds_read_b64_tr_b16 v[44:45], v3 offset:12288
    ds_read_b64_tr_b16 v[46:47], v3 offset:15360
    s_add_u32 s35, s3, 8
    v_xor_b32 v2, s35, v10
    v_lshl_add_u32 v2, v2, 5, v4
    ds_read_b64_tr_b16 a[48:49], v2 offset:0
    ds_read_b64_tr_b16 a[50:51], v2 offset:3072
    ds_read_b64_tr_b16 a[52:53], v2 offset:12288
    ds_read_b64_tr_b16 a[54:55], v2 offset:15360
    s_waitcnt vmcnt(24) lgkmcnt(0)
    s_barrier
    s_mul_i32 s33, s3, 3072
    s_add_u32 s34, s41, 6291456
    s_add_u32 m0, s33, 49152
    s_nop 0
    buffer_load_dwordx4 v6, s[12:15], s34 offen nt lds
    s_add_u32 m0, s33, 50176
    s_nop 0
    buffer_load_dwordx4 v7, s[12:15], s34 offen nt lds
    s_add_u32 m0, s33, 51200
    s_nop 0
    buffer_load_dwordx4 v8, s[12:15], s34 offen nt lds
    s_add_u32 s34, s41, 6684672
    s_add_u32 m0, s33, 61440
    s_nop 0
    buffer_load_dwordx4 v6, s[12:15], s34 offen nt lds
    s_add_u32 m0, s33, 62464
    s_nop 0
    buffer_load_dwordx4 v7, s[12:15], s34 offen nt lds
    s_add_u32 m0, s33, 63488
    s_nop 0
    buffer_load_dwordx4 v8, s[12:15], s34 offen nt lds
    v_add_u32 v4, 73728, v9
    s_lshl_b32 s35, s3, 1
    v_xor_b32 v2, s35, v10
    v_lshl_add_u32 v2, v2, 5, v4
    ds_read_b64_tr_b16 a[56:57], v2 offset:0
    ds_read_b64_tr_b16 a[58:59], v2 offset:3072
    ds_read_b64_tr_b16 a[60:61], v2 offset:12288
    ds_read_b64_tr_b16 a[62:63], v2 offset:15360
    s_lshl_b32 s35, s3, 1
    s_add_u32 s35, s35, 1
    v_xor_b32 v3, s35, v10
    v_lshl_add_u32 v3, v3, 5, v4
    ds_read_b64_tr_b16 v[48:49], v3 offset:0
    ds_read_b64_tr_b16 v[50:51], v3 offset:3072
    ds_read_b64_tr_b16 v[52:53], v3 offset:12288
    ds_read_b64_tr_b16 v[54:55], v3 offset:15360
    s_add_u32 s35, s3, 8
    v_xor_b32 v2, s35, v10
    v_lshl_add_u32 v2, v2, 5, v4
    ds_read_b64_tr_b16 a[64:65], v2 offset:0
    ds_read_b64_tr_b16 a[66:67], v2 offset:3072
    ds_read_b64_tr_b16 a[68:69], v2 offset:12288
    ds_read_b64_tr_b16 a[70:71], v2 offset:15360
    s_waitcnt vmcnt(24) lgkmcnt(0)
    s_barrier
    s_mul_i32 s33, s3, 3072
    s_add_u32 s34, s41, 7077888
    s_add_u32 m0, s33, 73728
    s_nop 0
    buffer_load_dwordx4 v6, s[12:15], s34 offen nt lds
    s_add_u32 m0, s33, 74752
    s_nop 0
    buffer_load_dwordx4 v7, s[12:15], s34 offen nt lds
    s_add_u32 m0, s33, 75776
    s_nop 0
    buffer_load_dwordx4 v8, s[12:15], s34 offen nt lds
    s_add_u32 s34, s41, 7471104
    s_add_u32 m0, s33, 86016
    s_nop 0
    buffer_load_dwordx4 v6, s[12:15], s34 offen nt lds
    s_add_u32 m0, s33, 87040
    s_nop 0
    buffer_load_dwordx4 v7, s[12:15], s34 offen nt lds
    s_add_u32 m0, s33, 88064
    s_nop 0
    buffer_load_dwordx4 v8, s[12:15], s34 offen nt lds
    v_add_u32 v4, 98304, v9
    s_lshl_b32 s35, s3, 1
    v_xor_b32 v2, s35, v10
    v_lshl_add_u32 v2, v2, 5, v4
    ds_read_b64_tr_b16 a[72:73], v2 offset:0
    ds_read_b64_tr_b16 a[74:75], v2 offset:3072
    ds_read_b64_tr_b16 a[76:77], v2 offset:12288
    ds_read_b64_tr_b16 a[78:79], v2 offset:15360
    s_lshl_b32 s35, s3, 1
    s_add_u32 s35, s35, 1
    v_xor_b32 v3, s35, v10
    v_lshl_add_u32 v3, v3, 5, v4
    ds_read_b64_tr_b16 a[80:81], v3 offset:0
    ds_read_b64_tr_b16 a[82:83], v3 offset:3072
    ds_read_b64_tr_b16 a[84:85], v3 offset:12288
    ds_read_b64_tr_b16 a[86:87], v3 offset:15360
    s_add_u32 s35, s3, 8
    v_xor_b32 v2, s35, v10
    v_lshl_add_u32 v2, v2, 5, v4
    ds_read_b64_tr_b16 a[88:89], v2 offset:0
    ds_read_b64_tr_b16 a[90:91], v2 offset:3072
    ds_read_b64_tr_b16 a[92:93], v2 offset:12288
    ds_read_b64_tr_b16 a[94:95], v2 offset:15360
    s_waitcnt vmcnt(24) lgkmcnt(0)
    s_barrier
    s_mul_i32 s33, s3, 3072
    s_add_u32 s34, s41, 0
    s_add_u32 m0, s33, 98304
    s_nop 0
    buffer_load_dwordx4 v11, s[16:19], s34 offen nt lds
    s_add_u32 m0, s33, 99328
    s_nop 0
    buffer_load_dwordx4 v12, s[16:19], s34 offen nt lds
    s_add_u32 m0, s33, 100352
    s_nop 0
    buffer_load_dwordx4 v13, s[16:19], s34 offen nt lds
    s_add_u32 s34, s41, 393216
    s_add_u32 m0, s33, 110592
    s_nop 0
    buffer_load_dwordx4 v11, s[16:19], s34 offen nt lds
    s_add_u32 m0, s33, 111616
    s_nop 0
    buffer_load_dwordx4 v12, s[16:19], s34 offen nt lds
    s_add_u32 m0, s33, 112640
    s_nop 0
    buffer_load_dwordx4 v13, s[16:19], s34 offen nt lds
    v_add_u32 v4, 122880, v9
    s_lshl_b32 s35, s3, 1
    v_xor_b32 v2, s35, v10
    v_lshl_add_u32 v2, v2, 5, v4
    ds_read_b64_tr_b16 a[96:97], v2 offset:0
    ds_read_b64_tr_b16 a[98:99], v2 offset:3072
    ds_read_b64_tr_b16 a[100:101], v2 offset:12288
    ds_read_b64_tr_b16 a[102:103], v2 offset:15360
    s_lshl_b32 s35, s3, 1
    s_add_u32 s35, s35, 1
    v_xor_b32 v3, s35, v10
    v_lshl_add_u32 v3, v3, 5, v4
    ds_read_b64_tr_b16 v[56:57], v3 offset:0
    ds_read_b64_tr_b16 v[58:59], v3 offset:3072
    ds_read_b64_tr_b16 v[60:61], v3 offset:12288
    ds_read_b64_tr_b16 v[62:63], v3 offset:15360
    s_add_u32 s35, s3, 8
    v_xor_b32 v2, s35, v10
    v_lshl_add_u32 v2, v2, 5, v4
    ds_read_b64_tr_b16 a[104:105], v2 offset:0
    ds_read_b64_tr_b16 a[106:107], v2 offset:3072
    ds_read_b64_tr_b16 a[108:109], v2 offset:12288
    ds_read_b64_tr_b16 a[110:111], v2 offset:15360
    s_waitcnt vmcnt(24) lgkmcnt(0)
    s_barrier
    s_mul_i32 s33, s3, 3072
    s_add_u32 s34, s41, 786432
    s_add_u32 m0, s33, 122880
    s_nop 0
    buffer_load_dwordx4 v11, s[16:19], s34 offen nt lds
    s_add_u32 m0, s33, 123904
    s_nop 0
    buffer_load_dwordx4 v12, s[16:19], s34 offen nt lds
    s_add_u32 m0, s33, 124928
    s_nop 0
    buffer_load_dwordx4 v13, s[16:19], s34 offen nt lds
    s_add_u32 s34, s41, 1179648
    s_add_u32 m0, s33, 135168
    s_nop 0
    buffer_load_dwordx4 v11, s[16:19], s34 offen nt lds
    s_add_u32 m0, s33, 136192
    s_nop 0
    buffer_load_dwordx4 v12, s[16:19], s34 offen nt lds
    s_add_u32 m0, s33, 137216
    s_nop 0
    buffer_load_dwordx4 v13, s[16:19], s34 offen nt lds
    v_add_u32 v4, 0, v9
    s_lshl_b32 s35, s3, 1
    v_xor_b32 v2, s35, v10
    v_lshl_add_u32 v2, v2, 5, v4
    ds_read_b64_tr_b16 a[112:113], v2 offset:0
    ds_read_b64_tr_b16 a[114:115], v2 offset:3072
    ds_read_b64_tr_b16 a[116:117], v2 offset:12288
    ds_read_b64_tr_b16 a[118:119], v2 offset:15360
    s_lshl_b32 s35, s3, 1
    s_add_u32 s35, s35, 1
    v_xor_b32 v3, s35, v10
    v_lshl_add_u32 v3, v3, 5, v4
    ds_read_b64_tr_b16 a[120:121], v3 offset:0
    ds_read_b64_tr_b16 a[122:123], v3 offset:3072
    ds_read_b64_tr_b16 a[124:125], v3 offset:12288
    ds_read_b64_tr_b16 a[126:127], v3 offset:15360
    s_add_u32 s35, s3, 8
    v_xor_b32 v2, s35, v10
    v_lshl_add_u32 v2, v2, 5, v4
    ds_read_b64_tr_b16 a[128:129], v2 offset:0
    ds_read_b64_tr_b16 a[130:131], v2 offset:3072
    ds_read_b64_tr_b16 a[132:133], v2 offset:12288
    ds_read_b64_tr_b16 a[134:135], v2 offset:15360
    s_waitcnt vmcnt(24) lgkmcnt(0)
    s_barrier
    s_mul_i32 s33, s3, 3072
    s_add_u32 s34, s41, 1572864
    s_add_u32 m0, s33, 0
    s_nop 0
    buffer_load_dwordx4 v11, s[16:19], s34 offen nt lds
    s_add_u32 m0, s33, 1024
    s_nop 0
    buffer_load_dwordx4 v12, s[16:19], s34 offen nt lds
    s_add_u32 m0, s33, 2048
    s_nop 0
    buffer_load_dwordx4 v13, s[16:19], s34 offen nt lds
    s_add_u32 s34, s41, 1966080
    s_add_u32 m0, s33, 12288
    s_nop 0
    buffer_load_dwordx4 v11, s[16:19], s34 offen nt lds
    s_add_u32 m0, s33, 13312
    s_nop 0
    buffer_load_dwordx4 v12, s[16:19], s34 offen nt lds
    s_add_u32 m0, s33, 14336
    s_nop 0
    buffer_load_dwordx4 v13, s[16:19], s34 offen nt lds
    v_lshlrev_b32 v23, 2, v1
    buffer_load_dword v22, v23, s[24:27], 0 offen offset:192 sc1
    v_add_u32 v4, 24576, v9
    s_lshl_b32 s35, s3, 1
    v_xor_b32 v2, s35, v10
    v_lshl_add_u32 v2, v2, 5, v4
    ds_read_b64_tr_b16 a[136:137], v2 offset:0
    ds_read_b64_tr_b16 a[138:139], v2 offset:3072
    ds_read_b64_tr_b16 a[140:141], v2 offset:12288
    ds_read_b64_tr_b16 a[142:143], v2 offset:15360
    s_lshl_b32 s35, s3, 1
    s_add_u32 s35, s35, 1
    v_xor_b32 v3, s35, v10
    v_lshl_add_u32 v3, v3, 5, v4
    ds_read_b64_tr_b16 v[64:65], v3 offset:0
    ds_read_b64_tr_b16 v[66:67], v3 offset:3072
    ds_read_b64_tr_b16 v[68:69], v3 offset:12288
    ds_read_b64_tr_b16 v[70:71], v3 offset:15360
    s_add_u32 s35, s3, 8
    v_xor_b32 v2, s35, v10
    v_lshl_add_u32 v2, v2, 5, v4
    ds_read_b64_tr_b16 a[144:145], v2 offset:0
    ds_read_b64_tr_b16 a[146:147], v2 offset:3072
    ds_read_b64_tr_b16 a[148:149], v2 offset:12288
    ds_read_b64_tr_b16 a[150:151], v2 offset:15360
    s_waitcnt vmcnt(25) lgkmcnt(0)
    s_barrier
    s_mul_i32 s33, s3, 3072
    s_add_u32 s34, s41, 2359296
    s_add_u32 m0, s33, 24576
    s_nop 0
    buffer_load_dwordx4 v11, s[16:19], s34 offen nt lds
    s_add_u32 m0, s33, 25600
    s_nop 0
    buffer_load_dwordx4 v12, s[16:19], s34 offen nt lds
    s_add_u32 m0, s33, 26624
    s_nop 0
    buffer_load_dwordx4 v13, s[16:19], s34 offen nt lds
    s_add_u32 s34, s41, 2752512
    s_add_u32 m0, s33, 36864
    s_nop 0
    buffer_load_dwordx4 v11, s[16:19], s34 offen nt lds
    s_add_u32 m0, s33, 37888
    s_nop 0
    buffer_load_dwordx4 v12, s[16:19], s34 offen nt lds
    s_add_u32 m0, s33, 38912
    s_nop 0
    buffer_load_dwordx4 v13, s[16:19], s34 offen nt lds
    v_add_u32 v4, 49152, v9
    s_lshl_b32 s35, s3, 1
    v_xor_b32 v2, s35, v10
    v_lshl_add_u32 v2, v2, 5, v4
    ds_read_b64_tr_b16 a[152:153], v2 offset:0
    ds_read_b64_tr_b16 a[154:155], v2 offset:3072
    ds_read_b64_tr_b16 a[156:157], v2 offset:12288
    ds_read_b64_tr_b16 a[158:159], v2 offset:15360
    s_lshl_b32 s35, s3, 1
    s_add_u32 s35, s35, 1
    v_xor_b32 v3, s35, v10
    v_lshl_add_u32 v3, v3, 5, v4
    ds_read_b64_tr_b16 v[72:73], v3 offset:0
    ds_read_b64_tr_b16 v[74:75], v3 offset:3072
    ds_read_b64_tr_b16 v[76:77], v3 offset:12288
    ds_read_b64_tr_b16 v[78:79], v3 offset:15360
    s_add_u32 s35, s3, 8
    v_xor_b32 v2, s35, v10
    v_lshl_add_u32 v2, v2, 5, v4
    ds_read_b64_tr_b16 a[176:177], v2 offset:0
    ds_read_b64_tr_b16 a[178:179], v2 offset:3072
    ds_read_b64_tr_b16 a[180:181], v2 offset:12288
    ds_read_b64_tr_b16 a[182:183], v2 offset:15360
    s_waitcnt vmcnt(25) lgkmcnt(0)
    s_barrier
    s_mul_i32 s33, s3, 3072
    s_add_u32 s34, s41, 3145728
    s_add_u32 m0, s33, 49152
    s_nop 0
    buffer_load_dwordx4 v11, s[16:19], s34 offen nt lds
    s_add_u32 m0, s33, 50176
    s_nop 0
    buffer_load_dwordx4 v12, s[16:19], s34 offen nt lds
    s_add_u32 m0, s33, 51200
    s_nop 0
    buffer_load_dwordx4 v13, s[16:19], s34 offen nt lds
    s_add_u32 s34, s41, 3538944
    s_add_u32 m0, s33, 61440
    s_nop 0
    buffer_load_dwordx4 v11, s[16:19], s34 offen nt lds
    s_add_u32 m0, s33, 62464
    s_nop 0
    buffer_load_dwordx4 v12, s[16:19], s34 offen nt lds
    s_add_u32 m0, s33, 63488
    s_nop 0
    buffer_load_dwordx4 v13, s[16:19], s34 offen nt lds
    v_add_u32 v4, 73728, v9
    s_lshl_b32 s35, s3, 1
    v_xor_b32 v2, s35, v10
    v_lshl_add_u32 v2, v2, 5, v4
    ds_read_b64_tr_b16 a[160:161], v2 offset:0
    ds_read_b64_tr_b16 a[162:163], v2 offset:3072
    ds_read_b64_tr_b16 a[164:165], v2 offset:12288
    ds_read_b64_tr_b16 a[166:167], v2 offset:15360
    s_lshl_b32 s35, s3, 1
    s_add_u32 s35, s35, 1
    v_xor_b32 v3, s35, v10
    v_lshl_add_u32 v3, v3, 5, v4
    ds_read_b64_tr_b16 a[168:169], v3 offset:0
    ds_read_b64_tr_b16 a[170:171], v3 offset:3072
    ds_read_b64_tr_b16 a[172:173], v3 offset:12288
    ds_read_b64_tr_b16 a[174:175], v3 offset:15360
    s_add_u32 s35, s3, 8
    v_xor_b32 v2, s35, v10
    v_lshl_add_u32 v2, v2, 5, v4
    ds_read_b64_tr_b16 a[184:185], v2 offset:0
    ds_read_b64_tr_b16 a[186:187], v2 offset:3072
    ds_read_b64_tr_b16 a[188:189], v2 offset:12288
    ds_read_b64_tr_b16 a[190:191], v2 offset:15360
    s_waitcnt vmcnt(25) lgkmcnt(0)
    s_barrier
    s_mul_i32 s33, s3, 3072
    s_add_u32 s34, s41, 3932160
    s_add_u32 m0, s33, 73728
    s_nop 0
    buffer_load_dwordx4 v11, s[16:19], s34 offen nt lds
    s_add_u32 m0, s33, 74752
    s_nop 0
    buffer_load_dwordx4 v12, s[16:19], s34 offen nt lds
    s_add_u32 m0, s33, 75776
    s_nop 0
    buffer_load_dwordx4 v13, s[16:19], s34 offen nt lds
    s_add_u32 s34, s41, 4325376
    s_add_u32 m0, s33, 86016
    s_nop 0
    buffer_load_dwordx4 v11, s[16:19], s34 offen nt lds
    s_add_u32 m0, s33, 87040
    s_nop 0
    buffer_load_dwordx4 v12, s[16:19], s34 offen nt lds
    s_add_u32 m0, s33, 88064
    s_nop 0
    buffer_load_dwordx4 v13, s[16:19], s34 offen nt lds
    v_add_u32 v4, 98304, v14
    s_lshl_b32 s35, s3, 1
    v_xor_b32 v2, s35, v15
    v_lshl_add_u32 v2, v2, 5, v4
    ds_read_b64_tr_b16 v[80:81], v2 offset:0
    ds_read_b64_tr_b16 v[82:83], v2 offset:3072
    ds_read_b64_tr_b16 v[84:85], v2 offset:12288
    ds_read_b64_tr_b16 v[86:87], v2 offset:15360
    s_lshl_b32 s35, s3, 1
    s_add_u32 s35, s35, 1
    v_xor_b32 v3, s35, v15
    v_lshl_add_u32 v3, v3, 5, v4
    ds_read_b64_tr_b16 a[248:249], v3 offset:0
    ds_read_b64_tr_b16 a[250:251], v3 offset:3072
    ds_read_b64_tr_b16 a[252:253], v3 offset:12288
    ds_read_b64_tr_b16 a[254:255], v3 offset:15360
    s_add_u32 s35, s3, 8
    v_xor_b32 v2, s35, v15
    v_lshl_add_u32 v2, v2, 5, v4
    ds_read_b64_tr_b16 v[120:121], v2 offset:0
    ds_read_b64_tr_b16 v[122:123], v2 offset:3072
    ds_read_b64_tr_b16 v[124:125], v2 offset:12288
    ds_read_b64_tr_b16 v[126:127], v2 offset:15360
    s_waitcnt vmcnt(25) lgkmcnt(0)
    s_barrier
    s_mul_i32 s33, s3, 3072
    s_add_u32 s34, s41, 4718592
    s_add_u32 m0, s33, 98304
    s_nop 0
    buffer_load_dwordx4 v11, s[16:19], s34 offen nt lds
    s_add_u32 m0, s33, 99328
    s_nop 0
    buffer_load_dwordx4 v12, s[16:19], s34 offen nt lds
    s_add_u32 m0, s33, 100352
    s_nop 0
    buffer_load_dwordx4 v13, s[16:19], s34 offen nt lds
    s_add_u32 s34, s41, 5111808
    s_add_u32 m0, s33, 110592
    s_nop 0
    buffer_load_dwordx4 v11, s[16:19], s34 offen nt lds
    s_add_u32 m0, s33, 111616
    s_nop 0
    buffer_load_dwordx4 v12, s[16:19], s34 offen nt lds
    s_add_u32 m0, s33, 112640
    s_nop 0
    buffer_load_dwordx4 v13, s[16:19], s34 offen nt lds
    v_add_u32 v4, 122880, v14
    s_lshl_b32 s35, s3, 1
    v_xor_b32 v2, s35, v15
    v_lshl_add_u32 v2, v2, 5, v4
    ds_read_b64_tr_b16 a[192:193], v2 offset:0
    ds_read_b64_tr_b16 a[194:195], v2 offset:3072
    ds_read_b64_tr_b16 a[196:197], v2 offset:12288
    ds_read_b64_tr_b16 a[198:199], v2 offset:15360
    s_lshl_b32 s35, s3, 1
    s_add_u32 s35, s35, 1
    v_xor_b32 v3, s35, v15
    v_lshl_add_u32 v3, v3, 5, v4
    ds_read_b64_tr_b16 v[144:145], v3 offset:0
    ds_read_b64_tr_b16 v[146:147], v3 offset:3072
    ds_read_b64_tr_b16 v[148:149], v3 offset:12288
    ds_read_b64_tr_b16 v[150:151], v3 offset:15360
    s_add_u32 s35, s3, 8
    v_xor_b32 v2, s35, v15
    v_lshl_add_u32 v2, v2, 5, v4
    ds_read_b64_tr_b16 v[200:201], v2 offset:0
    ds_read_b64_tr_b16 v[202:203], v2 offset:3072
    ds_read_b64_tr_b16 v[204:205], v2 offset:12288
    ds_read_b64_tr_b16 v[206:207], v2 offset:15360
    s_waitcnt vmcnt(25) lgkmcnt(0)
    s_barrier
    s_mul_i32 s33, s3, 3072
    s_add_u32 s34, s41, 5505024
    s_add_u32 m0, s33, 122880
    s_nop 0
    buffer_load_dwordx4 v11, s[16:19], s34 offen nt lds
    s_add_u32 m0, s33, 123904
    s_nop 0
    buffer_load_dwordx4 v12, s[16:19], s34 offen nt lds
    s_add_u32 m0, s33, 124928
    s_nop 0
    buffer_load_dwordx4 v13, s[16:19], s34 offen nt lds
    s_add_u32 s34, s41, 5898240
    s_add_u32 m0, s33, 135168
    s_nop 0
    buffer_load_dwordx4 v11, s[16:19], s34 offen nt lds
    s_add_u32 m0, s33, 136192
    s_nop 0
    buffer_load_dwordx4 v12, s[16:19], s34 offen nt lds
    s_add_u32 m0, s33, 137216
    s_nop 0
    buffer_load_dwordx4 v13, s[16:19], s34 offen nt lds
    v_add_u32 v4, 0, v14
    s_lshl_b32 s35, s3, 1
    v_xor_b32 v2, s35, v15
    v_lshl_add_u32 v2, v2, 5, v4
    ds_read_b64_tr_b16 a[200:201], v2 offset:0
    ds_read_b64_tr_b16 a[202:203], v2 offset:3072
    ds_read_b64_tr_b16 a[204:205], v2 offset:12288
    ds_read_b64_tr_b16 a[206:207], v2 offset:15360
    s_lshl_b32 s35, s3, 1
    s_add_u32 s35, s35, 1
    v_xor_b32 v3, s35, v15
    v_lshl_add_u32 v3, v3, 5, v4
    ds_read_b64_tr_b16 v[104:105], v3 offset:0
    ds_read_b64_tr_b16 v[106:107], v3 offset:3072
    ds_read_b64_tr_b16 v[108:109], v3 offset:12288
    ds_read_b64_tr_b16 v[110:111], v3 offset:15360
    s_add_u32 s35, s3, 8
    v_xor_b32 v2, s35, v15
    v_lshl_add_u32 v2, v2, 5, v4
    ds_read_b64_tr_b16 v[208:209], v2 offset:0
    ds_read_b64_tr_b16 v[210:211], v2 offset:3072
    ds_read_b64_tr_b16 v[212:213], v2 offset:12288
    ds_read_b64_tr_b16 v[214:215], v2 offset:15360
    s_waitcnt vmcnt(24) lgkmcnt(0)
    s_barrier
    s_mul_i32 s33, s3, 3072
    s_add_u32 s34, s41, 6291456
    s_add_u32 m0, s33, 0
    s_nop 0
    buffer_load_dwordx4 v11, s[16:19], s34 offen nt lds
    s_add_u32 m0, s33, 1024
    s_nop 0
    buffer_load_dwordx4 v12, s[16:19], s34 offen nt lds
    s_add_u32 m0, s33, 2048
    s_nop 0
    buffer_load_dwordx4 v13, s[16:19], s34 offen nt lds
    s_add_u32 s34, s41, 6684672
    s_add_u32 m0, s33, 12288
    s_nop 0
    buffer_load_dwordx4 v11, s[16:19], s34 offen nt lds
    s_add_u32 m0, s33, 13312
    s_nop 0
    buffer_load_dwordx4 v12, s[16:19], s34 offen nt lds
    s_add_u32 m0, s33, 14336
    s_nop 0
    buffer_load_dwordx4 v13, s[16:19], s34 offen nt lds
    v_add_u32 v4, 24576, v14
    s_lshl_b32 s35, s3, 1
    v_xor_b32 v2, s35, v15
    v_lshl_add_u32 v2, v2, 5, v4
    ds_read_b64_tr_b16 a[208:209], v2 offset:0
    ds_read_b64_tr_b16 a[210:211], v2 offset:3072
    ds_read_b64_tr_b16 a[212:213], v2 offset:12288
    ds_read_b64_tr_b16 a[214:215], v2 offset:15360
    s_lshl_b32 s35, s3, 1
    s_add_u32 s35, s35, 1
    v_xor_b32 v3, s35, v15
    v_lshl_add_u32 v3, v3, 5, v4
    ds_read_b64_tr_b16 v[152:153], v3 offset:0
    ds_read_b64_tr_b16 v[154:155], v3 offset:3072
    ds_read_b64_tr_b16 v[156:157], v3 offset:12288
    ds_read_b64_tr_b16 v[158:159], v3 offset:15360
    s_add_u32 s35, s3, 8
    v_xor_b32 v2, s35, v15
    v_lshl_add_u32 v2, v2, 5, v4
    ds_read_b64_tr_b16 v[216:217], v2 offset:0
    ds_read_b64_tr_b16 v[218:219], v2 offset:3072
    ds_read_b64_tr_b16 v[220:221], v2 offset:12288
    ds_read_b64_tr_b16 v[222:223], v2 offset:15360
    s_waitcnt vmcnt(24) lgkmcnt(0)
    s_barrier
    s_mul_i32 s33, s3, 3072
    s_add_u32 s34, s41, 7077888
    s_add_u32 m0, s33, 24576
    s_nop 0
    buffer_load_dwordx4 v11, s[16:19], s34 offen nt lds
    s_add_u32 m0, s33, 25600
    s_nop 0
    buffer_load_dwordx4 v12, s[16:19], s34 offen nt lds
    s_add_u32 m0, s33, 26624
    s_nop 0
    buffer_load_dwordx4 v13, s[16:19], s34 offen nt lds
    s_add_u32 s34, s41, 7471104
    s_add_u32 m0, s33, 36864
    s_nop 0
    buffer_load_dwordx4 v11, s[16:19], s34 offen nt lds
    s_add_u32 m0, s33, 37888
    s_nop 0
    buffer_load_dwordx4 v12, s[16:19], s34 offen nt lds
    s_add_u32 m0, s33, 38912
    s_nop 0
    buffer_load_dwordx4 v13, s[16:19], s34 offen nt lds
    v_lshlrev_b32 v29, 2, v1
    buffer_load_dword v28, v29, s[24:27], 0 offen offset:192 sc1
    v_readfirstlane_b32 s55, v22
    v_mov_b32 v30, 0
    buffer_load_dwordx4 v[24:27], v30, s[8:11], s56 offen sc1
    v_add_u32 v4, 49152, v14
    s_lshl_b32 s35, s3, 1
    v_xor_b32 v2, s35, v15
    v_lshl_add_u32 v2, v2, 5, v4
    ds_read_b64_tr_b16 v[88:89], v2 offset:0
    ds_read_b64_tr_b16 v[90:91], v2 offset:3072
    ds_read_b64_tr_b16 v[92:93], v2 offset:12288
    ds_read_b64_tr_b16 v[94:95], v2 offset:15360
    s_lshl_b32 s35, s3, 1
    s_add_u32 s35, s35, 1
    v_xor_b32 v3, s35, v15
    v_lshl_add_u32 v3, v3, 5, v4
    ds_read_b64_tr_b16 v[160:161], v3 offset:0
    ds_read_b64_tr_b16 v[162:163], v3 offset:3072
    ds_read_b64_tr_b16 v[164:165], v3 offset:12288
    ds_read_b64_tr_b16 v[166:167], v3 offset:15360
    s_add_u32 s35, s3, 8
    v_xor_b32 v2, s35, v15
    v_lshl_add_u32 v2, v2, 5, v4
    ds_read_b64_tr_b16 v[128:129], v2 offset:0
    ds_read_b64_tr_b16 v[130:131], v2 offset:3072
    ds_read_b64_tr_b16 v[132:133], v2 offset:12288
    ds_read_b64_tr_b16 v[134:135], v2 offset:15360
    s_waitcnt vmcnt(26) lgkmcnt(0)
    s_barrier
    v_add_u32 v4, 73728, v14
    s_lshl_b32 s35, s3, 1
    v_xor_b32 v2, s35, v15
    v_lshl_add_u32 v2, v2, 5, v4
    ds_read_b64_tr_b16 a[216:217], v2 offset:0
    ds_read_b64_tr_b16 a[218:219], v2 offset:3072
    ds_read_b64_tr_b16 a[220:221], v2 offset:12288
    ds_read_b64_tr_b16 a[222:223], v2 offset:15360
    s_lshl_b32 s35, s3, 1
    s_add_u32 s35, s35, 1
    v_xor_b32 v3, s35, v15
    v_lshl_add_u32 v3, v3, 5, v4
    ds_read_b64_tr_b16 v[168:169], v3 offset:0
    ds_read_b64_tr_b16 v[170:171], v3 offset:3072
    ds_read_b64_tr_b16 v[172:173], v3 offset:12288
    ds_read_b64_tr_b16 v[174:175], v3 offset:15360
    s_add_u32 s35, s3, 8
    v_xor_b32 v2, s35, v15
    v_lshl_add_u32 v2, v2, 5, v4
    ds_read_b64_tr_b16 v[224:225], v2 offset:0
    ds_read_b64_tr_b16 v[226:227], v2 offset:3072
    ds_read_b64_tr_b16 v[228:229], v2 offset:12288
    ds_read_b64_tr_b16 v[230:231], v2 offset:15360
    s_waitcnt vmcnt(20) lgkmcnt(0)
    s_barrier
    v_add_u32 v4, 98304, v14
    s_lshl_b32 s35, s3, 1
    v_xor_b32 v2, s35, v15
    v_lshl_add_u32 v2, v2, 5, v4
    ds_read_b64_tr_b16 a[224:225], v2 offset:0
    ds_read_b64_tr_b16 a[226:227], v2 offset:3072
    ds_read_b64_tr_b16 a[228:229], v2 offset:12288
    ds_read_b64_tr_b16 a[230:231], v2 offset:15360
    s_lshl_b32 s35, s3, 1
    s_add_u32 s35, s35, 1
    v_xor_b32 v3, s35, v15
    v_lshl_add_u32 v3, v3, 5, v4
    ds_read_b64_tr_b16 v[112:113], v3 offset:0
    ds_read_b64_tr_b16 v[114:115], v3 offset:3072
    ds_read_b64_tr_b16 v[116:117], v3 offset:12288
    ds_read_b64_tr_b16 v[118:119], v3 offset:15360
    s_add_u32 s35, s3, 8
    v_xor_b32 v2, s35, v15
    v_lshl_add_u32 v2, v2, 5, v4
    ds_read_b64_tr_b16 v[232:233], v2 offset:0
    ds_read_b64_tr_b16 v[234:235], v2 offset:3072
    ds_read_b64_tr_b16 v[236:237], v2 offset:12288
    ds_read_b64_tr_b16 v[238:239], v2 offset:15360
    s_waitcnt vmcnt(14) lgkmcnt(0)
    s_barrier
    v_add_u32 v4, 122880, v14
    s_lshl_b32 s35, s3, 1
    v_xor_b32 v2, s35, v15
    v_lshl_add_u32 v2, v2, 5, v4
    ds_read_b64_tr_b16 a[232:233], v2 offset:0
    ds_read_b64_tr_b16 a[234:235], v2 offset:3072
    ds_read_b64_tr_b16 a[236:237], v2 offset:12288
    ds_read_b64_tr_b16 a[238:239], v2 offset:15360
    s_lshl_b32 s35, s3, 1
    s_add_u32 s35, s35, 1
    v_xor_b32 v3, s35, v15
    v_lshl_add_u32 v3, v3, 5, v4
    ds_read_b64_tr_b16 v[176:177], v3 offset:0
    ds_read_b64_tr_b16 v[178:179], v3 offset:3072
    ds_read_b64_tr_b16 v[180:181], v3 offset:12288
    ds_read_b64_tr_b16 v[182:183], v3 offset:15360
    s_add_u32 s35, s3, 8
    v_xor_b32 v2, s35, v15
    v_lshl_add_u32 v2, v2, 5, v4
    ds_read_b64_tr_b16 v[240:241], v2 offset:0
    ds_read_b64_tr_b16 v[242:243], v2 offset:3072
    ds_read_b64_tr_b16 v[244:245], v2 offset:12288
    ds_read_b64_tr_b16 v[246:247], v2 offset:15360
    s_waitcnt vmcnt(8) lgkmcnt(0)
    s_barrier
    v_add_u32 v4, 0, v14
    s_lshl_b32 s35, s3, 1
    v_xor_b32 v2, s35, v15
    v_lshl_add_u32 v2, v2, 5, v4
    ds_read_b64_tr_b16 v[96:97], v2 offset:0
    ds_read_b64_tr_b16 v[98:99], v2 offset:3072
    ds_read_b64_tr_b16 v[100:101], v2 offset:12288
    ds_read_b64_tr_b16 v[102:103], v2 offset:15360
    s_lshl_b32 s35, s3, 1
    s_add_u32 s35, s35, 1
    v_xor_b32 v3, s35, v15
    v_lshl_add_u32 v3, v3, 5, v4
    ds_read_b64_tr_b16 v[184:185], v3 offset:0
    ds_read_b64_tr_b16 v[186:187], v3 offset:3072
    ds_read_b64_tr_b16 v[188:189], v3 offset:12288
    ds_read_b64_tr_b16 v[190:191], v3 offset:15360
    s_add_u32 s35, s3, 8
    v_xor_b32 v2, s35, v15
    v_lshl_add_u32 v2, v2, 5, v4
    ds_read_b64_tr_b16 v[136:137], v2 offset:0
    ds_read_b64_tr_b16 v[138:139], v2 offset:3072
    ds_read_b64_tr_b16 v[140:141], v2 offset:12288
    ds_read_b64_tr_b16 v[142:143], v2 offset:15360
    s_waitcnt vmcnt(2) lgkmcnt(0)
    s_barrier
    v_add_u32 v4, 24576, v14
    s_lshl_b32 s35, s3, 1
    v_xor_b32 v2, s35, v15
    v_lshl_add_u32 v2, v2, 5, v4
    ds_read_b64_tr_b16 a[240:241], v2 offset:0
    ds_read_b64_tr_b16 a[242:243], v2 offset:3072
    ds_read_b64_tr_b16 a[244:245], v2 offset:12288
    ds_read_b64_tr_b16 a[246:247], v2 offset:15360
    s_lshl_b32 s35, s3, 1
    s_add_u32 s35, s35, 1
    v_xor_b32 v3, s35, v15
    v_lshl_add_u32 v3, v3, 5, v4
    ds_read_b64_tr_b16 v[192:193], v3 offset:0
    ds_read_b64_tr_b16 v[194:195], v3 offset:3072
    ds_read_b64_tr_b16 v[196:197], v3 offset:12288
    ds_read_b64_tr_b16 v[198:199], v3 offset:15360
    s_add_u32 s35, s3, 8
    v_xor_b32 v2, s35, v15
    v_lshl_add_u32 v2, v2, 5, v4
    ds_read_b64_tr_b16 v[248:249], v2 offset:0
    ds_read_b64_tr_b16 v[250:251], v2 offset:3072
    ds_read_b64_tr_b16 v[252:253], v2 offset:12288
    ds_read_b64_tr_b16 v[254:255], v2 offset:15360
    s_waitcnt lgkmcnt(0)
    s_barrier
    s_mov_b32 s30, 0
    s_lshr_b32 s32, s30, 3
    s_xor_b32 s32, s32, s6
    s_lshl_b32 s31, s30, 16
    s_bitcmp1_b32 s32, 0
    s_cselect_b32 s30, 16384, 0
    s_add_u32 s31, s31, s30
    s_bitcmp1_b32 s32, 1
    s_cselect_b32 s30, 4096, 0
    s_add_u32 s31, s31, s30
    v_lshlrev_b32 v2, 4, v0
    v_add_u32 v5, 114688, v2
    v_add_u32 v2, s31, v2
    v_add_u32 v3, 65536, v2
    s_add_u32 s31, s31, 131072
    v_lshl_add_u32 v4, v0, 3, s31
    v_lshlrev_b32 v6, 3, v0
    v_add_u32 v6, 122880, v6
    s_mul_i32 s30, s3, 28672
    v_lshl_add_u32 v7, v1, 4, s30
    v_lshlrev_b32 v8, 4, v1
    v_add_u32 v8, 114688, v8
    v_and_b32 v9, 8, v1
    v_cmp_eq_u32 vcc, 0, v9
    v_mov_b32 v9, 0xeeee
    v_mov_b32 v10, 0x4444
    v_cndmask_b32 v9, v9, v10, vcc
    ds_write_b128 v7, v[32:35] offset:0
    ds_write_b128 v7, v[36:39] offset:1024
    ds_write_b128 v7, v[40:43] offset:2048
    ds_write_b128 v7, v[44:47] offset:3072
    ds_write_b128 v7, v[48:51] offset:4096
    ds_write_b128 v7, v[52:55] offset:5120
    ds_write_b128 v7, v[56:59] offset:6144
    ds_write_b128 v7, v[60:63] offset:7168
    ds_write_b128 v7, v[64:67] offset:8192
    ds_write_b128 v7, v[68:71] offset:9216
    ds_write_b128 v7, v[72:75] offset:10240
    ds_write_b128 v7, v[76:79] offset:11264
    ds_write_b128 v7, v[80:83] offset:12288
    ds_write_b128 v7, v[84:87] offset:13312
    ds_write_b128 v7, v[88:91] offset:14336
    ds_write_b128 v7, v[92:95] offset:15360
    ds_write_b128 v7, v[96:99] offset:16384
    ds_write_b128 v7, v[100:103] offset:17408
    ds_write_b128 v7, v[104:107] offset:18432
    ds_write_b128 v7, v[108:111] offset:19456
    ds_write_b128 v7, v[112:115] offset:20480
    ds_write_b128 v7, v[116:119] offset:21504
    ds_write_b128 v7, v[120:123] offset:22528
    ds_write_b128 v7, v[124:127] offset:23552
    ds_write_b128 v7, v[128:131] offset:24576
    ds_write_b128 v7, v[132:135] offset:25600
    ds_write_b128 v7, v[136:139] offset:26624
    ds_write_b128 v7, v[140:143] offset:27648
    s_waitcnt lgkmcnt(0)
    v_mov_b32 v10, 0
    v_and_b32 v20, 15, v1
    v_lshrrev_b32 v21, 4, v1
    v_lshrrev_b32 v22, 2, v20
    v_xor_b32 v23, v22, v21
    v_lshlrev_b32 v22, 5, v20
    v_lshl_add_u32 v22, v23, 3, v22
    s_lshl_b32 s30, s3, 10
    s_add_u32 s30, s30, 149504
    v_add_u32 v11, s30, v22
    s_lshl_b32 s30, s3, 9
    s_add_u32 s30, s30, 153600
    v_add_u32 v12, s30, v22
    v_xor_b32 v13, v1, v21
    v_lshlrev_b32 v13, 3, v13
    v_add_u32 v13, 149504, v13
    s_lshl_b32 s30, s3, 10
    v_add_u32 v140, s30, v13
    s_lshl_b32 s30, s3, 9
    v_add_u32 v141, s30, v13
    s_mov_b32 s44, 0x3dd53b95
    s_mov_b32 s45, 124928
    s_mov_b32 s57, 0
    s_mov_b32 s61, 0
    s_mul_i32 s50, s4, 12288
    s_lshl_b32 s30, s2, 7
    s_lshl_b32 s31, s3, 2
    s_add_u32 s30, s30, s31
    s_add_u32 s30, s30, 246415360
    v_mov_b32 v19, s30
    s_waitcnt vmcnt(0)
    v_min3_u32 v24, v24, v25, v26
    s_nop 0
    v_readfirstlane_b32 s57, v24
    s_cmp_eq_u32 s55, 0
    s_cselect_b32 s57, 0, s57
    s_mov_b32 s31, 0
    v_mov_b32 v20, v28
    s_nop 0
    v_readfirstlane_b32 s30, v20
    s_nop 0
    s_cmp_ge_u32 s30, 2
    s_nop 1
    s_cbranch_scc1 Lwo_3
Lwa_2:
    v_lshlrev_b32 v21, 2, v1
    buffer_load_dword v20, v21, s[24:27], 0 offen offset:192 sc1
    s_add_u32 s31, s31, 1
    s_cmp_gt_u32 s31, 400000
    s_cbranch_scc1 L_abort
    s_sleep 2
    s_waitcnt vmcnt(0)
    v_readfirstlane_b32 s30, v20
    s_nop 0
    s_cmp_lt_u32 s30, 2
    s_nop 1
    s_cbranch_scc1 Lwa_2
Lwo_3:
    v_readlane_b32 s60, v20, 1
    v_readlane_b32 s7, v20, 2
    v_readlane_b32 s28, v20, 3
    s_mov_b32 s29, 0
    s_lshr_b32 s37, s61, 1
    s_bitcmp1_b32 s7, s37
    s_cselect_b32 s38, 16384, 0
    s_bitcmp1_b32 s28, s37
    s_cselect_b32 s62, 4096, 0
    s_or_b32 s38, s38, s62
    s_lshl_b32 s62, s37, 21
    s_lshr_b32 s37, s60, s37
    s_and_b32 s37, s37, 1
    s_lshl_b32 s37, s37, 13
    s_add_u32 s62, s62, s37
    s_and_b32 s37, s61, 1
    s_lshl_b32 s37, s37, 15
    s_add_u32 s62, s62, s37
    s_xor_b32 s37, s38, s29
    s_mov_b32 s29, s38
    v_xor_b32 v2, s37, v2
    v_xor_b32 v3, s37, v3
    v_xor_b32 v4, s37, v4
    s_cmp_eq_u32 s3, 1
    s_cbranch_scc1 L_c_d
    s_cmp_ge_u32 s3, 2
    s_cbranch_scc1 L_c_x
    v_and_b32 v20, 15, v1
    v_lshrrev_b32 v21, 5, v1
    v_bfe_u32 v23, v1, 4, 1
    v_lshlrev_b32 v15, 4, v20
    v_lshl_add_u32 v15, v21, 8, v15
    v_lshl_add_u32 v15, v23, 3, v15
    v_add_u32 v15, s43, v15
    v_and_b32 v22, 7, v1
    v_lshlrev_b32 v16, 6, v23
    v_lshl_add_u32 v16, v22, 3, v16
    v_lshl_add_u32 v16, v21, 2, v16
    v_add_u32 v16, s43, v16
    v_lshl_add_u32 v17, v1, 4, s43
    s_mov_b32 s64, 0xffff
    s_mov_b32 s65, 0xffff
    v_mov_b32 v18, s44
    v_mov_b32 v20, 64
    s_mov_b64 exec, 1
    buffer_store_dword v20, v19, s[8:11], 0 offen sc1
    s_mov_b64 exec, -1
L_c_m_loop:
    s_add_u32 s36, s61, 2
    s_lshr_b32 s37, s36, 1
    s_lshl_b32 s63, s37, 21
    s_lshr_b32 s37, s60, s37
    s_and_b32 s37, s37, 1
    s_lshl_b32 s37, s37, 13
    s_add_u32 s63, s63, s37
    s_and_b32 s37, s36, 1
    s_lshl_b32 s37, s37, 15
    s_add_u32 s63, s63, s37
    s_cmp_lt_u32 s61, 62
    s_cselect_b32 s63, s63, 2146435072
    v_mov_b32 v136, -1
    v_mov_b32 v137, -1
    v_mov_b32 v138, -1
    v_mov_b32 v139, -1
    v_mov_b32 v64, 0
    v_mov_b32 v65, 0
    v_mov_b32 v66, 0
    v_mov_b32 v67, 0
    v_mov_b32 v68, 0
    v_mov_b32 v69, 0
    v_mov_b32 v70, 0
    v_mov_b32 v71, 0
    v_mov_b32 v72, 0
    v_mov_b32 v73, 0
    v_mov_b32 v74, 0
    v_mov_b32 v75, 0
    v_mov_b32 v76, 0
    v_mov_b32 v77, 0
    v_mov_b32 v78, 0
    v_mov_b32 v79, 0
    v_mov_b32 v80, 0
    v_mov_b32 v81, 0
    v_mov_b32 v82, 0
    v_mov_b32 v83, 0
    v_mov_b32 v84, 0
    v_mov_b32 v85, 0
    v_mov_b32 v86, 0
    v_mov_b32 v87, 0
    v_mov_b32 v116, 0
    v_mov_b32 v117, 0
    v_mov_b32 v120, 0
    v_mov_b32 v121, 0
    ds_read_b128 v[88:91], v7 offset:0
    ds_read_b128 v[92:95], v7 offset:1024
    ds_read_b128 v[96:99], v7 offset:2048
    ds_read_b128 v[100:103], v7 offset:3072
    ds_read_b128 v[104:107], v7 offset:4096
    ds_read_b128 v[108:111], v7 offset:5120
    s_lshl_b32 s30, s3, 10
    s_add_u32 s31, s30, s45
    v_lshl_add_u32 v14, v1, 4, s31
    s_lshr_b32 s31, s3, 1
    s_lshl_b32 s31, s31, 10
    s_add_u32 s31, s31, s45
    s_and_b32 s32, s3, 1
    s_lshl_b32 s32, s32, 3
    s_add_u32 s31, s31, s32
    v_lshl_add_u32 v132, v1, 4, s31
    s_xor_b32 s46, s45, 258048
    s_add_u32 s31, s30, s46
    v_lshl_add_u32 v142, v1, 4, s31
    s_mov_b32 s31, 0
    s_waitcnt lgkmcnt(0)
    s_cmp_eq_u32 s61, 0
    s_cbranch_scc1 Lnp_5
    s_sleep 14
Lnp_5:
Lgm_4:
    buffer_load_dwordx4 v[24:27], v2, s[8:11], s62 offen sc1
    buffer_load_dwordx4 v[40:43], v3, s[8:11], s62 offen sc1
    buffer_load_dwordx2 v[60:61], v4, s[8:11], s62 offen sc1
    s_add_u32 s31, s31, 1
    s_cmp_gt_u32 s31, 400000
    s_cbranch_scc1 L_abort
    s_waitcnt vmcnt(2)
    ds_write_b128 v5, v[24:27]
    v_max3_u32 v20, v24, v25, v26
    s_waitcnt vmcnt(1)
    ds_write_b128 v5, v[40:43] offset:4096
    v_max3_u32 v21, v27, v40, v41
    v_max3_u32 v20, v20, v42, v43
    s_waitcnt vmcnt(0)
    ds_write_b64 v6, v[60:61]
    v_max3_u32 v21, v21, v60, v61
    v_max_u32 v20, v20, v21
    v_cmp_eq_u32 vcc, -1, v20
    s_cbranch_vccnz Lgm_4
    v_smfmac_f32_16x16x64_bf16 v[64:67], v[24:27], a[0:7], v9
    v_smfmac_f32_16x16x64_bf16 v[68:71], v[24:27], v[88:95], v9
    s_waitcnt lgkmcnt(0)
    s_barrier
    ds_read_b128 v[28:31], v8 offset:1024
    ds_read_b128 v[32:35], v8 offset:2048
    v_smfmac_f32_16x16x64_bf16 v[72:75], v[24:27], a[8:15], v9
    ds_read_b128 v[36:39], v8 offset:3072
    ds_read_b128 v[44:47], v8 offset:5120
    v_smfmac_f32_16x16x64_bf16 v[64:67], v[40:43], a[72:79], v9
    ds_read_b128 v[48:51], v8 offset:6144
    ds_read_b128 v[52:55], v8 offset:7168
    v_smfmac_f32_16x16x64_bf16 v[68:71], v[40:43], a[80:87], v9
    ds_read_b128 v[56:59], v8 offset:8192
    ds_read_b128 v[60:63], v8 offset:9216
    v_smfmac_f32_16x16x64_bf16 v[72:75], v[40:43], a[88:95], v9
    ds_read_b128 v[88:91], v7 offset:6144
    s_waitcnt lgkmcnt(8)
    v_smfmac_f32_16x16x64_bf16 v[64:67], v[28:31], a[16:23], v9
    s_mov_b32 exec_hi, 0xff
    buffer_store_dwordx4 v[136:139], v17, s[8:11], s63 offen sc1
    s_mov_b64 exec, -1
    v_smfmac_f32_16x16x64_bf16 v[68:71], v[28:31], a[24:31], v9
    ds_read_b128 v[92:95], v7 offset:7168
    v_smfmac_f32_16x16x64_bf16 v[72:75], v[28:31], a[32:39], v9
    s_waitcnt lgkmcnt(8)
    v_smfmac_f32_16x16x64_bf16 v[64:67], v[32:35], a[40:47], v9
    v_smfmac_f32_16x16x64_bf16 v[68:71], v[32:35], v[96:103], v9
    ds_read_b128 v[96:99], v7 offset:8192
    v_smfmac_f32_16x16x64_bf16 v[72:75], v[32:35], a[48:55], v9
    ds_read_b128 v[100:103], v7 offset:9216
    s_waitcnt lgkmcnt(9)
    v_smfmac_f32_16x16x64_bf16 v[64:67], v[36:39], a[56:63], v9
    ds_read_b128 v[124:127], v14
    v_smfmac_f32_16x16x64_bf16 v[68:71], v[36:39], v[104:111], v9
    ds_read_b128 v[128:131], v14 offset:6144
    v_smfmac_f32_16x16x64_bf16 v[72:75], v[36:39], a[64:71], v9
    ds_read2st64_b64 v[132:135], v132 offset0:8 offset1:20
    s_waitcnt lgkmcnt(11)
    v_smfmac_f32_16x16x64_bf16 v[64:67], v[44:47], a[96:103], v9
    ds_read_b128 v[104:107], v7 offset:10240
    s_waitcnt lgkmcnt(6)
    v_smfmac_f32_16x16x64_bf16 v[68:71], v[44:47], v[88:95], v9
    ds_read_b128 v[108:111], v7 offset:11264
    v_smfmac_f32_16x16x64_bf16 v[72:75], v[44:47], a[104:111], v9
    ds_read_b128 v[88:91], v7 offset:12288
    v_smfmac_f32_16x16x64_bf16 v[64:67], v[48:51], a[112:119], v9
    ds_read_b128 v[92:95], v7 offset:13312
    v_smfmac_f32_16x16x64_bf16 v[68:71], v[48:51], a[120:127], v9
    v_smfmac_f32_16x16x64_bf16 v[72:75], v[48:51], a[128:135], v9
    v_smfmac_f32_16x16x64_bf16 v[64:67], v[52:55], a[136:143], v9
    s_waitcnt lgkmcnt(7)
    v_smfmac_f32_16x16x64_bf16 v[68:71], v[52:55], v[96:103], v9
    ds_read_b128 v[96:99], v7 offset:14336
    v_smfmac_f32_16x16x64_bf16 v[72:75], v[52:55], a[144:151], v9
    ds_read_b128 v[100:103], v7 offset:15360
    v_smfmac_f32_16x16x64_bf16 v[64:67], v[56:59], a[152:159], v9
    v_smfmac_f32_16x16x64_bf16 v[64:67], v[60:63], a[160:167], v9
    s_waitcnt lgkmcnt(4)
    v_smfmac_f32_16x16x64_bf16 v[68:71], v[56:59], v[104:111], v9
    ds_read_b128 v[104:107], v7 offset:16384
    v_smfmac_f32_16x16x64_bf16 v[68:71], v[60:63], a[168:175], v9
    ds_read_b128 v[108:111], v7 offset:17408
    v_smfmac_f32_16x16x64_bf16 v[72:75], v[56:59], a[176:183], v9
    s_nop 1
    v_cvt_pk_bf16_f32 v64, v64, v65
    v_smfmac_f32_16x16x64_bf16 v[72:75], v[60:63], a[184:191], v9
    s_waitcnt lgkmcnt(4)
    v_cvt_pk_bf16_f32 v65, v66, v67
    v_smfmac_f32_16x16x64_bf16 v[76:79], v[24:27], v[88:95], v9
    ds_write_b64 v11, v[64:65] offset:0
    v_cvt_pk_bf16_f32 v68, v68, v69
    v_smfmac_f32_16x16x64_bf16 v[76:79], v[28:31], a[192:199], v9
    ds_read_b128 v[88:91], v7 offset:18432
    v_cvt_pk_bf16_f32 v69, v70, v71
    v_smfmac_f32_16x16x64_bf16 v[76:79], v[32:35], a[200:207], v9
    ds_write_b64 v11, v[68:69] offset:512
    v_cvt_pk_bf16_f32 v72, v72, v73
    v_smfmac_f32_16x16x64_bf16 v[76:79], v[36:39], a[208:215], v9
    ds_read_b128 v[92:95], v7 offset:19456
    s_waitcnt lgkmcnt(6)
    v_cvt_pk_bf16_f32 v73, v74, v75
    v_smfmac_f32_16x16x64_bf16 v[76:79], v[40:43], v[96:103], v9
    ds_write_b64 v12, v[72:73] offset:0
    v_smfmac_f32_16x16x64_bf16 v[76:79], v[44:47], a[216:223], v9
    ds_read_b64_tr_b16 v[112:113], v140
    ds_read_b64_tr_b16 v[114:115], v140 offset:512
    v_smfmac_f32_16x16x64_bf16 v[76:79], v[48:51], a[224:231], v9
    ds_read_b64_tr_b16 v[118:119], v141 offset:4096
    v_smfmac_f32_16x16x64_bf16 v[76:79], v[52:55], a[232:239], v9
    ds_read_b128 v[96:99], v7 offset:20480
    s_waitcnt lgkmcnt(9)
    v_smfmac_f32_16x16x64_bf16 v[76:79], v[56:59], v[104:111], v9
    ds_read_b128 v[100:103], v7 offset:21504
    v_smfmac_f32_16x16x64_bf16 v[76:79], v[60:63], a[240:247], v9
    ds_read_b128 v[104:107], v7 offset:22528
    v_smfmac_f32_16x16x64_bf16 v[80:83], v[24:27], a[248:255], v9
    s_waitcnt lgkmcnt(6)
    s_barrier
    v_smfmac_f32_16x16x64_bf16 v[80:83], v[28:31], v[144:151], v9
    s_waitcnt lgkmcnt(4)
    v_mfma_f32_16x16x32_bf16 v[64:67], v[124:127], v[112:115], 0
    v_mfma_f32_16x16x32_bf16 v[68:71], v[128:131], v[112:115], 0
    s_waitcnt lgkmcnt(3)
    v_cvt_pk_bf16_f32 v76, v76, v77
    v_mfma_f32_16x16x32_bf16 v[64:67], v[132:135], v[118:121], v[64:67]
    v_cvt_pk_bf16_f32 v77, v78, v79
    v_mfma_f32_16x16x32_bf16 v[68:71], v[132:135], v[116:119], v[68:71]
    v_smfmac_f32_16x16x64_bf16 v[80:83], v[32:35], v[88:95], v9
    ds_write_b64 v11, v[76:77] offset:6144
    v_smfmac_f32_16x16x64_bf16 v[80:83], v[36:39], v[152:159], v9
    ds_read_b128 v[108:111], v7 offset:23552
    v_smfmac_f32_16x16x64_bf16 v[80:83], v[40:43], v[160:167], v9
    ds_read_b128 v[88:91], v7 offset:24576
    ds_read_b64_tr_b16 v[112:113], v13 offset:0
    v_add_f32_dpp v136, v64, v64 row_ror:8 row_mask:0xf bank_mask:0x3
    v_smfmac_f32_16x16x64_bf16 v[80:83], v[44:47], v[168:175], v9
    ds_read_b128 v[92:95], v7 offset:25600
    ds_read_b64_tr_b16 v[114:115], v13 offset:512
    s_waitcnt lgkmcnt(7)
    v_add_f32_dpp v137, v65, v65 row_ror:8 row_mask:0xf bank_mask:0x3
    v_smfmac_f32_16x16x64_bf16 v[80:83], v[48:51], v[96:103], v9
    ds_read_b128 v[96:99], v7 offset:26624
    ds_read_b64_tr_b16 v[116:117], v13 offset:1024
    v_add_f32_dpp v138, v68, v68 row_ror:8 row_mask:0xf bank_mask:0x3
    v_smfmac_f32_16x16x64_bf16 v[80:83], v[52:55], v[176:183], v9
    ds_read_b128 v[100:103], v7 offset:27648
    ds_read_b64_tr_b16 v[118:119], v13 offset:1536
    v_add_f32_dpp v139, v69, v69 row_ror:8 row_mask:0xf bank_mask:0x3
    v_smfmac_f32_16x16x64_bf16 v[80:83], v[56:59], v[184:191], v9
    ds_read_b64_tr_b16 v[120:121], v13 offset:2048
    v_add_f32_dpp v136, v66, v66 row_ror:8 row_mask:0xf bank_mask:0xc
    v_smfmac_f32_16x16x64_bf16 v[80:83], v[60:63], v[192:199], v9
    ds_read_b64_tr_b16 v[122:123], v13 offset:2560
    s_waitcnt lgkmcnt(10)
    v_add_f32_dpp v137, v67, v67 row_ror:8 row_mask:0xf bank_mask:0xc
    v_smfmac_f32_16x16x64_bf16 v[84:87], v[24:27], v[104:111], v9
    ds_read_b64_tr_b16 v[124:125], v13 offset:3072
    v_add_f32_dpp v138, v70, v70 row_ror:8 row_mask:0xf bank_mask:0xc
    v_smfmac_f32_16x16x64_bf16 v[84:87], v[28:31], v[200:207], v9
    ds_read_b64_tr_b16 v[126:127], v13 offset:3584
    v_add_f32_dpp v139, v71, v71 row_ror:8 row_mask:0xf bank_mask:0xc
    v_smfmac_f32_16x16x64_bf16 v[84:87], v[32:35], v[208:215], v9
    ds_read_b64_tr_b16 v[128:129], v13 offset:4096
    v_cvt_pk_bf16_f32 v80, v80, v81
    v_smfmac_f32_16x16x64_bf16 v[84:87], v[36:39], v[216:223], v9
    ds_read_b64_tr_b16 v[130:131], v13 offset:4608
    s_waitcnt lgkmcnt(11)
    v_cvt_pk_bf16_f32 v81, v82, v83
    v_smfmac_f32_16x16x64_bf16 v[84:87], v[40:43], v[88:95], v9
    ds_write_b64 v11, v[80:81] offset:6656
    v_smfmac_f32_16x16x64_bf16 v[84:87], v[44:47], v[224:231], v9
    ds_read_b64_tr_b16 v[132:133], v13 offset:5120
    v_smfmac_f32_16x16x64_bf16 v[84:87], v[48:51], v[232:239], v9
    ds_read_b64_tr_b16 v[134:135], v13 offset:5632
    v_smfmac_f32_16x16x64_bf16 v[84:87], v[52:55], v[240:247], v9
    s_waitcnt lgkmcnt(10)
    v_smfmac_f32_16x16x64_bf16 v[84:87], v[56:59], v[96:103], v9
    s_waitcnt lgkmcnt(2)
    s_barrier
    v_smfmac_f32_16x16x64_bf16 v[84:87], v[60:63], v[248:255], v9
    ds_read_b128 v[64:67], v142 offset:1024
    ds_read_b128 v[68:71], v142 offset:2048
    ds_read_b128 v[72:75], v142 offset:3072
    ds_read_b64_tr_b16 v[24:25], v13 offset:6144
    ds_read_b64_tr_b16 v[26:27], v13 offset:6656
    ds_read_b64_tr_b16 v[28:29], v13 offset:7168
    ds_read_b64_tr_b16 v[30:31], v13 offset:7680
    s_nop 0
    v_cvt_pk_bf16_f32 v84, v84, v85
    v_cvt_pk_bf16_f32 v85, v86, v87
    ds_write_b64 v12, v[84:85] offset:6144
    ds_read_b64_tr_b16 v[32:33], v13 offset:8192
    ds_read_b64_tr_b16 v[34:35], v13 offset:8704
    ds_read_b64_tr_b16 v[36:37], v13 offset:9216
    ds_read_b64_tr_b16 v[38:39], v13 offset:9728
    s_waitcnt lgkmcnt(11)
    v_pk_add_f32 v[136:137], v[136:137], v[64:65]
    v_pk_add_f32 v[138:139], v[138:139], v[66:67]
    s_waitcnt lgkmcnt(9)
    v_pk_add_f32 v[68:69], v[68:69], v[72:73]
    v_pk_add_f32 v[70:71], v[70:71], v[74:75]
    v_pk_add_f32 v[136:137], v[136:137], v[68:69]
    v_pk_add_f32 v[138:139], v[138:139], v[70:71]
    s_waitcnt lgkmcnt(4)
    s_barrier
    ds_read_b64_tr_b16 v[40:41], v13 offset:10240
    ds_read_b64_tr_b16 v[42:43], v13 offset:10752
    ds_read_b64_tr_b16 v[44:45], v13 offset:11264
    ds_read_b64_tr_b16 v[46:47], v13 offset:11776
    v_mfma_f32_16x16x32_bf16 v[76:79], v[24:27], v[112:115], 0
    v_max3_f32 v20, v136, v137, v138
    v_max_f32 v20, v20, v139
    v_mfma_f32_16x16x32_bf16 v[76:79], v[28:31], v[116:119], v[76:79]
    s_nop 0
    v_max_f32_dpp v20, v20, v20 row_ror:8 row_mask:0xf bank_mask:0xf
    v_mov_b32 v23, v20
    s_waitcnt lgkmcnt(6)
    v_mfma_f32_16x16x32_bf16 v[76:79], v[32:35], v[120:123], v[76:79]
    v_permlane32_swap_b32 v20, v23
    v_max_f32 v20, v20, v23
    v_mov_b32 v23, v20
    s_waitcnt lgkmcnt(4)
    v_mfma_f32_16x16x32_bf16 v[76:79], v[36:39], v[124:127], v[76:79]
    v_permlane16_swap_b32 v20, v23
    v_max_f32 v20, v20, v23
    v_mul_f32 v22, s44, v20
    v_fma_f32 v136, v136, s44, -v22
    v_fma_f32 v137, v137, s44, -v22
    v_fma_f32 v138, v138, s44, -v22
    v_fma_f32 v139, v139, s44, -v22
    s_waitcnt lgkmcnt(2)
    v_mfma_f32_16x16x32_bf16 v[76:79], v[40:43], v[128:131], v[76:79]
    v_exp_f32 v136, v136
    s_waitcnt lgkmcnt(0)
    v_mfma_f32_16x16x32_bf16 v[76:79], v[44:47], v[132:135], v[76:79]
    v_exp_f32 v137, v137
    v_exp_f32 v138, v138
    v_exp_f32 v139, v139
    v_add_f32 v21, v136, v137
    v_add_f32 v23, v138, v139
    v_add_f32 v21, v21, v23
    s_nop 1
    v_add_f32_dpp v21, v21, v21 row_ror:8 row_mask:0xf bank_mask:0xf
    v_permlane32_swap_b32 v76, v78
    v_permlane32_swap_b32 v77, v79
    v_pk_add_f32 v[76:77], v[76:77], v[78:79]
    v_fma_f32 v80, v76, s44, -v22
    v_fma_f32 v81, v77, s44, -v22
    s_nop 0
    v_fmac_f32_dpp v80, v76, v18 row_ror:8 row_mask:0xf bank_mask:0xf
    v_fmac_f32_dpp v81, v77, v18 row_ror:8 row_mask:0xf bank_mask:0xf
L_c_resc_back:
    v_exp_f32 v76, v80
    v_exp_f32 v77, v81
    v_add_f32 v82, v21, v76
    v_add_f32 v22, v82, v77
    v_add_f32 v23, v82, v77
    v_max_f32 v20, v80, v81
    v_cmp_lt_f32 vcc, 0x41800000, v20
    v_permlane32_swap_b32 v22, v23
    v_add_f32 v82, v22, v23
    v_add_f32 v23, v22, v23
    s_cbranch_vccnz L_c_resc
    s_nop 0
    v_permlane16_swap_b32 v82, v23
    v_add_f32 v22, v82, v23
    v_rcp_f32 v22, v22
    s_nop 0
    v_pk_mul_f32 v[76:77], v[76:77], v[22:23] op_sel_hi:[1,0]
    v_pk_mul_f32 v[136:137], v[136:137], v[22:23] op_sel_hi:[1,0]
    v_pk_mul_f32 v[138:139], v[138:139], v[22:23] op_sel_hi:[1,0]
    v_cvt_pk_bf16_f32 v76, v76, v77
    v_cvt_pk_bf16_f32 v136, v136, v137
    v_cvt_pk_bf16_f32 v137, v138, v139
    buffer_store_dword v76, v16, s[8:11], s62 offen offset:512 sc1
    buffer_store_dwordx2 v[136:137], v15, s[8:11], s62 offen sc1
    s_mov_b32 s45, s46
    s_add_u32 s61, s61, 1
    s_cmp_lg_u32 s61, 8
    s_cbranch_scc1 Lswm_6
    s_mov_b32 s31, 0
Lwa_7:
    v_lshlrev_b32 v21, 2, v1
    buffer_load_dword v20, v21, s[24:27], 0 offen offset:192 sc1
    s_add_u32 s31, s31, 1
    s_cmp_gt_u32 s31, 400000
    s_cbranch_scc1 L_abort
    s_sleep 2
    s_waitcnt vmcnt(0)
    v_readfirstlane_b32 s30, v20
    s_nop 0
    s_cmp_lt_u32 s30, 3
    s_nop 1
    s_cbranch_scc1 Lwa_7
    v_readlane_b32 s60, v20, 4
    v_readlane_b32 s7, v20, 5
    v_readlane_b32 s28, v20, 6
    s_nop 4
Lswm_6:
    s_lshr_b32 s37, s61, 1
    s_bitcmp1_b32 s7, s37
    s_cselect_b32 s38, 16384, 0
    s_bitcmp1_b32 s28, s37
    s_cselect_b32 s62, 4096, 0
    s_or_b32 s38, s38, s62
    s_lshl_b32 s62, s37, 21
    s_lshr_b32 s37, s60, s37
    s_and_b32 s37, s37, 1
    s_lshl_b32 s37, s37, 13
    s_add_u32 s62, s62, s37
    s_and_b32 s37, s61, 1
    s_lshl_b32 s37, s37, 15
    s_add_u32 s62, s62, s37
    s_xor_b32 s37, s38, s29
    s_mov_b32 s29, s38
    v_xor_b32 v2, s37, v2
    v_xor_b32 v3, s37, v3
    v_xor_b32 v4, s37, v4
    s_cmp_lt_u32 s61, 64
    s_cbranch_scc1 L_c_m_loop
    s_waitcnt vmcnt(0)
    s_barrier
    s_cmp_lg_u32 s3, 0
    s_cbranch_scc1 L_end
    v_mov_b32 v20, 64
    v_lshlrev_b32 v21, 2, v1
    s_lshl_b32 s30, s2, 7
    s_add_u32 s30, s30, 246415360
    s_mov_b64 exec, 0xffffffff
    buffer_store_dword v20, v21, s[8:11], s30 offen sc1
    s_branch L_end
L_c_resc:
    v_max_f32 v20, 0, v20
    v_mov_b32 v23, v20
    s_nop 1
    v_permlane32_swap_b32 v20, v23
    v_max_f32 v20, v20, v23
    v_mov_b32 v23, v20
    s_nop 1
    v_permlane16_swap_b32 v20, v23
    v_max_f32 v20, v20, v23
    v_sub_f32 v80, v80, v20
    v_sub_f32 v81, v81, v20
    v_exp_f32 v20, -v20
    s_nop 0
    v_mul_f32 v21, v21, v20
    v_mul_f32 v136, v136, v20
    v_mul_f32 v137, v137, v20
    v_mul_f32 v138, v138, v20
    v_mul_f32 v139, v139, v20
    s_nop 1
    s_branch L_c_resc_back
L_c_d:
    v_lshlrev_b32 v15, 4, v1
    v_add_u32 v16, s43, v15
    v_lshlrev_b32 v143, 7, v1
    s_add_u32 s50, s50, 92274688
    v_mov_b32 v20, 64
    s_mov_b64 exec, 1
    buffer_store_dword v20, v19, s[8:11], 0 offen sc1
    s_mov_b64 exec, -1
    s_cmp_gt_u32 s57, s61
    s_cbranch_scc1 Lfok_9
    s_mov_b32 s31, 0
Lfpl_10:
    buffer_load_dwordx4 v[20:23], v10, s[8:11], s56 offen sc1
    s_add_u32 s31, s31, 1
    s_cmp_gt_u32 s31, 400000
    s_cbranch_scc1 L_abort
    s_waitcnt vmcnt(0)
    v_min3_u32 v20, v20, v21, v22
    s_nop 0
    v_readfirstlane_b32 s57, v20
    s_nop 0
    s_cmp_le_u32 s57, s61
    s_nop 1
    s_cbranch_scc1 Lfpl_10
Lfok_9:
    s_add_u32 m0, s45, 0
    s_add_u32 s34, s50, 0
    buffer_load_dwordx4 v15, s[8:11], s34 offen offset:0 sc1 lds
    buffer_load_dwordx4 v15, s[8:11], s34 offen offset:1024 sc1 lds
    buffer_load_dwordx4 v15, s[8:11], s34 offen offset:2048 sc1 lds
    buffer_load_dwordx4 v15, s[8:11], s34 offen offset:3072 sc1 lds
    s_add_u32 m0, s45, 4096
    s_add_u32 s34, s50, 4096
    buffer_load_dwordx4 v15, s[8:11], s34 offen offset:0 sc1 lds
    buffer_load_dwordx4 v15, s[8:11], s34 offen offset:1024 sc1 lds
    buffer_load_dwordx4 v15, s[8:11], s34 offen offset:2048 sc1 lds
    buffer_load_dwordx4 v15, s[8:11], s34 offen offset:3072 sc1 lds
    s_add_u32 m0, s45, 8192
    s_add_u32 s34, s50, 8192
    buffer_load_dwordx4 v15, s[8:11], s34 offen offset:0 sc1 lds
    buffer_load_dwordx4 v15, s[8:11], s34 offen offset:1024 sc1 lds
    buffer_load_dwordx4 v15, s[8:11], s34 offen offset:2048 sc1 lds
    buffer_load_dwordx4 v15, s[8:11], s34 offen offset:3072 sc1 lds
L_c_d_loop:
    s_add_u32 s50, s50, 393216
    s_add_u32 s58, s61, 1
    s_min_u32 s59, s58, 63
    s_cmp_lt_u32 s58, 64
    s_cselect_b32 s50, s50, 2146435072
    s_cmp_gt_u32 s57, s59
    s_cselect_b32 s49, s50, 2146435072
    s_add_u32 s48, s49, 4096
    v_mov_b32 v64, 0
    v_mov_b32 v65, 0
    v_mov_b32 v66, 0
    v_mov_b32 v67, 0
    v_mov_b32 v68, 0
    v_mov_b32 v69, 0
    v_mov_b32 v70, 0
    v_mov_b32 v71, 0
    v_mov_b32 v72, 0
    v_mov_b32 v73, 0
    v_mov_b32 v74, 0
    v_mov_b32 v75, 0
    v_mov_b32 v76, 0
    v_mov_b32 v77, 0
    v_mov_b32 v78, 0
    v_mov_b32 v79, 0
    v_mov_b32 v80, 0
    v_mov_b32 v81, 0
    v_mov_b32 v82, 0
    v_mov_b32 v83, 0
    v_mov_b32 v84, 0
    v_mov_b32 v85, 0
    v_mov_b32 v86, 0
    v_mov_b32 v87, 0
    v_mov_b32 v116, 0
    v_mov_b32 v117, 0
    v_mov_b32 v120, 0
    v_mov_b32 v121, 0
    ds_read_b128 v[88:91], v7 offset:6144
    ds_read_b128 v[92:95], v7 offset:7168
    ds_read_b128 v[96:99], v7 offset:0
    ds_read_b128 v[100:103], v7 offset:1024
    ds_read_b128 v[104:107], v7 offset:2048
    ds_read_b128 v[108:111], v7 offset:3072
    s_lshl_b32 s30, s3, 10
    s_add_u32 s31, s30, s45
    v_lshl_add_u32 v14, v1, 4, s31
    s_lshr_b32 s31, s3, 1
    s_lshl_b32 s31, s31, 10
    s_add_u32 s31, s31, s45
    s_and_b32 s32, s3, 1
    s_lshl_b32 s32, s32, 3
    s_add_u32 s31, s31, s32
    v_lshl_add_u32 v132, v1, 4, s31
    s_xor_b32 s46, s45, 258048
    s_add_u32 s31, s30, s46
    v_lshl_add_u32 v142, v1, 4, s31
    s_mov_b32 s31, 0
    s_waitcnt lgkmcnt(0)
    s_cmp_eq_u32 s61, 0
    s_cbranch_scc1 Lnp_12
    s_sleep 8
Lnp_12:
Lgm_11:
    buffer_load_dwordx4 v[28:31], v2, s[8:11], s62 offen sc1
    buffer_load_dwordx4 v[44:47], v3, s[8:11], s62 offen sc1
    buffer_load_dwordx2 v[60:61], v4, s[8:11], s62 offen sc1
    s_add_u32 s31, s31, 1
    s_cmp_gt_u32 s31, 400000
    s_cbranch_scc1 L_abort
    s_waitcnt vmcnt(2)
    ds_write_b128 v5, v[28:31]
    v_max3_u32 v20, v28, v29, v30
    s_waitcnt vmcnt(1)
    ds_write_b128 v5, v[44:47] offset:4096
    v_max3_u32 v21, v31, v44, v45
    v_max3_u32 v20, v20, v46, v47
    s_waitcnt vmcnt(0)
    ds_write_b64 v6, v[60:61]
    v_max3_u32 v21, v21, v60, v61
    v_max_u32 v20, v20, v21
    v_cmp_eq_u32 vcc, -1, v20
    s_cbranch_vccnz Lgm_11
    v_smfmac_f32_16x16x64_bf16 v[64:67], v[28:31], a[16:23], v9
    v_smfmac_f32_16x16x64_bf16 v[68:71], v[28:31], a[24:31], v9
    s_waitcnt lgkmcnt(0)
    s_barrier
    ds_read_b128 v[24:27], v8 offset:0
    ds_read_b128 v[32:35], v8 offset:2048
    v_smfmac_f32_16x16x64_bf16 v[72:75], v[28:31], a[32:39], v9
    ds_read_b128 v[36:39], v8 offset:3072
    ds_read_b128 v[40:43], v8 offset:4096
    v_smfmac_f32_16x16x64_bf16 v[64:67], v[44:47], a[96:103], v9
    ds_read_b128 v[48:51], v8 offset:6144
    ds_read_b128 v[52:55], v8 offset:7168
    v_smfmac_f32_16x16x64_bf16 v[68:71], v[44:47], v[88:95], v9
    ds_read_b128 v[56:59], v8 offset:8192
    ds_read_b128 v[60:63], v8 offset:9216
    v_smfmac_f32_16x16x64_bf16 v[72:75], v[44:47], a[104:111], v9
    buffer_load_dword v22, v143, s[8:11], s49 offen sc1
    ds_read_b128 v[88:91], v7 offset:4096
    s_waitcnt lgkmcnt(8)
    v_smfmac_f32_16x16x64_bf16 v[64:67], v[24:27], a[0:7], v9
    ds_read_b128 v[92:95], v7 offset:5120
    v_smfmac_f32_16x16x64_bf16 v[68:71], v[24:27], v[96:103], v9
    buffer_load_dword v23, v143, s[8:11], s48 offen sc1
    v_smfmac_f32_16x16x64_bf16 v[72:75], v[24:27], a[8:15], v9
    ds_read_b128 v[96:99], v7 offset:8192
    s_waitcnt lgkmcnt(9)
    v_smfmac_f32_16x16x64_bf16 v[64:67], v[32:35], a[40:47], v9
    ds_read_b128 v[100:103], v7 offset:9216
    v_smfmac_f32_16x16x64_bf16 v[68:71], v[32:35], v[104:111], v9
    ds_read_b128 v[104:107], v7 offset:10240
    v_smfmac_f32_16x16x64_bf16 v[72:75], v[32:35], a[48:55], v9
    ds_read_b128 v[108:111], v7 offset:11264
    s_waitcnt lgkmcnt(11)
    v_smfmac_f32_16x16x64_bf16 v[64:67], v[36:39], a[56:63], v9
    ds_read_b128 v[124:127], v14
    s_waitcnt lgkmcnt(5)
    v_smfmac_f32_16x16x64_bf16 v[68:71], v[36:39], v[88:95], v9
    ds_read_b128 v[128:131], v14 offset:6144
    v_smfmac_f32_16x16x64_bf16 v[72:75], v[36:39], a[64:71], v9
    ds_read2st64_b64 v[132:135], v132 offset0:8 offset1:20
    v_smfmac_f32_16x16x64_bf16 v[64:67], v[40:43], a[72:79], v9
    ds_read_b128 v[88:91], v7 offset:12288
    v_smfmac_f32_16x16x64_bf16 v[68:71], v[40:43], a[80:87], v9
    ds_read_b128 v[92:95], v7 offset:13312
    v_smfmac_f32_16x16x64_bf16 v[72:75], v[40:43], a[88:95], v9
    v_smfmac_f32_16x16x64_bf16 v[64:67], v[48:51], a[112:119], v9
    v_smfmac_f32_16x16x64_bf16 v[68:71], v[48:51], a[120:127], v9
    v_smfmac_f32_16x16x64_bf16 v[72:75], v[48:51], a[128:135], v9
    v_smfmac_f32_16x16x64_bf16 v[64:67], v[52:55], a[136:143], v9
    s_waitcnt lgkmcnt(7)
    v_smfmac_f32_16x16x64_bf16 v[68:71], v[52:55], v[96:103], v9
    ds_read_b128 v[96:99], v7 offset:14336
    v_smfmac_f32_16x16x64_bf16 v[72:75], v[52:55], a[144:151], v9
    ds_read_b128 v[100:103], v7 offset:15360
    v_smfmac_f32_16x16x64_bf16 v[64:67], v[56:59], a[152:159], v9
    v_smfmac_f32_16x16x64_bf16 v[64:67], v[60:63], a[160:167], v9
    s_waitcnt lgkmcnt(7)
    v_smfmac_f32_16x16x64_bf16 v[68:71], v[56:59], v[104:111], v9
    ds_read_b128 v[104:107], v7 offset:16384
    v_smfmac_f32_16x16x64_bf16 v[68:71], v[60:63], a[168:175], v9
    ds_read_b128 v[108:111], v7 offset:17408
    v_smfmac_f32_16x16x64_bf16 v[72:75], v[56:59], a[176:183], v9
    s_nop 1
    v_cvt_pk_bf16_f32 v64, v64, v65
    v_smfmac_f32_16x16x64_bf16 v[72:75], v[60:63], a[184:191], v9
    s_waitcnt lgkmcnt(4)
    v_cvt_pk_bf16_f32 v65, v66, v67
    v_smfmac_f32_16x16x64_bf16 v[76:79], v[24:27], v[88:95], v9
    ds_write_b64 v11, v[64:65] offset:0
    v_cvt_pk_bf16_f32 v68, v68, v69
    v_smfmac_f32_16x16x64_bf16 v[76:79], v[28:31], a[192:199], v9
    ds_read_b128 v[88:91], v7 offset:18432
    v_cvt_pk_bf16_f32 v69, v70, v71
    v_smfmac_f32_16x16x64_bf16 v[76:79], v[32:35], a[200:207], v9
    ds_write_b64 v11, v[68:69] offset:512
    v_cvt_pk_bf16_f32 v72, v72, v73
    v_smfmac_f32_16x16x64_bf16 v[76:79], v[36:39], a[208:215], v9
    ds_read_b128 v[92:95], v7 offset:19456
    s_waitcnt lgkmcnt(6)
    v_cvt_pk_bf16_f32 v73, v74, v75
    v_smfmac_f32_16x16x64_bf16 v[76:79], v[40:43], v[96:103], v9
    ds_write_b64 v12, v[72:73] offset:0
    v_smfmac_f32_16x16x64_bf16 v[76:79], v[44:47], a[216:223], v9
    ds_read_b64_tr_b16 v[112:113], v140
    ds_read_b64_tr_b16 v[114:115], v140 offset:512
    v_smfmac_f32_16x16x64_bf16 v[76:79], v[48:51], a[224:231], v9
    ds_read_b64_tr_b16 v[118:119], v141 offset:4096
    v_smfmac_f32_16x16x64_bf16 v[76:79], v[52:55], a[232:239], v9
    ds_read_b128 v[96:99], v7 offset:20480
    s_waitcnt lgkmcnt(9)
    v_smfmac_f32_16x16x64_bf16 v[76:79], v[56:59], v[104:111], v9
    ds_read_b128 v[100:103], v7 offset:21504
    v_smfmac_f32_16x16x64_bf16 v[76:79], v[60:63], a[240:247], v9
    ds_read_b128 v[104:107], v7 offset:22528
    v_smfmac_f32_16x16x64_bf16 v[80:83], v[24:27], a[248:255], v9
    s_waitcnt lgkmcnt(6)
    s_barrier
    v_smfmac_f32_16x16x64_bf16 v[80:83], v[28:31], v[144:151], v9
    s_waitcnt lgkmcnt(4)
    v_mfma_f32_16x16x32_bf16 v[64:67], v[124:127], v[112:115], 0
    v_mfma_f32_16x16x32_bf16 v[68:71], v[128:131], v[112:115], 0
    s_waitcnt lgkmcnt(3)
    v_cvt_pk_bf16_f32 v76, v76, v77
    v_mfma_f32_16x16x32_bf16 v[64:67], v[132:135], v[118:121], v[64:67]
    v_cvt_pk_bf16_f32 v77, v78, v79
    v_mfma_f32_16x16x32_bf16 v[68:71], v[132:135], v[116:119], v[68:71]
    v_smfmac_f32_16x16x64_bf16 v[80:83], v[32:35], v[88:95], v9
    ds_write_b64 v11, v[76:77] offset:6144
    v_smfmac_f32_16x16x64_bf16 v[80:83], v[36:39], v[152:159], v9
    ds_read_b128 v[108:111], v7 offset:23552
    v_smfmac_f32_16x16x64_bf16 v[80:83], v[40:43], v[160:167], v9
    ds_read_b128 v[88:91], v7 offset:24576
    v_add_f32_dpp v136, v64, v64 row_ror:8 row_mask:0xf bank_mask:0x3
    v_smfmac_f32_16x16x64_bf16 v[80:83], v[44:47], v[168:175], v9
    ds_read_b128 v[92:95], v7 offset:25600
    s_waitcnt lgkmcnt(5)
    v_add_f32_dpp v137, v65, v65 row_ror:8 row_mask:0xf bank_mask:0x3
    v_smfmac_f32_16x16x64_bf16 v[80:83], v[48:51], v[96:103], v9
    ds_read_b128 v[96:99], v7 offset:26624
    v_add_f32_dpp v138, v68, v68 row_ror:8 row_mask:0xf bank_mask:0x3
    v_smfmac_f32_16x16x64_bf16 v[80:83], v[52:55], v[176:183], v9
    ds_read_b128 v[100:103], v7 offset:27648
    v_add_f32_dpp v139, v69, v69 row_ror:8 row_mask:0xf bank_mask:0x3
    v_smfmac_f32_16x16x64_bf16 v[80:83], v[56:59], v[184:191], v9
    v_add_f32_dpp v136, v66, v66 row_ror:8 row_mask:0xf bank_mask:0xc
    v_smfmac_f32_16x16x64_bf16 v[80:83], v[60:63], v[192:199], v9
    s_waitcnt lgkmcnt(4)
    v_add_f32_dpp v137, v67, v67 row_ror:8 row_mask:0xf bank_mask:0xc
    v_smfmac_f32_16x16x64_bf16 v[84:87], v[24:27], v[104:111], v9
    v_add_f32_dpp v138, v70, v70 row_ror:8 row_mask:0xf bank_mask:0xc
    v_smfmac_f32_16x16x64_bf16 v[84:87], v[28:31], v[200:207], v9
    v_add_f32_dpp v139, v71, v71 row_ror:8 row_mask:0xf bank_mask:0xc
    v_smfmac_f32_16x16x64_bf16 v[84:87], v[32:35], v[208:215], v9
    ds_write_b128 v142, v[136:139]
    v_cvt_pk_bf16_f32 v80, v80, v81
    v_smfmac_f32_16x16x64_bf16 v[84:87], v[36:39], v[216:223], v9
    s_waitcnt lgkmcnt(3)
    v_cvt_pk_bf16_f32 v81, v82, v83
    v_smfmac_f32_16x16x64_bf16 v[84:87], v[40:43], v[88:95], v9
    ds_write_b64 v11, v[80:81] offset:6656
    v_smfmac_f32_16x16x64_bf16 v[84:87], v[44:47], v[224:231], v9
    v_smfmac_f32_16x16x64_bf16 v[84:87], v[48:51], v[232:239], v9
    v_smfmac_f32_16x16x64_bf16 v[84:87], v[52:55], v[240:247], v9
    s_waitcnt lgkmcnt(2)
    v_smfmac_f32_16x16x64_bf16 v[84:87], v[56:59], v[96:103], v9
    s_waitcnt lgkmcnt(0)
    s_barrier
    v_smfmac_f32_16x16x64_bf16 v[84:87], v[60:63], v[248:255], v9
    s_nop 7
    v_cvt_pk_bf16_f32 v84, v84, v85
    v_cvt_pk_bf16_f32 v85, v86, v87
    ds_write_b64 v12, v[84:85] offset:6144
    s_waitcnt lgkmcnt(0)
    s_barrier
    s_waitcnt vmcnt(0)
    s_add_u32 s58, s59, 1
    s_min_u32 s58, s58, 63
    s_cmp_gt_u32 s57, s58
    s_cbranch_scc1 Lfok_13
    s_mov_b32 s31, 0
Lfpl_14:
    buffer_load_dwordx4 v[20:23], v10, s[8:11], s56 offen sc1
    s_add_u32 s31, s31, 1
    s_cmp_gt_u32 s31, 400000
    s_cbranch_scc1 L_abort
    s_waitcnt vmcnt(0)
    v_min3_u32 v20, v20, v21, v22
    s_nop 0
    v_readfirstlane_b32 s57, v20
    s_nop 0
    s_cmp_le_u32 s57, s59
    s_nop 1
    s_cbranch_scc1 Lfpl_14
Lfok_13:
    s_sleep 10
    s_add_u32 m0, s46, 0
    s_add_u32 s34, s50, 0
    buffer_load_dwordx4 v15, s[8:11], s34 offen offset:0 sc1 lds
    buffer_load_dwordx4 v15, s[8:11], s34 offen offset:1024 sc1 lds
    buffer_load_dwordx4 v15, s[8:11], s34 offen offset:2048 sc1 lds
    buffer_load_dwordx4 v15, s[8:11], s34 offen offset:3072 sc1 lds
    s_add_u32 m0, s46, 4096
    s_add_u32 s34, s50, 4096
    buffer_load_dwordx4 v15, s[8:11], s34 offen offset:0 sc1 lds
    buffer_load_dwordx4 v15, s[8:11], s34 offen offset:1024 sc1 lds
    buffer_load_dwordx4 v15, s[8:11], s34 offen offset:2048 sc1 lds
    buffer_load_dwordx4 v15, s[8:11], s34 offen offset:3072 sc1 lds
    s_add_u32 m0, s46, 8192
    s_add_u32 s34, s50, 8192
    buffer_load_dwordx4 v15, s[8:11], s34 offen offset:0 sc1 lds
    buffer_load_dwordx4 v15, s[8:11], s34 offen offset:1024 sc1 lds
    buffer_load_dwordx4 v15, s[8:11], s34 offen offset:2048 sc1 lds
    buffer_load_dwordx4 v15, s[8:11], s34 offen offset:3072 sc1 lds
    s_mov_b32 s45, s46
    s_add_u32 s61, s61, 1
    s_cmp_lg_u32 s61, 8
    s_cbranch_scc1 Lswm_15
    s_mov_b32 s31, 0
Lwa_16:
    v_lshlrev_b32 v21, 2, v1
    buffer_load_dword v20, v21, s[24:27], 0 offen offset:192 sc1
    s_add_u32 s31, s31, 1
    s_cmp_gt_u32 s31, 400000
    s_cbranch_scc1 L_abort
    s_sleep 2
    s_waitcnt vmcnt(0)
    v_readfirstlane_b32 s30, v20
    s_nop 0
    s_cmp_lt_u32 s30, 3
    s_nop 1
    s_cbranch_scc1 Lwa_16
    v_readlane_b32 s60, v20, 4
    v_readlane_b32 s7, v20, 5
    v_readlane_b32 s28, v20, 6
    s_nop 4
Lswm_15:
    s_lshr_b32 s37, s61, 1
    s_bitcmp1_b32 s7, s37
    s_cselect_b32 s38, 16384, 0
    s_bitcmp1_b32 s28, s37
    s_cselect_b32 s62, 4096, 0
    s_or_b32 s38, s38, s62
    s_lshl_b32 s62, s37, 21
    s_lshr_b32 s37, s60, s37
    s_and_b32 s37, s37, 1
    s_lshl_b32 s37, s37, 13
    s_add_u32 s62, s62, s37
    s_and_b32 s37, s61, 1
    s_lshl_b32 s37, s37, 15
    s_add_u32 s62, s62, s37
    s_xor_b32 s37, s38, s29
    s_mov_b32 s29, s38
    v_xor_b32 v2, s37, v2
    v_xor_b32 v3, s37, v3
    v_xor_b32 v4, s37, v4
    s_cmp_lt_u32 s61, 64
    s_cbranch_scc1 L_c_d_loop
    s_waitcnt vmcnt(0)
    s_barrier
    s_cmp_lg_u32 s3, 0
    s_cbranch_scc1 L_end
    v_mov_b32 v20, 64
    v_lshlrev_b32 v21, 2, v1
    s_lshl_b32 s30, s2, 7
    s_add_u32 s30, s30, 246415360
    s_mov_b64 exec, 0xffffffff
    buffer_store_dword v20, v21, s[8:11], s30 offen sc1
    s_branch L_end
L_c_x:
    s_and_b32 s47, s3, 1
    s_mul_i32 s30, s47, 6144
    v_lshl_add_u32 v15, v1, 4, s30
    v_add_u32 v16, 4096, v15
    v_min_u32 v143, 47, v1
    v_lshl_add_u32 v143, v143, 7, s30
    s_lshl_b32 s30, s47, 10
    v_lshl_add_u32 v17, v1, 4, s30
    v_and_b32 v20, 15, v1
    v_lshrrev_b32 v21, 4, v1
    s_lshl_b32 s30, s47, 8
    s_add_u32 s30, s30, 2048
    v_lshl_add_u32 v18, v20, 4, s30
    v_lshl_add_u32 v18, v21, 2, v18
    s_lshl_b32 s30, s47, 4
    v_add_u32 v20, s30, v20
    v_lshlrev_b32 v21, 2, v21
    v_sub_u32 v20, v20, v21
    s_add_u32 s50, s50, 67108864
    s_mul_i32 s51, s4, 2560
    s_add_u32 s51, s51, 226492416
    v_cmp_le_i32 s[64:65], 0, v20
    v_cmp_le_i32 s[66:67], 1, v20
    v_cmp_le_i32 s[68:69], 2, v20
    v_cmp_le_i32 s[70:71], 3, v20
    v_cmp_le_i32 s[72:73], 16, v20
    v_cmp_le_i32 s[74:75], 17, v20
    v_cmp_le_i32 s[76:77], 18, v20
    v_cmp_le_i32 s[78:79], 19, v20
    s_cmp_eq_u32 s3, 3
    s_nop 2
    s_cbranch_scc1 L_c_x3
L_c_x_loop2:
    s_cmp_gt_u32 s57, s61
    s_cselect_b32 s49, s50, 2146435072
    v_mov_b32 v64, 0
    v_mov_b32 v65, 0
    v_mov_b32 v66, 0
    v_mov_b32 v67, 0
    v_mov_b32 v68, 0
    v_mov_b32 v69, 0
    v_mov_b32 v70, 0
    v_mov_b32 v71, 0
    v_mov_b32 v72, 0
    v_mov_b32 v73, 0
    v_mov_b32 v74, 0
    v_mov_b32 v75, 0
    v_mov_b32 v76, 0
    v_mov_b32 v77, 0
    v_mov_b32 v78, 0
    v_mov_b32 v79, 0
    v_mov_b32 v80, 0
    v_mov_b32 v81, 0
    v_mov_b32 v82, 0
    v_mov_b32 v83, 0
    v_mov_b32 v84, 0
    v_mov_b32 v85, 0
    v_mov_b32 v86, 0
    v_mov_b32 v87, 0
    v_mov_b32 v116, 0
    v_mov_b32 v117, 0
    v_mov_b32 v120, 0
    v_mov_b32 v121, 0
    ds_read_b128 v[88:91], v7 offset:2048
    ds_read_b128 v[92:95], v7 offset:3072
    ds_read_b128 v[96:99], v7 offset:0
    ds_read_b128 v[100:103], v7 offset:1024
    ds_read_b128 v[104:107], v7 offset:4096
    ds_read_b128 v[108:111], v7 offset:5120
    s_lshl_b32 s30, s3, 10
    s_add_u32 s31, s30, s45
    v_lshl_add_u32 v14, v1, 4, s31
    s_lshr_b32 s31, s3, 1
    s_lshl_b32 s31, s31, 10
    s_add_u32 s31, s31, s45
    s_and_b32 s32, s3, 1
    s_lshl_b32 s32, s32, 3
    s_add_u32 s31, s31, s32
    v_lshl_add_u32 v132, v1, 4, s31
    s_xor_b32 s46, s45, 258048
    s_add_u32 s31, s30, s46
    v_lshl_add_u32 v142, v1, 4, s31
    s_mov_b32 s31, 0
    s_waitcnt lgkmcnt(0)
    s_cmp_eq_u32 s61, 0
    s_cbranch_scc1 Lnp_19
    s_sleep 4
Lnp_19:
Lgm_18:
    buffer_load_dwordx4 v[32:35], v2, s[8:11], s62 offen sc1
    buffer_load_dwordx4 v[48:51], v3, s[8:11], s62 offen sc1
    buffer_load_dwordx2 v[60:61], v4, s[8:11], s62 offen sc1
    s_add_u32 s31, s31, 1
    s_cmp_gt_u32 s31, 400000
    s_cbranch_scc1 L_abort
    s_waitcnt vmcnt(2)
    ds_write_b128 v5, v[32:35]
    v_max3_u32 v20, v32, v33, v34
    s_waitcnt vmcnt(1)
    ds_write_b128 v5, v[48:51] offset:4096
    v_max3_u32 v21, v35, v48, v49
    v_max3_u32 v20, v20, v50, v51
    s_waitcnt vmcnt(0)
    ds_write_b64 v6, v[60:61]
    v_max3_u32 v21, v21, v60, v61
    v_max_u32 v20, v20, v21
    v_cmp_eq_u32 vcc, -1, v20
    s_cbranch_vccnz Lgm_18
    v_smfmac_f32_16x16x64_bf16 v[64:67], v[32:35], a[40:47], v9
    v_smfmac_f32_16x16x64_bf16 v[68:71], v[32:35], v[88:95], v9
    s_waitcnt lgkmcnt(0)
    s_barrier
    ds_read_b128 v[24:27], v8 offset:0
    ds_read_b128 v[28:31], v8 offset:1024
    v_smfmac_f32_16x16x64_bf16 v[72:75], v[32:35], a[48:55], v9
    ds_read_b128 v[36:39], v8 offset:3072
    ds_read_b128 v[40:43], v8 offset:4096
    v_smfmac_f32_16x16x64_bf16 v[64:67], v[48:51], a[112:119], v9
    ds_read_b128 v[44:47], v8 offset:5120
    ds_read_b128 v[52:55], v8 offset:7168
    v_smfmac_f32_16x16x64_bf16 v[68:71], v[48:51], a[120:127], v9
    ds_read_b128 v[56:59], v8 offset:8192
    ds_read_b128 v[60:63], v8 offset:9216
    v_smfmac_f32_16x16x64_bf16 v[72:75], v[48:51], a[128:135], v9
    buffer_load_dword v22, v143, s[8:11], s49 offen sc1
    s_waitcnt lgkmcnt(7)
    v_smfmac_f32_16x16x64_bf16 v[64:67], v[24:27], a[0:7], v9
    ds_read_b128 v[88:91], v7 offset:6144
    v_smfmac_f32_16x16x64_bf16 v[68:71], v[24:27], v[96:103], v9
    ds_read_b128 v[92:95], v7 offset:7168
    v_smfmac_f32_16x16x64_bf16 v[72:75], v[24:27], a[8:15], v9
    ds_read_b128 v[96:99], v7 offset:8192
    s_waitcnt lgkmcnt(9)
    v_smfmac_f32_16x16x64_bf16 v[64:67], v[28:31], a[16:23], v9
    ds_read_b128 v[100:103], v7 offset:9216
    v_smfmac_f32_16x16x64_bf16 v[68:71], v[28:31], a[24:31], v9
    v_smfmac_f32_16x16x64_bf16 v[72:75], v[28:31], a[32:39], v9
    s_waitcnt lgkmcnt(9)
    v_smfmac_f32_16x16x64_bf16 v[64:67], v[36:39], a[56:63], v9
    ds_read_b128 v[124:127], v14
    v_smfmac_f32_16x16x64_bf16 v[68:71], v[36:39], v[104:111], v9
    ds_read_b128 v[128:131], v14 offset:6144
    v_smfmac_f32_16x16x64_bf16 v[72:75], v[36:39], a[64:71], v9
    ds_read2st64_b64 v[132:135], v132 offset0:8 offset1:20
    s_waitcnt lgkmcnt(11)
    v_smfmac_f32_16x16x64_bf16 v[64:67], v[40:43], a[72:79], v9
    ds_read_b128 v[104:107], v7 offset:10240
    v_smfmac_f32_16x16x64_bf16 v[68:71], v[40:43], a[80:87], v9
    ds_read_b128 v[108:111], v7 offset:11264
    v_smfmac_f32_16x16x64_bf16 v[72:75], v[40:43], a[88:95], v9
    s_waitcnt lgkmcnt(12)
    v_smfmac_f32_16x16x64_bf16 v[64:67], v[44:47], a[96:103], v9
    s_waitcnt lgkmcnt(7)
    v_smfmac_f32_16x16x64_bf16 v[68:71], v[44:47], v[88:95], v9
    ds_read_b128 v[88:91], v7 offset:12288
    v_smfmac_f32_16x16x64_bf16 v[72:75], v[44:47], a[104:111], v9
    ds_read_b128 v[92:95], v7 offset:13312
    v_smfmac_f32_16x16x64_bf16 v[64:67], v[52:55], a[136:143], v9
    s_waitcnt lgkmcnt(7)
    v_smfmac_f32_16x16x64_bf16 v[68:71], v[52:55], v[96:103], v9
    ds_read_b128 v[96:99], v7 offset:14336
    v_smfmac_f32_16x16x64_bf16 v[72:75], v[52:55], a[144:151], v9
    ds_read_b128 v[100:103], v7 offset:15360
    v_smfmac_f32_16x16x64_bf16 v[64:67], v[56:59], a[152:159], v9
    v_smfmac_f32_16x16x64_bf16 v[64:67], v[60:63], a[160:167], v9
    s_waitcnt lgkmcnt(4)
    v_smfmac_f32_16x16x64_bf16 v[68:71], v[56:59], v[104:111], v9
    ds_read_b128 v[104:107], v7 offset:16384
    v_smfmac_f32_16x16x64_bf16 v[68:71], v[60:63], a[168:175], v9
    ds_read_b128 v[108:111], v7 offset:17408
    v_smfmac_f32_16x16x64_bf16 v[72:75], v[56:59], a[176:183], v9
    s_nop 1
    v_cvt_pk_bf16_f32 v64, v64, v65
    v_smfmac_f32_16x16x64_bf16 v[72:75], v[60:63], a[184:191], v9
    s_waitcnt lgkmcnt(4)
    v_cvt_pk_bf16_f32 v65, v66, v67
    v_smfmac_f32_16x16x64_bf16 v[76:79], v[24:27], v[88:95], v9
    ds_write_b64 v11, v[64:65] offset:0
    v_cvt_pk_bf16_f32 v68, v68, v69
    v_smfmac_f32_16x16x64_bf16 v[76:79], v[28:31], a[192:199], v9
    ds_read_b128 v[88:91], v7 offset:18432
    v_cvt_pk_bf16_f32 v69, v70, v71
    v_smfmac_f32_16x16x64_bf16 v[76:79], v[32:35], a[200:207], v9
    ds_write_b64 v11, v[68:69] offset:512
    v_cvt_pk_bf16_f32 v72, v72, v73
    v_smfmac_f32_16x16x64_bf16 v[76:79], v[36:39], a[208:215], v9
    ds_read_b128 v[92:95], v7 offset:19456
    s_waitcnt lgkmcnt(6)
    v_cvt_pk_bf16_f32 v73, v74, v75
    v_smfmac_f32_16x16x64_bf16 v[76:79], v[40:43], v[96:103], v9
    ds_write_b64 v12, v[72:73] offset:0
    v_smfmac_f32_16x16x64_bf16 v[76:79], v[44:47], a[216:223], v9
    ds_read_b64_tr_b16 v[112:113], v140
    ds_read_b64_tr_b16 v[114:115], v140 offset:512
    v_smfmac_f32_16x16x64_bf16 v[76:79], v[48:51], a[224:231], v9
    ds_read_b64_tr_b16 v[118:119], v141 offset:4096
    v_smfmac_f32_16x16x64_bf16 v[76:79], v[52:55], a[232:239], v9
    ds_read_b128 v[96:99], v7 offset:20480
    s_waitcnt lgkmcnt(9)
    v_smfmac_f32_16x16x64_bf16 v[76:79], v[56:59], v[104:111], v9
    ds_read_b128 v[100:103], v7 offset:21504
    v_smfmac_f32_16x16x64_bf16 v[76:79], v[60:63], a[240:247], v9
    ds_read_b128 v[104:107], v7 offset:22528
    v_smfmac_f32_16x16x64_bf16 v[80:83], v[24:27], a[248:255], v9
    s_waitcnt lgkmcnt(6)
    s_barrier
    v_smfmac_f32_16x16x64_bf16 v[80:83], v[28:31], v[144:151], v9
    s_waitcnt lgkmcnt(4)
    v_mfma_f32_16x16x32_bf16 v[64:67], v[124:127], v[112:115], 0
    v_mfma_f32_16x16x32_bf16 v[68:71], v[128:131], v[112:115], 0
    s_waitcnt lgkmcnt(3)
    v_cvt_pk_bf16_f32 v76, v76, v77
    v_mfma_f32_16x16x32_bf16 v[64:67], v[132:135], v[118:121], v[64:67]
    v_cvt_pk_bf16_f32 v77, v78, v79
    v_mfma_f32_16x16x32_bf16 v[68:71], v[132:135], v[116:119], v[68:71]
    v_smfmac_f32_16x16x64_bf16 v[80:83], v[32:35], v[88:95], v9
    ds_write_b64 v11, v[76:77] offset:6144
    v_smfmac_f32_16x16x64_bf16 v[80:83], v[36:39], v[152:159], v9
    ds_read_b128 v[108:111], v7 offset:23552
    v_smfmac_f32_16x16x64_bf16 v[80:83], v[40:43], v[160:167], v9
    ds_read_b128 v[88:91], v7 offset:24576
    v_add_f32_dpp v136, v64, v64 row_ror:8 row_mask:0xf bank_mask:0x3
    v_smfmac_f32_16x16x64_bf16 v[80:83], v[44:47], v[168:175], v9
    ds_read_b128 v[92:95], v7 offset:25600
    s_waitcnt lgkmcnt(5)
    v_add_f32_dpp v137, v65, v65 row_ror:8 row_mask:0xf bank_mask:0x3
    v_smfmac_f32_16x16x64_bf16 v[80:83], v[48:51], v[96:103], v9
    ds_read_b128 v[96:99], v7 offset:26624
    v_add_f32_dpp v138, v68, v68 row_ror:8 row_mask:0xf bank_mask:0x3
    v_smfmac_f32_16x16x64_bf16 v[80:83], v[52:55], v[176:183], v9
    ds_read_b128 v[100:103], v7 offset:27648
    v_add_f32_dpp v139, v69, v69 row_ror:8 row_mask:0xf bank_mask:0x3
    v_smfmac_f32_16x16x64_bf16 v[80:83], v[56:59], v[184:191], v9
    v_add_f32_dpp v136, v66, v66 row_ror:8 row_mask:0xf bank_mask:0xc
    v_smfmac_f32_16x16x64_bf16 v[80:83], v[60:63], v[192:199], v9
    s_waitcnt lgkmcnt(4)
    v_add_f32_dpp v137, v67, v67 row_ror:8 row_mask:0xf bank_mask:0xc
    v_smfmac_f32_16x16x64_bf16 v[84:87], v[24:27], v[104:111], v9
    v_add_f32_dpp v138, v70, v70 row_ror:8 row_mask:0xf bank_mask:0xc
    v_smfmac_f32_16x16x64_bf16 v[84:87], v[28:31], v[200:207], v9
    v_add_f32_dpp v139, v71, v71 row_ror:8 row_mask:0xf bank_mask:0xc
    v_smfmac_f32_16x16x64_bf16 v[84:87], v[32:35], v[208:215], v9
    ds_write_b128 v142, v[136:139]
    v_cvt_pk_bf16_f32 v80, v80, v81
    v_smfmac_f32_16x16x64_bf16 v[84:87], v[36:39], v[216:223], v9
    s_waitcnt lgkmcnt(3)
    v_cvt_pk_bf16_f32 v81, v82, v83
    v_smfmac_f32_16x16x64_bf16 v[84:87], v[40:43], v[88:95], v9
    ds_write_b64 v11, v[80:81] offset:6656
    v_smfmac_f32_16x16x64_bf16 v[84:87], v[44:47], v[224:231], v9
    v_smfmac_f32_16x16x64_bf16 v[84:87], v[48:51], v[232:239], v9
    v_smfmac_f32_16x16x64_bf16 v[84:87], v[52:55], v[240:247], v9
    s_waitcnt lgkmcnt(2)
    v_smfmac_f32_16x16x64_bf16 v[84:87], v[56:59], v[96:103], v9
    s_waitcnt lgkmcnt(0)
    s_barrier
    v_smfmac_f32_16x16x64_bf16 v[84:87], v[60:63], v[248:255], v9
    s_nop 7
    v_cvt_pk_bf16_f32 v84, v84, v85
    v_cvt_pk_bf16_f32 v85, v86, v87
    ds_write_b64 v12, v[84:85] offset:6144
    s_waitcnt lgkmcnt(0)
    s_barrier
    s_waitcnt vmcnt(0)
    s_cmp_gt_u32 s57, s61
    s_cbranch_scc1 Lfok_20
    s_mov_b32 s31, 0
Lfpl_21:
    buffer_load_dwordx4 v[20:23], v10, s[8:11], s56 offen sc1
    s_add_u32 s31, s31, 1
    s_cmp_gt_u32 s31, 400000
    s_cbranch_scc1 L_abort
    s_waitcnt vmcnt(0)
    v_min3_u32 v20, v20, v21, v22
    s_nop 0
    v_readfirstlane_b32 s57, v20
    s_nop 0
    s_cmp_le_u32 s57, s61
    s_nop 1
    s_cbranch_scc1 Lfpl_21
Lfok_20:
    buffer_load_dwordx4 v[112:115], v15, s[8:11], s50 offen offset:0 sc1
    buffer_load_dwordx4 v[116:119], v15, s[8:11], s50 offen offset:1024 sc1
    buffer_load_dwordx4 v[120:123], v15, s[8:11], s50 offen offset:2048 sc1
    buffer_load_dwordx4 v[124:127], v15, s[8:11], s50 offen offset:3072 sc1
    buffer_load_dwordx4 v[128:131], v16, s[8:11], s50 offen offset:0 sc1
    buffer_load_dwordx4 v[132:135], v16, s[8:11], s50 offen offset:1024 sc1
    v_lshl_add_u32 v20, v1, 4, s45
    ds_read_b128 v[24:27], v20 offset:0
    ds_read_b128 v[28:31], v20 offset:6144
    ds_read_b64_tr_b16 v[32:33], v13 offset:6144
    ds_read_b64_tr_b16 v[34:35], v13 offset:6656
    ds_read_b128 v[36:39], v20 offset:1024
    ds_read_b128 v[40:43], v20 offset:7168
    ds_read_b64_tr_b16 v[44:45], v13 offset:7168
    ds_read_b64_tr_b16 v[46:47], v13 offset:7680
    ds_read_b128 v[48:51], v20 offset:2048
    ds_read_b128 v[52:55], v20 offset:8192
    ds_read_b64_tr_b16 v[56:57], v13 offset:8192
    ds_read_b64_tr_b16 v[58:59], v13 offset:8704
    s_waitcnt vmcnt(5) lgkmcnt(11)
    v_mfma_f32_16x16x32_bf16 v[64:67], v[24:27], v[112:115], 0
    ds_read_b128 v[60:63], v20 offset:3072
    s_waitcnt lgkmcnt(11)
    v_mfma_f32_16x16x32_bf16 v[68:71], v[28:31], v[112:115], 0
    ds_read_b128 v[24:27], v20 offset:9216
    s_waitcnt lgkmcnt(10)
    v_mfma_f32_16x16x32_bf16 v[72:75], v[32:35], v[112:115], 0
    ds_read_b64_tr_b16 v[28:29], v13 offset:9216
    ds_read_b64_tr_b16 v[30:31], v13 offset:9728
    s_waitcnt vmcnt(4) lgkmcnt(11)
    v_mfma_f32_16x16x32_bf16 v[64:67], v[36:39], v[116:119], v[64:67]
    ds_read_b128 v[32:35], v20 offset:4096
    s_waitcnt lgkmcnt(11)
    v_mfma_f32_16x16x32_bf16 v[68:71], v[40:43], v[116:119], v[68:71]
    ds_read_b128 v[36:39], v20 offset:10240
    s_waitcnt lgkmcnt(10)
    v_mfma_f32_16x16x32_bf16 v[72:75], v[44:47], v[116:119], v[72:75]
    ds_read_b64_tr_b16 v[40:41], v13 offset:10240
    ds_read_b64_tr_b16 v[42:43], v13 offset:10752
    s_waitcnt vmcnt(3) lgkmcnt(11)
    v_mfma_f32_16x16x32_bf16 v[64:67], v[48:51], v[120:123], v[64:67]
    ds_read_b128 v[44:47], v20 offset:5120
    s_waitcnt lgkmcnt(11)
    v_mfma_f32_16x16x32_bf16 v[68:71], v[52:55], v[120:123], v[68:71]
    ds_read_b128 v[48:51], v20 offset:11264
    s_waitcnt lgkmcnt(10)
    v_mfma_f32_16x16x32_bf16 v[72:75], v[56:59], v[120:123], v[72:75]
    ds_read_b64_tr_b16 v[52:53], v13 offset:11264
    ds_read_b64_tr_b16 v[54:55], v13 offset:11776
    s_waitcnt vmcnt(2) lgkmcnt(11)
    v_mfma_f32_16x16x32_bf16 v[64:67], v[60:63], v[124:127], v[64:67]
    s_waitcnt lgkmcnt(10)
    v_mfma_f32_16x16x32_bf16 v[68:71], v[24:27], v[124:127], v[68:71]
    s_waitcnt lgkmcnt(8)
    v_mfma_f32_16x16x32_bf16 v[72:75], v[28:31], v[124:127], v[72:75]
    s_waitcnt vmcnt(1) lgkmcnt(7)
    v_mfma_f32_16x16x32_bf16 v[64:67], v[32:35], v[128:131], v[64:67]
    s_waitcnt lgkmcnt(6)
    v_mfma_f32_16x16x32_bf16 v[68:71], v[36:39], v[128:131], v[68:71]
    s_waitcnt lgkmcnt(4)
    v_mfma_f32_16x16x32_bf16 v[72:75], v[40:43], v[128:131], v[72:75]
    s_waitcnt vmcnt(0) lgkmcnt(3)
    v_mfma_f32_16x16x32_bf16 v[64:67], v[44:47], v[132:135], v[64:67]
    s_waitcnt lgkmcnt(2)
    v_mfma_f32_16x16x32_bf16 v[68:71], v[48:51], v[132:135], v[68:71]
    s_waitcnt lgkmcnt(0)
    v_mfma_f32_16x16x32_bf16 v[72:75], v[52:55], v[132:135], v[72:75]
    v_mov_b32 v23, 0xf149f2ca
    s_nop 6
    v_permlane32_swap_b32 v72, v74
    v_permlane32_swap_b32 v73, v75
    v_add_f32 v72, v72, v74
    v_add_f32 v73, v73, v75
    v_cndmask_b32 v64, v23, v64, s[64:65]
    v_cndmask_b32 v65, v23, v65, s[66:67]
    v_cndmask_b32 v66, v23, v66, s[68:69]
    v_cndmask_b32 v67, v23, v67, s[70:71]
    v_cndmask_b32 v68, v23, v68, s[72:73]
    v_cndmask_b32 v69, v23, v69, s[74:75]
    v_cndmask_b32 v70, v23, v70, s[76:77]
    v_cndmask_b32 v71, v23, v71, s[78:79]
    v_max3_f32 v20, v64, v65, v66
    v_max3_f32 v21, v67, v68, v69
    v_max3_f32 v20, v20, v70, v71
    v_max3_f32 v21, v21, v72, v73
    v_max_f32 v20, v20, v21
    v_mov_b32 v23, v20
    s_nop 1
    v_permlane32_swap_b32 v20, v23
    v_max_f32 v20, v20, v23
    v_mov_b32 v23, v20
    s_nop 1
    v_permlane16_swap_b32 v20, v23
    v_max_f32 v20, v20, v23
    v_mul_f32 v20, s44, v20
    v_fma_f32 v64, v64, s44, -v20
    v_fma_f32 v65, v65, s44, -v20
    v_fma_f32 v66, v66, s44, -v20
    v_fma_f32 v67, v67, s44, -v20
    v_fma_f32 v68, v68, s44, -v20
    v_fma_f32 v69, v69, s44, -v20
    v_fma_f32 v70, v70, s44, -v20
    v_fma_f32 v71, v71, s44, -v20
    v_fma_f32 v72, v72, s44, -v20
    v_fma_f32 v73, v73, s44, -v20
    v_exp_f32 v64, v64
    v_exp_f32 v65, v65
    v_exp_f32 v66, v66
    v_exp_f32 v67, v67
    v_exp_f32 v68, v68
    v_exp_f32 v69, v69
    v_exp_f32 v70, v70
    v_exp_f32 v71, v71
    v_exp_f32 v72, v72
    v_exp_f32 v73, v73
    v_add_f32 v21, v64, v65
    v_add_f32 v23, v66, v67
    v_add_f32 v21, v21, v68
    v_add_f32 v23, v23, v69
    v_add_f32 v21, v21, v70
    v_add_f32 v23, v23, v71
    v_add_f32 v21, v21, v72
    v_add_f32 v23, v23, v73
    v_add_f32 v21, v21, v23
    v_mov_b32 v23, v21
    s_nop 1
    v_permlane32_swap_b32 v21, v23
    v_add_f32 v21, v21, v23
    v_mov_b32 v23, v21
    s_nop 1
    v_permlane16_swap_b32 v21, v23
    v_add_f32 v21, v21, v23
    v_rcp_f32 v21, v21
    s_nop 0
    v_mul_f32 v64, v64, v21
    v_mul_f32 v65, v65, v21
    v_mul_f32 v66, v66, v21
    v_mul_f32 v67, v67, v21
    v_mul_f32 v68, v68, v21
    v_mul_f32 v69, v69, v21
    v_mul_f32 v70, v70, v21
    v_mul_f32 v71, v71, v21
    v_mul_f32 v72, v72, v21
    v_mul_f32 v73, v73, v21
    v_cvt_pk_bf16_f32 v76, v64, v65
    v_cvt_pk_bf16_f32 v77, v66, v67
    v_cvt_pk_bf16_f32 v78, v68, v69
    v_cvt_pk_bf16_f32 v79, v70, v71
    v_cvt_pk_bf16_f32 v80, v72, v73
    buffer_store_dwordx4 v[76:79], v17, s[8:11], s51 offen sc1
    buffer_store_dword v80, v18, s[8:11], s51 offen sc1
    s_add_u32 s50, s50, 393216
    s_add_u32 s51, s51, 81920
    s_add_u32 s58, s61, 1
    s_min_u32 s58, s58, 63
    s_cmp_gt_u32 s57, s58
    s_cbranch_scc1 Lfok_22
    s_mov_b32 s31, 0
Lfpl_23:
    buffer_load_dwordx4 v[20:23], v10, s[8:11], s56 offen sc1
    s_add_u32 s31, s31, 1
    s_cmp_gt_u32 s31, 400000
    s_cbranch_scc1 L_abort
    s_waitcnt vmcnt(0)
    v_min3_u32 v20, v20, v21, v22
    s_nop 0
    v_readfirstlane_b32 s57, v20
    s_nop 0
    s_cmp_le_u32 s57, s61
    s_nop 1
    s_cbranch_scc1 Lfpl_23
Lfok_22:
    s_mov_b32 s45, s46
    s_add_u32 s61, s61, 1
    s_cmp_lg_u32 s61, 8
    s_cbranch_scc1 Lswm_24
    s_mov_b32 s31, 0
Lwa_25:
    v_lshlrev_b32 v21, 2, v1
    buffer_load_dword v20, v21, s[24:27], 0 offen offset:192 sc1
    s_add_u32 s31, s31, 1
    s_cmp_gt_u32 s31, 400000
    s_cbranch_scc1 L_abort
    s_sleep 2
    s_waitcnt vmcnt(0)
    v_readfirstlane_b32 s30, v20
    s_nop 0
    s_cmp_lt_u32 s30, 3
    s_nop 1
    s_cbranch_scc1 Lwa_25
    v_readlane_b32 s60, v20, 4
    v_readlane_b32 s7, v20, 5
    v_readlane_b32 s28, v20, 6
    s_nop 4
Lswm_24:
    s_lshr_b32 s37, s61, 1
    s_bitcmp1_b32 s7, s37
    s_cselect_b32 s38, 16384, 0
    s_bitcmp1_b32 s28, s37
    s_cselect_b32 s62, 4096, 0
    s_or_b32 s38, s38, s62
    s_lshl_b32 s62, s37, 21
    s_lshr_b32 s37, s60, s37
    s_and_b32 s37, s37, 1
    s_lshl_b32 s37, s37, 13
    s_add_u32 s62, s62, s37
    s_and_b32 s37, s61, 1
    s_lshl_b32 s37, s37, 15
    s_add_u32 s62, s62, s37
    s_xor_b32 s37, s38, s29
    s_mov_b32 s29, s38
    v_xor_b32 v2, s37, v2
    v_xor_b32 v3, s37, v3
    v_xor_b32 v4, s37, v4
    s_cmp_lt_u32 s61, 64
    s_cbranch_scc1 L_c_x_loop2
    s_waitcnt vmcnt(0)
    s_barrier
    s_cmp_lg_u32 s3, 0
    s_cbranch_scc1 L_end
    v_mov_b32 v20, 64
    v_lshlrev_b32 v21, 2, v1
    s_lshl_b32 s30, s2, 7
    s_add_u32 s30, s30, 246415360
    s_mov_b64 exec, 0xffffffff
    buffer_store_dword v20, v21, s[8:11], s30 offen sc1
    s_branch L_end
L_c_x3:
L_c_x_loop3:
    s_cmp_gt_u32 s57, s61
    s_cselect_b32 s49, s50, 2146435072
    v_mov_b32 v64, 0
    v_mov_b32 v65, 0
    v_mov_b32 v66, 0
    v_mov_b32 v67, 0
    v_mov_b32 v68, 0
    v_mov_b32 v69, 0
    v_mov_b32 v70, 0
    v_mov_b32 v71, 0
    v_mov_b32 v72, 0
    v_mov_b32 v73, 0
    v_mov_b32 v74, 0
    v_mov_b32 v75, 0
    v_mov_b32 v76, 0
    v_mov_b32 v77, 0
    v_mov_b32 v78, 0
    v_mov_b32 v79, 0
    v_mov_b32 v80, 0
    v_mov_b32 v81, 0
    v_mov_b32 v82, 0
    v_mov_b32 v83, 0
    v_mov_b32 v84, 0
    v_mov_b32 v85, 0
    v_mov_b32 v86, 0
    v_mov_b32 v87, 0
    v_mov_b32 v116, 0
    v_mov_b32 v117, 0
    v_mov_b32 v120, 0
    v_mov_b32 v121, 0
    ds_read_b128 v[88:91], v7 offset:4096
    ds_read_b128 v[92:95], v7 offset:5120
    ds_read_b128 v[96:99], v7 offset:8192
    ds_read_b128 v[100:103], v7 offset:9216
    ds_read_b128 v[104:107], v7 offset:0
    ds_read_b128 v[108:111], v7 offset:1024
    s_lshl_b32 s30, s3, 10
    s_add_u32 s31, s30, s45
    v_lshl_add_u32 v14, v1, 4, s31
    s_lshr_b32 s31, s3, 1
    s_lshl_b32 s31, s31, 10
    s_add_u32 s31, s31, s45
    s_and_b32 s32, s3, 1
    s_lshl_b32 s32, s32, 3
    s_add_u32 s31, s31, s32
    v_lshl_add_u32 v132, v1, 4, s31
    s_xor_b32 s46, s45, 258048
    s_add_u32 s31, s30, s46
    v_lshl_add_u32 v142, v1, 4, s31
    s_mov_b32 s31, 0
    s_waitcnt lgkmcnt(0)
    s_cmp_eq_u32 s61, 0
    s_cbranch_scc1 Lnp_28
    s_sleep 4
Lnp_28:
Lgm_27:
    buffer_load_dwordx4 v[36:39], v2, s[8:11], s62 offen sc1
    buffer_load_dwordx4 v[52:55], v3, s[8:11], s62 offen sc1
    buffer_load_dwordx2 v[60:61], v4, s[8:11], s62 offen sc1
    s_add_u32 s31, s31, 1
    s_cmp_gt_u32 s31, 400000
    s_cbranch_scc1 L_abort
    s_waitcnt vmcnt(2)
    ds_write_b128 v5, v[36:39]
    v_max3_u32 v20, v36, v37, v38
    s_waitcnt vmcnt(1)
    ds_write_b128 v5, v[52:55] offset:4096
    v_max3_u32 v21, v39, v52, v53
    v_max3_u32 v20, v20, v54, v55
    s_waitcnt vmcnt(0)
    ds_write_b64 v6, v[60:61]
    v_max3_u32 v21, v21, v60, v61
    v_max_u32 v20, v20, v21
    v_cmp_eq_u32 vcc, -1, v20
    s_cbranch_vccnz Lgm_27
    v_smfmac_f32_16x16x64_bf16 v[64:67], v[36:39], a[56:63], v9
    v_smfmac_f32_16x16x64_bf16 v[68:71], v[36:39], v[88:95], v9
    s_waitcnt lgkmcnt(0)
    s_barrier
    ds_read_b128 v[24:27], v8 offset:0
    ds_read_b128 v[28:31], v8 offset:1024
    v_smfmac_f32_16x16x64_bf16 v[72:75], v[36:39], a[64:71], v9
    ds_read_b128 v[32:35], v8 offset:2048
    ds_read_b128 v[40:43], v8 offset:4096
    v_smfmac_f32_16x16x64_bf16 v[64:67], v[52:55], a[136:143], v9
    ds_read_b128 v[44:47], v8 offset:5120
    ds_read_b128 v[48:51], v8 offset:6144
    v_smfmac_f32_16x16x64_bf16 v[68:71], v[52:55], v[96:103], v9
    ds_read_b128 v[56:59], v8 offset:8192
    ds_read_b128 v[60:63], v8 offset:9216
    v_smfmac_f32_16x16x64_bf16 v[72:75], v[52:55], a[144:151], v9
    buffer_load_dword v22, v143, s[8:11], s49 offen sc1
    s_waitcnt lgkmcnt(7)
    v_smfmac_f32_16x16x64_bf16 v[64:67], v[24:27], a[0:7], v9
    ds_read_b128 v[88:91], v7 offset:2048
    v_smfmac_f32_16x16x64_bf16 v[68:71], v[24:27], v[104:111], v9
    ds_read_b128 v[92:95], v7 offset:3072
    v_smfmac_f32_16x16x64_bf16 v[72:75], v[24:27], a[8:15], v9
    ds_read_b128 v[96:99], v7 offset:6144
    s_waitcnt lgkmcnt(9)
    v_smfmac_f32_16x16x64_bf16 v[64:67], v[28:31], a[16:23], v9
    ds_read_b128 v[100:103], v7 offset:7168
    v_smfmac_f32_16x16x64_bf16 v[68:71], v[28:31], a[24:31], v9
    ds_read_b128 v[104:107], v7 offset:10240
    v_smfmac_f32_16x16x64_bf16 v[72:75], v[28:31], a[32:39], v9
    ds_read_b128 v[108:111], v7 offset:11264
    s_waitcnt lgkmcnt(11)
    v_smfmac_f32_16x16x64_bf16 v[64:67], v[32:35], a[40:47], v9
    ds_read_b128 v[124:127], v14
    s_waitcnt lgkmcnt(5)
    v_smfmac_f32_16x16x64_bf16 v[68:71], v[32:35], v[88:95], v9
    ds_read_b128 v[128:131], v14 offset:6144
    v_smfmac_f32_16x16x64_bf16 v[72:75], v[32:35], a[48:55], v9
    ds_read2st64_b64 v[132:135], v132 offset0:8 offset1:20
    v_smfmac_f32_16x16x64_bf16 v[64:67], v[40:43], a[72:79], v9
    ds_read_b128 v[88:91], v7 offset:12288
    v_smfmac_f32_16x16x64_bf16 v[68:71], v[40:43], a[80:87], v9
    ds_read_b128 v[92:95], v7 offset:13312
    v_smfmac_f32_16x16x64_bf16 v[72:75], v[40:43], a[88:95], v9
    v_smfmac_f32_16x16x64_bf16 v[64:67], v[44:47], a[96:103], v9
    s_waitcnt lgkmcnt(7)
    v_smfmac_f32_16x16x64_bf16 v[68:71], v[44:47], v[96:103], v9
    ds_read_b128 v[96:99], v7 offset:14336
    v_smfmac_f32_16x16x64_bf16 v[72:75], v[44:47], a[104:111], v9
    ds_read_b128 v[100:103], v7 offset:15360
    v_smfmac_f32_16x16x64_bf16 v[64:67], v[48:51], a[112:119], v9
    v_smfmac_f32_16x16x64_bf16 v[68:71], v[48:51], a[120:127], v9
    v_smfmac_f32_16x16x64_bf16 v[72:75], v[48:51], a[128:135], v9
    v_smfmac_f32_16x16x64_bf16 v[64:67], v[56:59], a[152:159], v9
    v_smfmac_f32_16x16x64_bf16 v[64:67], v[60:63], a[160:167], v9
    s_waitcnt lgkmcnt(7)
    v_smfmac_f32_16x16x64_bf16 v[68:71], v[56:59], v[104:111], v9
    ds_read_b128 v[104:107], v7 offset:16384
    v_smfmac_f32_16x16x64_bf16 v[68:71], v[60:63], a[168:175], v9
    ds_read_b128 v[108:111], v7 offset:17408
    v_smfmac_f32_16x16x64_bf16 v[72:75], v[56:59], a[176:183], v9
    s_nop 1
    v_cvt_pk_bf16_f32 v64, v64, v65
    v_smfmac_f32_16x16x64_bf16 v[72:75], v[60:63], a[184:191], v9
    s_waitcnt lgkmcnt(4)
    v_cvt_pk_bf16_f32 v65, v66, v67
    v_smfmac_f32_16x16x64_bf16 v[76:79], v[24:27], v[88:95], v9
    ds_write_b64 v11, v[64:65] offset:0
    v_cvt_pk_bf16_f32 v68, v68, v69
    v_smfmac_f32_16x16x64_bf16 v[76:79], v[28:31], a[192:199], v9
    ds_read_b128 v[88:91], v7 offset:18432
    v_cvt_pk_bf16_f32 v69, v70, v71
    v_smfmac_f32_16x16x64_bf16 v[76:79], v[32:35], a[200:207], v9
    ds_write_b64 v11, v[68:69] offset:512
    v_cvt_pk_bf16_f32 v72, v72, v73
    v_smfmac_f32_16x16x64_bf16 v[76:79], v[36:39], a[208:215], v9
    ds_read_b128 v[92:95], v7 offset:19456
    s_waitcnt lgkmcnt(6)
    v_cvt_pk_bf16_f32 v73, v74, v75
    v_smfmac_f32_16x16x64_bf16 v[76:79], v[40:43], v[96:103], v9
    ds_write_b64 v12, v[72:73] offset:0
    v_smfmac_f32_16x16x64_bf16 v[76:79], v[44:47], a[216:223], v9
    ds_read_b64_tr_b16 v[112:113], v140
    ds_read_b64_tr_b16 v[114:115], v140 offset:512
    v_smfmac_f32_16x16x64_bf16 v[76:79], v[48:51], a[224:231], v9
    ds_read_b64_tr_b16 v[118:119], v141 offset:4096
    v_smfmac_f32_16x16x64_bf16 v[76:79], v[52:55], a[232:239], v9
    ds_read_b128 v[96:99], v7 offset:20480
    s_waitcnt lgkmcnt(9)
    v_smfmac_f32_16x16x64_bf16 v[76:79], v[56:59], v[104:111], v9
    ds_read_b128 v[100:103], v7 offset:21504
    v_smfmac_f32_16x16x64_bf16 v[76:79], v[60:63], a[240:247], v9
    ds_read_b128 v[104:107], v7 offset:22528
    v_smfmac_f32_16x16x64_bf16 v[80:83], v[24:27], a[248:255], v9
    s_waitcnt lgkmcnt(6)
    s_barrier
    v_smfmac_f32_16x16x64_bf16 v[80:83], v[28:31], v[144:151], v9
    s_waitcnt lgkmcnt(4)
    v_mfma_f32_16x16x32_bf16 v[64:67], v[124:127], v[112:115], 0
    v_mfma_f32_16x16x32_bf16 v[68:71], v[128:131], v[112:115], 0
    s_waitcnt lgkmcnt(3)
    v_cvt_pk_bf16_f32 v76, v76, v77
    v_mfma_f32_16x16x32_bf16 v[64:67], v[132:135], v[118:121], v[64:67]
    v_cvt_pk_bf16_f32 v77, v78, v79
    v_mfma_f32_16x16x32_bf16 v[68:71], v[132:135], v[116:119], v[68:71]
    v_smfmac_f32_16x16x64_bf16 v[80:83], v[32:35], v[88:95], v9
    ds_write_b64 v11, v[76:77] offset:6144
    v_smfmac_f32_16x16x64_bf16 v[80:83], v[36:39], v[152:159], v9
    ds_read_b128 v[108:111], v7 offset:23552
    v_smfmac_f32_16x16x64_bf16 v[80:83], v[40:43], v[160:167], v9
    ds_read_b128 v[88:91], v7 offset:24576
    v_add_f32_dpp v136, v64, v64 row_ror:8 row_mask:0xf bank_mask:0x3
    v_smfmac_f32_16x16x64_bf16 v[80:83], v[44:47], v[168:175], v9
    ds_read_b128 v[92:95], v7 offset:25600
    s_waitcnt lgkmcnt(5)
    v_add_f32_dpp v137, v65, v65 row_ror:8 row_mask:0xf bank_mask:0x3
    v_smfmac_f32_16x16x64_bf16 v[80:83], v[48:51], v[96:103], v9
    ds_read_b128 v[96:99], v7 offset:26624
    v_add_f32_dpp v138, v68, v68 row_ror:8 row_mask:0xf bank_mask:0x3
    v_smfmac_f32_16x16x64_bf16 v[80:83], v[52:55], v[176:183], v9
    ds_read_b128 v[100:103], v7 offset:27648
    v_add_f32_dpp v139, v69, v69 row_ror:8 row_mask:0xf bank_mask:0x3
    v_smfmac_f32_16x16x64_bf16 v[80:83], v[56:59], v[184:191], v9
    v_add_f32_dpp v136, v66, v66 row_ror:8 row_mask:0xf bank_mask:0xc
    v_smfmac_f32_16x16x64_bf16 v[80:83], v[60:63], v[192:199], v9
    s_waitcnt lgkmcnt(4)
    v_add_f32_dpp v137, v67, v67 row_ror:8 row_mask:0xf bank_mask:0xc
    v_smfmac_f32_16x16x64_bf16 v[84:87], v[24:27], v[104:111], v9
    v_add_f32_dpp v138, v70, v70 row_ror:8 row_mask:0xf bank_mask:0xc
    v_smfmac_f32_16x16x64_bf16 v[84:87], v[28:31], v[200:207], v9
    v_add_f32_dpp v139, v71, v71 row_ror:8 row_mask:0xf bank_mask:0xc
    v_smfmac_f32_16x16x64_bf16 v[84:87], v[32:35], v[208:215], v9
    ds_write_b128 v142, v[136:139]
    v_cvt_pk_bf16_f32 v80, v80, v81
    v_smfmac_f32_16x16x64_bf16 v[84:87], v[36:39], v[216:223], v9
    s_waitcnt lgkmcnt(3)
    v_cvt_pk_bf16_f32 v81, v82, v83
    v_smfmac_f32_16x16x64_bf16 v[84:87], v[40:43], v[88:95], v9
    ds_write_b64 v11, v[80:81] offset:6656
    v_smfmac_f32_16x16x64_bf16 v[84:87], v[44:47], v[224:231], v9
    v_smfmac_f32_16x16x64_bf16 v[84:87], v[48:51], v[232:239], v9
    v_smfmac_f32_16x16x64_bf16 v[84:87], v[52:55], v[240:247], v9
    s_waitcnt lgkmcnt(2)
    v_smfmac_f32_16x16x64_bf16 v[84:87], v[56:59], v[96:103], v9
    s_waitcnt lgkmcnt(0)
    s_barrier
    v_smfmac_f32_16x16x64_bf16 v[84:87], v[60:63], v[248:255], v9
    s_nop 7
    v_cvt_pk_bf16_f32 v84, v84, v85
    v_cvt_pk_bf16_f32 v85, v86, v87
    ds_write_b64 v12, v[84:85] offset:6144
    s_waitcnt lgkmcnt(0)
    s_barrier
    s_waitcnt vmcnt(0)
    s_cmp_gt_u32 s57, s61
    s_cbranch_scc1 Lfok_29
    s_mov_b32 s31, 0
Lfpl_30:
    buffer_load_dwordx4 v[20:23], v10, s[8:11], s56 offen sc1
    s_add_u32 s31, s31, 1
    s_cmp_gt_u32 s31, 400000
    s_cbranch_scc1 L_abort
    s_waitcnt vmcnt(0)
    v_min3_u32 v20, v20, v21, v22
    s_nop 0
    v_readfirstlane_b32 s57, v20
    s_nop 0
    s_cmp_le_u32 s57, s61
    s_nop 1
    s_cbranch_scc1 Lfpl_30
Lfok_29:
    buffer_load_dwordx4 v[112:115], v15, s[8:11], s50 offen offset:0 sc1
    buffer_load_dwordx4 v[116:119], v15, s[8:11], s50 offen offset:1024 sc1
    buffer_load_dwordx4 v[120:123], v15, s[8:11], s50 offen offset:2048 sc1
    buffer_load_dwordx4 v[124:127], v15, s[8:11], s50 offen offset:3072 sc1
    buffer_load_dwordx4 v[128:131], v16, s[8:11], s50 offen offset:0 sc1
    buffer_load_dwordx4 v[132:135], v16, s[8:11], s50 offen offset:1024 sc1
    v_lshl_add_u32 v20, v1, 4, s45
    ds_read_b128 v[24:27], v20 offset:0
    ds_read_b128 v[28:31], v20 offset:6144
    ds_read_b64_tr_b16 v[32:33], v13 offset:6144
    ds_read_b64_tr_b16 v[34:35], v13 offset:6656
    ds_read_b128 v[36:39], v20 offset:1024
    ds_read_b128 v[40:43], v20 offset:7168
    ds_read_b64_tr_b16 v[44:45], v13 offset:7168
    ds_read_b64_tr_b16 v[46:47], v13 offset:7680
    ds_read_b128 v[48:51], v20 offset:2048
    ds_read_b128 v[52:55], v20 offset:8192
    ds_read_b64_tr_b16 v[56:57], v13 offset:8192
    ds_read_b64_tr_b16 v[58:59], v13 offset:8704
    s_waitcnt vmcnt(5) lgkmcnt(11)
    v_mfma_f32_16x16x32_bf16 v[64:67], v[24:27], v[112:115], 0
    ds_read_b128 v[60:63], v20 offset:3072
    s_waitcnt lgkmcnt(11)
    v_mfma_f32_16x16x32_bf16 v[68:71], v[28:31], v[112:115], 0
    ds_read_b128 v[24:27], v20 offset:9216
    s_waitcnt lgkmcnt(10)
    v_mfma_f32_16x16x32_bf16 v[72:75], v[32:35], v[112:115], 0
    ds_read_b64_tr_b16 v[28:29], v13 offset:9216
    ds_read_b64_tr_b16 v[30:31], v13 offset:9728
    s_waitcnt vmcnt(4) lgkmcnt(11)
    v_mfma_f32_16x16x32_bf16 v[64:67], v[36:39], v[116:119], v[64:67]
    ds_read_b128 v[32:35], v20 offset:4096
    s_waitcnt lgkmcnt(11)
    v_mfma_f32_16x16x32_bf16 v[68:71], v[40:43], v[116:119], v[68:71]
    ds_read_b128 v[36:39], v20 offset:10240
    s_waitcnt lgkmcnt(10)
    v_mfma_f32_16x16x32_bf16 v[72:75], v[44:47], v[116:119], v[72:75]
    ds_read_b64_tr_b16 v[40:41], v13 offset:10240
    ds_read_b64_tr_b16 v[42:43], v13 offset:10752
    s_waitcnt vmcnt(3) lgkmcnt(11)
    v_mfma_f32_16x16x32_bf16 v[64:67], v[48:51], v[120:123], v[64:67]
    ds_read_b128 v[44:47], v20 offset:5120
    s_waitcnt lgkmcnt(11)
    v_mfma_f32_16x16x32_bf16 v[68:71], v[52:55], v[120:123], v[68:71]
    ds_read_b128 v[48:51], v20 offset:11264
    s_waitcnt lgkmcnt(10)
    v_mfma_f32_16x16x32_bf16 v[72:75], v[56:59], v[120:123], v[72:75]
    ds_read_b64_tr_b16 v[52:53], v13 offset:11264
    ds_read_b64_tr_b16 v[54:55], v13 offset:11776
    s_waitcnt vmcnt(2) lgkmcnt(11)
    v_mfma_f32_16x16x32_bf16 v[64:67], v[60:63], v[124:127], v[64:67]
    s_waitcnt lgkmcnt(10)
    v_mfma_f32_16x16x32_bf16 v[68:71], v[24:27], v[124:127], v[68:71]
    s_waitcnt lgkmcnt(8)
    v_mfma_f32_16x16x32_bf16 v[72:75], v[28:31], v[124:127], v[72:75]
    s_waitcnt vmcnt(1) lgkmcnt(7)
    v_mfma_f32_16x16x32_bf16 v[64:67], v[32:35], v[128:131], v[64:67]
    s_waitcnt lgkmcnt(6)
    v_mfma_f32_16x16x32_bf16 v[68:71], v[36:39], v[128:131], v[68:71]
    s_waitcnt lgkmcnt(4)
    v_mfma_f32_16x16x32_bf16 v[72:75], v[40:43], v[128:131], v[72:75]
    s_waitcnt vmcnt(0) lgkmcnt(3)
    v_mfma_f32_16x16x32_bf16 v[64:67], v[44:47], v[132:135], v[64:67]
    s_waitcnt lgkmcnt(2)
    v_mfma_f32_16x16x32_bf16 v[68:71], v[48:51], v[132:135], v[68:71]
    s_waitcnt lgkmcnt(0)
    v_mfma_f32_16x16x32_bf16 v[72:75], v[52:55], v[132:135], v[72:75]
    v_mov_b32 v23, 0xf149f2ca
    s_nop 6
    v_permlane32_swap_b32 v72, v74
    v_permlane32_swap_b32 v73, v75
    v_add_f32 v72, v72, v74
    v_add_f32 v73, v73, v75
    v_cndmask_b32 v64, v23, v64, s[64:65]
    v_cndmask_b32 v65, v23, v65, s[66:67]
    v_cndmask_b32 v66, v23, v66, s[68:69]
    v_cndmask_b32 v67, v23, v67, s[70:71]
    v_cndmask_b32 v68, v23, v68, s[72:73]
    v_cndmask_b32 v69, v23, v69, s[74:75]
    v_cndmask_b32 v70, v23, v70, s[76:77]
    v_cndmask_b32 v71, v23, v71, s[78:79]
    v_max3_f32 v20, v64, v65, v66
    v_max3_f32 v21, v67, v68, v69
    v_max3_f32 v20, v20, v70, v71
    v_max3_f32 v21, v21, v72, v73
    v_max_f32 v20, v20, v21
    v_mov_b32 v23, v20
    s_nop 1
    v_permlane32_swap_b32 v20, v23
    v_max_f32 v20, v20, v23
    v_mov_b32 v23, v20
    s_nop 1
    v_permlane16_swap_b32 v20, v23
    v_max_f32 v20, v20, v23
    v_mul_f32 v20, s44, v20
    v_fma_f32 v64, v64, s44, -v20
    v_fma_f32 v65, v65, s44, -v20
    v_fma_f32 v66, v66, s44, -v20
    v_fma_f32 v67, v67, s44, -v20
    v_fma_f32 v68, v68, s44, -v20
    v_fma_f32 v69, v69, s44, -v20
    v_fma_f32 v70, v70, s44, -v20
    v_fma_f32 v71, v71, s44, -v20
    v_fma_f32 v72, v72, s44, -v20
    v_fma_f32 v73, v73, s44, -v20
    v_exp_f32 v64, v64
    v_exp_f32 v65, v65
    v_exp_f32 v66, v66
    v_exp_f32 v67, v67
    v_exp_f32 v68, v68
    v_exp_f32 v69, v69
    v_exp_f32 v70, v70
    v_exp_f32 v71, v71
    v_exp_f32 v72, v72
    v_exp_f32 v73, v73
    v_add_f32 v21, v64, v65
    v_add_f32 v23, v66, v67
    v_add_f32 v21, v21, v68
    v_add_f32 v23, v23, v69
    v_add_f32 v21, v21, v70
    v_add_f32 v23, v23, v71
    v_add_f32 v21, v21, v72
    v_add_f32 v23, v23, v73
    v_add_f32 v21, v21, v23
    v_mov_b32 v23, v21
    s_nop 1
    v_permlane32_swap_b32 v21, v23
    v_add_f32 v21, v21, v23
    v_mov_b32 v23, v21
    s_nop 1
    v_permlane16_swap_b32 v21, v23
    v_add_f32 v21, v21, v23
    v_rcp_f32 v21, v21
    s_nop 0
    v_mul_f32 v64, v64, v21
    v_mul_f32 v65, v65, v21
    v_mul_f32 v66, v66, v21
    v_mul_f32 v67, v67, v21
    v_mul_f32 v68, v68, v21
    v_mul_f32 v69, v69, v21
    v_mul_f32 v70, v70, v21
    v_mul_f32 v71, v71, v21
    v_mul_f32 v72, v72, v21
    v_mul_f32 v73, v73, v21
    v_cvt_pk_bf16_f32 v76, v64, v65
    v_cvt_pk_bf16_f32 v77, v66, v67
    v_cvt_pk_bf16_f32 v78, v68, v69
    v_cvt_pk_bf16_f32 v79, v70, v71
    v_cvt_pk_bf16_f32 v80, v72, v73
    buffer_store_dwordx4 v[76:79], v17, s[8:11], s51 offen sc1
    buffer_store_dword v80, v18, s[8:11], s51 offen sc1
    s_add_u32 s50, s50, 393216
    s_add_u32 s51, s51, 81920
    s_add_u32 s58, s61, 1
    s_min_u32 s58, s58, 63
    s_cmp_gt_u32 s57, s58
    s_cbranch_scc1 Lfok_31
    s_mov_b32 s31, 0
Lfpl_32:
    buffer_load_dwordx4 v[20:23], v10, s[8:11], s56 offen sc1
    s_add_u32 s31, s31, 1
    s_cmp_gt_u32 s31, 400000
    s_cbranch_scc1 L_abort
    s_waitcnt vmcnt(0)
    v_min3_u32 v20, v20, v21, v22
    s_nop 0
    v_readfirstlane_b32 s57, v20
    s_nop 0
    s_cmp_le_u32 s57, s61
    s_nop 1
    s_cbranch_scc1 Lfpl_32
Lfok_31:
    s_mov_b32 s45, s46
    s_add_u32 s61, s61, 1
    s_cmp_lg_u32 s61, 8
    s_cbranch_scc1 Lswm_33
    s_mov_b32 s31, 0
Lwa_34:
    v_lshlrev_b32 v21, 2, v1
    buffer_load_dword v20, v21, s[24:27], 0 offen offset:192 sc1
    s_add_u32 s31, s31, 1
    s_cmp_gt_u32 s31, 400000
    s_cbranch_scc1 L_abort
    s_sleep 2
    s_waitcnt vmcnt(0)
    v_readfirstlane_b32 s30, v20
    s_nop 0
    s_cmp_lt_u32 s30, 3
    s_nop 1
    s_cbranch_scc1 Lwa_34
    v_readlane_b32 s60, v20, 4
    v_readlane_b32 s7, v20, 5
    v_readlane_b32 s28, v20, 6
    s_nop 4
Lswm_33:
    s_lshr_b32 s37, s61, 1
    s_bitcmp1_b32 s7, s37
    s_cselect_b32 s38, 16384, 0
    s_bitcmp1_b32 s28, s37
    s_cselect_b32 s62, 4096, 0
    s_or_b32 s38, s38, s62
    s_lshl_b32 s62, s37, 21
    s_lshr_b32 s37, s60, s37
    s_and_b32 s37, s37, 1
    s_lshl_b32 s37, s37, 13
    s_add_u32 s62, s62, s37
    s_and_b32 s37, s61, 1
    s_lshl_b32 s37, s37, 15
    s_add_u32 s62, s62, s37
    s_xor_b32 s37, s38, s29
    s_mov_b32 s29, s38
    v_xor_b32 v2, s37, v2
    v_xor_b32 v3, s37, v3
    v_xor_b32 v4, s37, v4
    s_cmp_lt_u32 s61, 64
    s_cbranch_scc1 L_c_x_loop3
    s_waitcnt vmcnt(0)
    s_barrier
    s_cmp_lg_u32 s3, 0
    s_cbranch_scc1 L_end
    v_mov_b32 v20, 64
    v_lshlrev_b32 v21, 2, v1
    s_lshl_b32 s30, s2, 7
    s_add_u32 s30, s30, 246415360
    s_mov_b64 exec, 0xffffffff
    buffer_store_dword v20, v21, s[8:11], s30 offen sc1
    s_branch L_end
.p2align 6
L_role_b:
    s_sub_u32 s4, s2, 32
    s_load_dwordx2 s[12:13], s[0:1], 32
    s_mov_b32 s14, 7864320
    s_mov_b32 s15, 0x20000
    s_load_dwordx2 s[16:17], s[0:1], 40
    s_mov_b32 s18, 7864320
    s_mov_b32 s19, 0x20000
    s_waitcnt lgkmcnt(0)
    s_cmp_lg_u32 s3, 0
    s_cbranch_scc1 Lar0_36
    v_mov_b32 v18, 0
    v_lshlrev_b32 v19, 2, v1
    s_lshl_b32 s30, s2, 7
    s_add_u32 s30, s30, 246415360
    s_mov_b64 exec, 0xffffffff
    buffer_store_dword v18, v19, s[8:11], s30 offen sc1
    s_mov_b64 exec, -1
    s_waitcnt vmcnt(0)
    s_cmp_eq_u32 s3, 0
    s_cselect_b32 s30, 0, 2146435072
    v_mov_b32 v18, 0
    v_mov_b32 v19, 1
    s_mov_b64 exec, 1
    buffer_atomic_add v19, v18, s[24:27], s30 offen sc1
    s_mov_b64 exec, -1
Lar0_36:
    s_mov_b32 s61, 0
    s_mul_i32 s41, s4, 384
    s_mul_i32 s42, s4, 245760
    s_lshr_b32 s30, s3, 1
    s_and_b32 s31, s3, 1
    s_lshl_b32 s30, s30, 4
    s_lshl_b32 s31, s31, 2
    s_add_u32 s30, s30, s31
    s_mov_b32 s32, 12288
    v_add_u32 v2, 0, v1
    v_mul_u32_u24 v3, 2731, v2
    v_lshrrev_b32 v3, 16, v3
    v_mul_u32_u24 v4, 24, v3
    v_sub_u32 v2, v2, v4
    v_lshrrev_b32 v4, 1, v3
    v_lshlrev_b32 v4, 1, v4
    v_xor_b32 v2, v2, v4
    v_and_b32 v4, 4, v3
    v_add_u32 v3, v3, v4
    v_add_u32 v3, s30, v3
    v_mul_lo_u32 v3, v3, s32
    v_lshl_add_u32 v6, v2, 4, v3
    v_add_u32 v2, 64, v1
    v_mul_u32_u24 v3, 2731, v2
    v_lshrrev_b32 v3, 16, v3
    v_mul_u32_u24 v4, 24, v3
    v_sub_u32 v2, v2, v4
    v_lshrrev_b32 v4, 1, v3
    v_lshlrev_b32 v4, 1, v4
    v_xor_b32 v2, v2, v4
    v_and_b32 v4, 4, v3
    v_add_u32 v3, v3, v4
    v_add_u32 v3, s30, v3
    v_mul_lo_u32 v3, v3, s32
    v_lshl_add_u32 v7, v2, 4, v3
    v_add_u32 v2, 128, v1
    v_mul_u32_u24 v3, 2731, v2
    v_lshrrev_b32 v3, 16, v3
    v_mul_u32_u24 v4, 24, v3
    v_sub_u32 v2, v2, v4
    v_lshrrev_b32 v4, 1, v3
    v_lshlrev_b32 v4, 1, v4
    v_xor_b32 v2, v2, v4
    v_and_b32 v4, 4, v3
    v_add_u32 v3, v3, v4
    v_add_u32 v3, s30, v3
    v_mul_lo_u32 v3, v3, s32
    v_lshl_add_u32 v8, v2, 4, v3
    v_bfe_u32 v2, v1, 2, 3
    v_lshrrev_b32 v10, 1, v2
    v_mul_u32_u24 v9, 384, v2
    v_lshrrev_b32 v2, 5, v1
    v_mul_u32_u24 v2, 6144, v2
    v_add_u32 v9, v9, v2
    v_and_b32 v2, 3, v1
    v_lshl_add_u32 v9, v2, 3, v9
    s_lshr_b32 s30, s3, 1
    s_and_b32 s31, s3, 1
    s_lshl_b32 s30, s30, 3
    s_lshl_b32 s31, s31, 4
    s_add_u32 s30, s30, s31
    s_mov_b32 s32, 1280
    v_add_u32 v2, 0, v1
    v_mul_u32_u24 v3, 820, v2
    v_lshrrev_b32 v3, 16, v3
    v_mul_u32_u24 v4, 80, v3
    v_sub_u32 v2, v2, v4
    v_lshrrev_b32 v4, 0, v3
    v_lshlrev_b32 v4, 1, v4
    v_xor_b32 v2, v2, v4
    v_add_u32 v3, s30, v3
    v_mul_lo_u32 v3, v3, s32
    v_lshl_add_u32 v11, v2, 4, v3
    v_add_u32 v2, 64, v1
    v_mul_u32_u24 v3, 820, v2
    v_lshrrev_b32 v3, 16, v3
    v_mul_u32_u24 v4, 80, v3
    v_sub_u32 v2, v2, v4
    v_lshrrev_b32 v4, 0, v3
    v_lshlrev_b32 v4, 1, v4
    v_xor_b32 v2, v2, v4
    v_add_u32 v3, s30, v3
    v_mul_lo_u32 v3, v3, s32
    v_lshl_add_u32 v12, v2, 4, v3
    v_add_u32 v2, 128, v1
    v_mul_u32_u24 v3, 820, v2
    v_lshrrev_b32 v3, 16, v3
    v_mul_u32_u24 v4, 80, v3
    v_sub_u32 v2, v2, v4
    v_lshrrev_b32 v4, 0, v3
    v_lshlrev_b32 v4, 1, v4
    v_xor_b32 v2, v2, v4
    v_add_u32 v3, s30, v3
    v_mul_lo_u32 v3, v3, s32
    v_lshl_add_u32 v13, v2, 4, v3
    v_add_u32 v2, 192, v1
    v_mul_u32_u24 v3, 820, v2
    v_lshrrev_b32 v3, 16, v3
    v_mul_u32_u24 v4, 80, v3
    v_sub_u32 v2, v2, v4
    v_lshrrev_b32 v4, 0, v3
    v_lshlrev_b32 v4, 1, v4
    v_xor_b32 v2, v2, v4
    v_add_u32 v3, s30, v3
    v_mul_lo_u32 v3, v3, s32
    v_lshl_add_u32 v14, v2, 4, v3
    v_add_u32 v2, 256, v1
    v_mul_u32_u24 v3, 820, v2
    v_lshrrev_b32 v3, 16, v3
    v_mul_u32_u24 v4, 80, v3
    v_sub_u32 v2, v2, v4
    v_lshrrev_b32 v4, 0, v3
    v_lshlrev_b32 v4, 1, v4
    v_xor_b32 v2, v2, v4
    v_add_u32 v3, s30, v3
    v_mul_lo_u32 v3, v3, s32
    v_lshl_add_u32 v15, v2, 4, v3
    v_add_u32 v2, 320, v1
    v_mul_u32_u24 v3, 820, v2
    v_lshrrev_b32 v3, 16, v3
    v_mul_u32_u24 v4, 80, v3
    v_sub_u32 v2, v2, v4
    v_lshrrev_b32 v4, 0, v3
    v_lshlrev_b32 v4, 1, v4
    v_xor_b32 v2, v2, v4
    v_add_u32 v3, s30, v3
    v_mul_lo_u32 v3, v3, s32
    v_lshl_add_u32 v16, v2, 4, v3
    v_add_u32 v2, 384, v1
    v_mul_u32_u24 v3, 820, v2
    v_lshrrev_b32 v3, 16, v3
    v_mul_u32_u24 v4, 80, v3
    v_sub_u32 v2, v2, v4
    v_lshrrev_b32 v4, 0, v3
    v_lshlrev_b32 v4, 1, v4
    v_xor_b32 v2, v2, v4
    v_add_u32 v3, s30, v3
    v_mul_lo_u32 v3, v3, s32
    v_lshl_add_u32 v17, v2, 4, v3
    v_add_u32 v2, 448, v1
    v_mul_u32_u24 v3, 820, v2
    v_lshrrev_b32 v3, 16, v3
    v_mul_u32_u24 v4, 80, v3
    v_sub_u32 v2, v2, v4
    v_lshrrev_b32 v4, 0, v3
    v_lshlrev_b32 v4, 1, v4
    v_xor_b32 v2, v2, v4
    v_add_u32 v3, s30, v3
    v_mul_lo_u32 v3, v3, s32
    v_lshl_add_u32 v18, v2, 4, v3
    v_add_u32 v2, 512, v1
    v_mul_u32_u24 v3, 820, v2
    v_lshrrev_b32 v3, 16, v3
    v_mul_u32_u24 v4, 80, v3
    v_sub_u32 v2, v2, v4
    v_lshrrev_b32 v4, 0, v3
    v_lshlrev_b32 v4, 1, v4
    v_xor_b32 v2, v2, v4
    v_add_u32 v3, s30, v3
    v_mul_lo_u32 v3, v3, s32
    v_lshl_add_u32 v19, v2, 4, v3
    v_add_u32 v2, 576, v1
    v_mul_u32_u24 v3, 820, v2
    v_lshrrev_b32 v3, 16, v3
    v_mul_u32_u24 v4, 80, v3
    v_sub_u32 v2, v2, v4
    v_lshrrev_b32 v4, 0, v3
    v_lshlrev_b32 v4, 1, v4
    v_xor_b32 v2, v2, v4
    v_add_u32 v3, s30, v3
    v_mul_lo_u32 v3, v3, s32
    v_lshl_add_u32 v20, v2, 4, v3
    v_lshrrev_b32 v2, 4, v1
    v_bfe_u32 v3, v1, 2, 1
    v_lshl_add_u32 v2, v2, 1, v3
    v_bfe_u32 v3, v1, 3, 1
    v_xor_b32 v22, v2, v3
    v_mul_u32_u24 v21, 1280, v2
    v_and_b32 v2, 3, v1
    v_lshl_add_u32 v21, v2, 3, v21
    s_mul_i32 s33, s3, 3072
    s_add_u32 s34, s41, 0
    s_add_u32 m0, s33, 0
    s_nop 0
    buffer_load_dwordx4 v6, s[12:15], s34 offen nt lds
    s_add_u32 m0, s33, 1024
    s_nop 0
    buffer_load_dwordx4 v7, s[12:15], s34 offen nt lds
    s_add_u32 m0, s33, 2048
    s_nop 0
    buffer_load_dwordx4 v8, s[12:15], s34 offen nt lds
    s_add_u32 s34, s41, 393216
    s_add_u32 m0, s33, 12288
    s_nop 0
    buffer_load_dwordx4 v6, s[12:15], s34 offen nt lds
    s_add_u32 m0, s33, 13312
    s_nop 0
    buffer_load_dwordx4 v7, s[12:15], s34 offen nt lds
    s_add_u32 m0, s33, 14336
    s_nop 0
    buffer_load_dwordx4 v8, s[12:15], s34 offen nt lds
    s_mul_i32 s33, s3, 3072
    s_add_u32 s34, s41, 786432
    s_add_u32 m0, s33, 24576
    s_nop 0
    buffer_load_dwordx4 v6, s[12:15], s34 offen nt lds
    s_add_u32 m0, s33, 25600
    s_nop 0
    buffer_load_dwordx4 v7, s[12:15], s34 offen nt lds
    s_add_u32 m0, s33, 26624
    s_nop 0
    buffer_load_dwordx4 v8, s[12:15], s34 offen nt lds
    s_add_u32 s34, s41, 1179648
    s_add_u32 m0, s33, 36864
    s_nop 0
    buffer_load_dwordx4 v6, s[12:15], s34 offen nt lds
    s_add_u32 m0, s33, 37888
    s_nop 0
    buffer_load_dwordx4 v7, s[12:15], s34 offen nt lds
    s_add_u32 m0, s33, 38912
    s_nop 0
    buffer_load_dwordx4 v8, s[12:15], s34 offen nt lds
    s_mul_i32 s33, s3, 3072
    s_add_u32 s34, s41, 1572864
    s_add_u32 m0, s33, 49152
    s_nop 0
    buffer_load_dwordx4 v6, s[12:15], s34 offen nt lds
    s_add_u32 m0, s33, 50176
    s_nop 0
    buffer_load_dwordx4 v7, s[12:15], s34 offen nt lds
    s_add_u32 m0, s33, 51200
    s_nop 0
    buffer_load_dwordx4 v8, s[12:15], s34 offen nt lds
    s_add_u32 s34, s41, 1966080
    s_add_u32 m0, s33, 61440
    s_nop 0
    buffer_load_dwordx4 v6, s[12:15], s34 offen nt lds
    s_add_u32 m0, s33, 62464
    s_nop 0
    buffer_load_dwordx4 v7, s[12:15], s34 offen nt lds
    s_add_u32 m0, s33, 63488
    s_nop 0
    buffer_load_dwordx4 v8, s[12:15], s34 offen nt lds
    s_mul_i32 s33, s3, 3072
    s_add_u32 s34, s41, 2359296
    s_add_u32 m0, s33, 73728
    s_nop 0
    buffer_load_dwordx4 v6, s[12:15], s34 offen nt lds
    s_add_u32 m0, s33, 74752
    s_nop 0
    buffer_load_dwordx4 v7, s[12:15], s34 offen nt lds
    s_add_u32 m0, s33, 75776
    s_nop 0
    buffer_load_dwordx4 v8, s[12:15], s34 offen nt lds
    s_add_u32 s34, s41, 2752512
    s_add_u32 m0, s33, 86016
    s_nop 0
    buffer_load_dwordx4 v6, s[12:15], s34 offen nt lds
    s_add_u32 m0, s33, 87040
    s_nop 0
    buffer_load_dwordx4 v7, s[12:15], s34 offen nt lds
    s_add_u32 m0, s33, 88064
    s_nop 0
    buffer_load_dwordx4 v8, s[12:15], s34 offen nt lds
    s_mul_i32 s33, s3, 3072
    s_add_u32 s34, s41, 3145728
    s_add_u32 m0, s33, 98304
    s_nop 0
    buffer_load_dwordx4 v6, s[12:15], s34 offen nt lds
    s_add_u32 m0, s33, 99328
    s_nop 0
    buffer_load_dwordx4 v7, s[12:15], s34 offen nt lds
    s_add_u32 m0, s33, 100352
    s_nop 0
    buffer_load_dwordx4 v8, s[12:15], s34 offen nt lds
    s_add_u32 s34, s41, 3538944
    s_add_u32 m0, s33, 110592
    s_nop 0
    buffer_load_dwordx4 v6, s[12:15], s34 offen nt lds
    s_add_u32 m0, s33, 111616
    s_nop 0
    buffer_load_dwordx4 v7, s[12:15], s34 offen nt lds
    s_add_u32 m0, s33, 112640
    s_nop 0
    buffer_load_dwordx4 v8, s[12:15], s34 offen nt lds
    s_mul_i32 s33, s3, 3072
    s_add_u32 s34, s41, 3932160
    s_add_u32 m0, s33, 122880
    s_nop 0
    buffer_load_dwordx4 v6, s[12:15], s34 offen nt lds
    s_add_u32 m0, s33, 123904
    s_nop 0
    buffer_load_dwordx4 v7, s[12:15], s34 offen nt lds
    s_add_u32 m0, s33, 124928
    s_nop 0
    buffer_load_dwordx4 v8, s[12:15], s34 offen nt lds
    s_add_u32 s34, s41, 4325376
    s_add_u32 m0, s33, 135168
    s_nop 0
    buffer_load_dwordx4 v6, s[12:15], s34 offen nt lds
    s_add_u32 m0, s33, 136192
    s_nop 0
    buffer_load_dwordx4 v7, s[12:15], s34 offen nt lds
    s_add_u32 m0, s33, 137216
    s_nop 0
    buffer_load_dwordx4 v8, s[12:15], s34 offen nt lds
    s_waitcnt vmcnt(30) lgkmcnt(0)
    s_barrier
    v_add_u32 v4, 0, v9
    s_add_u32 s35, s3, 0
    v_xor_b32 v2, s35, v10
    v_lshl_add_u32 v2, v2, 5, v4
    ds_read_b64_tr_b16 a[0:1], v2 offset:0
    ds_read_b64_tr_b16 a[2:3], v2 offset:3072
    ds_read_b64_tr_b16 a[4:5], v2 offset:12288
    ds_read_b64_tr_b16 a[6:7], v2 offset:15360
    s_add_u32 s35, s3, 4
    v_xor_b32 v3, s35, v10
    v_lshl_add_u32 v3, v3, 5, v4
    ds_read_b64_tr_b16 a[8:9], v3 offset:0
    ds_read_b64_tr_b16 a[10:11], v3 offset:3072
    ds_read_b64_tr_b16 a[12:13], v3 offset:12288
    ds_read_b64_tr_b16 a[14:15], v3 offset:15360
    s_add_u32 s35, s3, 8
    v_xor_b32 v2, s35, v10
    v_lshl_add_u32 v2, v2, 5, v4
    ds_read_b64_tr_b16 a[128:129], v2 offset:0
    ds_read_b64_tr_b16 a[130:131], v2 offset:3072
    ds_read_b64_tr_b16 a[132:133], v2 offset:12288
    ds_read_b64_tr_b16 a[134:135], v2 offset:15360
    s_waitcnt vmcnt(24) lgkmcnt(0)
    s_barrier
    s_mul_i32 s33, s3, 3072
    s_add_u32 s34, s41, 4718592
    s_add_u32 m0, s33, 0
    s_nop 0
    buffer_load_dwordx4 v6, s[12:15], s34 offen nt lds
    s_add_u32 m0, s33, 1024
    s_nop 0
    buffer_load_dwordx4 v7, s[12:15], s34 offen nt lds
    s_add_u32 m0, s33, 2048
    s_nop 0
    buffer_load_dwordx4 v8, s[12:15], s34 offen nt lds
    s_add_u32 s34, s41, 5111808
    s_add_u32 m0, s33, 12288
    s_nop 0
    buffer_load_dwordx4 v6, s[12:15], s34 offen nt lds
    s_add_u32 m0, s33, 13312
    s_nop 0
    buffer_load_dwordx4 v7, s[12:15], s34 offen nt lds
    s_add_u32 m0, s33, 14336
    s_nop 0
    buffer_load_dwordx4 v8, s[12:15], s34 offen nt lds
    v_add_u32 v4, 24576, v9
    s_add_u32 s35, s3, 0
    v_xor_b32 v2, s35, v10
    v_lshl_add_u32 v2, v2, 5, v4
    ds_read_b64_tr_b16 a[16:17], v2 offset:0
    ds_read_b64_tr_b16 a[18:19], v2 offset:3072
    ds_read_b64_tr_b16 a[20:21], v2 offset:12288
    ds_read_b64_tr_b16 a[22:23], v2 offset:15360
    s_add_u32 s35, s3, 4
    v_xor_b32 v3, s35, v10
    v_lshl_add_u32 v3, v3, 5, v4
    ds_read_b64_tr_b16 a[24:25], v3 offset:0
    ds_read_b64_tr_b16 a[26:27], v3 offset:3072
    ds_read_b64_tr_b16 a[28:29], v3 offset:12288
    ds_read_b64_tr_b16 a[30:31], v3 offset:15360
    s_add_u32 s35, s3, 8
    v_xor_b32 v2, s35, v10
    v_lshl_add_u32 v2, v2, 5, v4
    ds_read_b64_tr_b16 a[136:137], v2 offset:0
    ds_read_b64_tr_b16 a[138:139], v2 offset:3072
    ds_read_b64_tr_b16 a[140:141], v2 offset:12288
    ds_read_b64_tr_b16 a[142:143], v2 offset:15360
    s_waitcnt vmcnt(24) lgkmcnt(0)
    s_barrier
    s_mul_i32 s33, s3, 3072
    s_add_u32 s34, s41, 5505024
    s_add_u32 m0, s33, 24576
    s_nop 0
    buffer_load_dwordx4 v6, s[12:15], s34 offen nt lds
    s_add_u32 m0, s33, 25600
    s_nop 0
    buffer_load_dwordx4 v7, s[12:15], s34 offen nt lds
    s_add_u32 m0, s33, 26624
    s_nop 0
    buffer_load_dwordx4 v8, s[12:15], s34 offen nt lds
    s_add_u32 s34, s41, 5898240
    s_add_u32 m0, s33, 36864
    s_nop 0
    buffer_load_dwordx4 v6, s[12:15], s34 offen nt lds
    s_add_u32 m0, s33, 37888
    s_nop 0
    buffer_load_dwordx4 v7, s[12:15], s34 offen nt lds
    s_add_u32 m0, s33, 38912
    s_nop 0
    buffer_load_dwordx4 v8, s[12:15], s34 offen nt lds
    v_add_u32 v4, 49152, v9
    s_add_u32 s35, s3, 0
    v_xor_b32 v2, s35, v10
    v_lshl_add_u32 v2, v2, 5, v4
    ds_read_b64_tr_b16 a[32:33], v2 offset:0
    ds_read_b64_tr_b16 a[34:35], v2 offset:3072
    ds_read_b64_tr_b16 a[36:37], v2 offset:12288
    ds_read_b64_tr_b16 a[38:39], v2 offset:15360
    s_add_u32 s35, s3, 4
    v_xor_b32 v3, s35, v10
    v_lshl_add_u32 v3, v3, 5, v4
    ds_read_b64_tr_b16 a[40:41], v3 offset:0
    ds_read_b64_tr_b16 a[42:43], v3 offset:3072
    ds_read_b64_tr_b16 a[44:45], v3 offset:12288
    ds_read_b64_tr_b16 a[46:47], v3 offset:15360
    s_add_u32 s35, s3, 8
    v_xor_b32 v2, s35, v10
    v_lshl_add_u32 v2, v2, 5, v4
    ds_read_b64_tr_b16 a[144:145], v2 offset:0
    ds_read_b64_tr_b16 a[146:147], v2 offset:3072
    ds_read_b64_tr_b16 a[148:149], v2 offset:12288
    ds_read_b64_tr_b16 a[150:151], v2 offset:15360
    s_waitcnt vmcnt(24) lgkmcnt(0)
    s_barrier
    s_mul_i32 s33, s3, 3072
    s_add_u32 s34, s41, 6291456
    s_add_u32 m0, s33, 49152
    s_nop 0
    buffer_load_dwordx4 v6, s[12:15], s34 offen nt lds
    s_add_u32 m0, s33, 50176
    s_nop 0
    buffer_load_dwordx4 v7, s[12:15], s34 offen nt lds
    s_add_u32 m0, s33, 51200
    s_nop 0
    buffer_load_dwordx4 v8, s[12:15], s34 offen nt lds
    s_add_u32 s34, s41, 6684672
    s_add_u32 m0, s33, 61440
    s_nop 0
    buffer_load_dwordx4 v6, s[12:15], s34 offen nt lds
    s_add_u32 m0, s33, 62464
    s_nop 0
    buffer_load_dwordx4 v7, s[12:15], s34 offen nt lds
    s_add_u32 m0, s33, 63488
    s_nop 0
    buffer_load_dwordx4 v8, s[12:15], s34 offen nt lds
    v_add_u32 v4, 73728, v9
    s_add_u32 s35, s3, 0
    v_xor_b32 v2, s35, v10
    v_lshl_add_u32 v2, v2, 5, v4
    ds_read_b64_tr_b16 v[32:33], v2 offset:0
    ds_read_b64_tr_b16 v[34:35], v2 offset:3072
    ds_read_b64_tr_b16 v[36:37], v2 offset:12288
    ds_read_b64_tr_b16 v[38:39], v2 offset:15360
    s_add_u32 s35, s3, 4
    v_xor_b32 v3, s35, v10
    v_lshl_add_u32 v3, v3, 5, v4
    ds_read_b64_tr_b16 a[88:89], v3 offset:0
    ds_read_b64_tr_b16 a[90:91], v3 offset:3072
    ds_read_b64_tr_b16 a[92:93], v3 offset:12288
    ds_read_b64_tr_b16 a[94:95], v3 offset:15360
    s_add_u32 s35, s3, 8
    v_xor_b32 v2, s35, v10
    v_lshl_add_u32 v2, v2, 5, v4
    ds_read_b64_tr_b16 v[64:65], v2 offset:0
    ds_read_b64_tr_b16 v[66:67], v2 offset:3072
    ds_read_b64_tr_b16 v[68:69], v2 offset:12288
    ds_read_b64_tr_b16 v[70:71], v2 offset:15360
    s_waitcnt vmcnt(24) lgkmcnt(0)
    s_barrier
    s_mul_i32 s33, s3, 3072
    s_add_u32 s34, s41, 7077888
    s_add_u32 m0, s33, 73728
    s_nop 0
    buffer_load_dwordx4 v6, s[12:15], s34 offen nt lds
    s_add_u32 m0, s33, 74752
    s_nop 0
    buffer_load_dwordx4 v7, s[12:15], s34 offen nt lds
    s_add_u32 m0, s33, 75776
    s_nop 0
    buffer_load_dwordx4 v8, s[12:15], s34 offen nt lds
    s_add_u32 s34, s41, 7471104
    s_add_u32 m0, s33, 86016
    s_nop 0
    buffer_load_dwordx4 v6, s[12:15], s34 offen nt lds
    s_add_u32 m0, s33, 87040
    s_nop 0
    buffer_load_dwordx4 v7, s[12:15], s34 offen nt lds
    s_add_u32 m0, s33, 88064
    s_nop 0
    buffer_load_dwordx4 v8, s[12:15], s34 offen nt lds
    v_add_u32 v4, 98304, v9
    s_add_u32 s35, s3, 0
    v_xor_b32 v2, s35, v10
    v_lshl_add_u32 v2, v2, 5, v4
    ds_read_b64_tr_b16 a[48:49], v2 offset:0
    ds_read_b64_tr_b16 a[50:51], v2 offset:3072
    ds_read_b64_tr_b16 a[52:53], v2 offset:12288
    ds_read_b64_tr_b16 a[54:55], v2 offset:15360
    s_add_u32 s35, s3, 4
    v_xor_b32 v3, s35, v10
    v_lshl_add_u32 v3, v3, 5, v4
    ds_read_b64_tr_b16 v[48:49], v3 offset:0
    ds_read_b64_tr_b16 v[50:51], v3 offset:3072
    ds_read_b64_tr_b16 v[52:53], v3 offset:12288
    ds_read_b64_tr_b16 v[54:55], v3 offset:15360
    s_add_u32 s35, s3, 8
    v_xor_b32 v2, s35, v10
    v_lshl_add_u32 v2, v2, 5, v4
    ds_read_b64_tr_b16 a[152:153], v2 offset:0
    ds_read_b64_tr_b16 a[154:155], v2 offset:3072
    ds_read_b64_tr_b16 a[156:157], v2 offset:12288
    ds_read_b64_tr_b16 a[158:159], v2 offset:15360
    s_waitcnt vmcnt(24) lgkmcnt(0)
    s_barrier
    v_add_u32 v4, 122880, v9
    s_add_u32 s35, s3, 0
    v_xor_b32 v2, s35, v10
    v_lshl_add_u32 v2, v2, 5, v4
    ds_read_b64_tr_b16 a[56:57], v2 offset:0
    ds_read_b64_tr_b16 a[58:59], v2 offset:3072
    ds_read_b64_tr_b16 a[60:61], v2 offset:12288
    ds_read_b64_tr_b16 a[62:63], v2 offset:15360
    s_add_u32 s35, s3, 4
    v_xor_b32 v3, s35, v10
    v_lshl_add_u32 v3, v3, 5, v4
    ds_read_b64_tr_b16 a[96:97], v3 offset:0
    ds_read_b64_tr_b16 a[98:99], v3 offset:3072
    ds_read_b64_tr_b16 a[100:101], v3 offset:12288
    ds_read_b64_tr_b16 a[102:103], v3 offset:15360
    s_add_u32 s35, s3, 8
    v_xor_b32 v2, s35, v10
    v_lshl_add_u32 v2, v2, 5, v4
    ds_read_b64_tr_b16 a[160:161], v2 offset:0
    ds_read_b64_tr_b16 a[162:163], v2 offset:3072
    ds_read_b64_tr_b16 a[164:165], v2 offset:12288
    ds_read_b64_tr_b16 a[166:167], v2 offset:15360
    s_waitcnt vmcnt(18) lgkmcnt(0)
    s_barrier
    s_mul_i32 s33, s3, 10240
    s_add_u32 s34, s42, 0
    s_add_u32 m0, s33, 98304
    s_nop 0
    buffer_load_dwordx4 v11, s[16:19], s34 offen nt lds
    s_add_u32 m0, s33, 99328
    s_nop 0
    buffer_load_dwordx4 v12, s[16:19], s34 offen nt lds
    s_add_u32 m0, s33, 100352
    s_nop 0
    buffer_load_dwordx4 v13, s[16:19], s34 offen nt lds
    s_add_u32 m0, s33, 101376
    s_nop 0
    buffer_load_dwordx4 v14, s[16:19], s34 offen nt lds
    s_add_u32 m0, s33, 102400
    s_nop 0
    buffer_load_dwordx4 v15, s[16:19], s34 offen nt lds
    s_add_u32 m0, s33, 103424
    s_nop 0
    buffer_load_dwordx4 v16, s[16:19], s34 offen nt lds
    s_add_u32 m0, s33, 104448
    s_nop 0
    buffer_load_dwordx4 v17, s[16:19], s34 offen nt lds
    s_add_u32 m0, s33, 105472
    s_nop 0
    buffer_load_dwordx4 v18, s[16:19], s34 offen nt lds
    s_add_u32 m0, s33, 106496
    s_nop 0
    buffer_load_dwordx4 v19, s[16:19], s34 offen nt lds
    s_add_u32 m0, s33, 107520
    s_nop 0
    buffer_load_dwordx4 v20, s[16:19], s34 offen nt lds
    v_add_u32 v4, 0, v9
    s_add_u32 s35, s3, 0
    v_xor_b32 v2, s35, v10
    v_lshl_add_u32 v2, v2, 5, v4
    ds_read_b64_tr_b16 a[64:65], v2 offset:0
    ds_read_b64_tr_b16 a[66:67], v2 offset:3072
    ds_read_b64_tr_b16 a[68:69], v2 offset:12288
    ds_read_b64_tr_b16 a[70:71], v2 offset:15360
    s_add_u32 s35, s3, 4
    v_xor_b32 v3, s35, v10
    v_lshl_add_u32 v3, v3, 5, v4
    ds_read_b64_tr_b16 a[104:105], v3 offset:0
    ds_read_b64_tr_b16 a[106:107], v3 offset:3072
    ds_read_b64_tr_b16 a[108:109], v3 offset:12288
    ds_read_b64_tr_b16 a[110:111], v3 offset:15360
    s_add_u32 s35, s3, 8
    v_xor_b32 v2, s35, v10
    v_lshl_add_u32 v2, v2, 5, v4
    ds_read_b64_tr_b16 a[168:169], v2 offset:0
    ds_read_b64_tr_b16 a[170:171], v2 offset:3072
    ds_read_b64_tr_b16 a[172:173], v2 offset:12288
    ds_read_b64_tr_b16 a[174:175], v2 offset:15360
    s_waitcnt vmcnt(22) lgkmcnt(0)
    s_barrier
    v_add_u32 v4, 24576, v9
    s_add_u32 s35, s3, 0
    v_xor_b32 v2, s35, v10
    v_lshl_add_u32 v2, v2, 5, v4
    ds_read_b64_tr_b16 a[72:73], v2 offset:0
    ds_read_b64_tr_b16 a[74:75], v2 offset:3072
    ds_read_b64_tr_b16 a[76:77], v2 offset:12288
    ds_read_b64_tr_b16 a[78:79], v2 offset:15360
    s_add_u32 s35, s3, 4
    v_xor_b32 v3, s35, v10
    v_lshl_add_u32 v3, v3, 5, v4
    ds_read_b64_tr_b16 a[112:113], v3 offset:0
    ds_read_b64_tr_b16 a[114:115], v3 offset:3072
    ds_read_b64_tr_b16 a[116:117], v3 offset:12288
    ds_read_b64_tr_b16 a[118:119], v3 offset:15360
    s_add_u32 s35, s3, 8
    v_xor_b32 v2, s35, v10
    v_lshl_add_u32 v2, v2, 5, v4
    ds_read_b64_tr_b16 a[176:177], v2 offset:0
    ds_read_b64_tr_b16 a[178:179], v2 offset:3072
    ds_read_b64_tr_b16 a[180:181], v2 offset:12288
    ds_read_b64_tr_b16 a[182:183], v2 offset:15360
    s_waitcnt vmcnt(16) lgkmcnt(0)
    s_barrier
    s_mul_i32 s33, s3, 10240
    s_add_u32 s34, s42, 40960
    s_add_u32 m0, s33, 0
    s_nop 0
    buffer_load_dwordx4 v11, s[16:19], s34 offen nt lds
    s_add_u32 m0, s33, 1024
    s_nop 0
    buffer_load_dwordx4 v12, s[16:19], s34 offen nt lds
    s_add_u32 m0, s33, 2048
    s_nop 0
    buffer_load_dwordx4 v13, s[16:19], s34 offen nt lds
    s_add_u32 m0, s33, 3072
    s_nop 0
    buffer_load_dwordx4 v14, s[16:19], s34 offen nt lds
    s_add_u32 m0, s33, 4096
    s_nop 0
    buffer_load_dwordx4 v15, s[16:19], s34 offen nt lds
    s_add_u32 m0, s33, 5120
    s_nop 0
    buffer_load_dwordx4 v16, s[16:19], s34 offen nt lds
    s_add_u32 m0, s33, 6144
    s_nop 0
    buffer_load_dwordx4 v17, s[16:19], s34 offen nt lds
    s_add_u32 m0, s33, 7168
    s_nop 0
    buffer_load_dwordx4 v18, s[16:19], s34 offen nt lds
    s_add_u32 m0, s33, 8192
    s_nop 0
    buffer_load_dwordx4 v19, s[16:19], s34 offen nt lds
    s_add_u32 m0, s33, 9216
    s_nop 0
    buffer_load_dwordx4 v20, s[16:19], s34 offen nt lds
    v_add_u32 v4, 49152, v9
    s_add_u32 s35, s3, 0
    v_xor_b32 v2, s35, v10
    v_lshl_add_u32 v2, v2, 5, v4
    ds_read_b64_tr_b16 a[80:81], v2 offset:0
    ds_read_b64_tr_b16 a[82:83], v2 offset:3072
    ds_read_b64_tr_b16 a[84:85], v2 offset:12288
    ds_read_b64_tr_b16 a[86:87], v2 offset:15360
    s_add_u32 s35, s3, 4
    v_xor_b32 v3, s35, v10
    v_lshl_add_u32 v3, v3, 5, v4
    ds_read_b64_tr_b16 a[120:121], v3 offset:0
    ds_read_b64_tr_b16 a[122:123], v3 offset:3072
    ds_read_b64_tr_b16 a[124:125], v3 offset:12288
    ds_read_b64_tr_b16 a[126:127], v3 offset:15360
    s_add_u32 s35, s3, 8
    v_xor_b32 v2, s35, v10
    v_lshl_add_u32 v2, v2, 5, v4
    ds_read_b64_tr_b16 v[72:73], v2 offset:0
    ds_read_b64_tr_b16 v[74:75], v2 offset:3072
    ds_read_b64_tr_b16 v[76:77], v2 offset:12288
    ds_read_b64_tr_b16 v[78:79], v2 offset:15360
    s_waitcnt vmcnt(20) lgkmcnt(0)
    s_barrier
    v_add_u32 v4, 73728, v9
    s_add_u32 s35, s3, 0
    v_xor_b32 v2, s35, v10
    v_lshl_add_u32 v2, v2, 5, v4
    ds_read_b64_tr_b16 v[40:41], v2 offset:0
    ds_read_b64_tr_b16 v[42:43], v2 offset:3072
    ds_read_b64_tr_b16 v[44:45], v2 offset:12288
    ds_read_b64_tr_b16 v[46:47], v2 offset:15360
    s_add_u32 s35, s3, 4
    v_xor_b32 v3, s35, v10
    v_lshl_add_u32 v3, v3, 5, v4
    ds_read_b64_tr_b16 v[56:57], v3 offset:0
    ds_read_b64_tr_b16 v[58:59], v3 offset:3072
    ds_read_b64_tr_b16 v[60:61], v3 offset:12288
    ds_read_b64_tr_b16 v[62:63], v3 offset:15360
    s_add_u32 s35, s3, 8
    v_xor_b32 v2, s35, v10
    v_lshl_add_u32 v2, v2, 5, v4
    ds_read_b64_tr_b16 a[184:185], v2 offset:0
    ds_read_b64_tr_b16 a[186:187], v2 offset:3072
    ds_read_b64_tr_b16 a[188:189], v2 offset:12288
    ds_read_b64_tr_b16 a[190:191], v2 offset:15360
    s_waitcnt vmcnt(10) lgkmcnt(0)
    s_barrier
    s_mul_i32 s33, s3, 10240
    s_add_u32 s34, s42, 81920
    s_add_u32 m0, s33, 40960
    s_nop 0
    buffer_load_dwordx4 v11, s[16:19], s34 offen nt lds
    s_add_u32 m0, s33, 41984
    s_nop 0
    buffer_load_dwordx4 v12, s[16:19], s34 offen nt lds
    s_add_u32 m0, s33, 43008
    s_nop 0
    buffer_load_dwordx4 v13, s[16:19], s34 offen nt lds
    s_add_u32 m0, s33, 44032
    s_nop 0
    buffer_load_dwordx4 v14, s[16:19], s34 offen nt lds
    s_add_u32 m0, s33, 45056
    s_nop 0
    buffer_load_dwordx4 v15, s[16:19], s34 offen nt lds
    s_add_u32 m0, s33, 46080
    s_nop 0
    buffer_load_dwordx4 v16, s[16:19], s34 offen nt lds
    s_add_u32 m0, s33, 47104
    s_nop 0
    buffer_load_dwordx4 v17, s[16:19], s34 offen nt lds
    s_add_u32 m0, s33, 48128
    s_nop 0
    buffer_load_dwordx4 v18, s[16:19], s34 offen nt lds
    s_add_u32 m0, s33, 49152
    s_nop 0
    buffer_load_dwordx4 v19, s[16:19], s34 offen nt lds
    s_add_u32 m0, s33, 50176
    s_nop 0
    buffer_load_dwordx4 v20, s[16:19], s34 offen nt lds
    v_add_u32 v4, 98304, v21
    s_mul_i32 s35, s3, 10
    v_xor_b32 v2, s35, v22
    v_lshl_add_u32 v2, v2, 5, v4
    ds_read_b64_tr_b16 v[80:81], v2 offset:0
    ds_read_b64_tr_b16 v[82:83], v2 offset:10240
    ds_read_b64_tr_b16 v[84:85], v2 offset:20480
    ds_read_b64_tr_b16 v[86:87], v2 offset:30720
    s_mul_i32 s35, s3, 10
    s_add_u32 s35, s35, 2
    v_xor_b32 v3, s35, v22
    v_lshl_add_u32 v3, v3, 5, v4
    ds_read_b64_tr_b16 a[192:193], v3 offset:0
    ds_read_b64_tr_b16 a[194:195], v3 offset:10240
    ds_read_b64_tr_b16 a[196:197], v3 offset:20480
    ds_read_b64_tr_b16 a[198:199], v3 offset:30720
    s_mul_i32 s35, s3, 10
    s_add_u32 s35, s35, 4
    v_xor_b32 v2, s35, v22
    v_lshl_add_u32 v2, v2, 5, v4
    ds_read_b64_tr_b16 a[200:201], v2 offset:0
    ds_read_b64_tr_b16 a[202:203], v2 offset:10240
    ds_read_b64_tr_b16 a[204:205], v2 offset:20480
    ds_read_b64_tr_b16 a[206:207], v2 offset:30720
    s_mul_i32 s35, s3, 10
    s_add_u32 s35, s35, 6
    v_xor_b32 v3, s35, v22
    v_lshl_add_u32 v3, v3, 5, v4
    ds_read_b64_tr_b16 a[208:209], v3 offset:0
    ds_read_b64_tr_b16 a[210:211], v3 offset:10240
    ds_read_b64_tr_b16 a[212:213], v3 offset:20480
    ds_read_b64_tr_b16 a[214:215], v3 offset:30720
    s_mul_i32 s35, s3, 10
    s_add_u32 s35, s35, 8
    v_xor_b32 v2, s35, v22
    v_lshl_add_u32 v2, v2, 5, v4
    ds_read_b64_tr_b16 v[88:89], v2 offset:0
    ds_read_b64_tr_b16 v[90:91], v2 offset:10240
    ds_read_b64_tr_b16 v[92:93], v2 offset:20480
    ds_read_b64_tr_b16 v[94:95], v2 offset:30720
    s_waitcnt vmcnt(10) lgkmcnt(0)
    s_barrier
    s_mul_i32 s33, s3, 10240
    s_add_u32 s34, s42, 122880
    s_add_u32 m0, s33, 81920
    s_nop 0
    buffer_load_dwordx4 v11, s[16:19], s34 offen nt lds
    s_add_u32 m0, s33, 82944
    s_nop 0
    buffer_load_dwordx4 v12, s[16:19], s34 offen nt lds
    s_add_u32 m0, s33, 83968
    s_nop 0
    buffer_load_dwordx4 v13, s[16:19], s34 offen nt lds
    s_add_u32 m0, s33, 84992
    s_nop 0
    buffer_load_dwordx4 v14, s[16:19], s34 offen nt lds
    s_add_u32 m0, s33, 86016
    s_nop 0
    buffer_load_dwordx4 v15, s[16:19], s34 offen nt lds
    s_add_u32 m0, s33, 87040
    s_nop 0
    buffer_load_dwordx4 v16, s[16:19], s34 offen nt lds
    s_add_u32 m0, s33, 88064
    s_nop 0
    buffer_load_dwordx4 v17, s[16:19], s34 offen nt lds
    s_add_u32 m0, s33, 89088
    s_nop 0
    buffer_load_dwordx4 v18, s[16:19], s34 offen nt lds
    s_add_u32 m0, s33, 90112
    s_nop 0
    buffer_load_dwordx4 v19, s[16:19], s34 offen nt lds
    s_add_u32 m0, s33, 91136
    s_nop 0
    buffer_load_dwordx4 v20, s[16:19], s34 offen nt lds
    s_mul_i32 s33, s3, 10240
    s_add_u32 s34, s42, 163840
    s_add_u32 m0, s33, 122880
    s_nop 0
    buffer_load_dwordx4 v11, s[16:19], s34 offen nt lds
    s_add_u32 m0, s33, 123904
    s_nop 0
    buffer_load_dwordx4 v12, s[16:19], s34 offen nt lds
    s_add_u32 m0, s33, 124928
    s_nop 0
    buffer_load_dwordx4 v13, s[16:19], s34 offen nt lds
    s_add_u32 m0, s33, 125952
    s_nop 0
    buffer_load_dwordx4 v14, s[16:19], s34 offen nt lds
    s_add_u32 m0, s33, 126976
    s_nop 0
    buffer_load_dwordx4 v15, s[16:19], s34 offen nt lds
    s_add_u32 m0, s33, 128000
    s_nop 0
    buffer_load_dwordx4 v16, s[16:19], s34 offen nt lds
    s_add_u32 m0, s33, 129024
    s_nop 0
    buffer_load_dwordx4 v17, s[16:19], s34 offen nt lds
    s_add_u32 m0, s33, 130048
    s_nop 0
    buffer_load_dwordx4 v18, s[16:19], s34 offen nt lds
    s_add_u32 m0, s33, 131072
    s_nop 0
    buffer_load_dwordx4 v19, s[16:19], s34 offen nt lds
    s_add_u32 m0, s33, 132096
    s_nop 0
    buffer_load_dwordx4 v20, s[16:19], s34 offen nt lds
    v_add_u32 v4, 0, v21
    s_mul_i32 s35, s3, 10
    v_xor_b32 v2, s35, v22
    v_lshl_add_u32 v2, v2, 5, v4
    ds_read_b64_tr_b16 a[216:217], v2 offset:0
    ds_read_b64_tr_b16 a[218:219], v2 offset:10240
    ds_read_b64_tr_b16 a[220:221], v2 offset:20480
    ds_read_b64_tr_b16 a[222:223], v2 offset:30720
    s_mul_i32 s35, s3, 10
    s_add_u32 s35, s35, 2
    v_xor_b32 v3, s35, v22
    v_lshl_add_u32 v3, v3, 5, v4
    ds_read_b64_tr_b16 a[224:225], v3 offset:0
    ds_read_b64_tr_b16 a[226:227], v3 offset:10240
    ds_read_b64_tr_b16 a[228:229], v3 offset:20480
    ds_read_b64_tr_b16 a[230:231], v3 offset:30720
    s_mul_i32 s35, s3, 10
    s_add_u32 s35, s35, 4
    v_xor_b32 v2, s35, v22
    v_lshl_add_u32 v2, v2, 5, v4
    ds_read_b64_tr_b16 a[232:233], v2 offset:0
    ds_read_b64_tr_b16 a[234:235], v2 offset:10240
    ds_read_b64_tr_b16 a[236:237], v2 offset:20480
    ds_read_b64_tr_b16 a[238:239], v2 offset:30720
    s_mul_i32 s35, s3, 10
    s_add_u32 s35, s35, 6
    v_xor_b32 v3, s35, v22
    v_lshl_add_u32 v3, v3, 5, v4
    ds_read_b64_tr_b16 v[96:97], v3 offset:0
    ds_read_b64_tr_b16 v[98:99], v3 offset:10240
    ds_read_b64_tr_b16 v[100:101], v3 offset:20480
    ds_read_b64_tr_b16 v[102:103], v3 offset:30720
    s_mul_i32 s35, s3, 10
    s_add_u32 s35, s35, 8
    v_xor_b32 v2, s35, v22
    v_lshl_add_u32 v2, v2, 5, v4
    ds_read_b64_tr_b16 a[240:241], v2 offset:0
    ds_read_b64_tr_b16 a[242:243], v2 offset:10240
    ds_read_b64_tr_b16 a[244:245], v2 offset:20480
    ds_read_b64_tr_b16 a[246:247], v2 offset:30720
    s_waitcnt vmcnt(20) lgkmcnt(0)
    s_barrier
    s_mul_i32 s33, s3, 10240
    s_add_u32 s34, s42, 204800
    s_add_u32 m0, s33, 0
    s_nop 0
    buffer_load_dwordx4 v11, s[16:19], s34 offen nt lds
    s_add_u32 m0, s33, 1024
    s_nop 0
    buffer_load_dwordx4 v12, s[16:19], s34 offen nt lds
    s_add_u32 m0, s33, 2048
    s_nop 0
    buffer_load_dwordx4 v13, s[16:19], s34 offen nt lds
    s_add_u32 m0, s33, 3072
    s_nop 0
    buffer_load_dwordx4 v14, s[16:19], s34 offen nt lds
    s_add_u32 m0, s33, 4096
    s_nop 0
    buffer_load_dwordx4 v15, s[16:19], s34 offen nt lds
    s_add_u32 m0, s33, 5120
    s_nop 0
    buffer_load_dwordx4 v16, s[16:19], s34 offen nt lds
    s_add_u32 m0, s33, 6144
    s_nop 0
    buffer_load_dwordx4 v17, s[16:19], s34 offen nt lds
    s_add_u32 m0, s33, 7168
    s_nop 0
    buffer_load_dwordx4 v18, s[16:19], s34 offen nt lds
    s_add_u32 m0, s33, 8192
    s_nop 0
    buffer_load_dwordx4 v19, s[16:19], s34 offen nt lds
    s_add_u32 m0, s33, 9216
    s_nop 0
    buffer_load_dwordx4 v20, s[16:19], s34 offen nt lds
    v_lshlrev_b32 v29, 2, v1
    buffer_load_dword v28, v29, s[24:27], 0 offen offset:192 sc1
    v_add_u32 v4, 40960, v21
    s_mul_i32 s35, s3, 10
    v_xor_b32 v2, s35, v22
    v_lshl_add_u32 v2, v2, 5, v4
    ds_read_b64_tr_b16 a[248:249], v2 offset:0
    ds_read_b64_tr_b16 a[250:251], v2 offset:10240
    ds_read_b64_tr_b16 a[252:253], v2 offset:20480
    ds_read_b64_tr_b16 a[254:255], v2 offset:30720
    s_mul_i32 s35, s3, 10
    s_add_u32 s35, s35, 2
    v_xor_b32 v3, s35, v22
    v_lshl_add_u32 v3, v3, 5, v4
    ds_read_b64_tr_b16 v[144:145], v3 offset:0
    ds_read_b64_tr_b16 v[146:147], v3 offset:10240
    ds_read_b64_tr_b16 v[148:149], v3 offset:20480
    ds_read_b64_tr_b16 v[150:151], v3 offset:30720
    s_mul_i32 s35, s3, 10
    s_add_u32 s35, s35, 4
    v_xor_b32 v2, s35, v22
    v_lshl_add_u32 v2, v2, 5, v4
    ds_read_b64_tr_b16 v[104:105], v2 offset:0
    ds_read_b64_tr_b16 v[106:107], v2 offset:10240
    ds_read_b64_tr_b16 v[108:109], v2 offset:20480
    ds_read_b64_tr_b16 v[110:111], v2 offset:30720
    s_mul_i32 s35, s3, 10
    s_add_u32 s35, s35, 6
    v_xor_b32 v3, s35, v22
    v_lshl_add_u32 v3, v3, 5, v4
    ds_read_b64_tr_b16 v[152:153], v3 offset:0
    ds_read_b64_tr_b16 v[154:155], v3 offset:10240
    ds_read_b64_tr_b16 v[156:157], v3 offset:20480
    ds_read_b64_tr_b16 v[158:159], v3 offset:30720
    s_mul_i32 s35, s3, 10
    s_add_u32 s35, s35, 8
    v_xor_b32 v2, s35, v22
    v_lshl_add_u32 v2, v2, 5, v4
    ds_read_b64_tr_b16 v[232:233], v2 offset:0
    ds_read_b64_tr_b16 v[234:235], v2 offset:10240
    ds_read_b64_tr_b16 v[236:237], v2 offset:20480
    ds_read_b64_tr_b16 v[238:239], v2 offset:30720
    s_waitcnt vmcnt(21) lgkmcnt(0)
    s_barrier
    v_add_u32 v4, 81920, v21
    s_mul_i32 s35, s3, 10
    v_xor_b32 v2, s35, v22
    v_lshl_add_u32 v2, v2, 5, v4
    ds_read_b64_tr_b16 v[160:161], v2 offset:0
    ds_read_b64_tr_b16 v[162:163], v2 offset:10240
    ds_read_b64_tr_b16 v[164:165], v2 offset:20480
    ds_read_b64_tr_b16 v[166:167], v2 offset:30720
    s_mul_i32 s35, s3, 10
    s_add_u32 s35, s35, 2
    v_xor_b32 v3, s35, v22
    v_lshl_add_u32 v3, v3, 5, v4
    ds_read_b64_tr_b16 v[168:169], v3 offset:0
    ds_read_b64_tr_b16 v[170:171], v3 offset:10240
    ds_read_b64_tr_b16 v[172:173], v3 offset:20480
    ds_read_b64_tr_b16 v[174:175], v3 offset:30720
    s_mul_i32 s35, s3, 10
    s_add_u32 s35, s35, 4
    v_xor_b32 v2, s35, v22
    v_lshl_add_u32 v2, v2, 5, v4
    ds_read_b64_tr_b16 v[112:113], v2 offset:0
    ds_read_b64_tr_b16 v[114:115], v2 offset:10240
    ds_read_b64_tr_b16 v[116:117], v2 offset:20480
    ds_read_b64_tr_b16 v[118:119], v2 offset:30720
    s_mul_i32 s35, s3, 10
    s_add_u32 s35, s35, 6
    v_xor_b32 v3, s35, v22
    v_lshl_add_u32 v3, v3, 5, v4
    ds_read_b64_tr_b16 v[176:177], v3 offset:0
    ds_read_b64_tr_b16 v[178:179], v3 offset:10240
    ds_read_b64_tr_b16 v[180:181], v3 offset:20480
    ds_read_b64_tr_b16 v[182:183], v3 offset:30720
    s_mul_i32 s35, s3, 10
    s_add_u32 s35, s35, 8
    v_xor_b32 v2, s35, v22
    v_lshl_add_u32 v2, v2, 5, v4
    ds_read_b64_tr_b16 v[240:241], v2 offset:0
    ds_read_b64_tr_b16 v[242:243], v2 offset:10240
    ds_read_b64_tr_b16 v[244:245], v2 offset:20480
    ds_read_b64_tr_b16 v[246:247], v2 offset:30720
    s_waitcnt vmcnt(11) lgkmcnt(0)
    s_barrier
    v_add_u32 v4, 122880, v21
    s_mul_i32 s35, s3, 10
    v_xor_b32 v2, s35, v22
    v_lshl_add_u32 v2, v2, 5, v4
    ds_read_b64_tr_b16 v[184:185], v2 offset:0
    ds_read_b64_tr_b16 v[186:187], v2 offset:10240
    ds_read_b64_tr_b16 v[188:189], v2 offset:20480
    ds_read_b64_tr_b16 v[190:191], v2 offset:30720
    s_mul_i32 s35, s3, 10
    s_add_u32 s35, s35, 2
    v_xor_b32 v3, s35, v22
    v_lshl_add_u32 v3, v3, 5, v4
    ds_read_b64_tr_b16 v[120:121], v3 offset:0
    ds_read_b64_tr_b16 v[122:123], v3 offset:10240
    ds_read_b64_tr_b16 v[124:125], v3 offset:20480
    ds_read_b64_tr_b16 v[126:127], v3 offset:30720
    s_mul_i32 s35, s3, 10
    s_add_u32 s35, s35, 4
    v_xor_b32 v2, s35, v22
    v_lshl_add_u32 v2, v2, 5, v4
    ds_read_b64_tr_b16 v[208:209], v2 offset:0
    ds_read_b64_tr_b16 v[210:211], v2 offset:10240
    ds_read_b64_tr_b16 v[212:213], v2 offset:20480
    ds_read_b64_tr_b16 v[214:215], v2 offset:30720
    s_mul_i32 s35, s3, 10
    s_add_u32 s35, s35, 6
    v_xor_b32 v3, s35, v22
    v_lshl_add_u32 v3, v3, 5, v4
    ds_read_b64_tr_b16 v[128:129], v3 offset:0
    ds_read_b64_tr_b16 v[130:131], v3 offset:10240
    ds_read_b64_tr_b16 v[132:133], v3 offset:20480
    ds_read_b64_tr_b16 v[134:135], v3 offset:30720
    s_mul_i32 s35, s3, 10
    s_add_u32 s35, s35, 8
    v_xor_b32 v2, s35, v22
    v_lshl_add_u32 v2, v2, 5, v4
    ds_read_b64_tr_b16 v[136:137], v2 offset:0
    ds_read_b64_tr_b16 v[138:139], v2 offset:10240
    ds_read_b64_tr_b16 v[140:141], v2 offset:20480
    ds_read_b64_tr_b16 v[142:143], v2 offset:30720
    s_waitcnt vmcnt(1) lgkmcnt(0)
    s_barrier
    v_add_u32 v4, 0, v21
    s_mul_i32 s35, s3, 10
    v_xor_b32 v2, s35, v22
    v_lshl_add_u32 v2, v2, 5, v4
    ds_read_b64_tr_b16 v[192:193], v2 offset:0
    ds_read_b64_tr_b16 v[194:195], v2 offset:10240
    ds_read_b64_tr_b16 v[196:197], v2 offset:20480
    ds_read_b64_tr_b16 v[198:199], v2 offset:30720
    s_mul_i32 s35, s3, 10
    s_add_u32 s35, s35, 2
    v_xor_b32 v3, s35, v22
    v_lshl_add_u32 v3, v3, 5, v4
    ds_read_b64_tr_b16 v[200:201], v3 offset:0
    ds_read_b64_tr_b16 v[202:203], v3 offset:10240
    ds_read_b64_tr_b16 v[204:205], v3 offset:20480
    ds_read_b64_tr_b16 v[206:207], v3 offset:30720
    s_mul_i32 s35, s3, 10
    s_add_u32 s35, s35, 4
    v_xor_b32 v2, s35, v22
    v_lshl_add_u32 v2, v2, 5, v4
    ds_read_b64_tr_b16 v[216:217], v2 offset:0
    ds_read_b64_tr_b16 v[218:219], v2 offset:10240
    ds_read_b64_tr_b16 v[220:221], v2 offset:20480
    ds_read_b64_tr_b16 v[222:223], v2 offset:30720
    s_mul_i32 s35, s3, 10
    s_add_u32 s35, s35, 6
    v_xor_b32 v3, s35, v22
    v_lshl_add_u32 v3, v3, 5, v4
    ds_read_b64_tr_b16 v[224:225], v3 offset:0
    ds_read_b64_tr_b16 v[226:227], v3 offset:10240
    ds_read_b64_tr_b16 v[228:229], v3 offset:20480
    ds_read_b64_tr_b16 v[230:231], v3 offset:30720
    s_mul_i32 s35, s3, 10
    s_add_u32 s35, s35, 8
    v_xor_b32 v2, s35, v22
    v_lshl_add_u32 v2, v2, 5, v4
    ds_read_b64_tr_b16 v[248:249], v2 offset:0
    ds_read_b64_tr_b16 v[250:251], v2 offset:10240
    ds_read_b64_tr_b16 v[252:253], v2 offset:20480
    ds_read_b64_tr_b16 v[254:255], v2 offset:30720
    s_waitcnt lgkmcnt(0)
    s_barrier
    s_mov_b32 s30, 0
    s_lshr_b32 s32, s30, 3
    s_xor_b32 s32, s32, s6
    s_lshl_b32 s31, s30, 16
    s_bitcmp1_b32 s32, 0
    s_cselect_b32 s30, 16384, 0
    s_add_u32 s31, s31, s30
    s_bitcmp1_b32 s32, 1
    s_cselect_b32 s30, 4096, 0
    s_add_u32 s31, s31, s30
    v_lshlrev_b32 v2, 4, v0
    v_add_u32 v5, 114688, v2
    v_add_u32 v2, s31, v2
    v_add_u32 v3, 65536, v2
    s_add_u32 s31, s31, 131072
    v_lshl_add_u32 v4, v0, 3, s31
    v_lshlrev_b32 v6, 3, v0
    v_add_u32 v6, 122880, v6
    s_mul_i32 s30, s3, 28672
    v_lshl_add_u32 v7, v1, 4, s30
    v_lshlrev_b32 v8, 4, v1
    v_add_u32 v8, 114688, v8
    v_and_b32 v9, 8, v1
    v_cmp_eq_u32 vcc, 0, v9
    v_mov_b32 v9, 0xeeee
    v_mov_b32 v10, 0x4444
    v_cndmask_b32 v9, v9, v10, vcc
    ds_write_b128 v7, v[32:35] offset:0
    ds_write_b128 v7, v[36:39] offset:1024
    ds_write_b128 v7, v[40:43] offset:2048
    ds_write_b128 v7, v[44:47] offset:3072
    ds_write_b128 v7, v[48:51] offset:4096
    ds_write_b128 v7, v[52:55] offset:5120
    ds_write_b128 v7, v[56:59] offset:6144
    ds_write_b128 v7, v[60:63] offset:7168
    ds_write_b128 v7, v[64:67] offset:8192
    ds_write_b128 v7, v[68:71] offset:9216
    ds_write_b128 v7, v[72:75] offset:10240
    ds_write_b128 v7, v[76:79] offset:11264
    ds_write_b128 v7, v[80:83] offset:12288
    ds_write_b128 v7, v[84:87] offset:13312
    ds_write_b128 v7, v[88:91] offset:14336
    ds_write_b128 v7, v[92:95] offset:15360
    ds_write_b128 v7, v[96:99] offset:16384
    ds_write_b128 v7, v[100:103] offset:17408
    ds_write_b128 v7, v[104:107] offset:18432
    ds_write_b128 v7, v[108:111] offset:19456
    ds_write_b128 v7, v[112:115] offset:20480
    ds_write_b128 v7, v[116:119] offset:21504
    ds_write_b128 v7, v[120:123] offset:22528
    ds_write_b128 v7, v[124:127] offset:23552
    ds_write_b128 v7, v[128:131] offset:24576
    ds_write_b128 v7, v[132:135] offset:25600
    ds_write_b128 v7, v[136:139] offset:26624
    ds_write_b128 v7, v[140:143] offset:27648
    s_waitcnt lgkmcnt(0)
    s_mul_i32 s30, s3, 10
    s_and_b32 s31, s4, 15
    s_lshl_b32 s31, s31, 8
    s_lshr_b32 s32, s4, 4
    v_and_b32 v18, 15, v1
    v_lshl_add_u32 v11, v18, 4, s31
    v_mov_b32 v12, v11
    v_bfe_u32 v20, v1, 4, 1
    v_lshl_add_u32 v13, v20, 3, v11
    v_lshrrev_b32 v21, 5, v1
    v_add_u32 v21, s30, v21
    v_lshl_add_u32 v22, v20, 1, v21
    v_add_u32 v23, 4, v22
    v_add_u32 v21, 8, v21
    v_lshrrev_b32 v18, 2, v22
    v_lshl_add_u32 v18, v18, 1, s32
    v_add_u32 v18, 3, v18
    v_lshl_add_u32 v11, v18, 16, v11
    v_lshrrev_b32 v18, 3, v18
    v_xor_b32 v22, v22, v18
    v_and_b32 v18, 1, v22
    v_lshl_add_u32 v11, v18, 14, v11
    v_bfe_u32 v18, v22, 1, 1
    v_lshl_add_u32 v11, v18, 12, v11
    v_lshrrev_b32 v18, 2, v23
    v_lshl_add_u32 v18, v18, 1, s32
    v_add_u32 v18, 3, v18
    v_lshl_add_u32 v12, v18, 16, v12
    v_lshrrev_b32 v18, 3, v18
    v_xor_b32 v23, v23, v18
    v_and_b32 v18, 1, v23
    v_lshl_add_u32 v12, v18, 14, v12
    v_bfe_u32 v18, v23, 1, 1
    v_lshl_add_u32 v12, v18, 12, v12
    v_lshrrev_b32 v18, 2, v21
    v_lshl_add_u32 v18, v18, 1, s32
    v_add_u32 v18, 3, v18
    v_lshl_add_u32 v13, v18, 16, v13
    v_lshrrev_b32 v18, 3, v18
    v_xor_b32 v21, v21, v18
    v_and_b32 v18, 1, v21
    v_lshl_add_u32 v13, v18, 14, v13
    v_bfe_u32 v18, v21, 1, 1
    v_lshl_add_u32 v13, v18, 12, v13
    v_and_b32 v18, 15, v1
    v_lshlrev_b32 v18, 4, v18
    v_lshrrev_b32 v19, 1, v1
    v_xor_b32 v19, v19, v1
    v_and_b32 v19, 8, v19
    v_add_u32 v18, v18, v19
    v_lshrrev_b32 v19, 5, v1
    s_lshl_b32 s30, s3, 8
    s_add_u32 s30, s30, 149504
    v_lshl_add_u32 v15, v19, 2, v18
    s_and_b32 s31, s3, 1
    s_lshl_b32 s31, s31, 5
    v_xor_b32 v15, s31, v15
    v_add_u32 v15, s30, v15
    v_lshrrev_b32 v16, 4, v1
    v_lshlrev_b32 v16, 6, v16
    v_bfe_u32 v18, v1, 3, 1
    v_lshl_add_u32 v16, v18, 8, v16
    v_lshl_add_u32 v16, v18, 5, v16
    v_bfe_u32 v18, v1, 2, 1
    v_lshl_add_u32 v16, v18, 4, v16
    v_lshrrev_b32 v18, 5, v1
    v_xor_b32 v18, v18, v1
    v_and_b32 v18, 1, v18
    v_lshl_add_u32 v16, v18, 3, v16
    v_add_u32 v16, 149504, v16
    v_xor_b32 v17, 32, v16
    s_lshl_b32 s30, s2, 7
    s_lshl_b32 s31, s3, 2
    s_add_u32 s30, s30, s31
    s_add_u32 s30, s30, 246415360
    v_mov_b32 v10, s30
    s_mov_b32 s31, 0
    s_waitcnt vmcnt(0)
    v_mov_b32 v18, v28
    s_nop 0
    v_readfirstlane_b32 s30, v18
    s_nop 0
    s_cmp_ge_u32 s30, 2
    s_nop 1
    s_cbranch_scc1 Lwo_38
Lwa_37:
    v_lshlrev_b32 v19, 2, v1
    buffer_load_dword v18, v19, s[24:27], 0 offen offset:192 sc1
    s_add_u32 s31, s31, 1
    s_cmp_gt_u32 s31, 400000
    s_cbranch_scc1 L_abort
    s_sleep 2
    s_waitcnt vmcnt(0)
    v_readfirstlane_b32 s30, v18
    s_nop 0
    s_cmp_lt_u32 s30, 2
    s_nop 1
    s_cbranch_scc1 Lwa_37
Lwo_38:
    v_readlane_b32 s60, v18, 1
    v_readlane_b32 s7, v18, 2
    v_readlane_b32 s28, v18, 3
    s_mov_b32 s29, 0
    s_lshr_b32 s37, s61, 1
    s_bitcmp1_b32 s7, s37
    s_cselect_b32 s38, 16384, 0
    s_bitcmp1_b32 s28, s37
    s_cselect_b32 s62, 4096, 0
    s_or_b32 s38, s38, s62
    s_lshl_b32 s62, s37, 21
    s_lshr_b32 s37, s60, s37
    s_and_b32 s37, s37, 1
    s_lshl_b32 s37, s37, 13
    s_add_u32 s62, s62, s37
    s_and_b32 s37, s61, 1
    s_lshl_b32 s37, s37, 15
    s_add_u32 s62, s62, s37
    s_xor_b32 s37, s38, s29
    s_mov_b32 s29, s38
    v_xor_b32 v2, s37, v2
    v_xor_b32 v3, s37, v3
    v_xor_b32 v4, s37, v4
    v_xor_b32 v11, s37, v11
    v_xor_b32 v12, s37, v12
    v_xor_b32 v13, s37, v13
    s_or_b32 s30, s4, s3
    s_cselect_b32 s47, 2146435072, 0
    s_mov_b32 s64, 0xffff
    s_mov_b32 s65, 0xffff
    s_cmp_eq_u32 s3, 1
    s_cbranch_scc1 L_b_w1
    s_cmp_eq_u32 s3, 2
    s_cbranch_scc1 L_b_w2
    s_cmp_eq_u32 s3, 3
    s_cbranch_scc1 L_b_w3
L_b_loop0:
    v_mov_b32 v64, 0
    v_mov_b32 v65, 0
    v_mov_b32 v66, 0
    v_mov_b32 v67, 0
    v_mov_b32 v68, 0
    v_mov_b32 v69, 0
    v_mov_b32 v70, 0
    v_mov_b32 v71, 0
    v_mov_b32 v72, 0
    v_mov_b32 v73, 0
    v_mov_b32 v74, 0
    v_mov_b32 v75, 0
    v_mov_b32 v100, 0
    v_mov_b32 v101, 0
    v_mov_b32 v102, 0
    v_mov_b32 v103, 0
    v_mov_b32 v104, 0
    v_mov_b32 v105, 0
    v_mov_b32 v106, 0
    v_mov_b32 v107, 0
    v_mov_b32 v108, 0
    v_mov_b32 v109, 0
    v_mov_b32 v110, 0
    v_mov_b32 v111, 0
    v_mov_b32 v112, 0
    v_mov_b32 v113, 0
    v_mov_b32 v114, 0
    v_mov_b32 v115, 0
    v_mov_b32 v116, 0
    v_mov_b32 v117, 0
    v_mov_b32 v118, 0
    v_mov_b32 v119, 0
    ds_read_b128 v[76:79], v7 offset:4096
    ds_read_b128 v[80:83], v7 offset:5120
    ds_read_b128 v[84:87], v7 offset:0
    ds_read_b128 v[88:91], v7 offset:1024
    ds_read_b128 v[92:95], v7 offset:2048
    ds_read_b128 v[96:99], v7 offset:3072
    s_mov_b32 s31, 0
    s_waitcnt lgkmcnt(0)
    s_cmp_eq_u32 s61, 0
    s_cbranch_scc1 Lnp_40
    s_sleep 30
Lnp_40:
Lgm_39:
    buffer_load_dwordx4 v[24:27], v2, s[8:11], s62 offen sc1
    buffer_load_dwordx4 v[40:43], v3, s[8:11], s62 offen sc1
    buffer_load_dwordx2 v[60:61], v4, s[8:11], s62 offen sc1
    s_add_u32 s31, s31, 1
    s_cmp_gt_u32 s31, 400000
    s_cbranch_scc1 L_abort
    s_waitcnt vmcnt(2)
    ds_write_b128 v5, v[24:27]
    v_max3_u32 v18, v24, v25, v26
    s_waitcnt vmcnt(1)
    ds_write_b128 v5, v[40:43] offset:4096
    v_max3_u32 v19, v27, v40, v41
    v_max3_u32 v18, v18, v42, v43
    s_waitcnt vmcnt(0)
    ds_write_b64 v6, v[60:61]
    v_max3_u32 v19, v19, v60, v61
    v_max_u32 v18, v18, v19
    v_cmp_eq_u32 vcc, -1, v18
    s_cbranch_vccnz Lgm_39
    v_smfmac_f32_16x16x64_bf16 v[64:67], v[24:27], a[0:7], v9
    v_smfmac_f32_16x16x64_bf16 v[68:71], v[24:27], a[8:15], v9
    s_waitcnt lgkmcnt(0)
    s_barrier
    ds_read_b128 v[28:31], v8 offset:1024
    ds_read_b128 v[32:35], v8 offset:2048
    v_smfmac_f32_16x16x64_bf16 v[64:67], v[40:43], a[48:55], v9
    ds_read_b128 v[36:39], v8 offset:3072
    ds_read_b128 v[44:47], v8 offset:5120
    v_smfmac_f32_16x16x64_bf16 v[68:71], v[40:43], v[76:83], v9
    ds_read_b128 v[48:51], v8 offset:6144
    ds_read_b128 v[52:55], v8 offset:7168
    s_waitcnt lgkmcnt(5)
    v_smfmac_f32_16x16x64_bf16 v[64:67], v[28:31], a[16:23], v9
    ds_read_b128 v[56:59], v8 offset:8192
    ds_read_b128 v[60:63], v8 offset:9216
    v_smfmac_f32_16x16x64_bf16 v[68:71], v[28:31], a[24:31], v9
    ds_read_b128 v[76:79], v7 offset:6144
    s_waitcnt lgkmcnt(7)
    v_smfmac_f32_16x16x64_bf16 v[64:67], v[32:35], a[32:39], v9
    ds_read_b128 v[80:83], v7 offset:7168
    v_smfmac_f32_16x16x64_bf16 v[68:71], v[32:35], a[40:47], v9
    s_waitcnt lgkmcnt(7)
    v_smfmac_f32_16x16x64_bf16 v[64:67], v[36:39], v[84:91], v9
    ds_read_b128 v[84:87], v7 offset:8192
    s_waitcnt lgkmcnt(7)
    v_smfmac_f32_16x16x64_bf16 v[64:67], v[44:47], a[56:63], v9
    ds_read_b128 v[88:91], v7 offset:9216
    s_waitcnt lgkmcnt(7)
    v_smfmac_f32_16x16x64_bf16 v[64:67], v[48:51], a[64:71], v9
    s_waitcnt lgkmcnt(6)
    v_smfmac_f32_16x16x64_bf16 v[64:67], v[52:55], a[72:79], v9
    s_waitcnt lgkmcnt(5)
    v_smfmac_f32_16x16x64_bf16 v[64:67], v[56:59], a[80:87], v9
    s_waitcnt lgkmcnt(4)
    v_smfmac_f32_16x16x64_bf16 v[64:67], v[60:63], v[92:99], v9
    ds_read_b128 v[92:95], v7 offset:10240
    v_smfmac_f32_16x16x64_bf16 v[68:71], v[36:39], a[88:95], v9
    ds_read_b128 v[96:99], v7 offset:11264
    v_smfmac_f32_16x16x64_bf16 v[68:71], v[44:47], a[96:103], v9
    v_smfmac_f32_16x16x64_bf16 v[68:71], v[48:51], a[104:111], v9
    s_nop 2
    v_permlane32_swap_b32 v64, v66
    v_smfmac_f32_16x16x64_bf16 v[68:71], v[52:55], a[112:119], v9
    v_permlane32_swap_b32 v65, v67
    v_smfmac_f32_16x16x64_bf16 v[68:71], v[56:59], a[120:127], v9
    s_waitcnt lgkmcnt(4)
    v_add_f32 v64, v64, v66
    v_smfmac_f32_16x16x64_bf16 v[68:71], v[60:63], v[76:83], v9
    ds_read_b128 v[76:79], v7 offset:12288
    v_add_f32 v65, v65, v67
    v_smfmac_f32_16x16x64_bf16 v[72:75], v[24:27], a[128:135], v9
    ds_read_b128 v[80:83], v7 offset:13312
    v_cvt_pk_bf16_f32 v64, v64, v65
    v_smfmac_f32_16x16x64_bf16 v[72:75], v[40:43], a[152:159], v9
    ds_write_b32 v15, v64 offset:0
    v_smfmac_f32_16x16x64_bf16 v[72:75], v[28:31], a[136:143], v9
    v_permlane32_swap_b32 v68, v70
    v_smfmac_f32_16x16x64_bf16 v[72:75], v[32:35], a[144:151], v9
    s_waitcnt lgkmcnt(5)
    v_permlane32_swap_b32 v69, v71
    v_smfmac_f32_16x16x64_bf16 v[72:75], v[36:39], v[84:91], v9
    ds_read_b128 v[84:87], v7 offset:14336
    ds_read_b128 v[88:91], v7 offset:15360
    v_add_f32 v68, v68, v70
    v_smfmac_f32_16x16x64_bf16 v[72:75], v[44:47], a[160:167], v9
    s_waitcnt lgkmcnt(2)
    s_barrier
    v_smfmac_f32_16x16x64_bf16 v[72:75], v[48:51], a[168:175], v9
    ds_read_b64_tr_b16 v[120:121], v16 offset:0
    ds_read_b64_tr_b16 v[122:123], v17 offset:0
    v_add_f32 v69, v69, v71
    v_smfmac_f32_16x16x64_bf16 v[72:75], v[52:55], a[176:183], v9
    ds_read_b64_tr_b16 v[124:125], v16 offset:512
    ds_read_b64_tr_b16 v[126:127], v17 offset:512
    v_cvt_pk_bf16_f32 v68, v68, v69
    v_smfmac_f32_16x16x64_bf16 v[72:75], v[56:59], v[92:99], v9
    ds_write_b32 v15, v68 offset:1024
    v_smfmac_f32_16x16x64_bf16 v[72:75], v[60:63], a[184:191], v9
    ds_read_b128 v[92:95], v7 offset:16384
    s_waitcnt lgkmcnt(4)
    v_smfmac_f32_16x16x64_bf16 v[100:103], v[120:123], v[76:83], v9
    ds_read_b128 v[96:99], v7 offset:17408
    ds_read_b128 v[76:79], v7 offset:18432
    v_smfmac_f32_16x16x64_bf16 v[104:107], v[120:123], a[192:199], v9
    ds_read_b128 v[80:83], v7 offset:19456
    v_smfmac_f32_16x16x64_bf16 v[108:111], v[120:123], a[200:207], v9
    s_waitcnt lgkmcnt(4)
    s_barrier
    v_smfmac_f32_16x16x64_bf16 v[112:115], v[120:123], a[208:215], v9
    ds_read_b64_tr_b16 v[128:129], v16 offset:1024
    v_permlane32_swap_b32 v72, v74
    v_smfmac_f32_16x16x64_bf16 v[116:119], v[120:123], v[84:91], v9
    ds_read_b64_tr_b16 v[130:131], v17 offset:1024
    v_permlane32_swap_b32 v73, v75
    v_smfmac_f32_16x16x64_bf16 v[100:103], v[124:127], a[216:223], v9
    ds_read_b64_tr_b16 v[132:133], v16 offset:1536
    v_add_f32 v72, v72, v74
    v_smfmac_f32_16x16x64_bf16 v[104:107], v[124:127], a[224:231], v9
    ds_read_b64_tr_b16 v[134:135], v17 offset:1536
    v_add_f32 v73, v73, v75
    v_smfmac_f32_16x16x64_bf16 v[108:111], v[124:127], a[232:239], v9
    ds_read_b128 v[84:87], v7 offset:20480
    s_waitcnt lgkmcnt(7)
    v_cvt_pk_bf16_f32 v72, v72, v73
    v_smfmac_f32_16x16x64_bf16 v[112:115], v[124:127], v[92:99], v9
    ds_write_b32 v15, v72 offset:2048
    v_smfmac_f32_16x16x64_bf16 v[116:119], v[124:127], a[240:247], v9
    ds_read_b128 v[88:91], v7 offset:21504
    s_waitcnt lgkmcnt(5)
    v_smfmac_f32_16x16x64_bf16 v[100:103], v[128:131], a[248:255], v9
    ds_read_b128 v[92:95], v7 offset:22528
    v_smfmac_f32_16x16x64_bf16 v[104:107], v[128:131], v[144:151], v9
    ds_read_b128 v[96:99], v7 offset:23552
    v_smfmac_f32_16x16x64_bf16 v[108:111], v[128:131], v[76:83], v9
    s_waitcnt lgkmcnt(3)
    s_barrier
    v_smfmac_f32_16x16x64_bf16 v[112:115], v[128:131], v[152:159], v9
    ds_read_b64_tr_b16 v[136:137], v16 offset:2048
    v_smfmac_f32_16x16x64_bf16 v[100:103], v[132:135], v[160:167], v9
    ds_read_b64_tr_b16 v[138:139], v17 offset:2048
    v_smfmac_f32_16x16x64_bf16 v[104:107], v[132:135], v[168:175], v9
    ds_read_b64_tr_b16 v[140:141], v16 offset:2560
    s_waitcnt lgkmcnt(5)
    v_smfmac_f32_16x16x64_bf16 v[108:111], v[132:135], v[84:91], v9
    ds_read_b64_tr_b16 v[142:143], v17 offset:2560
    v_smfmac_f32_16x16x64_bf16 v[112:115], v[132:135], v[176:183], v9
    ds_read_b128 v[76:79], v7 offset:24576
    s_waitcnt lgkmcnt(3)
    v_smfmac_f32_16x16x64_bf16 v[100:103], v[136:139], v[184:191], v9
    ds_read_b128 v[80:83], v7 offset:25600
    s_waitcnt lgkmcnt(2)
    v_smfmac_f32_16x16x64_bf16 v[100:103], v[140:143], v[192:199], v9
    ds_read_b128 v[84:87], v7 offset:26624
    v_smfmac_f32_16x16x64_bf16 v[104:107], v[136:139], v[92:99], v9
    ds_read_b128 v[88:91], v7 offset:27648
    v_smfmac_f32_16x16x64_bf16 v[104:107], v[140:143], v[200:207], v9
    v_smfmac_f32_16x16x64_bf16 v[108:111], v[136:139], v[208:215], v9
    v_smfmac_f32_16x16x64_bf16 v[108:111], v[140:143], v[216:223], v9
    s_waitcnt lgkmcnt(2)
    s_nop 0
    v_cvt_pk_bf16_f32 v24, v100, v101
    v_smfmac_f32_16x16x64_bf16 v[112:115], v[136:139], v[76:83], v9
    v_cvt_pk_bf16_f32 v26, v102, v103
    v_smfmac_f32_16x16x64_bf16 v[112:115], v[140:143], v[224:231], v9
    v_cvt_pk_bf16_f32 v25, v104, v105
    v_smfmac_f32_16x16x64_bf16 v[116:119], v[128:131], v[232:239], v9
    v_cvt_pk_bf16_f32 v27, v106, v107
    v_smfmac_f32_16x16x64_bf16 v[116:119], v[132:135], v[240:247], v9
    s_waitcnt lgkmcnt(0)
    v_permlane16_swap_b32 v24, v25
    v_smfmac_f32_16x16x64_bf16 v[116:119], v[136:139], v[84:91], v9
    v_permlane16_swap_b32 v26, v27
    v_smfmac_f32_16x16x64_bf16 v[116:119], v[140:143], v[248:255], v9
    buffer_store_dwordx4 v[24:27], v11, s[8:11], s62 offen sc1
    v_cvt_pk_bf16_f32 v28, v108, v109
    v_cvt_pk_bf16_f32 v30, v110, v111
    v_cvt_pk_bf16_f32 v29, v112, v113
    v_cvt_pk_bf16_f32 v31, v114, v115
    s_nop 0
    v_permlane16_swap_b32 v28, v29
    v_permlane16_swap_b32 v30, v31
    v_cvt_pk_bf16_f32 v32, v116, v117
    buffer_store_dwordx4 v[28:31], v12, s[8:11], s62 offen sc1
    v_cvt_pk_bf16_f32 v33, v118, v119
    s_nop 1
    v_permlane16_swap_b32 v32, v33
    buffer_store_dwordx2 v[32:33], v13, s[8:11], s62 offen sc1
    v_mov_b32 v18, s61
    s_mov_b64 exec, 1
    buffer_store_dword v18, v10, s[8:11], s47 offen sc1
    s_mov_b64 exec, -1
    s_add_u32 s61, s61, 1
    s_cmp_lg_u32 s61, 8
    s_cbranch_scc1 Lswm_41
    s_mov_b32 s31, 0
Lwa_42:
    v_lshlrev_b32 v19, 2, v1
    buffer_load_dword v18, v19, s[24:27], 0 offen offset:192 sc1
    s_add_u32 s31, s31, 1
    s_cmp_gt_u32 s31, 400000
    s_cbranch_scc1 L_abort
    s_sleep 2
    s_waitcnt vmcnt(0)
    v_readfirstlane_b32 s30, v18
    s_nop 0
    s_cmp_lt_u32 s30, 3
    s_nop 1
    s_cbranch_scc1 Lwa_42
    v_readlane_b32 s60, v18, 4
    v_readlane_b32 s7, v18, 5
    v_readlane_b32 s28, v18, 6
    s_nop 4
Lswm_41:
    s_lshr_b32 s37, s61, 1
    s_bitcmp1_b32 s7, s37
    s_cselect_b32 s38, 16384, 0
    s_bitcmp1_b32 s28, s37
    s_cselect_b32 s62, 4096, 0
    s_or_b32 s38, s38, s62
    s_lshl_b32 s62, s37, 21
    s_lshr_b32 s37, s60, s37
    s_and_b32 s37, s37, 1
    s_lshl_b32 s37, s37, 13
    s_add_u32 s62, s62, s37
    s_and_b32 s37, s61, 1
    s_lshl_b32 s37, s37, 15
    s_add_u32 s62, s62, s37
    s_xor_b32 s37, s38, s29
    s_mov_b32 s29, s38
    v_xor_b32 v2, s37, v2
    v_xor_b32 v3, s37, v3
    v_xor_b32 v4, s37, v4
    v_xor_b32 v11, s37, v11
    v_xor_b32 v12, s37, v12
    v_xor_b32 v13, s37, v13
    s_cmp_lt_u32 s61, 64
    s_cbranch_scc1 L_b_loop0
    s_waitcnt vmcnt(0)
    s_barrier
    s_cmp_lg_u32 s3, 0
    s_cbranch_scc1 L_end
    v_mov_b32 v18, 64
    v_lshlrev_b32 v19, 2, v1
    s_lshl_b32 s30, s2, 7
    s_add_u32 s30, s30, 246415360
    s_mov_b64 exec, 0xffffffff
    buffer_store_dword v18, v19, s[8:11], s30 offen sc1
    s_branch L_end
L_b_w1:
L_b_loop1:
    v_mov_b32 v64, 0
    v_mov_b32 v65, 0
    v_mov_b32 v66, 0
    v_mov_b32 v67, 0
    v_mov_b32 v68, 0
    v_mov_b32 v69, 0
    v_mov_b32 v70, 0
    v_mov_b32 v71, 0
    v_mov_b32 v72, 0
    v_mov_b32 v73, 0
    v_mov_b32 v74, 0
    v_mov_b32 v75, 0
    v_mov_b32 v100, 0
    v_mov_b32 v101, 0
    v_mov_b32 v102, 0
    v_mov_b32 v103, 0
    v_mov_b32 v104, 0
    v_mov_b32 v105, 0
    v_mov_b32 v106, 0
    v_mov_b32 v107, 0
    v_mov_b32 v108, 0
    v_mov_b32 v109, 0
    v_mov_b32 v110, 0
    v_mov_b32 v111, 0
    v_mov_b32 v112, 0
    v_mov_b32 v113, 0
    v_mov_b32 v114, 0
    v_mov_b32 v115, 0
    v_mov_b32 v116, 0
    v_mov_b32 v117, 0
    v_mov_b32 v118, 0
    v_mov_b32 v119, 0
    ds_read_b128 v[76:79], v7 offset:0
    ds_read_b128 v[80:83], v7 offset:1024
    ds_read_b128 v[84:87], v7 offset:2048
    ds_read_b128 v[88:91], v7 offset:3072
    ds_read_b128 v[92:95], v7 offset:4096
    ds_read_b128 v[96:99], v7 offset:5120
    s_mov_b32 s31, 0
    s_waitcnt lgkmcnt(0)
    s_cmp_eq_u32 s61, 0
    s_cbranch_scc1 Lnp_45
    s_sleep 30
Lnp_45:
Lgm_44:
    buffer_load_dwordx4 v[28:31], v2, s[8:11], s62 offen sc1
    buffer_load_dwordx4 v[44:47], v3, s[8:11], s62 offen sc1
    buffer_load_dwordx2 v[60:61], v4, s[8:11], s62 offen sc1
    s_add_u32 s31, s31, 1
    s_cmp_gt_u32 s31, 400000
    s_cbranch_scc1 L_abort
    s_waitcnt vmcnt(2)
    ds_write_b128 v5, v[28:31]
    v_max3_u32 v18, v28, v29, v30
    s_waitcnt vmcnt(1)
    ds_write_b128 v5, v[44:47] offset:4096
    v_max3_u32 v19, v31, v44, v45
    v_max3_u32 v18, v18, v46, v47
    s_waitcnt vmcnt(0)
    ds_write_b64 v6, v[60:61]
    v_max3_u32 v19, v19, v60, v61
    v_max_u32 v18, v18, v19
    v_cmp_eq_u32 vcc, -1, v18
    s_cbranch_vccnz Lgm_44
    v_smfmac_f32_16x16x64_bf16 v[64:67], v[28:31], a[16:23], v9
    v_smfmac_f32_16x16x64_bf16 v[68:71], v[28:31], a[24:31], v9
    s_waitcnt lgkmcnt(0)
    s_barrier
    ds_read_b128 v[24:27], v8 offset:0
    ds_read_b128 v[32:35], v8 offset:2048
    v_smfmac_f32_16x16x64_bf16 v[64:67], v[44:47], a[56:63], v9
    ds_read_b128 v[36:39], v8 offset:3072
    ds_read_b128 v[40:43], v8 offset:4096
    v_smfmac_f32_16x16x64_bf16 v[68:71], v[44:47], a[96:103], v9
    ds_read_b128 v[48:51], v8 offset:6144
    ds_read_b128 v[52:55], v8 offset:7168
    s_waitcnt lgkmcnt(5)
    v_smfmac_f32_16x16x64_bf16 v[64:67], v[24:27], a[0:7], v9
    ds_read_b128 v[56:59], v8 offset:8192
    ds_read_b128 v[60:63], v8 offset:9216
    v_smfmac_f32_16x16x64_bf16 v[68:71], v[24:27], a[8:15], v9
    s_waitcnt lgkmcnt(6)
    v_smfmac_f32_16x16x64_bf16 v[64:67], v[32:35], a[32:39], v9
    v_smfmac_f32_16x16x64_bf16 v[68:71], v[32:35], a[40:47], v9
    s_waitcnt lgkmcnt(5)
    v_smfmac_f32_16x16x64_bf16 v[64:67], v[36:39], v[76:83], v9
    ds_read_b128 v[76:79], v7 offset:6144
    s_waitcnt lgkmcnt(5)
    v_smfmac_f32_16x16x64_bf16 v[64:67], v[40:43], a[48:55], v9
    ds_read_b128 v[80:83], v7 offset:7168
    s_waitcnt lgkmcnt(5)
    v_smfmac_f32_16x16x64_bf16 v[64:67], v[48:51], a[64:71], v9
    s_waitcnt lgkmcnt(4)
    v_smfmac_f32_16x16x64_bf16 v[64:67], v[52:55], a[72:79], v9
    s_waitcnt lgkmcnt(3)
    v_smfmac_f32_16x16x64_bf16 v[64:67], v[56:59], a[80:87], v9
    s_waitcnt lgkmcnt(2)
    v_smfmac_f32_16x16x64_bf16 v[64:67], v[60:63], v[84:91], v9
    ds_read_b128 v[84:87], v7 offset:8192
    v_smfmac_f32_16x16x64_bf16 v[68:71], v[36:39], a[88:95], v9
    ds_read_b128 v[88:91], v7 offset:9216
    v_smfmac_f32_16x16x64_bf16 v[68:71], v[40:43], v[92:99], v9
    ds_read_b128 v[92:95], v7 offset:10240
    v_smfmac_f32_16x16x64_bf16 v[68:71], v[48:51], a[104:111], v9
    s_nop 1
    v_permlane32_swap_b32 v64, v66
    v_smfmac_f32_16x16x64_bf16 v[68:71], v[52:55], a[112:119], v9
    v_permlane32_swap_b32 v65, v67
    v_smfmac_f32_16x16x64_bf16 v[68:71], v[56:59], a[120:127], v9
    ds_read_b128 v[96:99], v7 offset:11264
    s_waitcnt lgkmcnt(4)
    v_add_f32 v64, v64, v66
    v_smfmac_f32_16x16x64_bf16 v[68:71], v[60:63], v[76:83], v9
    ds_read_b128 v[76:79], v7 offset:12288
    v_add_f32 v65, v65, v67
    v_smfmac_f32_16x16x64_bf16 v[72:75], v[28:31], a[136:143], v9
    ds_read_b128 v[80:83], v7 offset:13312
    v_cvt_pk_bf16_f32 v64, v64, v65
    v_smfmac_f32_16x16x64_bf16 v[72:75], v[44:47], a[160:167], v9
    ds_write_b32 v15, v64 offset:0
    v_smfmac_f32_16x16x64_bf16 v[72:75], v[24:27], a[128:135], v9
    v_permlane32_swap_b32 v68, v70
    v_smfmac_f32_16x16x64_bf16 v[72:75], v[32:35], a[144:151], v9
    s_waitcnt lgkmcnt(5)
    v_permlane32_swap_b32 v69, v71
    v_smfmac_f32_16x16x64_bf16 v[72:75], v[36:39], v[84:91], v9
    ds_read_b128 v[84:87], v7 offset:14336
    ds_read_b128 v[88:91], v7 offset:15360
    v_add_f32 v68, v68, v70
    v_smfmac_f32_16x16x64_bf16 v[72:75], v[40:43], a[152:159], v9
    s_waitcnt lgkmcnt(2)
    s_barrier
    v_smfmac_f32_16x16x64_bf16 v[72:75], v[48:51], a[168:175], v9
    ds_read_b64_tr_b16 v[120:121], v16 offset:0
    ds_read_b64_tr_b16 v[122:123], v17 offset:0
    v_add_f32 v69, v69, v71
    v_smfmac_f32_16x16x64_bf16 v[72:75], v[52:55], a[176:183], v9
    ds_read_b64_tr_b16 v[124:125], v16 offset:512
    ds_read_b64_tr_b16 v[126:127], v17 offset:512
    v_cvt_pk_bf16_f32 v68, v68, v69
    v_smfmac_f32_16x16x64_bf16 v[72:75], v[56:59], v[92:99], v9
    ds_write_b32 v15, v68 offset:1024
    v_smfmac_f32_16x16x64_bf16 v[72:75], v[60:63], a[184:191], v9
    ds_read_b128 v[92:95], v7 offset:16384
    s_waitcnt lgkmcnt(4)
    v_smfmac_f32_16x16x64_bf16 v[100:103], v[120:123], v[76:83], v9
    ds_read_b128 v[96:99], v7 offset:17408
    ds_read_b128 v[76:79], v7 offset:18432
    v_smfmac_f32_16x16x64_bf16 v[104:107], v[120:123], a[192:199], v9
    ds_read_b128 v[80:83], v7 offset:19456
    v_smfmac_f32_16x16x64_bf16 v[108:111], v[120:123], a[200:207], v9
    s_waitcnt lgkmcnt(4)
    s_barrier
    v_smfmac_f32_16x16x64_bf16 v[112:115], v[120:123], a[208:215], v9
    ds_read_b64_tr_b16 v[128:129], v16 offset:1024
    v_permlane32_swap_b32 v72, v74
    v_smfmac_f32_16x16x64_bf16 v[116:119], v[120:123], v[84:91], v9
    ds_read_b64_tr_b16 v[130:131], v17 offset:1024
    v_permlane32_swap_b32 v73, v75
    v_smfmac_f32_16x16x64_bf16 v[100:103], v[124:127], a[216:223], v9
    ds_read_b64_tr_b16 v[132:133], v16 offset:1536
    v_add_f32 v72, v72, v74
    v_smfmac_f32_16x16x64_bf16 v[104:107], v[124:127], a[224:231], v9
    ds_read_b64_tr_b16 v[134:135], v17 offset:1536
    v_add_f32 v73, v73, v75
    v_smfmac_f32_16x16x64_bf16 v[108:111], v[124:127], a[232:239], v9
    ds_read_b128 v[84:87], v7 offset:20480
    s_waitcnt lgkmcnt(7)
    v_cvt_pk_bf16_f32 v72, v72, v73
    v_smfmac_f32_16x16x64_bf16 v[112:115], v[124:127], v[92:99], v9
    ds_write_b32 v15, v72 offset:2048
    v_smfmac_f32_16x16x64_bf16 v[116:119], v[124:127], a[240:247], v9
    ds_read_b128 v[88:91], v7 offset:21504
    s_waitcnt lgkmcnt(5)
    v_smfmac_f32_16x16x64_bf16 v[100:103], v[128:131], a[248:255], v9
    ds_read_b128 v[92:95], v7 offset:22528
    v_smfmac_f32_16x16x64_bf16 v[104:107], v[128:131], v[144:151], v9
    ds_read_b128 v[96:99], v7 offset:23552
    v_smfmac_f32_16x16x64_bf16 v[108:111], v[128:131], v[76:83], v9
    s_waitcnt lgkmcnt(3)
    s_barrier
    v_smfmac_f32_16x16x64_bf16 v[112:115], v[128:131], v[152:159], v9
    ds_read_b64_tr_b16 v[136:137], v16 offset:2048
    v_smfmac_f32_16x16x64_bf16 v[100:103], v[132:135], v[160:167], v9
    ds_read_b64_tr_b16 v[138:139], v17 offset:2048
    v_smfmac_f32_16x16x64_bf16 v[104:107], v[132:135], v[168:175], v9
    ds_read_b64_tr_b16 v[140:141], v16 offset:2560
    s_waitcnt lgkmcnt(5)
    v_smfmac_f32_16x16x64_bf16 v[108:111], v[132:135], v[84:91], v9
    ds_read_b64_tr_b16 v[142:143], v17 offset:2560
    v_smfmac_f32_16x16x64_bf16 v[112:115], v[132:135], v[176:183], v9
    ds_read_b128 v[76:79], v7 offset:24576
    s_waitcnt lgkmcnt(3)
    v_smfmac_f32_16x16x64_bf16 v[100:103], v[136:139], v[184:191], v9
    ds_read_b128 v[80:83], v7 offset:25600
    s_waitcnt lgkmcnt(2)
    v_smfmac_f32_16x16x64_bf16 v[100:103], v[140:143], v[192:199], v9
    ds_read_b128 v[84:87], v7 offset:26624
    v_smfmac_f32_16x16x64_bf16 v[104:107], v[136:139], v[92:99], v9
    ds_read_b128 v[88:91], v7 offset:27648
    v_smfmac_f32_16x16x64_bf16 v[104:107], v[140:143], v[200:207], v9
    v_smfmac_f32_16x16x64_bf16 v[108:111], v[136:139], v[208:215], v9
    v_smfmac_f32_16x16x64_bf16 v[108:111], v[140:143], v[216:223], v9
    s_waitcnt lgkmcnt(2)
    s_nop 0
    v_cvt_pk_bf16_f32 v24, v100, v101
    v_smfmac_f32_16x16x64_bf16 v[112:115], v[136:139], v[76:83], v9
    v_cvt_pk_bf16_f32 v26, v102, v103
    v_smfmac_f32_16x16x64_bf16 v[112:115], v[140:143], v[224:231], v9
    v_cvt_pk_bf16_f32 v25, v104, v105
    v_smfmac_f32_16x16x64_bf16 v[116:119], v[128:131], v[232:239], v9
    v_cvt_pk_bf16_f32 v27, v106, v107
    v_smfmac_f32_16x16x64_bf16 v[116:119], v[132:135], v[240:247], v9
    s_waitcnt lgkmcnt(0)
    v_permlane16_swap_b32 v24, v25
    v_smfmac_f32_16x16x64_bf16 v[116:119], v[136:139], v[84:91], v9
    v_permlane16_swap_b32 v26, v27
    v_smfmac_f32_16x16x64_bf16 v[116:119], v[140:143], v[248:255], v9
    buffer_store_dwordx4 v[24:27], v11, s[8:11], s62 offen sc1
    v_cvt_pk_bf16_f32 v28, v108, v109
    v_cvt_pk_bf16_f32 v30, v110, v111
    v_cvt_pk_bf16_f32 v29, v112, v113
    v_cvt_pk_bf16_f32 v31, v114, v115
    s_nop 0
    v_permlane16_swap_b32 v28, v29
    v_permlane16_swap_b32 v30, v31
    v_cvt_pk_bf16_f32 v32, v116, v117
    buffer_store_dwordx4 v[28:31], v12, s[8:11], s62 offen sc1
    v_cvt_pk_bf16_f32 v33, v118, v119
    s_nop 1
    v_permlane16_swap_b32 v32, v33
    buffer_store_dwordx2 v[32:33], v13, s[8:11], s62 offen sc1
    v_mov_b32 v18, s61
    s_mov_b64 exec, 1
    buffer_store_dword v18, v10, s[8:11], s47 offen sc1
    s_mov_b64 exec, -1
    s_add_u32 s61, s61, 1
    s_cmp_lg_u32 s61, 8
    s_cbranch_scc1 Lswm_46
    s_mov_b32 s31, 0
Lwa_47:
    v_lshlrev_b32 v19, 2, v1
    buffer_load_dword v18, v19, s[24:27], 0 offen offset:192 sc1
    s_add_u32 s31, s31, 1
    s_cmp_gt_u32 s31, 400000
    s_cbranch_scc1 L_abort
    s_sleep 2
    s_waitcnt vmcnt(0)
    v_readfirstlane_b32 s30, v18
    s_nop 0
    s_cmp_lt_u32 s30, 3
    s_nop 1
    s_cbranch_scc1 Lwa_47
    v_readlane_b32 s60, v18, 4
    v_readlane_b32 s7, v18, 5
    v_readlane_b32 s28, v18, 6
    s_nop 4
Lswm_46:
    s_lshr_b32 s37, s61, 1
    s_bitcmp1_b32 s7, s37
    s_cselect_b32 s38, 16384, 0
    s_bitcmp1_b32 s28, s37
    s_cselect_b32 s62, 4096, 0
    s_or_b32 s38, s38, s62
    s_lshl_b32 s62, s37, 21
    s_lshr_b32 s37, s60, s37
    s_and_b32 s37, s37, 1
    s_lshl_b32 s37, s37, 13
    s_add_u32 s62, s62, s37
    s_and_b32 s37, s61, 1
    s_lshl_b32 s37, s37, 15
    s_add_u32 s62, s62, s37
    s_xor_b32 s37, s38, s29
    s_mov_b32 s29, s38
    v_xor_b32 v2, s37, v2
    v_xor_b32 v3, s37, v3
    v_xor_b32 v4, s37, v4
    v_xor_b32 v11, s37, v11
    v_xor_b32 v12, s37, v12
    v_xor_b32 v13, s37, v13
    s_cmp_lt_u32 s61, 64
    s_cbranch_scc1 L_b_loop1
    s_waitcnt vmcnt(0)
    s_barrier
    s_cmp_lg_u32 s3, 0
    s_cbranch_scc1 L_end
    v_mov_b32 v18, 64
    v_lshlrev_b32 v19, 2, v1
    s_lshl_b32 s30, s2, 7
    s_add_u32 s30, s30, 246415360
    s_mov_b64 exec, 0xffffffff
    buffer_store_dword v18, v19, s[8:11], s30 offen sc1
    s_branch L_end
L_b_w2:
L_b_loop2:
    v_mov_b32 v64, 0
    v_mov_b32 v65, 0
    v_mov_b32 v66, 0
    v_mov_b32 v67, 0
    v_mov_b32 v68, 0
    v_mov_b32 v69, 0
    v_mov_b32 v70, 0
    v_mov_b32 v71, 0
    v_mov_b32 v72, 0
    v_mov_b32 v73, 0
    v_mov_b32 v74, 0
    v_mov_b32 v75, 0
    v_mov_b32 v100, 0
    v_mov_b32 v101, 0
    v_mov_b32 v102, 0
    v_mov_b32 v103, 0
    v_mov_b32 v104, 0
    v_mov_b32 v105, 0
    v_mov_b32 v106, 0
    v_mov_b32 v107, 0
    v_mov_b32 v108, 0
    v_mov_b32 v109, 0
    v_mov_b32 v110, 0
    v_mov_b32 v111, 0
    v_mov_b32 v112, 0
    v_mov_b32 v113, 0
    v_mov_b32 v114, 0
    v_mov_b32 v115, 0
    v_mov_b32 v116, 0
    v_mov_b32 v117, 0
    v_mov_b32 v118, 0
    v_mov_b32 v119, 0
    ds_read_b128 v[76:79], v7 offset:0
    ds_read_b128 v[80:83], v7 offset:1024
    ds_read_b128 v[84:87], v7 offset:2048
    ds_read_b128 v[88:91], v7 offset:3072
    ds_read_b128 v[92:95], v7 offset:4096
    ds_read_b128 v[96:99], v7 offset:5120
    s_mov_b32 s31, 0
    s_waitcnt lgkmcnt(0)
    s_cmp_eq_u32 s61, 0
    s_cbranch_scc1 Lnp_50
    s_sleep 30
Lnp_50:
Lgm_49:
    buffer_load_dwordx4 v[32:35], v2, s[8:11], s62 offen sc1
    buffer_load_dwordx4 v[48:51], v3, s[8:11], s62 offen sc1
    buffer_load_dwordx2 v[60:61], v4, s[8:11], s62 offen sc1
    s_add_u32 s31, s31, 1
    s_cmp_gt_u32 s31, 400000
    s_cbranch_scc1 L_abort
    s_waitcnt vmcnt(2)
    ds_write_b128 v5, v[32:35]
    v_max3_u32 v18, v32, v33, v34
    s_waitcnt vmcnt(1)
    ds_write_b128 v5, v[48:51] offset:4096
    v_max3_u32 v19, v35, v48, v49
    v_max3_u32 v18, v18, v50, v51
    s_waitcnt vmcnt(0)
    ds_write_b64 v6, v[60:61]
    v_max3_u32 v19, v19, v60, v61
    v_max_u32 v18, v18, v19
    v_cmp_eq_u32 vcc, -1, v18
    s_cbranch_vccnz Lgm_49
    v_smfmac_f32_16x16x64_bf16 v[64:67], v[32:35], a[32:39], v9
    v_smfmac_f32_16x16x64_bf16 v[68:71], v[32:35], a[40:47], v9
    s_waitcnt lgkmcnt(0)
    s_barrier
    ds_read_b128 v[24:27], v8 offset:0
    ds_read_b128 v[28:31], v8 offset:1024
    v_smfmac_f32_16x16x64_bf16 v[64:67], v[48:51], a[64:71], v9
    ds_read_b128 v[36:39], v8 offset:3072
    ds_read_b128 v[40:43], v8 offset:4096
    v_smfmac_f32_16x16x64_bf16 v[68:71], v[48:51], a[104:111], v9
    ds_read_b128 v[44:47], v8 offset:5120
    ds_read_b128 v[52:55], v8 offset:7168
    s_waitcnt lgkmcnt(5)
    v_smfmac_f32_16x16x64_bf16 v[64:67], v[24:27], a[0:7], v9
    ds_read_b128 v[56:59], v8 offset:8192
    ds_read_b128 v[60:63], v8 offset:9216
    v_smfmac_f32_16x16x64_bf16 v[68:71], v[24:27], a[8:15], v9
    s_waitcnt lgkmcnt(6)
    v_smfmac_f32_16x16x64_bf16 v[64:67], v[28:31], a[16:23], v9
    v_smfmac_f32_16x16x64_bf16 v[68:71], v[28:31], a[24:31], v9
    s_waitcnt lgkmcnt(5)
    v_smfmac_f32_16x16x64_bf16 v[64:67], v[36:39], v[76:83], v9
    ds_read_b128 v[76:79], v7 offset:6144
    s_waitcnt lgkmcnt(5)
    v_smfmac_f32_16x16x64_bf16 v[64:67], v[40:43], a[48:55], v9
    ds_read_b128 v[80:83], v7 offset:7168
    s_waitcnt lgkmcnt(5)
    v_smfmac_f32_16x16x64_bf16 v[64:67], v[44:47], a[56:63], v9
    s_waitcnt lgkmcnt(4)
    v_smfmac_f32_16x16x64_bf16 v[64:67], v[52:55], a[72:79], v9
    s_waitcnt lgkmcnt(3)
    v_smfmac_f32_16x16x64_bf16 v[64:67], v[56:59], a[80:87], v9
    s_waitcnt lgkmcnt(2)
    v_smfmac_f32_16x16x64_bf16 v[64:67], v[60:63], v[84:91], v9
    ds_read_b128 v[84:87], v7 offset:8192
    v_smfmac_f32_16x16x64_bf16 v[68:71], v[36:39], a[88:95], v9
    ds_read_b128 v[88:91], v7 offset:9216
    v_smfmac_f32_16x16x64_bf16 v[68:71], v[40:43], v[92:99], v9
    ds_read_b128 v[92:95], v7 offset:10240
    v_smfmac_f32_16x16x64_bf16 v[68:71], v[44:47], a[96:103], v9
    s_nop 1
    v_permlane32_swap_b32 v64, v66
    v_smfmac_f32_16x16x64_bf16 v[68:71], v[52:55], a[112:119], v9
    v_permlane32_swap_b32 v65, v67
    v_smfmac_f32_16x16x64_bf16 v[68:71], v[56:59], a[120:127], v9
    ds_read_b128 v[96:99], v7 offset:11264
    s_waitcnt lgkmcnt(4)
    v_add_f32 v64, v64, v66
    v_smfmac_f32_16x16x64_bf16 v[68:71], v[60:63], v[76:83], v9
    ds_read_b128 v[76:79], v7 offset:12288
    v_add_f32 v65, v65, v67
    v_smfmac_f32_16x16x64_bf16 v[72:75], v[32:35], a[144:151], v9
    ds_read_b128 v[80:83], v7 offset:13312
    v_cvt_pk_bf16_f32 v64, v64, v65
    v_smfmac_f32_16x16x64_bf16 v[72:75], v[48:51], a[168:175], v9
    ds_write_b32 v15, v64 offset:0
    v_smfmac_f32_16x16x64_bf16 v[72:75], v[24:27], a[128:135], v9
    v_permlane32_swap_b32 v68, v70
    v_smfmac_f32_16x16x64_bf16 v[72:75], v[28:31], a[136:143], v9
    s_waitcnt lgkmcnt(5)
    v_permlane32_swap_b32 v69, v71
    v_smfmac_f32_16x16x64_bf16 v[72:75], v[36:39], v[84:91], v9
    ds_read_b128 v[84:87], v7 offset:14336
    ds_read_b128 v[88:91], v7 offset:15360
    v_add_f32 v68, v68, v70
    v_smfmac_f32_16x16x64_bf16 v[72:75], v[40:43], a[152:159], v9
    s_waitcnt lgkmcnt(2)
    s_barrier
    v_smfmac_f32_16x16x64_bf16 v[72:75], v[44:47], a[160:167], v9
    ds_read_b64_tr_b16 v[120:121], v16 offset:0
    ds_read_b64_tr_b16 v[122:123], v17 offset:0
    v_add_f32 v69, v69, v71
    v_smfmac_f32_16x16x64_bf16 v[72:75], v[52:55], a[176:183], v9
    ds_read_b64_tr_b16 v[124:125], v16 offset:512
    ds_read_b64_tr_b16 v[126:127], v17 offset:512
    v_cvt_pk_bf16_f32 v68, v68, v69
    v_smfmac_f32_16x16x64_bf16 v[72:75], v[56:59], v[92:99], v9
    ds_write_b32 v15, v68 offset:1024
    v_smfmac_f32_16x16x64_bf16 v[72:75], v[60:63], a[184:191], v9
    ds_read_b128 v[92:95], v7 offset:16384
    s_waitcnt lgkmcnt(4)
    v_smfmac_f32_16x16x64_bf16 v[100:103], v[120:123], v[76:83], v9
    ds_read_b128 v[96:99], v7 offset:17408
    ds_read_b128 v[76:79], v7 offset:18432
    v_smfmac_f32_16x16x64_bf16 v[104:107], v[120:123], a[192:199], v9
    ds_read_b128 v[80:83], v7 offset:19456
    v_smfmac_f32_16x16x64_bf16 v[108:111], v[120:123], a[200:207], v9
    s_waitcnt lgkmcnt(4)
    s_barrier
    v_smfmac_f32_16x16x64_bf16 v[112:115], v[120:123], a[208:215], v9
    ds_read_b64_tr_b16 v[128:129], v16 offset:1024
    v_permlane32_swap_b32 v72, v74
    v_smfmac_f32_16x16x64_bf16 v[116:119], v[120:123], v[84:91], v9
    ds_read_b64_tr_b16 v[130:131], v17 offset:1024
    v_permlane32_swap_b32 v73, v75
    v_smfmac_f32_16x16x64_bf16 v[100:103], v[124:127], a[216:223], v9
    ds_read_b64_tr_b16 v[132:133], v16 offset:1536
    v_add_f32 v72, v72, v74
    v_smfmac_f32_16x16x64_bf16 v[104:107], v[124:127], a[224:231], v9
    ds_read_b64_tr_b16 v[134:135], v17 offset:1536
    v_add_f32 v73, v73, v75
    v_smfmac_f32_16x16x64_bf16 v[108:111], v[124:127], a[232:239], v9
    ds_read_b128 v[84:87], v7 offset:20480
    s_waitcnt lgkmcnt(7)
    v_cvt_pk_bf16_f32 v72, v72, v73
    v_smfmac_f32_16x16x64_bf16 v[112:115], v[124:127], v[92:99], v9
    ds_write_b32 v15, v72 offset:2048
    v_smfmac_f32_16x16x64_bf16 v[116:119], v[124:127], a[240:247], v9
    ds_read_b128 v[88:91], v7 offset:21504
    s_waitcnt lgkmcnt(5)
    v_smfmac_f32_16x16x64_bf16 v[100:103], v[128:131], a[248:255], v9
    ds_read_b128 v[92:95], v7 offset:22528
    v_smfmac_f32_16x16x64_bf16 v[104:107], v[128:131], v[144:151], v9
    ds_read_b128 v[96:99], v7 offset:23552
    v_smfmac_f32_16x16x64_bf16 v[108:111], v[128:131], v[76:83], v9
    s_waitcnt lgkmcnt(3)
    s_barrier
    v_smfmac_f32_16x16x64_bf16 v[112:115], v[128:131], v[152:159], v9
    ds_read_b64_tr_b16 v[136:137], v16 offset:2048
    v_smfmac_f32_16x16x64_bf16 v[100:103], v[132:135], v[160:167], v9
    ds_read_b64_tr_b16 v[138:139], v17 offset:2048
    v_smfmac_f32_16x16x64_bf16 v[104:107], v[132:135], v[168:175], v9
    ds_read_b64_tr_b16 v[140:141], v16 offset:2560
    s_waitcnt lgkmcnt(5)
    v_smfmac_f32_16x16x64_bf16 v[108:111], v[132:135], v[84:91], v9
    ds_read_b64_tr_b16 v[142:143], v17 offset:2560
    v_smfmac_f32_16x16x64_bf16 v[112:115], v[132:135], v[176:183], v9
    ds_read_b128 v[76:79], v7 offset:24576
    s_waitcnt lgkmcnt(3)
    v_smfmac_f32_16x16x64_bf16 v[100:103], v[136:139], v[184:191], v9
    ds_read_b128 v[80:83], v7 offset:25600
    s_waitcnt lgkmcnt(2)
    v_smfmac_f32_16x16x64_bf16 v[100:103], v[140:143], v[192:199], v9
    ds_read_b128 v[84:87], v7 offset:26624
    v_smfmac_f32_16x16x64_bf16 v[104:107], v[136:139], v[92:99], v9
    ds_read_b128 v[88:91], v7 offset:27648
    v_smfmac_f32_16x16x64_bf16 v[104:107], v[140:143], v[200:207], v9
    v_smfmac_f32_16x16x64_bf16 v[108:111], v[136:139], v[208:215], v9
    v_smfmac_f32_16x16x64_bf16 v[108:111], v[140:143], v[216:223], v9
    s_waitcnt lgkmcnt(2)
    s_nop 0
    v_cvt_pk_bf16_f32 v24, v100, v101
    v_smfmac_f32_16x16x64_bf16 v[112:115], v[136:139], v[76:83], v9
    v_cvt_pk_bf16_f32 v26, v102, v103
    v_smfmac_f32_16x16x64_bf16 v[112:115], v[140:143], v[224:231], v9
    v_cvt_pk_bf16_f32 v25, v104, v105
    v_smfmac_f32_16x16x64_bf16 v[116:119], v[128:131], v[232:239], v9
    v_cvt_pk_bf16_f32 v27, v106, v107
    v_smfmac_f32_16x16x64_bf16 v[116:119], v[132:135], v[240:247], v9
    s_waitcnt lgkmcnt(0)
    v_permlane16_swap_b32 v24, v25
    v_smfmac_f32_16x16x64_bf16 v[116:119], v[136:139], v[84:91], v9
    v_permlane16_swap_b32 v26, v27
    v_smfmac_f32_16x16x64_bf16 v[116:119], v[140:143], v[248:255], v9
    buffer_store_dwordx4 v[24:27], v11, s[8:11], s62 offen sc1
    v_cvt_pk_bf16_f32 v28, v108, v109
    v_cvt_pk_bf16_f32 v30, v110, v111
    v_cvt_pk_bf16_f32 v29, v112, v113
    v_cvt_pk_bf16_f32 v31, v114, v115
    s_nop 0
    v_permlane16_swap_b32 v28, v29
    v_permlane16_swap_b32 v30, v31
    v_cvt_pk_bf16_f32 v32, v116, v117
    buffer_store_dwordx4 v[28:31], v12, s[8:11], s62 offen sc1
    v_cvt_pk_bf16_f32 v33, v118, v119
    s_nop 1
    v_permlane16_swap_b32 v32, v33
    buffer_store_dwordx2 v[32:33], v13, s[8:11], s62 offen sc1
    v_mov_b32 v18, s61
    s_mov_b64 exec, 1
    buffer_store_dword v18, v10, s[8:11], s47 offen sc1
    s_mov_b64 exec, -1
    s_add_u32 s61, s61, 1
    s_cmp_lg_u32 s61, 8
    s_cbranch_scc1 Lswm_51
    s_mov_b32 s31, 0
Lwa_52:
    v_lshlrev_b32 v19, 2, v1
    buffer_load_dword v18, v19, s[24:27], 0 offen offset:192 sc1
    s_add_u32 s31, s31, 1
    s_cmp_gt_u32 s31, 400000
    s_cbranch_scc1 L_abort
    s_sleep 2
    s_waitcnt vmcnt(0)
    v_readfirstlane_b32 s30, v18
    s_nop 0
    s_cmp_lt_u32 s30, 3
    s_nop 1
    s_cbranch_scc1 Lwa_52
    v_readlane_b32 s60, v18, 4
    v_readlane_b32 s7, v18, 5
    v_readlane_b32 s28, v18, 6
    s_nop 4
Lswm_51:
    s_lshr_b32 s37, s61, 1
    s_bitcmp1_b32 s7, s37
    s_cselect_b32 s38, 16384, 0
    s_bitcmp1_b32 s28, s37
    s_cselect_b32 s62, 4096, 0
    s_or_b32 s38, s38, s62
    s_lshl_b32 s62, s37, 21
    s_lshr_b32 s37, s60, s37
    s_and_b32 s37, s37, 1
    s_lshl_b32 s37, s37, 13
    s_add_u32 s62, s62, s37
    s_and_b32 s37, s61, 1
    s_lshl_b32 s37, s37, 15
    s_add_u32 s62, s62, s37
    s_xor_b32 s37, s38, s29
    s_mov_b32 s29, s38
    v_xor_b32 v2, s37, v2
    v_xor_b32 v3, s37, v3
    v_xor_b32 v4, s37, v4
    v_xor_b32 v11, s37, v11
    v_xor_b32 v12, s37, v12
    v_xor_b32 v13, s37, v13
    s_cmp_lt_u32 s61, 64
    s_cbranch_scc1 L_b_loop2
    s_waitcnt vmcnt(0)
    s_barrier
    s_cmp_lg_u32 s3, 0
    s_cbranch_scc1 L_end
    v_mov_b32 v18, 64
    v_lshlrev_b32 v19, 2, v1
    s_lshl_b32 s30, s2, 7
    s_add_u32 s30, s30, 246415360
    s_mov_b64 exec, 0xffffffff
    buffer_store_dword v18, v19, s[8:11], s30 offen sc1
    s_branch L_end
L_b_w3:
L_b_loop3:
    v_mov_b32 v64, 0
    v_mov_b32 v65, 0
    v_mov_b32 v66, 0
    v_mov_b32 v67, 0
    v_mov_b32 v68, 0
    v_mov_b32 v69, 0
    v_mov_b32 v70, 0
    v_mov_b32 v71, 0
    v_mov_b32 v72, 0
    v_mov_b32 v73, 0
    v_mov_b32 v74, 0
    v_mov_b32 v75, 0
    v_mov_b32 v100, 0
    v_mov_b32 v101, 0
    v_mov_b32 v102, 0
    v_mov_b32 v103, 0
    v_mov_b32 v104, 0
    v_mov_b32 v105, 0
    v_mov_b32 v106, 0
    v_mov_b32 v107, 0
    v_mov_b32 v108, 0
    v_mov_b32 v109, 0
    v_mov_b32 v110, 0
    v_mov_b32 v111, 0
    v_mov_b32 v112, 0
    v_mov_b32 v113, 0
    v_mov_b32 v114, 0
    v_mov_b32 v115, 0
    v_mov_b32 v116, 0
    v_mov_b32 v117, 0
    v_mov_b32 v118, 0
    v_mov_b32 v119, 0
    ds_read_b128 v[76:79], v7 offset:0
    ds_read_b128 v[80:83], v7 offset:1024
    ds_read_b128 v[84:87], v7 offset:2048
    ds_read_b128 v[88:91], v7 offset:3072
    ds_read_b128 v[92:95], v7 offset:4096
    ds_read_b128 v[96:99], v7 offset:5120
    s_mov_b32 s31, 0
    s_waitcnt lgkmcnt(0)
    s_cmp_eq_u32 s61, 0
    s_cbranch_scc1 Lnp_55
    s_sleep 30
Lnp_55:
Lgm_54:
    buffer_load_dwordx4 v[36:39], v2, s[8:11], s62 offen sc1
    buffer_load_dwordx4 v[52:55], v3, s[8:11], s62 offen sc1
    buffer_load_dwordx2 v[60:61], v4, s[8:11], s62 offen sc1
    s_add_u32 s31, s31, 1
    s_cmp_gt_u32 s31, 400000
    s_cbranch_scc1 L_abort
    s_waitcnt vmcnt(2)
    ds_write_b128 v5, v[36:39]
    v_max3_u32 v18, v36, v37, v38
    s_waitcnt vmcnt(1)
    ds_write_b128 v5, v[52:55] offset:4096
    v_max3_u32 v19, v39, v52, v53
    v_max3_u32 v18, v18, v54, v55
    s_waitcnt vmcnt(0)
    ds_write_b64 v6, v[60:61]
    v_max3_u32 v19, v19, v60, v61
    v_max_u32 v18, v18, v19
    v_cmp_eq_u32 vcc, -1, v18
    s_cbranch_vccnz Lgm_54
    v_smfmac_f32_16x16x64_bf16 v[64:67], v[36:39], v[76:83], v9
    ds_read_b128 v[76:79], v7 offset:6144
    v_smfmac_f32_16x16x64_bf16 v[68:71], v[36:39], a[88:95], v9
    s_waitcnt lgkmcnt(0)
    s_barrier
    ds_read_b128 v[24:27], v8 offset:0
    ds_read_b128 v[28:31], v8 offset:1024
    v_smfmac_f32_16x16x64_bf16 v[64:67], v[52:55], a[72:79], v9
    ds_read_b128 v[32:35], v8 offset:2048
    ds_read_b128 v[40:43], v8 offset:4096
    v_smfmac_f32_16x16x64_bf16 v[68:71], v[52:55], a[112:119], v9
    ds_read_b128 v[44:47], v8 offset:5120
    ds_read_b128 v[48:51], v8 offset:6144
    s_waitcnt lgkmcnt(5)
    v_smfmac_f32_16x16x64_bf16 v[64:67], v[24:27], a[0:7], v9
    ds_read_b128 v[56:59], v8 offset:8192
    ds_read_b128 v[60:63], v8 offset:9216
    v_smfmac_f32_16x16x64_bf16 v[68:71], v[24:27], a[8:15], v9
    ds_read_b128 v[80:83], v7 offset:7168
    s_waitcnt lgkmcnt(7)
    v_smfmac_f32_16x16x64_bf16 v[64:67], v[28:31], a[16:23], v9
    v_smfmac_f32_16x16x64_bf16 v[68:71], v[28:31], a[24:31], v9
    s_waitcnt lgkmcnt(6)
    v_smfmac_f32_16x16x64_bf16 v[64:67], v[32:35], a[32:39], v9
    s_waitcnt lgkmcnt(5)
    v_smfmac_f32_16x16x64_bf16 v[64:67], v[40:43], a[48:55], v9
    s_waitcnt lgkmcnt(4)
    v_smfmac_f32_16x16x64_bf16 v[64:67], v[44:47], a[56:63], v9
    s_waitcnt lgkmcnt(3)
    v_smfmac_f32_16x16x64_bf16 v[64:67], v[48:51], a[64:71], v9
    s_waitcnt lgkmcnt(2)
    v_smfmac_f32_16x16x64_bf16 v[64:67], v[56:59], a[80:87], v9
    s_waitcnt lgkmcnt(1)
    v_smfmac_f32_16x16x64_bf16 v[64:67], v[60:63], v[84:91], v9
    ds_read_b128 v[84:87], v7 offset:8192
    v_smfmac_f32_16x16x64_bf16 v[68:71], v[32:35], a[40:47], v9
    ds_read_b128 v[88:91], v7 offset:9216
    v_smfmac_f32_16x16x64_bf16 v[68:71], v[40:43], v[92:99], v9
    ds_read_b128 v[92:95], v7 offset:10240
    v_smfmac_f32_16x16x64_bf16 v[68:71], v[44:47], a[96:103], v9
    s_nop 1
    v_permlane32_swap_b32 v64, v66
    v_smfmac_f32_16x16x64_bf16 v[68:71], v[48:51], a[104:111], v9
    v_permlane32_swap_b32 v65, v67
    v_smfmac_f32_16x16x64_bf16 v[68:71], v[56:59], a[120:127], v9
    ds_read_b128 v[96:99], v7 offset:11264
    s_waitcnt lgkmcnt(4)
    v_add_f32 v64, v64, v66
    v_smfmac_f32_16x16x64_bf16 v[68:71], v[60:63], v[76:83], v9
    ds_read_b128 v[76:79], v7 offset:12288
    s_waitcnt lgkmcnt(3)
    v_add_f32 v65, v65, v67
    v_smfmac_f32_16x16x64_bf16 v[72:75], v[36:39], v[84:91], v9
    ds_read_b128 v[80:83], v7 offset:13312
    ds_read_b128 v[84:87], v7 offset:14336
    v_cvt_pk_bf16_f32 v64, v64, v65
    v_smfmac_f32_16x16x64_bf16 v[72:75], v[52:55], a[176:183], v9
    ds_write_b32 v15, v64 offset:0
    ds_read_b128 v[88:91], v7 offset:15360
    v_smfmac_f32_16x16x64_bf16 v[72:75], v[24:27], a[128:135], v9
    v_permlane32_swap_b32 v68, v70
    v_smfmac_f32_16x16x64_bf16 v[72:75], v[28:31], a[136:143], v9
    v_permlane32_swap_b32 v69, v71
    v_smfmac_f32_16x16x64_bf16 v[72:75], v[32:35], a[144:151], v9
    v_add_f32 v68, v68, v70
    v_smfmac_f32_16x16x64_bf16 v[72:75], v[40:43], a[152:159], v9
    s_waitcnt lgkmcnt(1)
    s_barrier
    v_smfmac_f32_16x16x64_bf16 v[72:75], v[44:47], a[160:167], v9
    ds_read_b64_tr_b16 v[120:121], v16 offset:0
    ds_read_b64_tr_b16 v[122:123], v17 offset:0
    v_add_f32 v69, v69, v71
    v_smfmac_f32_16x16x64_bf16 v[72:75], v[48:51], a[168:175], v9
    ds_read_b64_tr_b16 v[124:125], v16 offset:512
    ds_read_b64_tr_b16 v[126:127], v17 offset:512
    v_cvt_pk_bf16_f32 v68, v68, v69
    v_smfmac_f32_16x16x64_bf16 v[72:75], v[56:59], v[92:99], v9
    ds_write_b32 v15, v68 offset:1024
    v_smfmac_f32_16x16x64_bf16 v[72:75], v[60:63], a[184:191], v9
    ds_read_b128 v[92:95], v7 offset:16384
    s_waitcnt lgkmcnt(4)
    v_smfmac_f32_16x16x64_bf16 v[100:103], v[120:123], v[76:83], v9
    ds_read_b128 v[96:99], v7 offset:17408
    ds_read_b128 v[76:79], v7 offset:18432
    v_smfmac_f32_16x16x64_bf16 v[104:107], v[120:123], a[192:199], v9
    ds_read_b128 v[80:83], v7 offset:19456
    v_smfmac_f32_16x16x64_bf16 v[108:111], v[120:123], a[200:207], v9
    s_waitcnt lgkmcnt(4)
    s_barrier
    v_smfmac_f32_16x16x64_bf16 v[112:115], v[120:123], a[208:215], v9
    ds_read_b64_tr_b16 v[128:129], v16 offset:1024
    v_permlane32_swap_b32 v72, v74
    v_smfmac_f32_16x16x64_bf16 v[116:119], v[120:123], v[84:91], v9
    ds_read_b64_tr_b16 v[130:131], v17 offset:1024
    v_permlane32_swap_b32 v73, v75
    v_smfmac_f32_16x16x64_bf16 v[100:103], v[124:127], a[216:223], v9
    ds_read_b64_tr_b16 v[132:133], v16 offset:1536
    v_add_f32 v72, v72, v74
    v_smfmac_f32_16x16x64_bf16 v[104:107], v[124:127], a[224:231], v9
    ds_read_b64_tr_b16 v[134:135], v17 offset:1536
    v_add_f32 v73, v73, v75
    v_smfmac_f32_16x16x64_bf16 v[108:111], v[124:127], a[232:239], v9
    ds_read_b128 v[84:87], v7 offset:20480
    s_waitcnt lgkmcnt(7)
    v_cvt_pk_bf16_f32 v72, v72, v73
    v_smfmac_f32_16x16x64_bf16 v[112:115], v[124:127], v[92:99], v9
    ds_write_b32 v15, v72 offset:2048
    v_smfmac_f32_16x16x64_bf16 v[116:119], v[124:127], a[240:247], v9
    ds_read_b128 v[88:91], v7 offset:21504
    s_waitcnt lgkmcnt(5)
    v_smfmac_f32_16x16x64_bf16 v[100:103], v[128:131], a[248:255], v9
    ds_read_b128 v[92:95], v7 offset:22528
    v_smfmac_f32_16x16x64_bf16 v[104:107], v[128:131], v[144:151], v9
    ds_read_b128 v[96:99], v7 offset:23552
    v_smfmac_f32_16x16x64_bf16 v[108:111], v[128:131], v[76:83], v9
    s_waitcnt lgkmcnt(3)
    s_barrier
    v_smfmac_f32_16x16x64_bf16 v[112:115], v[128:131], v[152:159], v9
    ds_read_b64_tr_b16 v[136:137], v16 offset:2048
    v_smfmac_f32_16x16x64_bf16 v[100:103], v[132:135], v[160:167], v9
    ds_read_b64_tr_b16 v[138:139], v17 offset:2048
    v_smfmac_f32_16x16x64_bf16 v[104:107], v[132:135], v[168:175], v9
    ds_read_b64_tr_b16 v[140:141], v16 offset:2560
    s_waitcnt lgkmcnt(5)
    v_smfmac_f32_16x16x64_bf16 v[108:111], v[132:135], v[84:91], v9
    ds_read_b64_tr_b16 v[142:143], v17 offset:2560
    v_smfmac_f32_16x16x64_bf16 v[112:115], v[132:135], v[176:183], v9
    ds_read_b128 v[76:79], v7 offset:24576
    s_waitcnt lgkmcnt(3)
    v_smfmac_f32_16x16x64_bf16 v[100:103], v[136:139], v[184:191], v9
    ds_read_b128 v[80:83], v7 offset:25600
    s_waitcnt lgkmcnt(2)
    v_smfmac_f32_16x16x64_bf16 v[100:103], v[140:143], v[192:199], v9
    ds_read_b128 v[84:87], v7 offset:26624
    v_smfmac_f32_16x16x64_bf16 v[104:107], v[136:139], v[92:99], v9
    ds_read_b128 v[88:91], v7 offset:27648
    v_smfmac_f32_16x16x64_bf16 v[104:107], v[140:143], v[200:207], v9
    v_smfmac_f32_16x16x64_bf16 v[108:111], v[136:139], v[208:215], v9
    v_smfmac_f32_16x16x64_bf16 v[108:111], v[140:143], v[216:223], v9
    s_waitcnt lgkmcnt(2)
    s_nop 0
    v_cvt_pk_bf16_f32 v24, v100, v101
    v_smfmac_f32_16x16x64_bf16 v[112:115], v[136:139], v[76:83], v9
    v_cvt_pk_bf16_f32 v26, v102, v103
    v_smfmac_f32_16x16x64_bf16 v[112:115], v[140:143], v[224:231], v9
    v_cvt_pk_bf16_f32 v25, v104, v105
    v_smfmac_f32_16x16x64_bf16 v[116:119], v[128:131], v[232:239], v9
    v_cvt_pk_bf16_f32 v27, v106, v107
    v_smfmac_f32_16x16x64_bf16 v[116:119], v[132:135], v[240:247], v9
    s_waitcnt lgkmcnt(0)
    v_permlane16_swap_b32 v24, v25
    v_smfmac_f32_16x16x64_bf16 v[116:119], v[136:139], v[84:91], v9
    v_permlane16_swap_b32 v26, v27
    v_smfmac_f32_16x16x64_bf16 v[116:119], v[140:143], v[248:255], v9
    buffer_store_dwordx4 v[24:27], v11, s[8:11], s62 offen sc1
    v_cvt_pk_bf16_f32 v28, v108, v109
    v_cvt_pk_bf16_f32 v30, v110, v111
    v_cvt_pk_bf16_f32 v29, v112, v113
    v_cvt_pk_bf16_f32 v31, v114, v115
    s_nop 0
    v_permlane16_swap_b32 v28, v29
    v_permlane16_swap_b32 v30, v31
    v_cvt_pk_bf16_f32 v32, v116, v117
    buffer_store_dwordx4 v[28:31], v12, s[8:11], s62 offen sc1
    v_cvt_pk_bf16_f32 v33, v118, v119
    s_nop 1
    v_permlane16_swap_b32 v32, v33
    buffer_store_dwordx2 v[32:33], v13, s[8:11], s62 offen sc1
    v_mov_b32 v18, s61
    s_mov_b64 exec, 1
    buffer_store_dword v18, v10, s[8:11], s47 offen sc1
    s_mov_b64 exec, -1
    s_add_u32 s61, s61, 1
    s_cmp_lg_u32 s61, 8
    s_cbranch_scc1 Lswm_56
    s_mov_b32 s31, 0
Lwa_57:
    v_lshlrev_b32 v19, 2, v1
    buffer_load_dword v18, v19, s[24:27], 0 offen offset:192 sc1
    s_add_u32 s31, s31, 1
    s_cmp_gt_u32 s31, 400000
    s_cbranch_scc1 L_abort
    s_sleep 2
    s_waitcnt vmcnt(0)
    v_readfirstlane_b32 s30, v18
    s_nop 0
    s_cmp_lt_u32 s30, 3
    s_nop 1
    s_cbranch_scc1 Lwa_57
    v_readlane_b32 s60, v18, 4
    v_readlane_b32 s7, v18, 5
    v_readlane_b32 s28, v18, 6
    s_nop 4
Lswm_56:
    s_lshr_b32 s37, s61, 1
    s_bitcmp1_b32 s7, s37
    s_cselect_b32 s38, 16384, 0
    s_bitcmp1_b32 s28, s37
    s_cselect_b32 s62, 4096, 0
    s_or_b32 s38, s38, s62
    s_lshl_b32 s62, s37, 21
    s_lshr_b32 s37, s60, s37
    s_and_b32 s37, s37, 1
    s_lshl_b32 s37, s37, 13
    s_add_u32 s62, s62, s37
    s_and_b32 s37, s61, 1
    s_lshl_b32 s37, s37, 15
    s_add_u32 s62, s62, s37
    s_xor_b32 s37, s38, s29
    s_mov_b32 s29, s38
    v_xor_b32 v2, s37, v2
    v_xor_b32 v3, s37, v3
    v_xor_b32 v4, s37, v4
    v_xor_b32 v11, s37, v11
    v_xor_b32 v12, s37, v12
    v_xor_b32 v13, s37, v13
    s_cmp_lt_u32 s61, 64
    s_cbranch_scc1 L_b_loop3
    s_waitcnt vmcnt(0)
    s_barrier
    s_cmp_lg_u32 s3, 0
    s_cbranch_scc1 L_end
    v_mov_b32 v18, 64
    v_lshlrev_b32 v19, 2, v1
    s_lshl_b32 s30, s2, 7
    s_add_u32 s30, s30, 246415360
    s_mov_b64 exec, 0xffffffff
    buffer_store_dword v18, v19, s[8:11], s30 offen sc1
    s_branch L_end
.p2align 6
L_role_r:
    s_sub_u32 s4, s2, 64
    s_load_dwordx2 s[12:13], s[0:1], 8
    s_mov_b32 s14, 10240
    s_mov_b32 s15, 0x20000
    s_waitcnt lgkmcnt(0)
    s_lshr_b32 s76, s4, 2
    s_xor_b32 s76, s76, s3
    s_and_b32 s76, s76, 3
    s_xor_b32 s32, s4, s76
    s_mov_b32 s30, 31
    s_lshr_b32 s31, s30, 3
    s_xor_b32 s31, s31, s32
    s_lshl_b32 s64, s30, 16
    s_bitcmp1_b32 s31, 0
    s_cselect_b32 s30, 16384, 0
    s_add_u32 s64, s64, s30
    s_bitcmp1_b32 s31, 1
    s_cselect_b32 s30, 4096, 0
    s_add_u32 s64, s64, s30
    s_and_b32 s30, s4, 31
    s_lshl_b32 s30, s30, 21
    s_add_u32 s64, s64, s30
    s_add_u32 s65, s64, 8192
    v_mov_b32 v16, 0
    s_mov_b64 exec, 1
    buffer_atomic_add v16, v16, s[8:11], s64 offen sc1
    buffer_atomic_add v16, v16, s[8:11], s65 offen sc1
    s_mov_b64 exec, -1
    s_lshr_b32 s30, s3, 1
    s_add_u32 s30, s30, 24
    s_lshl_b32 s30, s30, 16
    s_and_b32 s40, s3, 1
    s_lshl_b32 s40, s40, 14
    s_add_u32 s40, s40, s30
    s_lshr_b32 s30, s4, 2
    s_lshl_b32 s30, s30, 1
    s_lshr_b32 s31, s3, 1
    s_add_u32 s30, s30, s31
    s_add_u32 s30, s30, 3
    s_lshr_b32 s31, s30, 3
    s_xor_b32 s31, s31, s4
    s_lshl_b32 s41, s30, 16
    s_bitcmp1_b32 s31, 0
    s_cselect_b32 s30, 16384, 0
    s_add_u32 s41, s41, s30
    s_bitcmp1_b32 s31, 1
    s_cselect_b32 s30, 4096, 0
    s_add_u32 s41, s41, s30
    s_lshr_b32 s30, s4, 4
    s_lshr_b32 s31, s30, 3
    s_xor_b32 s31, s31, s3
    s_lshl_b32 s42, s30, 16
    s_bitcmp1_b32 s31, 0
    s_cselect_b32 s30, 16384, 0
    s_add_u32 s42, s42, s30
    s_bitcmp1_b32 s31, 1
    s_cselect_b32 s30, 4096, 0
    s_add_u32 s42, s42, s30
    v_bfe_u32 v16, v1, 3, 1
    v_and_b32 v17, 7, v1
    v_lshrrev_b32 v18, 4, v1
    v_lshrrev_b32 v19, 5, v1
    v_mul_u32_u24 v2, 768, v19
    v_and_b32 v19, 31, v1
    v_lshl_add_u32 v2, v19, 4, v2
    v_add_u32 v2, s40, v2
    v_add_u32 v3, 3072, v2
    v_mul_u32_u24 v4, 1536, v18
    v_lshl_add_u32 v4, v16, 6, v4
    v_lshl_add_u32 v4, v17, 3, v4
    v_add_u32 v4, s40, v4
    v_and_b32 v19, 1, v18
    s_and_b32 s31, s3, 1
    s_lshl_b32 s31, s31, 11
    s_add_u32 s30, s41, s31
    v_lshl_add_u32 v7, v1, 4, s30
    s_lshl_b32 s30, s4, 15
    s_lshl_b32 s31, s3, 13
    s_add_u32 s30, s30, s31
    v_lshl_add_u32 v8, v1, 4, s30
    v_add_u32 v9, 4096, v8
    v_lshlrev_b32 v10, 10, v19
    v_lshrrev_b32 v19, 5, v1
    v_lshl_add_u32 v10, v19, 9, v10
    v_bfe_u32 v19, v1, 1, 3
    v_lshl_add_u32 v10, v19, 5, v10
    v_and_b32 v19, 1, v1
    v_lshl_add_u32 v10, v19, 2, v10
    s_lshl_b32 s30, s3, 3
    v_add_u32 v10, s30, v10
    v_bfe_u32 v16, v1, 2, 3
    v_and_b32 v17, 3, v1
    v_lshrrev_b32 v18, 5, v1
    v_lshl_add_u32 v17, v17, 1, v18
    v_lshlrev_b32 v11, 8, v16
    v_lshl_add_u32 v11, v17, 5, v11
    s_and_b32 s30, s4, 15
    s_lshl_b32 s30, s30, 8
    s_add_u32 s30, s30, s42
    v_lshl_add_u32 v12, v1, 2, s30
    v_mul_u32_u24 v16, 1280, v16
    v_lshl_add_u32 v16, v17, 2, v16
    s_lshl_b32 s30, s4, 5
    buffer_load_dword v20, v16, s[12:15], s30 offen
    s_mul_i32 s30, s4, 6554
    s_lshr_b32 s30, s30, 16
    s_lshl_b32 s30, s30, 2
    s_lshl_b32 s31, s3, 10
    s_add_u32 s30, s30, s31
    s_add_u32 s30, s30, 246440960
    v_and_b32 v16, 7, v1
    v_lshl_add_u32 v13, v16, 7, s30
    v_and_b32 v14, 8, v1
    v_cmp_eq_u32 vcc, 0, v14
    v_mov_b32 v14, 0xeeee
    v_mov_b32 v15, 0x4444
    v_cndmask_b32 v14, v14, v15, vcc
    v_mov_b32 v21, -1
    v_mov_b32 v5, -1
    s_mov_b32 s30, 0
    s_waitcnt vmcnt(0)
    buffer_store_dword v20, v12, s[8:11], s30 offen sc1
    s_mov_b32 s30, 32768
    buffer_store_dword v5, v12, s[8:11], s30 offen sc1
    s_mov_b32 s30, 8192
    buffer_store_dword v20, v12, s[8:11], s30 offen sc1
    s_mov_b32 s30, 40960
    buffer_store_dword v5, v12, s[8:11], s30 offen sc1
    v_mov_b32 v96, -1
    v_mov_b32 v97, -1
    v_mov_b32 v98, -1
    v_mov_b32 v99, -1
    s_mov_b32 s30, 0
    buffer_store_dwordx4 v[96:99], v7, s[8:11], s30 offen offset:0 sc1
    buffer_store_dwordx4 v[96:99], v7, s[8:11], s30 offen offset:1024 sc1
    s_mov_b32 s30, 8192
    buffer_store_dwordx4 v[96:99], v7, s[8:11], s30 offen offset:0 sc1
    buffer_store_dwordx4 v[96:99], v7, s[8:11], s30 offen offset:1024 sc1
    v_mov_b32 v16, 0
    v_lshlrev_b32 v17, 2, v1
    s_lshl_b32 s30, s2, 7
    s_add_u32 s30, s30, 246415360
    s_mov_b64 exec, 0xffffffff
    buffer_store_dword v16, v17, s[8:11], s30 offen sc1
    s_mov_b64 exec, -1
    s_waitcnt vmcnt(0)
    s_barrier
    s_cmp_eq_u32 s3, 0
    s_cselect_b32 s30, 0, 2146435072
    v_mov_b32 v16, 0
    v_mov_b32 v17, 1
    s_mov_b64 exec, 1
    buffer_atomic_add v17, v16, s[24:27], s30 offen sc1
    s_mov_b64 exec, -1
    s_cmp_ge_u32 s4, 32
    s_cbranch_scc1 Lcal_59
    s_mov_b32 s66, -1
    s_mov_b32 s67, -1
    s_mov_b32 s68, 0
    v_mov_b32 v16, 0
    s_mov_b64 exec, 1
    s_waitcnt vmcnt(0)
Lcalp_60:
    v_mov_b32 v17, 0
    s_memtime s[70:71]
    s_waitcnt lgkmcnt(0)
    buffer_atomic_add v17, v16, s[8:11], s64 offen sc0 sc1
    s_waitcnt vmcnt(0)
    s_memtime s[72:73]
    s_waitcnt lgkmcnt(0)
    s_sub_u32 s70, s72, s70
    s_min_u32 s66, s66, s70
    v_mov_b32 v17, 0
    s_memtime s[70:71]
    s_waitcnt lgkmcnt(0)
    buffer_atomic_add v17, v16, s[8:11], s65 offen sc0 sc1
    s_waitcnt vmcnt(0)
    s_memtime s[72:73]
    s_waitcnt lgkmcnt(0)
    s_sub_u32 s70, s72, s70
    s_min_u32 s67, s67, s70
    s_add_u32 s68, s68, 1
    s_cmp_lt_u32 s68, 4
    s_cbranch_scc1 Lcalp_60
    s_lshl_b32 s30, s4, 5
    s_lshl_b32 s31, s76, 3
    s_add_u32 s30, s30, s31
    s_add_u32 s30, s30, 246480896
    v_mov_b32 v18, s66
    v_mov_b32 v19, s67
    buffer_store_dwordx2 v[18:19], v16, s[8:11], s30 offen sc1
    s_mov_b64 exec, -1
    s_waitcnt vmcnt(0)
    s_barrier
    s_cmp_eq_u32 s3, 0
    s_cselect_b32 s30, 0, 2146435072
    v_mov_b32 v16, 12
    v_mov_b32 v17, 1
    s_mov_b64 exec, 1
    buffer_atomic_add v17, v16, s[24:27], s30 offen sc1
    s_mov_b64 exec, -1
Lcal_59:
    s_mov_b32 s31, 0
Lwa_61:
    v_lshlrev_b32 v17, 2, v1
    buffer_load_dword v16, v17, s[24:27], 0 offen offset:192 sc1
    s_add_u32 s31, s31, 1
    s_cmp_gt_u32 s31, 400000
    s_cbranch_scc1 L_abort
    s_sleep 2
    s_waitcnt vmcnt(0)
    v_readfirstlane_b32 s30, v16
    s_nop 0
    s_cmp_lt_u32 s30, 2
    s_nop 1
    s_cbranch_scc1 Lwa_61
    v_readlane_b32 s60, v16, 1
    v_readlane_b32 s7, v16, 2
    v_readlane_b32 s28, v16, 3
    v_mov_b32 v104, 0
    v_mov_b32 v100, v7
    v_mov_b32 v101, v12
    s_mov_b32 s61, 0
    s_mov_b32 s57, 0
    s_mov_b32 s50, 142606336
    s_mov_b32 s51, 0
L_r_loop:
    s_cmp_lg_u32 s61, 8
    s_cbranch_scc1 Lswm_63
    s_mov_b32 s31, 0
Lwa_64:
    v_lshlrev_b32 v17, 2, v1
    buffer_load_dword v16, v17, s[24:27], 0 offen offset:192 sc1
    s_add_u32 s31, s31, 1
    s_cmp_gt_u32 s31, 400000
    s_cbranch_scc1 L_abort
    s_sleep 2
    s_waitcnt vmcnt(0)
    v_readfirstlane_b32 s30, v16
    s_nop 0
    s_cmp_lt_u32 s30, 3
    s_nop 1
    s_cbranch_scc1 Lwa_64
    v_readlane_b32 s60, v16, 4
    v_readlane_b32 s7, v16, 5
    v_readlane_b32 s28, v16, 6
    s_nop 4
Lswm_63:
    s_add_u32 s36, s61, 2
    s_lshr_b32 s37, s36, 1
    s_bitcmp1_b32 s7, s37
    s_cselect_b32 s38, 16384, 0
    s_bitcmp1_b32 s28, s37
    s_cselect_b32 s63, 4096, 0
    s_or_b32 s38, s38, s63
    s_lshl_b32 s63, s37, 21
    s_lshr_b32 s37, s60, s37
    s_and_b32 s37, s37, 1
    s_lshl_b32 s37, s37, 13
    s_add_u32 s63, s63, s37
    s_and_b32 s37, s36, 1
    s_lshl_b32 s37, s37, 15
    s_add_u32 s63, s63, s37
    v_xor_b32 v103, s38, v101
    s_cmp_lt_u32 s61, 62
    s_cselect_b32 s63, s63, 2146435072
    s_mov_b32 s52, s63
    s_lshr_b32 s37, s61, 1
    s_bitcmp1_b32 s7, s37
    s_cselect_b32 s38, 16384, 0
    s_bitcmp1_b32 s28, s37
    s_cselect_b32 s62, 4096, 0
    s_or_b32 s38, s38, s62
    s_lshl_b32 s62, s37, 21
    s_lshr_b32 s37, s60, s37
    s_and_b32 s37, s37, 1
    s_lshl_b32 s37, s37, 13
    s_add_u32 s62, s62, s37
    s_and_b32 s37, s61, 1
    s_lshl_b32 s37, s37, 15
    s_add_u32 s62, s62, s37
    v_xor_b32 v7, s38, v100
    s_add_u32 s36, s61, 1
    s_lshr_b32 s37, s36, 1
    s_bitcmp1_b32 s7, s37
    s_cselect_b32 s38, 16384, 0
    s_bitcmp1_b32 s28, s37
    s_cselect_b32 s63, 4096, 0
    s_or_b32 s38, s38, s63
    s_lshl_b32 s63, s37, 21
    s_lshr_b32 s37, s60, s37
    s_and_b32 s37, s37, 1
    s_lshl_b32 s37, s37, 13
    s_add_u32 s63, s63, s37
    s_and_b32 s37, s36, 1
    s_lshl_b32 s37, s37, 15
    s_add_u32 s63, s63, s37
    v_xor_b32 v102, s38, v100
    v_xor_b32 v12, s38, v101
    v_min_u32_dpp v104, v104, v104 row_ror:4 row_mask:0xf bank_mask:0xf
    s_nop 1
    v_min_u32_dpp v104, v104, v104 row_ror:2 row_mask:0xf bank_mask:0xf
    s_nop 1
    v_min_u32_dpp v104, v104, v104 row_ror:1 row_mask:0xf bank_mask:0xf
    s_nop 0
    v_readfirstlane_b32 s30, v104
    s_nop 0
    s_max_u32 s57, s57, s30
    s_cmp_gt_u32 s57, s61
    s_nop 0
    s_cbranch_scc1 Lrok_66
    s_mov_b32 s31, 0
Lrpl_67:
    buffer_load_dword v104, v13, s[8:11], 0 offen sc1
    s_add_u32 s31, s31, 1
    s_cmp_gt_u32 s31, 400000
    s_cbranch_scc1 L_abort
    s_waitcnt vmcnt(0)
    v_min_u32_dpp v104, v104, v104 row_ror:4 row_mask:0xf bank_mask:0xf
    s_nop 1
    v_min_u32_dpp v104, v104, v104 row_ror:2 row_mask:0xf bank_mask:0xf
    s_nop 1
    v_min_u32_dpp v104, v104, v104 row_ror:1 row_mask:0xf bank_mask:0xf
    s_nop 0
    v_readfirstlane_b32 s30, v104
    s_nop 0
    s_max_u32 s57, s57, s30
    s_cmp_le_u32 s57, s61
    s_nop 0
    s_cbranch_scc1 Lrpl_67
Lrok_66:
    buffer_load_dwordx4 v[64:67], v8, s[8:11], s50 offen offset:0 sc1
    buffer_load_dwordx4 v[68:71], v8, s[8:11], s50 offen offset:1024 sc1
    buffer_load_dwordx4 v[72:75], v8, s[8:11], s50 offen offset:2048 sc1
    buffer_load_dwordx4 v[76:79], v8, s[8:11], s50 offen offset:3072 sc1
    buffer_load_dwordx4 v[80:83], v9, s[8:11], s50 offen offset:0 sc1
    buffer_load_dwordx4 v[84:87], v9, s[8:11], s50 offen offset:1024 sc1
    buffer_load_dwordx4 v[88:91], v9, s[8:11], s50 offen offset:2048 sc1
    buffer_load_dwordx4 v[92:95], v9, s[8:11], s50 offen offset:3072 sc1
    s_add_u32 s30, s61, 1
    s_cmp_le_u32 s57, s30
    s_cselect_b32 s30, 0, 2146435072
    buffer_load_dword v104, v13, s[8:11], s30 offen sc1
    v_mov_b32 v56, 0
    v_mov_b32 v57, 0
    v_mov_b32 v58, 0
    v_mov_b32 v59, 0
    v_add_u32 v18, s51, v10
    v_add_u32 v19, s51, v11
    buffer_store_dword v5, v103, s[8:11], s52 offen sc1
    buffer_store_dwordx4 v[96:99], v102, s[8:11], s63 offen offset:0 sc1
    buffer_store_dwordx4 v[96:99], v102, s[8:11], s63 offen offset:1024 sc1
    s_mov_b32 s31, 0
    s_nop 0
Lpz_70:
    s_sleep 1
    buffer_load_dwordx4 v[44:47], v7, s[8:11], s62 offen offset:0 sc1
    buffer_load_dwordx4 v[48:51], v7, s[8:11], s62 offen offset:1024 sc1
    s_add_u32 s31, s31, 1
    s_cmp_gt_u32 s31, 400000
    s_cbranch_scc1 L_abort
    s_waitcnt vmcnt(1)
    v_max3_u32 v16, v44, v45, v46
    s_waitcnt vmcnt(0)
    v_max3_u32 v17, v47, v48, v49
    v_max3_u32 v16, v16, v50, v51
    v_max_u32 v16, v16, v17
    v_cmp_eq_u32 vcc, -1, v16
    s_cbranch_vccnz Lpz_70
    s_nop 0
Lrq_68:
    buffer_load_dwordx2 v[40:41], v4, s[8:11], s62 offen offset:512 sc1
    buffer_load_dwordx2 v[42:43], v4, s[8:11], s62 offen offset:1280 sc1
    buffer_load_dwordx4 v[24:27], v2, s[8:11], s62 offen offset:0 sc1
    buffer_load_dwordx4 v[28:31], v2, s[8:11], s62 offen offset:1536 sc1
    buffer_load_dwordx4 v[32:35], v3, s[8:11], s62 offen offset:0 sc1
    buffer_load_dwordx4 v[36:39], v3, s[8:11], s62 offen offset:1536 sc1
    s_add_u32 s31, s31, 1
    s_cmp_gt_u32 s31, 400000
    s_cbranch_scc1 L_abort
    s_waitcnt vmcnt(4)
    v_smfmac_f32_16x16x64_bf16 v[56:59], v[40:43], v[44:51], v14
    v_max_u32 v16, v40, v41
    v_max_u32 v17, v42, v43
    s_waitcnt vmcnt(3)
    v_smfmac_f32_16x16x64_bf16 v[56:59], v[24:27], v[64:71], v14
    v_max3_u32 v16, v16, v24, v25
    v_max3_u32 v17, v17, v26, v27
    s_waitcnt vmcnt(2)
    v_smfmac_f32_16x16x64_bf16 v[56:59], v[28:31], v[72:79], v14
    v_max3_u32 v16, v16, v28, v29
    v_max3_u32 v17, v17, v30, v31
    s_waitcnt vmcnt(1)
    v_smfmac_f32_16x16x64_bf16 v[56:59], v[32:35], v[80:87], v14
    v_max3_u32 v16, v16, v32, v33
    v_max3_u32 v17, v17, v34, v35
    s_waitcnt vmcnt(0)
    v_smfmac_f32_16x16x64_bf16 v[56:59], v[36:39], v[88:95], v14
    v_max3_u32 v16, v16, v36, v37
    v_max3_u32 v17, v17, v38, v39
    v_max_u32 v16, v16, v17
    v_cmp_eq_u32 vcc, -1, v16
    s_nop 3
    v_permlane32_swap_b32 v56, v58
    v_permlane32_swap_b32 v57, v59
    v_pk_add_f32 v[56:57], v[56:57], v[58:59]
    ds_write2_b32 v18, v56, v57 offset0:0 offset1:64
    s_cbranch_vccz Lrgo_69
    v_mov_b32 v56, 0
    v_mov_b32 v57, 0
    v_mov_b32 v58, 0
    v_mov_b32 v59, 0
    s_nop 0
    s_branch Lrq_68
Lrgo_69:
    s_waitcnt lgkmcnt(0)
    s_barrier
    ds_read_b128 v[24:27], v19
    ds_read_b128 v[28:31], v19 offset:16
    s_waitcnt lgkmcnt(1)
    v_pk_add_f32 v[24:25], v[24:25], v[26:27]
    s_waitcnt lgkmcnt(0)
    v_pk_add_f32 v[28:29], v[28:29], v[30:31]
    v_pk_add_f32 v[24:25], v[24:25], v[28:29]
    v_cvt_pk_bf16_f32 v24, v24, v25
    buffer_store_dword v24, v12, s[8:11], s63 offen sc1
    s_xor_b32 s51, s51, 2048
    s_add_u32 s50, s50, 1310720
    s_add_u32 s61, s61, 1
    s_cmp_lt_u32 s61, 63
    s_cbranch_scc1 L_r_loop
    s_waitcnt vmcnt(0)
    s_branch L_end
.p2align 6
L_role_s5a:
    s_sub_u32 s4, s2, 232
    s_load_dwordx2 s[12:13], s[0:1], 0
    s_mov_b32 s14, 2621440
    s_mov_b32 s15, 0x20000
    s_load_dwordx2 s[16:17], s[0:1], 80
    s_mov_b32 s18, 819200
    s_mov_b32 s19, 0x20000
    s_load_dwordx2 s[20:21], s[0:1], 88
    s_mov_b32 s22, 819200
    s_mov_b32 s23, 0x20000
    s_load_dwordx2 s[44:45], s[0:1], 64
    s_mov_b32 s46, 1280
    s_mov_b32 s47, 0x20000
    s_load_dwordx2 s[48:49], s[0:1], 72
    s_mov_b32 s50, 1280
    s_mov_b32 s51, 0x20000
    s_load_dwordx2 s[64:65], s[0:1], 112
    s_mov_b32 s66, 1280
    s_mov_b32 s67, 0x20000
    s_waitcnt lgkmcnt(0)
    v_mov_b32 v8, 0
    v_lshlrev_b32 v9, 2, v1
    s_lshl_b32 s30, s2, 7
    s_add_u32 s30, s30, 246415360
    s_mov_b64 exec, 0xffffffff
    buffer_store_dword v8, v9, s[8:11], s30 offen sc1
    s_mov_b64 exec, -1
    s_waitcnt vmcnt(0)
    s_barrier
    s_cmp_eq_u32 s3, 0
    s_cselect_b32 s30, 0, 2146435072
    v_mov_b32 v8, 0
    v_mov_b32 v9, 1
    s_mov_b64 exec, 1
    buffer_atomic_add v9, v8, s[24:27], s30 offen sc1
    s_mov_b64 exec, -1
    s_load_dwordx2 s[72:73], s[0:1], 24
    s_mov_b32 s74, 7864320
    s_mov_b32 s75, 0x20000
    s_load_dwordx2 s[76:77], s[0:1], 16
    s_mov_b32 s78, 7864320
    s_mov_b32 s79, 0x20000
    s_waitcnt lgkmcnt(0)
    s_sub_u32 s30, s2, 232
    s_and_b32 s41, s30, 3
    s_andn2_b32 s30, s30, 3
    s_add_u32 s30, s30, s3
    s_lshl_b32 s30, s30, 6
    v_add_u32 v2, s30, v1
    s_mov_b32 s43, 0
    s_mov_b32 s42, 6144
    s_add_u32 s39, s41, 0
    s_mov_b32 s40, 43691
    v_add_u32 v3, 0, v2
    v_mul_lo_u32 v4, v3, s40
    v_lshrrev_b32 v4, 19, v4
    v_mul_u32_u24 v5, 12, v4
    v_sub_u32 v3, v3, v5
    v_mul_u32_u24 v4, 12288, v4
    v_lshrrev_b32 v5, 1, v3
    v_lshl_add_u32 v4, v5, 10, v4
    v_mov_b32 v5, s41
    v_and_b32 v5, 3, v5
    v_xor_b32 v5, 2, v5
    v_lshl_add_u32 v4, v5, 8, v4
    v_and_b32 v3, 1, v3
    v_lshl_add_u32 v4, v3, 7, v4
    buffer_load_dword v16, v4, s[72:75], s42 offen
    v_add_u32 v3, 0, v2
    v_mul_lo_u32 v4, v3, s40
    v_lshrrev_b32 v4, 20, v4
    v_mul_u32_u24 v5, 24, v4
    v_sub_u32 v3, v3, v5
    v_mul_u32_u24 v4, 12288, v4
    v_lshrrev_b32 v5, 1, v3
    v_lshl_add_u32 v4, v5, 10, v4
    v_mov_b32 v5, s41
    v_and_b32 v5, 3, v5
    v_xor_b32 v5, 2, v5
    v_lshl_add_u32 v4, v5, 8, v4
    v_and_b32 v3, 1, v3
    v_lshl_add_u32 v4, v3, 7, v4
    buffer_load_dword v17, v4, s[76:79], s43 offen
    v_add_u32 v3, 1280, v2
    v_mul_lo_u32 v4, v3, s40
    v_lshrrev_b32 v4, 20, v4
    v_mul_u32_u24 v5, 24, v4
    v_sub_u32 v3, v3, v5
    v_mul_u32_u24 v4, 12288, v4
    v_lshrrev_b32 v5, 1, v3
    v_lshl_add_u32 v4, v5, 10, v4
    v_mov_b32 v5, s41
    v_and_b32 v5, 3, v5
    v_xor_b32 v5, 2, v5
    v_lshl_add_u32 v4, v5, 8, v4
    v_and_b32 v3, 1, v3
    v_lshl_add_u32 v4, v3, 7, v4
    buffer_load_dword v18, v4, s[76:79], s43 offen
    v_add_u32 v3, 1280, v2
    v_mul_lo_u32 v4, v3, s40
    v_lshrrev_b32 v4, 19, v4
    v_mul_u32_u24 v5, 12, v4
    v_sub_u32 v3, v3, v5
    v_mul_u32_u24 v4, 12288, v4
    v_lshrrev_b32 v5, 1, v3
    v_lshl_add_u32 v4, v5, 10, v4
    v_mov_b32 v5, s41
    v_and_b32 v5, 3, v5
    v_xor_b32 v5, 2, v5
    v_lshl_add_u32 v4, v5, 8, v4
    v_and_b32 v3, 1, v3
    v_lshl_add_u32 v4, v3, 7, v4
    buffer_load_dword v19, v4, s[72:75], s42 offen
    v_add_u32 v3, 2560, v2
    v_mul_lo_u32 v4, v3, s40
    v_lshrrev_b32 v4, 20, v4
    v_mul_u32_u24 v5, 24, v4
    v_sub_u32 v3, v3, v5
    v_mul_u32_u24 v4, 12288, v4
    v_lshrrev_b32 v5, 1, v3
    v_lshl_add_u32 v4, v5, 10, v4
    v_mov_b32 v5, s41
    v_and_b32 v5, 3, v5
    v_xor_b32 v5, 2, v5
    v_lshl_add_u32 v4, v5, 8, v4
    v_and_b32 v3, 1, v3
    v_lshl_add_u32 v4, v3, 7, v4
    buffer_load_dword v20, v4, s[76:79], s43 offen
    v_add_u32 v3, 3840, v2
    v_mul_lo_u32 v4, v3, s40
    v_lshrrev_b32 v4, 20, v4
    v_mul_u32_u24 v5, 24, v4
    v_sub_u32 v3, v3, v5
    v_mul_u32_u24 v4, 12288, v4
    v_lshrrev_b32 v5, 1, v3
    v_lshl_add_u32 v4, v5, 10, v4
    v_mov_b32 v5, s41
    v_and_b32 v5, 3, v5
    v_xor_b32 v5, 2, v5
    v_lshl_add_u32 v4, v5, 8, v4
    v_and_b32 v3, 1, v3
    v_lshl_add_u32 v4, v3, 7, v4
    buffer_load_dword v21, v4, s[76:79], s43 offen
    v_add_u32 v3, 2560, v2
    v_mul_lo_u32 v4, v3, s40
    v_lshrrev_b32 v4, 19, v4
    v_mul_u32_u24 v5, 12, v4
    v_sub_u32 v3, v3, v5
    v_mul_u32_u24 v4, 12288, v4
    v_lshrrev_b32 v5, 1, v3
    v_lshl_add_u32 v4, v5, 10, v4
    v_mov_b32 v5, s41
    v_and_b32 v5, 3, v5
    v_xor_b32 v5, 2, v5
    v_lshl_add_u32 v4, v5, 8, v4
    v_and_b32 v3, 1, v3
    v_lshl_add_u32 v4, v3, 7, v4
    buffer_load_dword v22, v4, s[72:75], s42 offen
    v_add_u32 v3, 5120, v2
    v_mul_lo_u32 v4, v3, s40
    v_lshrrev_b32 v4, 20, v4
    v_mul_u32_u24 v5, 24, v4
    v_sub_u32 v3, v3, v5
    v_mul_u32_u24 v4, 12288, v4
    v_lshrrev_b32 v5, 1, v3
    v_lshl_add_u32 v4, v5, 10, v4
    v_mov_b32 v5, s41
    v_and_b32 v5, 3, v5
    v_xor_b32 v5, 2, v5
    v_lshl_add_u32 v4, v5, 8, v4
    v_and_b32 v3, 1, v3
    v_lshl_add_u32 v4, v3, 7, v4
    buffer_load_dword v23, v4, s[76:79], s43 offen
    v_add_u32 v3, 6400, v2
    v_mul_lo_u32 v4, v3, s40
    v_lshrrev_b32 v4, 20, v4
    v_mul_u32_u24 v5, 24, v4
    v_sub_u32 v3, v3, v5
    v_mul_u32_u24 v4, 12288, v4
    v_lshrrev_b32 v5, 1, v3
    v_lshl_add_u32 v4, v5, 10, v4
    v_mov_b32 v5, s41
    v_and_b32 v5, 3, v5
    v_xor_b32 v5, 2, v5
    v_lshl_add_u32 v4, v5, 8, v4
    v_and_b32 v3, 1, v3
    v_lshl_add_u32 v4, v3, 7, v4
    buffer_load_dword v24, v4, s[76:79], s43 offen
    v_add_u32 v3, 3840, v2
    v_mul_lo_u32 v4, v3, s40
    v_lshrrev_b32 v4, 19, v4
    v_mul_u32_u24 v5, 12, v4
    v_sub_u32 v3, v3, v5
    v_mul_u32_u24 v4, 12288, v4
    v_lshrrev_b32 v5, 1, v3
    v_lshl_add_u32 v4, v5, 10, v4
    v_mov_b32 v5, s41
    v_and_b32 v5, 3, v5
    v_xor_b32 v5, 2, v5
    v_lshl_add_u32 v4, v5, 8, v4
    v_and_b32 v3, 1, v3
    v_lshl_add_u32 v4, v3, 7, v4
    buffer_load_dword v25, v4, s[72:75], s42 offen
    v_add_u32 v3, 7680, v2
    v_mul_lo_u32 v4, v3, s40
    v_lshrrev_b32 v4, 20, v4
    v_mul_u32_u24 v5, 24, v4
    v_sub_u32 v3, v3, v5
    v_mul_u32_u24 v4, 12288, v4
    v_lshrrev_b32 v5, 1, v3
    v_lshl_add_u32 v4, v5, 10, v4
    v_mov_b32 v5, s41
    v_and_b32 v5, 3, v5
    v_xor_b32 v5, 2, v5
    v_lshl_add_u32 v4, v5, 8, v4
    v_and_b32 v3, 1, v3
    v_lshl_add_u32 v4, v3, 7, v4
    buffer_load_dword v26, v4, s[76:79], s43 offen
    v_add_u32 v3, 8960, v2
    v_mul_lo_u32 v4, v3, s40
    v_lshrrev_b32 v4, 20, v4
    v_mul_u32_u24 v5, 24, v4
    v_sub_u32 v3, v3, v5
    v_mul_u32_u24 v4, 12288, v4
    v_lshrrev_b32 v5, 1, v3
    v_lshl_add_u32 v4, v5, 10, v4
    v_mov_b32 v5, s41
    v_and_b32 v5, 3, v5
    v_xor_b32 v5, 2, v5
    v_lshl_add_u32 v4, v5, 8, v4
    v_and_b32 v3, 1, v3
    v_lshl_add_u32 v4, v3, 7, v4
    buffer_load_dword v27, v4, s[76:79], s43 offen
    v_add_u32 v3, 5120, v2
    v_mul_lo_u32 v4, v3, s40
    v_lshrrev_b32 v4, 19, v4
    v_mul_u32_u24 v5, 12, v4
    v_sub_u32 v3, v3, v5
    v_mul_u32_u24 v4, 12288, v4
    v_lshrrev_b32 v5, 1, v3
    v_lshl_add_u32 v4, v5, 10, v4
    v_mov_b32 v5, s41
    v_and_b32 v5, 3, v5
    v_xor_b32 v5, 2, v5
    v_lshl_add_u32 v4, v5, 8, v4
    v_and_b32 v3, 1, v3
    v_lshl_add_u32 v4, v3, 7, v4
    buffer_load_dword v28, v4, s[72:75], s42 offen
    v_add_u32 v3, 10240, v2
    v_mul_lo_u32 v4, v3, s40
    v_lshrrev_b32 v4, 20, v4
    v_mul_u32_u24 v5, 24, v4
    v_sub_u32 v3, v3, v5
    v_mul_u32_u24 v4, 12288, v4
    v_lshrrev_b32 v5, 1, v3
    v_lshl_add_u32 v4, v5, 10, v4
    v_mov_b32 v5, s41
    v_and_b32 v5, 3, v5
    v_xor_b32 v5, 2, v5
    v_lshl_add_u32 v4, v5, 8, v4
    v_and_b32 v3, 1, v3
    v_lshl_add_u32 v4, v3, 7, v4
    buffer_load_dword v29, v4, s[76:79], s43 offen
    v_add_u32 v3, 11520, v2
    v_mul_lo_u32 v4, v3, s40
    v_lshrrev_b32 v4, 20, v4
    v_mul_u32_u24 v5, 24, v4
    v_sub_u32 v3, v3, v5
    v_mul_u32_u24 v4, 12288, v4
    v_lshrrev_b32 v5, 1, v3
    v_lshl_add_u32 v4, v5, 10, v4
    v_mov_b32 v5, s41
    v_and_b32 v5, 3, v5
    v_xor_b32 v5, 2, v5
    v_lshl_add_u32 v4, v5, 8, v4
    v_and_b32 v3, 1, v3
    v_lshl_add_u32 v4, v3, 7, v4
    buffer_load_dword v30, v4, s[76:79], s43 offen
    v_add_u32 v3, 6400, v2
    v_mul_lo_u32 v4, v3, s40
    v_lshrrev_b32 v4, 19, v4
    v_mul_u32_u24 v5, 12, v4
    v_sub_u32 v3, v3, v5
    v_mul_u32_u24 v4, 12288, v4
    v_lshrrev_b32 v5, 1, v3
    v_lshl_add_u32 v4, v5, 10, v4
    v_mov_b32 v5, s41
    v_and_b32 v5, 3, v5
    v_xor_b32 v5, 2, v5
    v_lshl_add_u32 v4, v5, 8, v4
    v_and_b32 v3, 1, v3
    v_lshl_add_u32 v4, v3, 7, v4
    buffer_load_dword v31, v4, s[72:75], s42 offen
    v_add_u32 v3, 12800, v2
    v_mul_lo_u32 v4, v3, s40
    v_lshrrev_b32 v4, 20, v4
    v_mul_u32_u24 v5, 24, v4
    v_sub_u32 v3, v3, v5
    v_mul_u32_u24 v4, 12288, v4
    v_lshrrev_b32 v5, 1, v3
    v_lshl_add_u32 v4, v5, 10, v4
    v_mov_b32 v5, s41
    v_and_b32 v5, 3, v5
    v_xor_b32 v5, 2, v5
    v_lshl_add_u32 v4, v5, 8, v4
    v_and_b32 v3, 1, v3
    v_lshl_add_u32 v4, v3, 7, v4
    buffer_load_dword v32, v4, s[76:79], s43 offen
    v_add_u32 v3, 14080, v2
    v_mul_lo_u32 v4, v3, s40
    v_lshrrev_b32 v4, 20, v4
    v_mul_u32_u24 v5, 24, v4
    v_sub_u32 v3, v3, v5
    v_mul_u32_u24 v4, 12288, v4
    v_lshrrev_b32 v5, 1, v3
    v_lshl_add_u32 v4, v5, 10, v4
    v_mov_b32 v5, s41
    v_and_b32 v5, 3, v5
    v_xor_b32 v5, 2, v5
    v_lshl_add_u32 v4, v5, 8, v4
    v_and_b32 v3, 1, v3
    v_lshl_add_u32 v4, v3, 7, v4
    buffer_load_dword v33, v4, s[76:79], s43 offen
    s_waitcnt vmcnt(0)
    s_mov_b32 s31, 0
Lwa_71:
    v_lshlrev_b32 v9, 2, v1
    buffer_load_dword v8, v9, s[24:27], 0 offen offset:192 sc1
    s_add_u32 s31, s31, 1
    s_cmp_gt_u32 s31, 400000
    s_cbranch_scc1 L_abort
    s_sleep 2
    s_waitcnt vmcnt(0)
    v_readfirstlane_b32 s30, v8
    s_nop 0
    s_cmp_lt_u32 s30, 1
    s_nop 1
    s_cbranch_scc1 Lwa_71
    s_and_b32 s30, s2, 31
    s_lshl_b32 s30, s30, 7
    s_add_u32 s30, s30, 246415360
    v_mov_b32 v9, s30
    s_mov_b32 s31, 0
    s_nop 0
Lacs_73:
    buffer_load_dword v8, v9, s[8:11], 0 offen sc1
    s_add_u32 s31, s31, 1
    s_cmp_gt_u32 s31, 400000
    s_cbranch_scc1 L_abort
    s_sleep 8
    s_waitcnt vmcnt(0)
    v_readfirstlane_b32 s30, v8
    s_nop 0
    s_cmp_eq_u32 s30, 0
    s_nop 1
    s_cbranch_scc1 Lacs_73
    s_lshl_b32 s41, s4, 2
    s_add_u32 s41, s41, s3
    s_lshl_b32 s30, s41, 4
    v_and_b32 v14, 15, v1
    v_add_u32 v14, s30, v14
    v_lshrrev_b32 v15, 4, v1
    v_mul_u32_u24 v16, 1280, v14
    v_lshl_add_u32 v16, v15, 4, v16
    v_lshlrev_b32 v17, 1, v14
    buffer_load_ushort v18, v17, s[44:47], 0 offen
    buffer_load_ushort v19, v17, s[48:51], 0 offen
    buffer_load_ushort v20, v17, s[64:67], 0 offen
    buffer_load_dwordx4 a[0:3], v16, s[16:19], 0 offen offset:0
    buffer_load_dwordx4 a[4:7], v16, s[16:19], 0 offen offset:64
    buffer_load_dwordx4 a[8:11], v16, s[16:19], 0 offen offset:128
    buffer_load_dwordx4 a[12:15], v16, s[16:19], 0 offen offset:192
    buffer_load_dwordx4 a[16:19], v16, s[16:19], 0 offen offset:256
    buffer_load_dwordx4 a[20:23], v16, s[16:19], 0 offen offset:320
    buffer_load_dwordx4 a[24:27], v16, s[16:19], 0 offen offset:384
    buffer_load_dwordx4 a[28:31], v16, s[16:19], 0 offen offset:448
    buffer_load_dwordx4 a[32:35], v16, s[16:19], 0 offen offset:512
    buffer_load_dwordx4 a[36:39], v16, s[16:19], 0 offen offset:576
    buffer_load_dwordx4 a[40:43], v16, s[16:19], 0 offen offset:640
    buffer_load_dwordx4 a[44:47], v16, s[16:19], 0 offen offset:704
    buffer_load_dwordx4 a[48:51], v16, s[16:19], 0 offen offset:768
    buffer_load_dwordx4 a[52:55], v16, s[16:19], 0 offen offset:832
    buffer_load_dwordx4 a[56:59], v16, s[16:19], 0 offen offset:896
    buffer_load_dwordx4 a[60:63], v16, s[16:19], 0 offen offset:960
    buffer_load_dwordx4 a[64:67], v16, s[16:19], 0 offen offset:1024
    buffer_load_dwordx4 a[68:71], v16, s[16:19], 0 offen offset:1088
    buffer_load_dwordx4 a[72:75], v16, s[16:19], 0 offen offset:1152
    buffer_load_dwordx4 a[76:79], v16, s[16:19], 0 offen offset:1216
    buffer_load_dwordx4 a[80:83], v16, s[20:23], 0 offen offset:0
    buffer_load_dwordx4 a[84:87], v16, s[20:23], 0 offen offset:64
    buffer_load_dwordx4 a[88:91], v16, s[20:23], 0 offen offset:128
    buffer_load_dwordx4 a[92:95], v16, s[20:23], 0 offen offset:192
    buffer_load_dwordx4 a[96:99], v16, s[20:23], 0 offen offset:256
    buffer_load_dwordx4 a[100:103], v16, s[20:23], 0 offen offset:320
    buffer_load_dwordx4 a[104:107], v16, s[20:23], 0 offen offset:384
    buffer_load_dwordx4 a[108:111], v16, s[20:23], 0 offen offset:448
    buffer_load_dwordx4 a[112:115], v16, s[20:23], 0 offen offset:512
    buffer_load_dwordx4 a[116:119], v16, s[20:23], 0 offen offset:576
    buffer_load_dwordx4 a[120:123], v16, s[20:23], 0 offen offset:640
    buffer_load_dwordx4 a[124:127], v16, s[20:23], 0 offen offset:704
    buffer_load_dwordx4 a[128:131], v16, s[20:23], 0 offen offset:768
    buffer_load_dwordx4 a[132:135], v16, s[20:23], 0 offen offset:832
    buffer_load_dwordx4 a[136:139], v16, s[20:23], 0 offen offset:896
    buffer_load_dwordx4 a[140:143], v16, s[20:23], 0 offen offset:960
    buffer_load_dwordx4 a[144:147], v16, s[20:23], 0 offen offset:1024
    buffer_load_dwordx4 a[148:151], v16, s[20:23], 0 offen offset:1088
    buffer_load_dwordx4 a[152:155], v16, s[20:23], 0 offen offset:1152
    buffer_load_dwordx4 a[156:159], v16, s[20:23], 0 offen offset:1216
    s_waitcnt vmcnt(42)
    v_lshlrev_b32 v18, 16, v18
    s_waitcnt vmcnt(41)
    v_lshlrev_b32 v19, 16, v19
    s_waitcnt vmcnt(40)
    v_lshlrev_b32 v20, 16, v20
    v_mul_f32 v20, 0x3fb8aa3b, v20
    v_exp_f32 v20, v20
    s_nop 0
    v_cvt_pk_bf16_f32 v20, v20, v20
    v_lshlrev_b32 v20, 16, v20
    v_mul_f32 v14, v20, v18
    v_mul_f32 v15, v20, v19
    v_mul_f32 v14, 0x3fb8aa3b, v14
    v_exp_f32 v14, v14
    v_mul_f32 v15, 0.15915494, v15
    v_rndne_f32 v16, v15
    v_sub_f32 v15, v15, v16
    v_cos_f32 v16, v15
    v_sin_f32 v17, v15
    v_mul_f32 v72, v14, v16
    v_mul_f32 v73, v14, v17
    v_add_f32 v14, -1.0, v72
    v_mul_f32 v16, v18, v18
    v_fmac_f32 v16, v19, v19
    v_rcp_f32 v16, v16
    v_mul_f32 v88, v14, v18
    v_fmac_f32 v88, v73, v19
    v_mul_f32 v89, v73, v18
    v_fma_f32 v89, -v14, v19, v89
    v_add_f32 v16, v16, v16
    v_mul_f32 v88, v88, v16
    v_mul_f32 v89, v89, v16
    v_mov_b32 v90, 0
    v_mov_b32 v91, 0
    v_mul_f32 v74, v72, v72
    v_fma_f32 v74, -v73, v73, v74
    v_mul_f32 v75, v72, v73
    v_fmac_f32 v75, v73, v72
    v_mul_f32 v76, v74, v72
    v_fma_f32 v76, -v75, v73, v76
    v_mul_f32 v77, v74, v73
    v_fmac_f32 v77, v75, v72
    v_mul_f32 v78, v76, v72
    v_fma_f32 v78, -v77, v73, v78
    v_mul_f32 v79, v76, v73
    v_fmac_f32 v79, v77, v72
    v_mul_f32 v80, v78, v72
    v_fma_f32 v80, -v79, v73, v80
    v_mul_f32 v81, v78, v73
    v_fmac_f32 v81, v79, v72
    v_mul_f32 v82, v80, v72
    v_fma_f32 v82, -v81, v73, v82
    v_mul_f32 v83, v80, v73
    v_fmac_f32 v83, v81, v72
    v_mul_f32 v84, v82, v72
    v_fma_f32 v84, -v83, v73, v84
    v_mul_f32 v85, v82, v73
    v_fmac_f32 v85, v83, v72
    v_mul_f32 v86, v84, v72
    v_fma_f32 v86, -v85, v73, v86
    v_mul_f32 v87, v84, v73
    v_fmac_f32 v87, v85, v72
    v_lshrrev_b32 v2, 3, v1
    v_and_b32 v4, 7, v1
    v_xor_b32 v4, v4, v2
    v_and_b32 v5, 4, v2
    v_add_u32 v2, v2, v5
    s_and_b32 s30, s3, 1
    s_lshl_b32 s30, s30, 4
    s_lshr_b32 s31, s3, 1
    s_lshl_b32 s31, s31, 2
    s_add_u32 s30, s30, s31
    v_add_u32 v2, s30, v2
    v_mul_u32_u24 v2, 1280, v2
    v_lshl_add_u32 v2, v4, 4, v2
    s_mul_i32 s40, s3, 10240
    v_and_b32 v4, 7, v1
    v_lshrrev_b32 v5, 4, v1
    v_xor_b32 v5, v5, v4
    v_lshlrev_b32 v5, 4, v5
    v_lshl_add_u32 v4, v4, 7, v5
    v_bfe_u32 v5, v1, 3, 1
    v_mul_u32_u24 v5, 10240, v5
    v_add_u32 v4, v4, v5
    v_xor_b32 v5, 64, v4
    v_mov_b32 v6, v4
    v_mov_b32 v7, v5
    v_add_u32 v8, 40960, v4
    v_add_u32 v9, 40960, v5
    s_lshl_b32 s30, s41, 11
    v_lshl_add_u32 v10, v1, 4, s30
    v_and_b32 v14, 15, v1
    v_lshrrev_b32 v15, 4, v1
    v_cmp_le_u32 s[68:69], 1, v15
    v_cmp_le_u32 s[70:71], 2, v15
    v_cmp_le_u32 s[72:73], 3, v15
    s_lshl_b32 s30, s3, 11
    s_add_u32 s30, s30, 122880
    v_lshl_add_u32 v12, v14, 6, s30
    v_lshl_add_u32 v12, v15, 4, v12
    v_lshl_add_u32 v13, v15, 9, s30
    v_bfe_u32 v14, v1, 2, 2
    v_lshl_add_u32 v13, v14, 6, v13
    v_and_b32 v14, 3, v1
    v_lshl_add_u32 v13, v14, 3, v13
    s_mov_b32 s50, 232783872
    s_mov_b32 s52, 0
    s_mov_b32 s53, 0
    s_mov_b32 s54, s40
    s_lshl_b32 s30, s2, 7
    s_lshl_b32 s31, s3, 2
    s_add_u32 s30, s30, s31
    s_add_u32 s30, s30, 246415360
    v_mov_b32 v11, s30
    s_add_u32 m0, s54, 0
    s_add_u32 s34, s53, 0
    buffer_load_dwordx4 v2, s[12:15], s34 offen lds
    s_add_u32 m0, s54, 1024
    s_add_u32 s34, s53, 128
    buffer_load_dwordx4 v2, s[12:15], s34 offen lds
    s_add_u32 m0, s54, 2048
    s_add_u32 s34, s53, 256
    buffer_load_dwordx4 v2, s[12:15], s34 offen lds
    s_add_u32 m0, s54, 3072
    s_add_u32 s34, s53, 384
    buffer_load_dwordx4 v2, s[12:15], s34 offen lds
    s_add_u32 m0, s54, 4096
    s_add_u32 s34, s53, 512
    buffer_load_dwordx4 v2, s[12:15], s34 offen lds
    s_add_u32 m0, s54, 5120
    s_add_u32 s34, s53, 640
    buffer_load_dwordx4 v2, s[12:15], s34 offen lds
    s_add_u32 m0, s54, 6144
    s_add_u32 s34, s53, 768
    buffer_load_dwordx4 v2, s[12:15], s34 offen lds
    s_add_u32 m0, s54, 7168
    s_add_u32 s34, s53, 896
    buffer_load_dwordx4 v2, s[12:15], s34 offen lds
    s_add_u32 m0, s54, 8192
    s_add_u32 s34, s53, 1024
    buffer_load_dwordx4 v2, s[12:15], s34 offen lds
    s_add_u32 m0, s54, 9216
    s_add_u32 s34, s53, 1152
    buffer_load_dwordx4 v2, s[12:15], s34 offen lds
    s_mov_b32 s53, 40960
    s_add_u32 s54, s40, 40960
    s_add_u32 m0, s54, 0
    s_add_u32 s34, s53, 0
    buffer_load_dwordx4 v2, s[12:15], s34 offen lds
    s_add_u32 m0, s54, 1024
    s_add_u32 s34, s53, 128
    buffer_load_dwordx4 v2, s[12:15], s34 offen lds
    s_add_u32 m0, s54, 2048
    s_add_u32 s34, s53, 256
    buffer_load_dwordx4 v2, s[12:15], s34 offen lds
    s_add_u32 m0, s54, 3072
    s_add_u32 s34, s53, 384
    buffer_load_dwordx4 v2, s[12:15], s34 offen lds
    s_add_u32 m0, s54, 4096
    s_add_u32 s34, s53, 512
    buffer_load_dwordx4 v2, s[12:15], s34 offen lds
    s_add_u32 m0, s54, 5120
    s_add_u32 s34, s53, 640
    buffer_load_dwordx4 v2, s[12:15], s34 offen lds
    s_add_u32 m0, s54, 6144
    s_add_u32 s34, s53, 768
    buffer_load_dwordx4 v2, s[12:15], s34 offen lds
    s_add_u32 m0, s54, 7168
    s_add_u32 s34, s53, 896
    buffer_load_dwordx4 v2, s[12:15], s34 offen lds
    s_add_u32 m0, s54, 8192
    s_add_u32 s34, s53, 1024
    buffer_load_dwordx4 v2, s[12:15], s34 offen lds
    s_add_u32 m0, s54, 9216
    s_add_u32 s34, s53, 1152
    buffer_load_dwordx4 v2, s[12:15], s34 offen lds
    s_mov_b32 s53, 81920
    s_add_u32 s54, s40, 81920
    s_mov_b32 s55, 81920
    s_waitcnt vmcnt(10)
    s_barrier
    ds_read_b128 v[24:27], v6 offset:0
    ds_read_b128 v[28:31], v7 offset:0
    ds_read_b128 v[32:35], v6 offset:1024
    ds_read_b128 v[36:39], v7 offset:1024
    ds_read_b128 v[40:43], v6 offset:2048
    ds_read_b128 v[44:47], v7 offset:2048
    s_waitcnt lgkmcnt(0)
    v_mov_b32 v128, 0
    v_mov_b32 v129, 0
    v_mov_b32 v130, 0
    v_mov_b32 v131, 0
    v_mov_b32 v132, 0
    v_mov_b32 v133, 0
    v_mov_b32 v134, 0
    v_mov_b32 v135, 0
    v_mov_b32 v136, 0
    v_mov_b32 v137, 0
    v_mov_b32 v138, 0
    v_mov_b32 v139, 0
    v_mov_b32 v140, 0
    v_mov_b32 v141, 0
    v_mov_b32 v142, 0
    v_mov_b32 v143, 0
    s_mov_b32 s51, 2146435072
    s_mov_b32 s57, 0
L_sa_loop:
    v_mfma_f32_16x16x32_bf16 v[56:59], v[24:27], a[0:3], 0
    ds_read_b128 v[48:51], v6 offset:3072
    v_fmac_f32 v129, v72, v128
    v_fmac_f32 v137, v72, v136
    v_mfma_f32_16x16x32_bf16 v[64:67], v[24:27], a[80:83], 0
    s_barrier
    v_fma_f32 v129, -v73, v136, v129
    v_fmac_f32 v137, v73, v128
    v_mfma_f32_16x16x32_bf16 v[56:59], v[28:31], a[4:7], v[56:59]
    ds_read_b128 v[52:55], v7 offset:3072
    v_fmac_f32 v130, v72, v129
    v_fmac_f32 v138, v72, v137
    v_mfma_f32_16x16x32_bf16 v[64:67], v[28:31], a[84:87], v[64:67]
    s_add_u32 m0, s54, 0
    s_add_u32 s34, s53, 0
    buffer_load_dwordx4 v2, s[12:15], s34 offen lds
    v_fma_f32 v130, -v73, v137, v130
    v_fmac_f32 v138, v73, v129
    v_mfma_f32_16x16x32_bf16 v[56:59], v[32:35], a[8:11], v[56:59]
    ds_read_b128 v[24:27], v6 offset:4096
    v_fmac_f32 v131, v72, v130
    v_fmac_f32 v139, v72, v138
    v_mfma_f32_16x16x32_bf16 v[64:67], v[32:35], a[88:91], v[64:67]
    v_fma_f32 v131, -v73, v138, v131
    v_fmac_f32 v139, v73, v130
    v_mfma_f32_16x16x32_bf16 v[56:59], v[36:39], a[12:15], v[56:59]
    ds_read_b128 v[28:31], v7 offset:4096
    v_fmac_f32 v132, v72, v131
    v_fmac_f32 v140, v72, v139
    v_mfma_f32_16x16x32_bf16 v[64:67], v[36:39], a[92:95], v[64:67]
    v_fma_f32 v132, -v73, v139, v132
    v_fmac_f32 v140, v73, v131
    v_mfma_f32_16x16x32_bf16 v[56:59], v[40:43], a[16:19], v[56:59]
    ds_read_b128 v[32:35], v6 offset:5120
    v_fmac_f32 v133, v72, v132
    v_fmac_f32 v141, v72, v140
    v_mfma_f32_16x16x32_bf16 v[64:67], v[40:43], a[96:99], v[64:67]
    s_add_u32 m0, s54, 1024
    s_add_u32 s34, s53, 128
    buffer_load_dwordx4 v2, s[12:15], s34 offen lds
    v_fma_f32 v133, -v73, v140, v133
    v_fmac_f32 v141, v73, v132
    v_mfma_f32_16x16x32_bf16 v[56:59], v[44:47], a[20:23], v[56:59]
    ds_read_b128 v[36:39], v7 offset:5120
    v_fmac_f32 v134, v72, v133
    v_fmac_f32 v142, v72, v141
    v_mfma_f32_16x16x32_bf16 v[64:67], v[44:47], a[100:103], v[64:67]
    s_waitcnt lgkmcnt(5)
    v_fma_f32 v134, -v73, v141, v134
    v_fmac_f32 v142, v73, v133
    v_mfma_f32_16x16x32_bf16 v[56:59], v[48:51], a[24:27], v[56:59]
    ds_read_b128 v[40:43], v6 offset:6144
    v_fmac_f32 v135, v72, v134
    v_fmac_f32 v143, v72, v142
    v_mfma_f32_16x16x32_bf16 v[64:67], v[48:51], a[104:107], v[64:67]
    s_waitcnt lgkmcnt(5)
    v_fma_f32 v135, -v73, v142, v135
    v_fmac_f32 v143, v73, v134
    v_mfma_f32_16x16x32_bf16 v[56:59], v[52:55], a[28:31], v[56:59]
    ds_read_b128 v[44:47], v7 offset:6144
    v_mov_b32 v92, v135
    v_mov_b32 v93, v135
    v_mfma_f32_16x16x32_bf16 v[64:67], v[52:55], a[108:111], v[64:67]
    s_add_u32 m0, s54, 2048
    s_add_u32 s34, s53, 256
    buffer_load_dwordx4 v2, s[12:15], s34 offen lds
    s_waitcnt lgkmcnt(5)
    v_mov_b32 v96, v143
    v_mov_b32 v97, v143
    v_mfma_f32_16x16x32_bf16 v[56:59], v[24:27], a[32:35], v[56:59]
    ds_read_b128 v[48:51], v6 offset:7168
    v_mov_b32 v100, v90
    v_mov_b32 v101, v91
    v_mfma_f32_16x16x32_bf16 v[64:67], v[24:27], a[112:115], v[64:67]
    s_waitcnt lgkmcnt(5)
    v_permlane16_swap_b32 v92, v93
    v_permlane16_swap_b32 v96, v97
    v_mfma_f32_16x16x32_bf16 v[56:59], v[28:31], a[36:39], v[56:59]
    ds_read_b128 v[52:55], v7 offset:7168
    v_mov_b32 v94, v92
    v_mov_b32 v95, v93
    v_mfma_f32_16x16x32_bf16 v[64:67], v[28:31], a[116:119], v[64:67]
    s_waitcnt lgkmcnt(5)
    v_mov_b32 v98, v96
    v_mov_b32 v99, v97
    v_mfma_f32_16x16x32_bf16 v[56:59], v[32:35], a[40:43], v[56:59]
    ds_read_b128 v[24:27], v6 offset:8192
    v_permlane32_swap_b32 v92, v94
    v_permlane32_swap_b32 v93, v95
    v_mfma_f32_16x16x32_bf16 v[64:67], v[32:35], a[120:123], v[64:67]
    s_add_u32 m0, s54, 3072
    s_add_u32 s34, s53, 384
    buffer_load_dwordx4 v2, s[12:15], s34 offen lds
    s_waitcnt lgkmcnt(5)
    v_permlane32_swap_b32 v96, v98
    v_permlane32_swap_b32 v97, v99
    v_mfma_f32_16x16x32_bf16 v[56:59], v[36:39], a[44:47], v[56:59]
    ds_read_b128 v[28:31], v7 offset:8192
    v_fmac_f32 v92, v86, v90
    v_fmac_f32 v96, v86, v91
    v_mfma_f32_16x16x32_bf16 v[64:67], v[36:39], a[124:127], v[64:67]
    s_waitcnt lgkmcnt(5)
    v_fma_f32 v92, -v87, v91, v92
    v_fmac_f32 v96, v87, v90
    v_mfma_f32_16x16x32_bf16 v[56:59], v[40:43], a[48:51], v[56:59]
    ds_read_b128 v[32:35], v6 offset:9216
    v_cndmask_b32 v100, v100, v92, s[68:69]
    v_cndmask_b32 v101, v101, v96, s[68:69]
    v_mfma_f32_16x16x32_bf16 v[64:67], v[40:43], a[128:131], v[64:67]
    s_waitcnt lgkmcnt(5)
    v_fmac_f32 v93, v86, v92
    v_fmac_f32 v97, v86, v96
    v_mfma_f32_16x16x32_bf16 v[56:59], v[44:47], a[52:55], v[56:59]
    ds_read_b128 v[36:39], v7 offset:9216
    v_fma_f32 v93, -v87, v96, v93
    v_fmac_f32 v97, v87, v92
    v_mfma_f32_16x16x32_bf16 v[64:67], v[44:47], a[132:135], v[64:67]
    s_add_u32 m0, s54, 4096
    s_add_u32 s34, s53, 512
    buffer_load_dwordx4 v2, s[12:15], s34 offen lds
    s_waitcnt lgkmcnt(5)
    v_cndmask_b32 v100, v100, v93, s[70:71]
    v_cndmask_b32 v101, v101, v97, s[70:71]
    v_mfma_f32_16x16x32_bf16 v[56:59], v[48:51], a[56:59], v[56:59]
    ds_read_b128 v[40:43], v6 offset:20480
    v_fmac_f32 v94, v86, v93
    v_fmac_f32 v98, v86, v97
    v_mfma_f32_16x16x32_bf16 v[64:67], v[48:51], a[136:139], v[64:67]
    s_waitcnt lgkmcnt(5)
    v_fma_f32 v94, -v87, v97, v94
    v_fmac_f32 v98, v87, v93
    v_mfma_f32_16x16x32_bf16 v[56:59], v[52:55], a[60:63], v[56:59]
    ds_read_b128 v[44:47], v7 offset:20480
    v_cndmask_b32 v100, v100, v94, s[72:73]
    v_cndmask_b32 v101, v101, v98, s[72:73]
    v_mfma_f32_16x16x32_bf16 v[64:67], v[52:55], a[140:143], v[64:67]
    s_waitcnt lgkmcnt(5)
    v_fmac_f32 v95, v86, v94
    v_fmac_f32 v99, v86, v98
    v_mfma_f32_16x16x32_bf16 v[56:59], v[24:27], a[64:67], v[56:59]
    ds_read_b128 v[48:51], v6 offset:21504
    v_fma_f32 v95, -v87, v98, v95
    v_fmac_f32 v99, v87, v94
    v_mfma_f32_16x16x32_bf16 v[64:67], v[24:27], a[144:147], v[64:67]
    s_add_u32 m0, s54, 5120
    s_add_u32 s34, s53, 640
    buffer_load_dwordx4 v2, s[12:15], s34 offen lds
    s_waitcnt lgkmcnt(5)
    v_mov_b32 v90, v95
    v_mov_b32 v91, v99
    v_mfma_f32_16x16x32_bf16 v[56:59], v[28:31], a[68:71], v[56:59]
    ds_read_b128 v[52:55], v7 offset:21504
    v_fmac_f32 v128, v72, v100
    v_fmac_f32 v136, v72, v101
    v_mfma_f32_16x16x32_bf16 v[64:67], v[28:31], a[148:151], v[64:67]
    s_waitcnt lgkmcnt(5)
    v_fma_f32 v128, -v73, v101, v128
    v_fmac_f32 v136, v73, v100
    v_mfma_f32_16x16x32_bf16 v[56:59], v[32:35], a[72:75], v[56:59]
    ds_read_b128 v[24:27], v6 offset:22528
    v_fmac_f32 v129, v74, v100
    v_fmac_f32 v137, v74, v101
    v_mfma_f32_16x16x32_bf16 v[64:67], v[32:35], a[152:155], v[64:67]
    s_waitcnt lgkmcnt(5)
    v_fma_f32 v129, -v75, v101, v129
    v_fmac_f32 v137, v75, v100
    v_mfma_f32_16x16x32_bf16 v[56:59], v[36:39], a[76:79], v[56:59]
    ds_read_b128 v[28:31], v7 offset:22528
    v_fmac_f32 v130, v76, v100
    v_fmac_f32 v138, v76, v101
    v_mfma_f32_16x16x32_bf16 v[64:67], v[36:39], a[156:159], v[64:67]
    s_add_u32 m0, s54, 6144
    s_add_u32 s34, s53, 768
    buffer_load_dwordx4 v2, s[12:15], s34 offen lds
    s_waitcnt lgkmcnt(5)
    v_fma_f32 v130, -v77, v101, v130
    v_fmac_f32 v138, v77, v100
    v_mfma_f32_16x16x32_bf16 v[60:63], v[40:43], a[0:3], 0
    ds_read_b128 v[32:35], v6 offset:23552
    v_fmac_f32 v131, v78, v100
    v_fmac_f32 v139, v78, v101
    v_mfma_f32_16x16x32_bf16 v[68:71], v[40:43], a[80:83], 0
    s_waitcnt lgkmcnt(5)
    v_fma_f32 v131, -v79, v101, v131
    v_fmac_f32 v139, v79, v100
    v_mfma_f32_16x16x32_bf16 v[60:63], v[44:47], a[4:7], v[60:63]
    ds_read_b128 v[36:39], v7 offset:23552
    v_fmac_f32 v132, v80, v100
    v_fmac_f32 v140, v80, v101
    v_mfma_f32_16x16x32_bf16 v[68:71], v[44:47], a[84:87], v[68:71]
    s_waitcnt lgkmcnt(5)
    v_fma_f32 v132, -v81, v101, v132
    v_fmac_f32 v140, v81, v100
    v_mfma_f32_16x16x32_bf16 v[60:63], v[48:51], a[8:11], v[60:63]
    ds_read_b128 v[40:43], v6 offset:24576
    v_fmac_f32 v133, v82, v100
    v_fmac_f32 v141, v82, v101
    v_mfma_f32_16x16x32_bf16 v[68:71], v[48:51], a[88:91], v[68:71]
    s_add_u32 m0, s54, 7168
    s_add_u32 s34, s53, 896
    buffer_load_dwordx4 v2, s[12:15], s34 offen lds
    s_waitcnt lgkmcnt(5)
    v_fma_f32 v133, -v83, v101, v133
    v_fmac_f32 v141, v83, v100
    v_mfma_f32_16x16x32_bf16 v[60:63], v[52:55], a[12:15], v[60:63]
    ds_read_b128 v[44:47], v7 offset:24576
    v_fmac_f32 v134, v84, v100
    v_fmac_f32 v142, v84, v101
    v_mfma_f32_16x16x32_bf16 v[68:71], v[52:55], a[92:95], v[68:71]
    s_waitcnt lgkmcnt(5)
    v_fma_f32 v134, -v85, v101, v134
    v_fmac_f32 v142, v85, v100
    v_mfma_f32_16x16x32_bf16 v[60:63], v[24:27], a[16:19], v[60:63]
    ds_read_b128 v[48:51], v6 offset:25600
    v_fmac_f32 v135, v86, v100
    v_fmac_f32 v143, v86, v101
    v_mfma_f32_16x16x32_bf16 v[68:71], v[24:27], a[96:99], v[68:71]
    s_waitcnt lgkmcnt(5)
    v_fma_f32 v135, -v87, v101, v135
    v_fmac_f32 v143, v87, v100
    v_mfma_f32_16x16x32_bf16 v[60:63], v[28:31], a[20:23], v[60:63]
    ds_read_b128 v[52:55], v7 offset:25600
    v_mul_f32 v92, v88, v128
    v_mul_f32 v128, v89, v128
    v_mfma_f32_16x16x32_bf16 v[68:71], v[28:31], a[100:103], v[68:71]
    s_add_u32 m0, s54, 8192
    s_add_u32 s34, s53, 1024
    buffer_load_dwordx4 v2, s[12:15], s34 offen lds
    s_waitcnt lgkmcnt(5)
    v_fma_f32 v92, -v89, v136, v92
    v_fma_f32 v136, -v88, v136, -v128
    v_mfma_f32_16x16x32_bf16 v[60:63], v[32:35], a[24:27], v[60:63]
    ds_read_b128 v[24:27], v6 offset:26624
    v_mul_f32 v93, v88, v129
    v_mul_f32 v129, v89, v129
    v_mfma_f32_16x16x32_bf16 v[68:71], v[32:35], a[104:107], v[68:71]
    s_waitcnt lgkmcnt(5)
    v_fma_f32 v93, -v89, v137, v93
    v_fma_f32 v137, -v88, v137, -v129
    v_mfma_f32_16x16x32_bf16 v[60:63], v[36:39], a[28:31], v[60:63]
    ds_read_b128 v[28:31], v7 offset:26624
    v_cvt_pk_bf16_f32 v108, v92, v93
    v_cvt_pk_bf16_f32 v112, v136, v137
    v_mfma_f32_16x16x32_bf16 v[68:71], v[36:39], a[108:111], v[68:71]
    s_waitcnt lgkmcnt(5)
    v_mul_f32 v94, v88, v130
    v_mul_f32 v130, v89, v130
    v_mfma_f32_16x16x32_bf16 v[60:63], v[40:43], a[32:35], v[60:63]
    ds_read_b128 v[32:35], v6 offset:27648
    v_fma_f32 v94, -v89, v138, v94
    v_fma_f32 v138, -v88, v138, -v130
    v_mfma_f32_16x16x32_bf16 v[68:71], v[40:43], a[112:115], v[68:71]
    s_add_u32 m0, s54, 9216
    s_add_u32 s34, s53, 1152
    buffer_load_dwordx4 v2, s[12:15], s34 offen lds
    s_waitcnt lgkmcnt(5)
    v_mul_f32 v95, v88, v131
    v_mul_f32 v131, v89, v131
    v_mfma_f32_16x16x32_bf16 v[60:63], v[44:47], a[36:39], v[60:63]
    ds_read_b128 v[36:39], v7 offset:27648
    v_fma_f32 v95, -v89, v139, v95
    v_fma_f32 v139, -v88, v139, -v131
    v_mfma_f32_16x16x32_bf16 v[68:71], v[44:47], a[116:119], v[68:71]
    s_waitcnt lgkmcnt(5)
    v_cvt_pk_bf16_f32 v109, v94, v95
    v_cvt_pk_bf16_f32 v113, v138, v139
    v_mfma_f32_16x16x32_bf16 v[60:63], v[48:51], a[40:43], v[60:63]
    ds_read_b128 v[40:43], v6 offset:28672
    v_mul_f32 v92, v88, v132
    v_mul_f32 v132, v89, v132
    v_mfma_f32_16x16x32_bf16 v[68:71], v[48:51], a[120:123], v[68:71]
    s_waitcnt lgkmcnt(5)
    v_fma_f32 v92, -v89, v140, v92
    v_fma_f32 v140, -v88, v140, -v132
    v_mfma_f32_16x16x32_bf16 v[60:63], v[52:55], a[44:47], v[60:63]
    ds_read_b128 v[44:47], v7 offset:28672
    v_mul_f32 v93, v88, v133
    v_mul_f32 v133, v89, v133
    v_mfma_f32_16x16x32_bf16 v[68:71], v[52:55], a[124:127], v[68:71]
    s_waitcnt lgkmcnt(5)
    v_fma_f32 v93, -v89, v141, v93
    v_fma_f32 v141, -v88, v141, -v133
    v_mfma_f32_16x16x32_bf16 v[60:63], v[24:27], a[48:51], v[60:63]
    ds_read_b128 v[48:51], v6 offset:29696
    v_cvt_pk_bf16_f32 v110, v92, v93
    v_cvt_pk_bf16_f32 v114, v140, v141
    v_mfma_f32_16x16x32_bf16 v[68:71], v[24:27], a[128:131], v[68:71]
    s_waitcnt vmcnt(10)
    s_barrier
    v_mov_b32 v14, s57
    s_mov_b64 exec, 1
    buffer_store_dword v14, v11, s[8:11], 0 offen sc1
    s_mov_b64 exec, -1
    s_waitcnt lgkmcnt(5)
    v_mul_f32 v94, v88, v134
    v_mul_f32 v134, v89, v134
    v_mfma_f32_16x16x32_bf16 v[60:63], v[28:31], a[52:55], v[60:63]
    ds_read_b128 v[52:55], v7 offset:29696
    v_fma_f32 v94, -v89, v142, v94
    v_fma_f32 v142, -v88, v142, -v134
    v_mfma_f32_16x16x32_bf16 v[68:71], v[28:31], a[132:135], v[68:71]
    s_waitcnt lgkmcnt(5)
    v_mul_f32 v95, v88, v135
    v_mul_f32 v135, v89, v135
    v_mfma_f32_16x16x32_bf16 v[60:63], v[32:35], a[56:59], v[60:63]
    ds_read_b128 v[24:27], v8 offset:0
    v_fma_f32 v95, -v89, v143, v95
    v_fma_f32 v143, -v88, v143, -v135
    v_mfma_f32_16x16x32_bf16 v[68:71], v[32:35], a[136:139], v[68:71]
    s_waitcnt lgkmcnt(5)
    v_cvt_pk_bf16_f32 v111, v94, v95
    v_cvt_pk_bf16_f32 v115, v142, v143
    v_mfma_f32_16x16x32_bf16 v[60:63], v[36:39], a[60:63], v[60:63]
    ds_read_b128 v[28:31], v9 offset:0
    v_mfma_f32_16x16x32_bf16 v[68:71], v[36:39], a[140:143], v[68:71]
    ds_write_b128 v12, v[108:111]
    s_waitcnt lgkmcnt(6)
    v_mfma_f32_16x16x32_bf16 v[60:63], v[40:43], a[64:67], v[60:63]
    ds_read_b128 v[32:35], v8 offset:1024
    ds_write_b128 v12, v[112:115] offset:1024
    v_mfma_f32_16x16x32_bf16 v[68:71], v[40:43], a[144:147], v[68:71]
    ds_read_b64_tr_b16 v[116:117], v13 offset:0
    ds_read_b64_tr_b16 v[118:119], v13 offset:256
    s_waitcnt lgkmcnt(9)
    v_mfma_f32_16x16x32_bf16 v[60:63], v[44:47], a[68:71], v[60:63]
    ds_read_b128 v[36:39], v9 offset:1024
    ds_read_b64_tr_b16 v[120:121], v13 offset:32
    ds_read_b64_tr_b16 v[122:123], v13 offset:288
    v_mov_b32 v128, v56
    v_mov_b32 v129, v57
    v_mfma_f32_16x16x32_bf16 v[68:71], v[44:47], a[148:151], v[68:71]
    s_add_u32 s53, s53, 40960
    s_mov_b32 s57, s52
    s_add_u32 s52, s52, 1
    s_waitcnt lgkmcnt(11)
    v_mov_b32 v130, v58
    v_mov_b32 v131, v59
    v_mfma_f32_16x16x32_bf16 v[60:63], v[48:51], a[72:75], v[60:63]
    ds_read_b128 v[40:43], v8 offset:2048
    v_mov_b32 v6, v8
    v_mov_b32 v7, v9
    v_mov_b32 v136, v64
    v_mov_b32 v137, v65
    v_mfma_f32_16x16x32_bf16 v[68:71], v[48:51], a[152:155], v[68:71]
    s_add_u32 s56, s55, 40960
    s_cmp_eq_u32 s56, 122880
    s_cselect_b32 s56, 0, s56
    s_add_u32 s54, s56, s40
    s_waitcnt lgkmcnt(11)
    v_mov_b32 v138, v66
    v_mov_b32 v139, v67
    v_mfma_f32_16x16x32_bf16 v[60:63], v[52:55], a[76:79], v[60:63]
    ds_read_b128 v[44:47], v9 offset:2048
    v_mfma_f32_16x16x32_bf16 v[68:71], v[52:55], a[156:159], v[68:71]
    s_waitcnt lgkmcnt(5)
    buffer_store_dwordx4 v[116:119], v10, s[8:11], s51 offen offset:0 sc1
    s_waitcnt lgkmcnt(2)
    buffer_store_dwordx4 v[120:123], v10, s[8:11], s51 offen offset:1024 sc1
    v_add_u32 v8, s55, v4
    v_add_u32 v9, s55, v5
    s_mov_b32 s55, s56
    s_mov_b32 s51, s50
    s_add_u32 s50, s50, 81920
    v_mov_b32 v132, v60
    v_mov_b32 v133, v61
    v_mov_b32 v134, v62
    v_mov_b32 v135, v63
    v_mov_b32 v140, v68
    v_mov_b32 v141, v69
    v_mov_b32 v142, v70
    v_mov_b32 v143, v71
    s_waitcnt lgkmcnt(0)
    s_cmp_lt_u32 s52, 64
    s_cbranch_scc1 L_sa_loop
    v_fmac_f32 v129, v72, v128
    v_fmac_f32 v137, v72, v136
    v_fma_f32 v129, -v73, v136, v129
    v_fmac_f32 v137, v73, v128
    v_fmac_f32 v130, v72, v129
    v_fmac_f32 v138, v72, v137
    v_fma_f32 v130, -v73, v137, v130
    v_fmac_f32 v138, v73, v129
    v_fmac_f32 v131, v72, v130
    v_fmac_f32 v139, v72, v138
    v_fma_f32 v131, -v73, v138, v131
    v_fmac_f32 v139, v73, v130
    v_fmac_f32 v132, v72, v131
    v_fmac_f32 v140, v72, v139
    v_fma_f32 v132, -v73, v139, v132
    v_fmac_f32 v140, v73, v131
    v_fmac_f32 v133, v72, v132
    v_fmac_f32 v141, v72, v140
    v_fma_f32 v133, -v73, v140, v133
    v_fmac_f32 v141, v73, v132
    v_fmac_f32 v134, v72, v133
    v_fmac_f32 v142, v72, v141
    v_fma_f32 v134, -v73, v141, v134
    v_fmac_f32 v142, v73, v133
    v_fmac_f32 v135, v72, v134
    v_fmac_f32 v143, v72, v142
    v_fma_f32 v135, -v73, v142, v135
    v_fmac_f32 v143, v73, v134
    v_mov_b32 v92, v135
    v_mov_b32 v93, v135
    v_mov_b32 v96, v143
    v_mov_b32 v97, v143
    v_mov_b32 v100, v90
    v_mov_b32 v101, v91
    v_permlane16_swap_b32 v92, v93
    v_permlane16_swap_b32 v96, v97
    v_mov_b32 v94, v92
    v_mov_b32 v95, v93
    v_mov_b32 v98, v96
    v_mov_b32 v99, v97
    v_permlane32_swap_b32 v92, v94
    v_permlane32_swap_b32 v93, v95
    v_permlane32_swap_b32 v96, v98
    v_permlane32_swap_b32 v97, v99
    v_fmac_f32 v92, v86, v90
    v_fmac_f32 v96, v86, v91
    v_fma_f32 v92, -v87, v91, v92
    v_fmac_f32 v96, v87, v90
    v_cndmask_b32 v100, v100, v92, s[68:69]
    v_cndmask_b32 v101, v101, v96, s[68:69]
    v_fmac_f32 v93, v86, v92
    v_fmac_f32 v97, v86, v96
    v_fma_f32 v93, -v87, v96, v93
    v_fmac_f32 v97, v87, v92
    v_cndmask_b32 v100, v100, v93, s[70:71]
    v_cndmask_b32 v101, v101, v97, s[70:71]
    v_fmac_f32 v94, v86, v93
    v_fmac_f32 v98, v86, v97
    v_fma_f32 v94, -v87, v97, v94
    v_fmac_f32 v98, v87, v93
    v_cndmask_b32 v100, v100, v94, s[72:73]
    v_cndmask_b32 v101, v101, v98, s[72:73]
    v_fmac_f32 v95, v86, v94
    v_fmac_f32 v99, v86, v98
    v_fma_f32 v95, -v87, v98, v95
    v_fmac_f32 v99, v87, v94
    v_mov_b32 v90, v95
    v_mov_b32 v91, v99
    v_fmac_f32 v128, v72, v100
    v_fmac_f32 v136, v72, v101
    v_fma_f32 v128, -v73, v101, v128
    v_fmac_f32 v136, v73, v100
    v_fmac_f32 v129, v74, v100
    v_fmac_f32 v137, v74, v101
    v_fma_f32 v129, -v75, v101, v129
    v_fmac_f32 v137, v75, v100
    v_fmac_f32 v130, v76, v100
    v_fmac_f32 v138, v76, v101
    v_fma_f32 v130, -v77, v101, v130
    v_fmac_f32 v138, v77, v100
    v_fmac_f32 v131, v78, v100
    v_fmac_f32 v139, v78, v101
    v_fma_f32 v131, -v79, v101, v131
    v_fmac_f32 v139, v79, v100
    v_fmac_f32 v132, v80, v100
    v_fmac_f32 v140, v80, v101
    v_fma_f32 v132, -v81, v101, v132
    v_fmac_f32 v140, v81, v100
    v_fmac_f32 v133, v82, v100
    v_fmac_f32 v141, v82, v101
    v_fma_f32 v133, -v83, v101, v133
    v_fmac_f32 v141, v83, v100
    v_fmac_f32 v134, v84, v100
    v_fmac_f32 v142, v84, v101
    v_fma_f32 v134, -v85, v101, v134
    v_fmac_f32 v142, v85, v100
    v_fmac_f32 v135, v86, v100
    v_fmac_f32 v143, v86, v101
    v_fma_f32 v135, -v87, v101, v135
    v_fmac_f32 v143, v87, v100
    v_mul_f32 v92, v88, v128
    v_mul_f32 v128, v89, v128
    v_fma_f32 v92, -v89, v136, v92
    v_fma_f32 v136, -v88, v136, -v128
    v_mul_f32 v93, v88, v129
    v_mul_f32 v129, v89, v129
    v_fma_f32 v93, -v89, v137, v93
    v_fma_f32 v137, -v88, v137, -v129
    v_cvt_pk_bf16_f32 v108, v92, v93
    v_cvt_pk_bf16_f32 v112, v136, v137
    v_mul_f32 v94, v88, v130
    v_mul_f32 v130, v89, v130
    v_fma_f32 v94, -v89, v138, v94
    v_fma_f32 v138, -v88, v138, -v130
    v_mul_f32 v95, v88, v131
    v_mul_f32 v131, v89, v131
    v_fma_f32 v95, -v89, v139, v95
    v_fma_f32 v139, -v88, v139, -v131
    v_cvt_pk_bf16_f32 v109, v94, v95
    v_cvt_pk_bf16_f32 v113, v138, v139
    v_mul_f32 v92, v88, v132
    v_mul_f32 v132, v89, v132
    v_fma_f32 v92, -v89, v140, v92
    v_fma_f32 v140, -v88, v140, -v132
    v_mul_f32 v93, v88, v133
    v_mul_f32 v133, v89, v133
    v_fma_f32 v93, -v89, v141, v93
    v_fma_f32 v141, -v88, v141, -v133
    v_cvt_pk_bf16_f32 v110, v92, v93
    v_cvt_pk_bf16_f32 v114, v140, v141
    v_mul_f32 v94, v88, v134
    v_mul_f32 v134, v89, v134
    v_fma_f32 v94, -v89, v142, v94
    v_fma_f32 v142, -v88, v142, -v134
    v_mul_f32 v95, v88, v135
    v_mul_f32 v135, v89, v135
    v_fma_f32 v95, -v89, v143, v95
    v_fma_f32 v143, -v88, v143, -v135
    v_cvt_pk_bf16_f32 v111, v94, v95
    v_cvt_pk_bf16_f32 v115, v142, v143
    ds_write_b128 v12, v[108:111]
    ds_write_b128 v12, v[112:115] offset:1024
    ds_read_b64_tr_b16 v[116:117], v13 offset:0
    ds_read_b64_tr_b16 v[118:119], v13 offset:256
    ds_read_b64_tr_b16 v[120:121], v13 offset:32
    ds_read_b64_tr_b16 v[122:123], v13 offset:288
    s_waitcnt lgkmcnt(2)
    buffer_store_dwordx4 v[116:119], v10, s[8:11], s51 offen offset:0 sc1
    s_waitcnt lgkmcnt(0)
    buffer_store_dwordx4 v[120:123], v10, s[8:11], s51 offen offset:1024 sc1
    s_waitcnt vmcnt(0) lgkmcnt(0)
    v_mov_b32 v14, s52
    s_mov_b64 exec, 1
    buffer_store_dword v14, v11, s[8:11], 0 offen sc1
    s_mov_b64 exec, -1
    s_barrier
    s_branch L_xc
.p2align 6
L_role_s5b:
    s_sub_u32 s4, s2, 242
    s_cmp_ge_u32 s4, 5
    s_cselect_b32 s52, 1, 0
    s_cselect_b32 s30, 5, 0
    s_sub_u32 s4, s4, s30
    s_load_dwordx2 s[16:17], s[0:1], 96
    s_mov_b32 s18, 819200
    s_mov_b32 s19, 0x20000
    s_load_dwordx2 s[20:21], s[0:1], 104
    s_mov_b32 s22, 819200
    s_mov_b32 s23, 0x20000
    s_waitcnt lgkmcnt(0)
    v_mov_b32 v8, 0
    v_lshlrev_b32 v9, 2, v1
    s_lshl_b32 s30, s2, 7
    s_add_u32 s30, s30, 246415360
    s_mov_b64 exec, 0xffffffff
    buffer_store_dword v8, v9, s[8:11], s30 offen sc1
    s_mov_b64 exec, -1
    s_waitcnt vmcnt(0)
    s_barrier
    s_cmp_eq_u32 s3, 0
    s_cselect_b32 s30, 0, 2146435072
    v_mov_b32 v8, 0
    v_mov_b32 v9, 1
    s_mov_b64 exec, 1
    buffer_atomic_add v9, v8, s[24:27], s30 offen sc1
    s_mov_b64 exec, -1
    s_load_dwordx2 s[72:73], s[0:1], 24
    s_mov_b32 s74, 7864320
    s_mov_b32 s75, 0x20000
    s_load_dwordx2 s[76:77], s[0:1], 16
    s_mov_b32 s78, 7864320
    s_mov_b32 s79, 0x20000
    s_waitcnt lgkmcnt(0)
    s_sub_u32 s30, s2, 232
    s_and_b32 s41, s30, 3
    s_andn2_b32 s30, s30, 3
    s_add_u32 s30, s30, s3
    s_lshl_b32 s30, s30, 6
    v_add_u32 v2, s30, v1
    s_mov_b32 s43, 0
    s_mov_b32 s42, 6144
    s_add_u32 s39, s41, 0
    s_mov_b32 s40, 43691
    v_add_u32 v3, 0, v2
    v_mul_lo_u32 v4, v3, s40
    v_lshrrev_b32 v4, 19, v4
    v_mul_u32_u24 v5, 12, v4
    v_sub_u32 v3, v3, v5
    v_mul_u32_u24 v4, 12288, v4
    v_lshrrev_b32 v5, 1, v3
    v_lshl_add_u32 v4, v5, 10, v4
    v_mov_b32 v5, s41
    v_and_b32 v5, 3, v5
    v_xor_b32 v5, 2, v5
    v_lshl_add_u32 v4, v5, 8, v4
    v_and_b32 v3, 1, v3
    v_lshl_add_u32 v4, v3, 7, v4
    buffer_load_dword v16, v4, s[72:75], s42 offen
    v_add_u32 v3, 0, v2
    v_mul_lo_u32 v4, v3, s40
    v_lshrrev_b32 v4, 20, v4
    v_mul_u32_u24 v5, 24, v4
    v_sub_u32 v3, v3, v5
    v_mul_u32_u24 v4, 12288, v4
    v_lshrrev_b32 v5, 1, v3
    v_lshl_add_u32 v4, v5, 10, v4
    v_mov_b32 v5, s41
    v_and_b32 v5, 3, v5
    v_xor_b32 v5, 2, v5
    v_lshl_add_u32 v4, v5, 8, v4
    v_and_b32 v3, 1, v3
    v_lshl_add_u32 v4, v3, 7, v4
    buffer_load_dword v17, v4, s[76:79], s43 offen
    v_add_u32 v3, 1280, v2
    v_mul_lo_u32 v4, v3, s40
    v_lshrrev_b32 v4, 20, v4
    v_mul_u32_u24 v5, 24, v4
    v_sub_u32 v3, v3, v5
    v_mul_u32_u24 v4, 12288, v4
    v_lshrrev_b32 v5, 1, v3
    v_lshl_add_u32 v4, v5, 10, v4
    v_mov_b32 v5, s41
    v_and_b32 v5, 3, v5
    v_xor_b32 v5, 2, v5
    v_lshl_add_u32 v4, v5, 8, v4
    v_and_b32 v3, 1, v3
    v_lshl_add_u32 v4, v3, 7, v4
    buffer_load_dword v18, v4, s[76:79], s43 offen
    v_add_u32 v3, 1280, v2
    v_mul_lo_u32 v4, v3, s40
    v_lshrrev_b32 v4, 19, v4
    v_mul_u32_u24 v5, 12, v4
    v_sub_u32 v3, v3, v5
    v_mul_u32_u24 v4, 12288, v4
    v_lshrrev_b32 v5, 1, v3
    v_lshl_add_u32 v4, v5, 10, v4
    v_mov_b32 v5, s41
    v_and_b32 v5, 3, v5
    v_xor_b32 v5, 2, v5
    v_lshl_add_u32 v4, v5, 8, v4
    v_and_b32 v3, 1, v3
    v_lshl_add_u32 v4, v3, 7, v4
    buffer_load_dword v19, v4, s[72:75], s42 offen
    v_add_u32 v3, 2560, v2
    v_mul_lo_u32 v4, v3, s40
    v_lshrrev_b32 v4, 20, v4
    v_mul_u32_u24 v5, 24, v4
    v_sub_u32 v3, v3, v5
    v_mul_u32_u24 v4, 12288, v4
    v_lshrrev_b32 v5, 1, v3
    v_lshl_add_u32 v4, v5, 10, v4
    v_mov_b32 v5, s41
    v_and_b32 v5, 3, v5
    v_xor_b32 v5, 2, v5
    v_lshl_add_u32 v4, v5, 8, v4
    v_and_b32 v3, 1, v3
    v_lshl_add_u32 v4, v3, 7, v4
    buffer_load_dword v20, v4, s[76:79], s43 offen
    v_add_u32 v3, 3840, v2
    v_mul_lo_u32 v4, v3, s40
    v_lshrrev_b32 v4, 20, v4
    v_mul_u32_u24 v5, 24, v4
    v_sub_u32 v3, v3, v5
    v_mul_u32_u24 v4, 12288, v4
    v_lshrrev_b32 v5, 1, v3
    v_lshl_add_u32 v4, v5, 10, v4
    v_mov_b32 v5, s41
    v_and_b32 v5, 3, v5
    v_xor_b32 v5, 2, v5
    v_lshl_add_u32 v4, v5, 8, v4
    v_and_b32 v3, 1, v3
    v_lshl_add_u32 v4, v3, 7, v4
    buffer_load_dword v21, v4, s[76:79], s43 offen
    v_add_u32 v3, 2560, v2
    v_mul_lo_u32 v4, v3, s40
    v_lshrrev_b32 v4, 19, v4
    v_mul_u32_u24 v5, 12, v4
    v_sub_u32 v3, v3, v5
    v_mul_u32_u24 v4, 12288, v4
    v_lshrrev_b32 v5, 1, v3
    v_lshl_add_u32 v4, v5, 10, v4
    v_mov_b32 v5, s41
    v_and_b32 v5, 3, v5
    v_xor_b32 v5, 2, v5
    v_lshl_add_u32 v4, v5, 8, v4
    v_and_b32 v3, 1, v3
    v_lshl_add_u32 v4, v3, 7, v4
    buffer_load_dword v22, v4, s[72:75], s42 offen
    v_add_u32 v3, 5120, v2
    v_mul_lo_u32 v4, v3, s40
    v_lshrrev_b32 v4, 20, v4
    v_mul_u32_u24 v5, 24, v4
    v_sub_u32 v3, v3, v5
    v_mul_u32_u24 v4, 12288, v4
    v_lshrrev_b32 v5, 1, v3
    v_lshl_add_u32 v4, v5, 10, v4
    v_mov_b32 v5, s41
    v_and_b32 v5, 3, v5
    v_xor_b32 v5, 2, v5
    v_lshl_add_u32 v4, v5, 8, v4
    v_and_b32 v3, 1, v3
    v_lshl_add_u32 v4, v3, 7, v4
    buffer_load_dword v23, v4, s[76:79], s43 offen
    v_add_u32 v3, 6400, v2
    v_mul_lo_u32 v4, v3, s40
    v_lshrrev_b32 v4, 20, v4
    v_mul_u32_u24 v5, 24, v4
    v_sub_u32 v3, v3, v5
    v_mul_u32_u24 v4, 12288, v4
    v_lshrrev_b32 v5, 1, v3
    v_lshl_add_u32 v4, v5, 10, v4
    v_mov_b32 v5, s41
    v_and_b32 v5, 3, v5
    v_xor_b32 v5, 2, v5
    v_lshl_add_u32 v4, v5, 8, v4
    v_and_b32 v3, 1, v3
    v_lshl_add_u32 v4, v3, 7, v4
    buffer_load_dword v24, v4, s[76:79], s43 offen
    v_add_u32 v3, 3840, v2
    v_mul_lo_u32 v4, v3, s40
    v_lshrrev_b32 v4, 19, v4
    v_mul_u32_u24 v5, 12, v4
    v_sub_u32 v3, v3, v5
    v_mul_u32_u24 v4, 12288, v4
    v_lshrrev_b32 v5, 1, v3
    v_lshl_add_u32 v4, v5, 10, v4
    v_mov_b32 v5, s41
    v_and_b32 v5, 3, v5
    v_xor_b32 v5, 2, v5
    v_lshl_add_u32 v4, v5, 8, v4
    v_and_b32 v3, 1, v3
    v_lshl_add_u32 v4, v3, 7, v4
    buffer_load_dword v25, v4, s[72:75], s42 offen
    v_add_u32 v3, 7680, v2
    v_mul_lo_u32 v4, v3, s40
    v_lshrrev_b32 v4, 20, v4
    v_mul_u32_u24 v5, 24, v4
    v_sub_u32 v3, v3, v5
    v_mul_u32_u24 v4, 12288, v4
    v_lshrrev_b32 v5, 1, v3
    v_lshl_add_u32 v4, v5, 10, v4
    v_mov_b32 v5, s41
    v_and_b32 v5, 3, v5
    v_xor_b32 v5, 2, v5
    v_lshl_add_u32 v4, v5, 8, v4
    v_and_b32 v3, 1, v3
    v_lshl_add_u32 v4, v3, 7, v4
    buffer_load_dword v26, v4, s[76:79], s43 offen
    v_add_u32 v3, 8960, v2
    v_mul_lo_u32 v4, v3, s40
    v_lshrrev_b32 v4, 20, v4
    v_mul_u32_u24 v5, 24, v4
    v_sub_u32 v3, v3, v5
    v_mul_u32_u24 v4, 12288, v4
    v_lshrrev_b32 v5, 1, v3
    v_lshl_add_u32 v4, v5, 10, v4
    v_mov_b32 v5, s41
    v_and_b32 v5, 3, v5
    v_xor_b32 v5, 2, v5
    v_lshl_add_u32 v4, v5, 8, v4
    v_and_b32 v3, 1, v3
    v_lshl_add_u32 v4, v3, 7, v4
    buffer_load_dword v27, v4, s[76:79], s43 offen
    v_add_u32 v3, 5120, v2
    v_mul_lo_u32 v4, v3, s40
    v_lshrrev_b32 v4, 19, v4
    v_mul_u32_u24 v5, 12, v4
    v_sub_u32 v3, v3, v5
    v_mul_u32_u24 v4, 12288, v4
    v_lshrrev_b32 v5, 1, v3
    v_lshl_add_u32 v4, v5, 10, v4
    v_mov_b32 v5, s41
    v_and_b32 v5, 3, v5
    v_xor_b32 v5, 2, v5
    v_lshl_add_u32 v4, v5, 8, v4
    v_and_b32 v3, 1, v3
    v_lshl_add_u32 v4, v3, 7, v4
    buffer_load_dword v28, v4, s[72:75], s42 offen
    v_add_u32 v3, 10240, v2
    v_mul_lo_u32 v4, v3, s40
    v_lshrrev_b32 v4, 20, v4
    v_mul_u32_u24 v5, 24, v4
    v_sub_u32 v3, v3, v5
    v_mul_u32_u24 v4, 12288, v4
    v_lshrrev_b32 v5, 1, v3
    v_lshl_add_u32 v4, v5, 10, v4
    v_mov_b32 v5, s41
    v_and_b32 v5, 3, v5
    v_xor_b32 v5, 2, v5
    v_lshl_add_u32 v4, v5, 8, v4
    v_and_b32 v3, 1, v3
    v_lshl_add_u32 v4, v3, 7, v4
    buffer_load_dword v29, v4, s[76:79], s43 offen
    v_add_u32 v3, 11520, v2
    v_mul_lo_u32 v4, v3, s40
    v_lshrrev_b32 v4, 20, v4
    v_mul_u32_u24 v5, 24, v4
    v_sub_u32 v3, v3, v5
    v_mul_u32_u24 v4, 12288, v4
    v_lshrrev_b32 v5, 1, v3
    v_lshl_add_u32 v4, v5, 10, v4
    v_mov_b32 v5, s41
    v_and_b32 v5, 3, v5
    v_xor_b32 v5, 2, v5
    v_lshl_add_u32 v4, v5, 8, v4
    v_and_b32 v3, 1, v3
    v_lshl_add_u32 v4, v3, 7, v4
    buffer_load_dword v30, v4, s[76:79], s43 offen
    v_add_u32 v3, 6400, v2
    v_mul_lo_u32 v4, v3, s40
    v_lshrrev_b32 v4, 19, v4
    v_mul_u32_u24 v5, 12, v4
    v_sub_u32 v3, v3, v5
    v_mul_u32_u24 v4, 12288, v4
    v_lshrrev_b32 v5, 1, v3
    v_lshl_add_u32 v4, v5, 10, v4
    v_mov_b32 v5, s41
    v_and_b32 v5, 3, v5
    v_xor_b32 v5, 2, v5
    v_lshl_add_u32 v4, v5, 8, v4
    v_and_b32 v3, 1, v3
    v_lshl_add_u32 v4, v3, 7, v4
    buffer_load_dword v31, v4, s[72:75], s42 offen
    v_add_u32 v3, 12800, v2
    v_mul_lo_u32 v4, v3, s40
    v_lshrrev_b32 v4, 20, v4
    v_mul_u32_u24 v5, 24, v4
    v_sub_u32 v3, v3, v5
    v_mul_u32_u24 v4, 12288, v4
    v_lshrrev_b32 v5, 1, v3
    v_lshl_add_u32 v4, v5, 10, v4
    v_mov_b32 v5, s41
    v_and_b32 v5, 3, v5
    v_xor_b32 v5, 2, v5
    v_lshl_add_u32 v4, v5, 8, v4
    v_and_b32 v3, 1, v3
    v_lshl_add_u32 v4, v3, 7, v4
    buffer_load_dword v32, v4, s[76:79], s43 offen
    v_add_u32 v3, 14080, v2
    v_mul_lo_u32 v4, v3, s40
    v_lshrrev_b32 v4, 20, v4
    v_mul_u32_u24 v5, 24, v4
    v_sub_u32 v3, v3, v5
    v_mul_u32_u24 v4, 12288, v4
    v_lshrrev_b32 v5, 1, v3
    v_lshl_add_u32 v4, v5, 10, v4
    v_mov_b32 v5, s41
    v_and_b32 v5, 3, v5
    v_xor_b32 v5, 2, v5
    v_lshl_add_u32 v4, v5, 8, v4
    v_and_b32 v3, 1, v3
    v_lshl_add_u32 v4, v3, 7, v4
    buffer_load_dword v33, v4, s[76:79], s43 offen
    s_waitcnt vmcnt(0)
    s_lshl_b32 s30, s4, 7
    v_and_b32 v16, 15, v1
    v_add_u32 v16, s30, v16
    v_mul_u32_u24 v16, 1280, v16
    v_bfe_u32 v17, v1, 4, 1
    v_lshl_add_u32 v16, v17, 4, v16
    s_mul_i32 s30, s3, 320
    v_add_u32 v16, s30, v16
    s_mov_b64 exec, 0xffffffff
    s_mov_b32 s34, 0
    buffer_load_dwordx4 a[0:3], v16, s[16:19], s34 offen offset:0
    buffer_load_dwordx4 a[4:7], v16, s[16:19], s34 offen offset:32
    buffer_load_dwordx4 a[8:11], v16, s[16:19], s34 offen offset:64
    buffer_load_dwordx4 a[12:15], v16, s[16:19], s34 offen offset:96
    buffer_load_dwordx4 a[16:19], v16, s[16:19], s34 offen offset:128
    buffer_load_dwordx4 a[20:23], v16, s[16:19], s34 offen offset:160
    buffer_load_dwordx4 a[24:27], v16, s[16:19], s34 offen offset:192
    buffer_load_dwordx4 a[28:31], v16, s[16:19], s34 offen offset:224
    buffer_load_dwordx4 a[32:35], v16, s[16:19], s34 offen offset:256
    buffer_load_dwordx4 a[36:39], v16, s[16:19], s34 offen offset:288
    s_mov_b32 s34, 20480
    buffer_load_dwordx4 a[40:43], v16, s[16:19], s34 offen offset:0
    buffer_load_dwordx4 a[44:47], v16, s[16:19], s34 offen offset:32
    buffer_load_dwordx4 a[48:51], v16, s[16:19], s34 offen offset:64
    buffer_load_dwordx4 a[52:55], v16, s[16:19], s34 offen offset:96
    buffer_load_dwordx4 a[56:59], v16, s[16:19], s34 offen offset:128
    buffer_load_dwordx4 a[60:63], v16, s[16:19], s34 offen offset:160
    buffer_load_dwordx4 a[64:67], v16, s[16:19], s34 offen offset:192
    buffer_load_dwordx4 a[68:71], v16, s[16:19], s34 offen offset:224
    buffer_load_dwordx4 a[72:75], v16, s[16:19], s34 offen offset:256
    buffer_load_dwordx4 a[76:79], v16, s[16:19], s34 offen offset:288
    s_mov_b32 s34, 40960
    buffer_load_dwordx4 a[80:83], v16, s[16:19], s34 offen offset:0
    buffer_load_dwordx4 a[84:87], v16, s[16:19], s34 offen offset:32
    buffer_load_dwordx4 a[88:91], v16, s[16:19], s34 offen offset:64
    buffer_load_dwordx4 a[92:95], v16, s[16:19], s34 offen offset:96
    buffer_load_dwordx4 a[96:99], v16, s[16:19], s34 offen offset:128
    buffer_load_dwordx4 a[100:103], v16, s[16:19], s34 offen offset:160
    buffer_load_dwordx4 a[104:107], v16, s[16:19], s34 offen offset:192
    buffer_load_dwordx4 a[108:111], v16, s[16:19], s34 offen offset:224
    buffer_load_dwordx4 a[112:115], v16, s[16:19], s34 offen offset:256
    buffer_load_dwordx4 a[116:119], v16, s[16:19], s34 offen offset:288
    s_mov_b32 s34, 61440
    buffer_load_dwordx4 a[120:123], v16, s[16:19], s34 offen offset:0
    buffer_load_dwordx4 a[124:127], v16, s[16:19], s34 offen offset:32
    buffer_load_dwordx4 a[128:131], v16, s[16:19], s34 offen offset:64
    buffer_load_dwordx4 a[132:135], v16, s[16:19], s34 offen offset:96
    buffer_load_dwordx4 a[136:139], v16, s[16:19], s34 offen offset:128
    buffer_load_dwordx4 a[140:143], v16, s[16:19], s34 offen offset:160
    buffer_load_dwordx4 a[144:147], v16, s[16:19], s34 offen offset:192
    buffer_load_dwordx4 a[148:151], v16, s[16:19], s34 offen offset:224
    buffer_load_dwordx4 a[152:155], v16, s[16:19], s34 offen offset:256
    buffer_load_dwordx4 a[156:159], v16, s[16:19], s34 offen offset:288
    s_mov_b32 s34, 81920
    buffer_load_dwordx4 a[160:163], v16, s[16:19], s34 offen offset:0
    buffer_load_dwordx4 a[164:167], v16, s[16:19], s34 offen offset:32
    buffer_load_dwordx4 a[168:171], v16, s[16:19], s34 offen offset:64
    buffer_load_dwordx4 a[172:175], v16, s[16:19], s34 offen offset:96
    buffer_load_dwordx4 a[176:179], v16, s[16:19], s34 offen offset:128
    buffer_load_dwordx4 a[180:183], v16, s[16:19], s34 offen offset:160
    buffer_load_dwordx4 a[184:187], v16, s[16:19], s34 offen offset:192
    buffer_load_dwordx4 a[188:191], v16, s[16:19], s34 offen offset:224
    buffer_load_dwordx4 a[192:195], v16, s[16:19], s34 offen offset:256
    buffer_load_dwordx4 a[196:199], v16, s[16:19], s34 offen offset:288
    s_mov_b32 s34, 102400
    buffer_load_dwordx4 a[200:203], v16, s[16:19], s34 offen offset:0
    buffer_load_dwordx4 a[204:207], v16, s[16:19], s34 offen offset:32
    buffer_load_dwordx4 a[208:211], v16, s[16:19], s34 offen offset:64
    buffer_load_dwordx4 a[212:215], v16, s[16:19], s34 offen offset:96
    buffer_load_dwordx4 a[216:219], v16, s[16:19], s34 offen offset:128
    buffer_load_dwordx4 a[220:223], v16, s[16:19], s34 offen offset:160
    buffer_load_dwordx4 a[224:227], v16, s[16:19], s34 offen offset:192
    buffer_load_dwordx4 a[228:231], v16, s[16:19], s34 offen offset:224
    buffer_load_dwordx4 a[232:235], v16, s[16:19], s34 offen offset:256
    buffer_load_dwordx4 a[236:239], v16, s[16:19], s34 offen offset:288
    s_mov_b32 s34, 122880
    buffer_load_dwordx4 a[240:243], v16, s[16:19], s34 offen offset:0
    buffer_load_dwordx4 a[244:247], v16, s[16:19], s34 offen offset:32
    buffer_load_dwordx4 a[248:251], v16, s[16:19], s34 offen offset:64
    buffer_load_dwordx4 a[252:255], v16, s[16:19], s34 offen offset:96
    buffer_load_dwordx4 v[192:195], v16, s[16:19], s34 offen offset:128
    buffer_load_dwordx4 v[196:199], v16, s[16:19], s34 offen offset:160
    buffer_load_dwordx4 v[200:203], v16, s[16:19], s34 offen offset:192
    buffer_load_dwordx4 v[204:207], v16, s[16:19], s34 offen offset:224
    buffer_load_dwordx4 v[208:211], v16, s[16:19], s34 offen offset:256
    buffer_load_dwordx4 v[212:215], v16, s[16:19], s34 offen offset:288
    s_mov_b32 s34, 143360
    buffer_load_dwordx4 v[216:219], v16, s[16:19], s34 offen offset:0
    buffer_load_dwordx4 v[220:223], v16, s[16:19], s34 offen offset:32
    buffer_load_dwordx4 v[224:227], v16, s[16:19], s34 offen offset:64
    buffer_load_dwordx4 v[228:231], v16, s[16:19], s34 offen offset:96
    buffer_load_dwordx4 v[232:235], v16, s[16:19], s34 offen offset:128
    buffer_load_dwordx4 v[236:239], v16, s[16:19], s34 offen offset:160
    buffer_load_dwordx4 v[240:243], v16, s[16:19], s34 offen offset:192
    buffer_load_dwordx4 v[244:247], v16, s[16:19], s34 offen offset:224
    buffer_load_dwordx4 v[248:251], v16, s[16:19], s34 offen offset:256
    buffer_load_dwordx4 v[252:255], v16, s[16:19], s34 offen offset:288
    s_mov_b32 exec_lo, 0
    s_mov_b32 exec_hi, -1
    s_waitcnt vmcnt(0)
    s_mov_b32 s34, 0
    buffer_load_dwordx4 a[0:3], v16, s[20:23], s34 offen offset:0
    buffer_load_dwordx4 a[4:7], v16, s[20:23], s34 offen offset:32
    buffer_load_dwordx4 a[8:11], v16, s[20:23], s34 offen offset:64
    buffer_load_dwordx4 a[12:15], v16, s[20:23], s34 offen offset:96
    buffer_load_dwordx4 a[16:19], v16, s[20:23], s34 offen offset:128
    buffer_load_dwordx4 a[20:23], v16, s[20:23], s34 offen offset:160
    buffer_load_dwordx4 a[24:27], v16, s[20:23], s34 offen offset:192
    buffer_load_dwordx4 a[28:31], v16, s[20:23], s34 offen offset:224
    buffer_load_dwordx4 a[32:35], v16, s[20:23], s34 offen offset:256
    buffer_load_dwordx4 a[36:39], v16, s[20:23], s34 offen offset:288
    s_mov_b32 s34, 20480
    buffer_load_dwordx4 a[40:43], v16, s[20:23], s34 offen offset:0
    buffer_load_dwordx4 a[44:47], v16, s[20:23], s34 offen offset:32
    buffer_load_dwordx4 a[48:51], v16, s[20:23], s34 offen offset:64
    buffer_load_dwordx4 a[52:55], v16, s[20:23], s34 offen offset:96
    buffer_load_dwordx4 a[56:59], v16, s[20:23], s34 offen offset:128
    buffer_load_dwordx4 a[60:63], v16, s[20:23], s34 offen offset:160
    buffer_load_dwordx4 a[64:67], v16, s[20:23], s34 offen offset:192
    buffer_load_dwordx4 a[68:71], v16, s[20:23], s34 offen offset:224
    buffer_load_dwordx4 a[72:75], v16, s[20:23], s34 offen offset:256
    buffer_load_dwordx4 a[76:79], v16, s[20:23], s34 offen offset:288
    s_mov_b32 s34, 40960
    buffer_load_dwordx4 a[80:83], v16, s[20:23], s34 offen offset:0
    buffer_load_dwordx4 a[84:87], v16, s[20:23], s34 offen offset:32
    buffer_load_dwordx4 a[88:91], v16, s[20:23], s34 offen offset:64
    buffer_load_dwordx4 a[92:95], v16, s[20:23], s34 offen offset:96
    buffer_load_dwordx4 a[96:99], v16, s[20:23], s34 offen offset:128
    buffer_load_dwordx4 a[100:103], v16, s[20:23], s34 offen offset:160
    buffer_load_dwordx4 a[104:107], v16, s[20:23], s34 offen offset:192
    buffer_load_dwordx4 a[108:111], v16, s[20:23], s34 offen offset:224
    buffer_load_dwordx4 a[112:115], v16, s[20:23], s34 offen offset:256
    buffer_load_dwordx4 a[116:119], v16, s[20:23], s34 offen offset:288
    s_mov_b32 s34, 61440
    buffer_load_dwordx4 a[120:123], v16, s[20:23], s34 offen offset:0
    buffer_load_dwordx4 a[124:127], v16, s[20:23], s34 offen offset:32
    buffer_load_dwordx4 a[128:131], v16, s[20:23], s34 offen offset:64
    buffer_load_dwordx4 a[132:135], v16, s[20:23], s34 offen offset:96
    buffer_load_dwordx4 a[136:139], v16, s[20:23], s34 offen offset:128
    buffer_load_dwordx4 a[140:143], v16, s[20:23], s34 offen offset:160
    buffer_load_dwordx4 a[144:147], v16, s[20:23], s34 offen offset:192
    buffer_load_dwordx4 a[148:151], v16, s[20:23], s34 offen offset:224
    buffer_load_dwordx4 a[152:155], v16, s[20:23], s34 offen offset:256
    buffer_load_dwordx4 a[156:159], v16, s[20:23], s34 offen offset:288
    s_mov_b32 s34, 81920
    buffer_load_dwordx4 a[160:163], v16, s[20:23], s34 offen offset:0
    buffer_load_dwordx4 a[164:167], v16, s[20:23], s34 offen offset:32
    buffer_load_dwordx4 a[168:171], v16, s[20:23], s34 offen offset:64
    buffer_load_dwordx4 a[172:175], v16, s[20:23], s34 offen offset:96
    buffer_load_dwordx4 a[176:179], v16, s[20:23], s34 offen offset:128
    buffer_load_dwordx4 a[180:183], v16, s[20:23], s34 offen offset:160
    buffer_load_dwordx4 a[184:187], v16, s[20:23], s34 offen offset:192
    buffer_load_dwordx4 a[188:191], v16, s[20:23], s34 offen offset:224
    buffer_load_dwordx4 a[192:195], v16, s[20:23], s34 offen offset:256
    buffer_load_dwordx4 a[196:199], v16, s[20:23], s34 offen offset:288
    s_mov_b32 s34, 102400
    buffer_load_dwordx4 a[200:203], v16, s[20:23], s34 offen offset:0
    buffer_load_dwordx4 a[204:207], v16, s[20:23], s34 offen offset:32
    buffer_load_dwordx4 a[208:211], v16, s[20:23], s34 offen offset:64
    buffer_load_dwordx4 a[212:215], v16, s[20:23], s34 offen offset:96
    buffer_load_dwordx4 a[216:219], v16, s[20:23], s34 offen offset:128
    buffer_load_dwordx4 a[220:223], v16, s[20:23], s34 offen offset:160
    buffer_load_dwordx4 a[224:227], v16, s[20:23], s34 offen offset:192
    buffer_load_dwordx4 a[228:231], v16, s[20:23], s34 offen offset:224
    buffer_load_dwordx4 a[232:235], v16, s[20:23], s34 offen offset:256
    buffer_load_dwordx4 a[236:239], v16, s[20:23], s34 offen offset:288
    s_mov_b32 s34, 122880
    buffer_load_dwordx4 a[240:243], v16, s[20:23], s34 offen offset:0
    buffer_load_dwordx4 a[244:247], v16, s[20:23], s34 offen offset:32
    buffer_load_dwordx4 a[248:251], v16, s[20:23], s34 offen offset:64
    buffer_load_dwordx4 a[252:255], v16, s[20:23], s34 offen offset:96
    buffer_load_dwordx4 v[192:195], v16, s[20:23], s34 offen offset:128
    buffer_load_dwordx4 v[196:199], v16, s[20:23], s34 offen offset:160
    buffer_load_dwordx4 v[200:203], v16, s[20:23], s34 offen offset:192
    buffer_load_dwordx4 v[204:207], v16, s[20:23], s34 offen offset:224
    buffer_load_dwordx4 v[208:211], v16, s[20:23], s34 offen offset:256
    buffer_load_dwordx4 v[212:215], v16, s[20:23], s34 offen offset:288
    s_mov_b32 s34, 143360
    buffer_load_dwordx4 v[216:219], v16, s[20:23], s34 offen offset:0
    buffer_load_dwordx4 v[220:223], v16, s[20:23], s34 offen offset:32
    buffer_load_dwordx4 v[224:227], v16, s[20:23], s34 offen offset:64
    buffer_load_dwordx4 v[228:231], v16, s[20:23], s34 offen offset:96
    buffer_load_dwordx4 v[232:235], v16, s[20:23], s34 offen offset:128
    buffer_load_dwordx4 v[236:239], v16, s[20:23], s34 offen offset:160
    buffer_load_dwordx4 v[240:243], v16, s[20:23], s34 offen offset:192
    buffer_load_dwordx4 v[244:247], v16, s[20:23], s34 offen offset:224
    buffer_load_dwordx4 v[248:251], v16, s[20:23], s34 offen offset:256
    buffer_load_dwordx4 v[252:255], v16, s[20:23], s34 offen offset:288
    s_mov_b64 exec, -1
    s_mul_i32 s30, s3, 20480
    v_lshl_add_u32 v2, v1, 4, s30
    v_add_u32 v3, 4096, v2
    v_add_u32 v4, 8192, v2
    v_add_u32 v5, 12288, v2
    v_add_u32 v6, 16384, v2
    s_lshl_b32 s30, s3, 14
    v_lshl_add_u32 v8, v1, 4, s30
    s_lshl_b32 s30, s3, 12
    v_lshl_add_u32 v9, v1, 4, s30
    s_lshr_b32 s30, s3, 1
    s_mul_i32 s30, s30, 40
    s_and_b32 s31, s3, 1
    s_lshl_b32 s31, s31, 2
    s_add_u32 s30, s30, s31
    s_lshl_b32 s31, s4, 3
    s_add_u32 s30, s30, s31
    s_lshl_b32 s30, s30, 10
    v_lshl_add_u32 v10, v1, 4, s30
    v_min_u32 v16, 9, v1
    v_lshlrev_b32 v12, 7, v16
    v_add_u32 v12, 246445056, v12
    s_mul_i32 s30, s52, 81920
    s_add_u32 s50, s30, 232783872
    s_add_u32 s51, s30, 239075328
    s_mov_b32 s53, 0
    s_mov_b32 s57, 0
    s_lshl_b32 s30, s2, 7
    s_lshl_b32 s31, s3, 2
    s_add_u32 s30, s30, s31
    s_add_u32 s30, s30, 246415360
    v_mov_b32 v11, s30
    s_waitcnt vmcnt(0)
    s_mov_b32 s31, 0
Lwa_74:
    v_lshlrev_b32 v17, 2, v1
    buffer_load_dword v16, v17, s[24:27], 0 offen offset:192 sc1
    s_add_u32 s31, s31, 1
    s_cmp_gt_u32 s31, 400000
    s_cbranch_scc1 L_abort
    s_sleep 2
    s_waitcnt vmcnt(0)
    v_readfirstlane_b32 s30, v16
    s_nop 0
    s_cmp_lt_u32 s30, 1
    s_nop 1
    s_cbranch_scc1 Lwa_74
    s_mov_b32 s31, 0
    s_min_u32 s30, s52, 63
    s_cmp_gt_u32 s57, s30
    s_cbranch_scc1 Lsbo_77
Lsbp_76:
    buffer_load_dwordx4 v[20:23], v12, s[8:11], 0 offen sc1
    s_add_u32 s31, s31, 1
    s_cmp_gt_u32 s31, 400000
    s_cbranch_scc1 L_abort
    s_waitcnt vmcnt(0)
    v_min_u32 v20, v20, v21
    v_min3_u32 v20, v20, v22, v23
    s_nop 1
    v_min_u32_dpp v20, v20, v20 row_ror:8 row_mask:0xf bank_mask:0xf
    s_nop 1
    v_min_u32_dpp v20, v20, v20 row_ror:4 row_mask:0xf bank_mask:0xf
    s_nop 1
    v_min_u32_dpp v20, v20, v20 row_ror:2 row_mask:0xf bank_mask:0xf
    s_nop 1
    v_min_u32_dpp v20, v20, v20 row_ror:1 row_mask:0xf bank_mask:0xf
    s_nop 0
    v_readfirstlane_b32 s57, v20
    s_nop 0
    s_cmp_le_u32 s57, s30
    s_nop 1
    s_cbranch_scc1 Lsbp_76
Lsbo_77:
    buffer_load_dwordx4 v[88:91], v2, s[8:11], s50 offen offset:0 sc1
    buffer_load_dwordx4 v[92:95], v2, s[8:11], s50 offen offset:1024 sc1
    buffer_load_dwordx4 v[96:99], v2, s[8:11], s50 offen offset:2048 sc1
    buffer_load_dwordx4 v[100:103], v2, s[8:11], s50 offen offset:3072 sc1
    buffer_load_dwordx4 v[104:107], v3, s[8:11], s50 offen offset:0 sc1
    buffer_load_dwordx4 v[108:111], v3, s[8:11], s50 offen offset:1024 sc1
    buffer_load_dwordx4 v[112:115], v3, s[8:11], s50 offen offset:2048 sc1
    buffer_load_dwordx4 v[116:119], v3, s[8:11], s50 offen offset:3072 sc1
    buffer_load_dwordx4 v[120:123], v4, s[8:11], s50 offen offset:0 sc1
    buffer_load_dwordx4 v[124:127], v4, s[8:11], s50 offen offset:1024 sc1
    buffer_load_dwordx4 v[128:131], v4, s[8:11], s50 offen offset:2048 sc1
    buffer_load_dwordx4 v[132:135], v4, s[8:11], s50 offen offset:3072 sc1
    buffer_load_dwordx4 v[136:139], v5, s[8:11], s50 offen offset:0 sc1
    buffer_load_dwordx4 v[140:143], v5, s[8:11], s50 offen offset:1024 sc1
    buffer_load_dwordx4 v[144:147], v5, s[8:11], s50 offen offset:2048 sc1
    buffer_load_dwordx4 v[148:151], v5, s[8:11], s50 offen offset:3072 sc1
    buffer_load_dwordx4 v[152:155], v6, s[8:11], s50 offen offset:0 sc1
    buffer_load_dwordx4 v[156:159], v6, s[8:11], s50 offen offset:1024 sc1
    buffer_load_dwordx4 v[160:163], v6, s[8:11], s50 offen offset:2048 sc1
    buffer_load_dwordx4 v[164:167], v6, s[8:11], s50 offen offset:3072 sc1
    s_add_u32 s50, s50, 163840
    s_waitcnt vmcnt(0)
L_sb_loop:
    s_add_u32 s58, s52, 2
    s_mov_b32 s31, 0
    s_min_u32 s30, s58, 63
    s_cmp_gt_u32 s57, s30
    s_cbranch_scc1 Lsbo_79
Lsbp_78:
    buffer_load_dwordx4 v[20:23], v12, s[8:11], 0 offen sc1
    s_add_u32 s31, s31, 1
    s_cmp_gt_u32 s31, 400000
    s_cbranch_scc1 L_abort
    s_waitcnt vmcnt(0)
    v_min_u32 v20, v20, v21
    v_min3_u32 v20, v20, v22, v23
    s_nop 1
    v_min_u32_dpp v20, v20, v20 row_ror:8 row_mask:0xf bank_mask:0xf
    s_nop 1
    v_min_u32_dpp v20, v20, v20 row_ror:4 row_mask:0xf bank_mask:0xf
    s_nop 1
    v_min_u32_dpp v20, v20, v20 row_ror:2 row_mask:0xf bank_mask:0xf
    s_nop 1
    v_min_u32_dpp v20, v20, v20 row_ror:1 row_mask:0xf bank_mask:0xf
    s_nop 0
    v_readfirstlane_b32 s57, v20
    s_nop 0
    s_cmp_le_u32 s57, s30
    s_nop 1
    s_cbranch_scc1 Lsbp_78
Lsbo_79:
    s_cmp_lt_u32 s58, 64
    s_cselect_b32 s50, s50, 2146435072
    s_waitcnt vmcnt(24)
    v_mfma_f32_16x16x32_bf16 v[24:27], a[0:3], v[88:91], 0
    v_mfma_f32_16x16x32_bf16 v[28:31], a[40:43], v[88:91], 0
    v_mfma_f32_16x16x32_bf16 v[32:35], a[80:83], v[88:91], 0
    v_mfma_f32_16x16x32_bf16 v[36:39], a[120:123], v[88:91], 0
    v_mfma_f32_16x16x32_bf16 v[40:43], a[160:163], v[88:91], 0
    v_mfma_f32_16x16x32_bf16 v[44:47], a[200:203], v[88:91], 0
    v_mfma_f32_16x16x32_bf16 v[48:51], a[240:243], v[88:91], 0
    v_mfma_f32_16x16x32_bf16 v[52:55], v[216:219], v[88:91], 0
    buffer_load_dwordx4 v[88:91], v2, s[8:11], s50 offen offset:0 sc1
    s_waitcnt vmcnt(24)
    v_mfma_f32_16x16x32_bf16 v[56:59], a[0:3], v[92:95], 0
    v_mfma_f32_16x16x32_bf16 v[60:63], a[40:43], v[92:95], 0
    v_mfma_f32_16x16x32_bf16 v[64:67], a[80:83], v[92:95], 0
    v_mfma_f32_16x16x32_bf16 v[68:71], a[120:123], v[92:95], 0
    v_mfma_f32_16x16x32_bf16 v[72:75], a[160:163], v[92:95], 0
    v_mfma_f32_16x16x32_bf16 v[76:79], a[200:203], v[92:95], 0
    v_mfma_f32_16x16x32_bf16 v[80:83], a[240:243], v[92:95], 0
    v_mfma_f32_16x16x32_bf16 v[84:87], v[216:219], v[92:95], 0
    buffer_load_dwordx4 v[92:95], v2, s[8:11], s50 offen offset:1024 sc1
    s_waitcnt vmcnt(24)
    v_mfma_f32_16x16x32_bf16 v[24:27], a[4:7], v[96:99], v[24:27]
    v_mfma_f32_16x16x32_bf16 v[28:31], a[44:47], v[96:99], v[28:31]
    v_mfma_f32_16x16x32_bf16 v[32:35], a[84:87], v[96:99], v[32:35]
    v_mfma_f32_16x16x32_bf16 v[36:39], a[124:127], v[96:99], v[36:39]
    v_mfma_f32_16x16x32_bf16 v[40:43], a[164:167], v[96:99], v[40:43]
    v_mfma_f32_16x16x32_bf16 v[44:47], a[204:207], v[96:99], v[44:47]
    v_mfma_f32_16x16x32_bf16 v[48:51], a[244:247], v[96:99], v[48:51]
    v_mfma_f32_16x16x32_bf16 v[52:55], v[220:223], v[96:99], v[52:55]
    buffer_load_dwordx4 v[96:99], v2, s[8:11], s50 offen offset:2048 sc1
    s_waitcnt vmcnt(24)
    v_mfma_f32_16x16x32_bf16 v[56:59], a[4:7], v[100:103], v[56:59]
    v_mfma_f32_16x16x32_bf16 v[60:63], a[44:47], v[100:103], v[60:63]
    v_mfma_f32_16x16x32_bf16 v[64:67], a[84:87], v[100:103], v[64:67]
    v_mfma_f32_16x16x32_bf16 v[68:71], a[124:127], v[100:103], v[68:71]
    v_mfma_f32_16x16x32_bf16 v[72:75], a[164:167], v[100:103], v[72:75]
    v_mfma_f32_16x16x32_bf16 v[76:79], a[204:207], v[100:103], v[76:79]
    v_mfma_f32_16x16x32_bf16 v[80:83], a[244:247], v[100:103], v[80:83]
    v_mfma_f32_16x16x32_bf16 v[84:87], v[220:223], v[100:103], v[84:87]
    buffer_load_dwordx4 v[100:103], v2, s[8:11], s50 offen offset:3072 sc1
    s_waitcnt vmcnt(24)
    v_mfma_f32_16x16x32_bf16 v[24:27], a[8:11], v[104:107], v[24:27]
    v_mfma_f32_16x16x32_bf16 v[28:31], a[48:51], v[104:107], v[28:31]
    v_mfma_f32_16x16x32_bf16 v[32:35], a[88:91], v[104:107], v[32:35]
    v_mfma_f32_16x16x32_bf16 v[36:39], a[128:131], v[104:107], v[36:39]
    v_mfma_f32_16x16x32_bf16 v[40:43], a[168:171], v[104:107], v[40:43]
    v_mfma_f32_16x16x32_bf16 v[44:47], a[208:211], v[104:107], v[44:47]
    v_mfma_f32_16x16x32_bf16 v[48:51], a[248:251], v[104:107], v[48:51]
    v_mfma_f32_16x16x32_bf16 v[52:55], v[224:227], v[104:107], v[52:55]
    buffer_load_dwordx4 v[104:107], v3, s[8:11], s50 offen offset:0 sc1
    s_waitcnt vmcnt(24)
    v_mfma_f32_16x16x32_bf16 v[56:59], a[8:11], v[108:111], v[56:59]
    v_mfma_f32_16x16x32_bf16 v[60:63], a[48:51], v[108:111], v[60:63]
    v_mfma_f32_16x16x32_bf16 v[64:67], a[88:91], v[108:111], v[64:67]
    v_mfma_f32_16x16x32_bf16 v[68:71], a[128:131], v[108:111], v[68:71]
    v_mfma_f32_16x16x32_bf16 v[72:75], a[168:171], v[108:111], v[72:75]
    v_mfma_f32_16x16x32_bf16 v[76:79], a[208:211], v[108:111], v[76:79]
    v_mfma_f32_16x16x32_bf16 v[80:83], a[248:251], v[108:111], v[80:83]
    v_mfma_f32_16x16x32_bf16 v[84:87], v[224:227], v[108:111], v[84:87]
    buffer_load_dwordx4 v[108:111], v3, s[8:11], s50 offen offset:1024 sc1
    s_waitcnt vmcnt(24)
    v_mfma_f32_16x16x32_bf16 v[24:27], a[12:15], v[112:115], v[24:27]
    v_mfma_f32_16x16x32_bf16 v[28:31], a[52:55], v[112:115], v[28:31]
    v_mfma_f32_16x16x32_bf16 v[32:35], a[92:95], v[112:115], v[32:35]
    v_mfma_f32_16x16x32_bf16 v[36:39], a[132:135], v[112:115], v[36:39]
    v_mfma_f32_16x16x32_bf16 v[40:43], a[172:175], v[112:115], v[40:43]
    v_mfma_f32_16x16x32_bf16 v[44:47], a[212:215], v[112:115], v[44:47]
    v_mfma_f32_16x16x32_bf16 v[48:51], a[252:255], v[112:115], v[48:51]
    v_mfma_f32_16x16x32_bf16 v[52:55], v[228:231], v[112:115], v[52:55]
    buffer_load_dwordx4 v[112:115], v3, s[8:11], s50 offen offset:2048 sc1
    s_waitcnt vmcnt(24)
    v_mfma_f32_16x16x32_bf16 v[56:59], a[12:15], v[116:119], v[56:59]
    v_mfma_f32_16x16x32_bf16 v[60:63], a[52:55], v[116:119], v[60:63]
    v_mfma_f32_16x16x32_bf16 v[64:67], a[92:95], v[116:119], v[64:67]
    v_mfma_f32_16x16x32_bf16 v[68:71], a[132:135], v[116:119], v[68:71]
    v_mfma_f32_16x16x32_bf16 v[72:75], a[172:175], v[116:119], v[72:75]
    v_mfma_f32_16x16x32_bf16 v[76:79], a[212:215], v[116:119], v[76:79]
    v_mfma_f32_16x16x32_bf16 v[80:83], a[252:255], v[116:119], v[80:83]
    v_mfma_f32_16x16x32_bf16 v[84:87], v[228:231], v[116:119], v[84:87]
    buffer_load_dwordx4 v[116:119], v3, s[8:11], s50 offen offset:3072 sc1
    s_waitcnt vmcnt(24)
    v_mfma_f32_16x16x32_bf16 v[24:27], a[16:19], v[120:123], v[24:27]
    v_mfma_f32_16x16x32_bf16 v[28:31], a[56:59], v[120:123], v[28:31]
    v_mfma_f32_16x16x32_bf16 v[32:35], a[96:99], v[120:123], v[32:35]
    v_mfma_f32_16x16x32_bf16 v[36:39], a[136:139], v[120:123], v[36:39]
    v_mfma_f32_16x16x32_bf16 v[40:43], a[176:179], v[120:123], v[40:43]
    v_mfma_f32_16x16x32_bf16 v[44:47], a[216:219], v[120:123], v[44:47]
    v_mfma_f32_16x16x32_bf16 v[48:51], v[192:195], v[120:123], v[48:51]
    v_mfma_f32_16x16x32_bf16 v[52:55], v[232:235], v[120:123], v[52:55]
    buffer_load_dwordx4 v[120:123], v4, s[8:11], s50 offen offset:0 sc1
    s_waitcnt vmcnt(24)
    v_mfma_f32_16x16x32_bf16 v[56:59], a[16:19], v[124:127], v[56:59]
    v_mfma_f32_16x16x32_bf16 v[60:63], a[56:59], v[124:127], v[60:63]
    v_mfma_f32_16x16x32_bf16 v[64:67], a[96:99], v[124:127], v[64:67]
    v_mfma_f32_16x16x32_bf16 v[68:71], a[136:139], v[124:127], v[68:71]
    v_mfma_f32_16x16x32_bf16 v[72:75], a[176:179], v[124:127], v[72:75]
    v_mfma_f32_16x16x32_bf16 v[76:79], a[216:219], v[124:127], v[76:79]
    v_mfma_f32_16x16x32_bf16 v[80:83], v[192:195], v[124:127], v[80:83]
    v_mfma_f32_16x16x32_bf16 v[84:87], v[232:235], v[124:127], v[84:87]
    buffer_load_dwordx4 v[124:127], v4, s[8:11], s50 offen offset:1024 sc1
    s_waitcnt vmcnt(24)
    v_mfma_f32_16x16x32_bf16 v[24:27], a[20:23], v[128:131], v[24:27]
    v_mfma_f32_16x16x32_bf16 v[28:31], a[60:63], v[128:131], v[28:31]
    v_mfma_f32_16x16x32_bf16 v[32:35], a[100:103], v[128:131], v[32:35]
    v_mfma_f32_16x16x32_bf16 v[36:39], a[140:143], v[128:131], v[36:39]
    v_mfma_f32_16x16x32_bf16 v[40:43], a[180:183], v[128:131], v[40:43]
    v_mfma_f32_16x16x32_bf16 v[44:47], a[220:223], v[128:131], v[44:47]
    v_mfma_f32_16x16x32_bf16 v[48:51], v[196:199], v[128:131], v[48:51]
    v_mfma_f32_16x16x32_bf16 v[52:55], v[236:239], v[128:131], v[52:55]
    buffer_load_dwordx4 v[128:131], v4, s[8:11], s50 offen offset:2048 sc1
    s_waitcnt vmcnt(24)
    v_mfma_f32_16x16x32_bf16 v[56:59], a[20:23], v[132:135], v[56:59]
    v_mfma_f32_16x16x32_bf16 v[60:63], a[60:63], v[132:135], v[60:63]
    v_mfma_f32_16x16x32_bf16 v[64:67], a[100:103], v[132:135], v[64:67]
    v_mfma_f32_16x16x32_bf16 v[68:71], a[140:143], v[132:135], v[68:71]
    v_mfma_f32_16x16x32_bf16 v[72:75], a[180:183], v[132:135], v[72:75]
    v_mfma_f32_16x16x32_bf16 v[76:79], a[220:223], v[132:135], v[76:79]
    v_mfma_f32_16x16x32_bf16 v[80:83], v[196:199], v[132:135], v[80:83]
    v_mfma_f32_16x16x32_bf16 v[84:87], v[236:239], v[132:135], v[84:87]
    buffer_load_dwordx4 v[132:135], v4, s[8:11], s50 offen offset:3072 sc1
    s_waitcnt vmcnt(24)
    v_mfma_f32_16x16x32_bf16 v[24:27], a[24:27], v[136:139], v[24:27]
    v_mfma_f32_16x16x32_bf16 v[28:31], a[64:67], v[136:139], v[28:31]
    v_mfma_f32_16x16x32_bf16 v[32:35], a[104:107], v[136:139], v[32:35]
    v_mfma_f32_16x16x32_bf16 v[36:39], a[144:147], v[136:139], v[36:39]
    v_mfma_f32_16x16x32_bf16 v[40:43], a[184:187], v[136:139], v[40:43]
    v_mfma_f32_16x16x32_bf16 v[44:47], a[224:227], v[136:139], v[44:47]
    v_mfma_f32_16x16x32_bf16 v[48:51], v[200:203], v[136:139], v[48:51]
    v_mfma_f32_16x16x32_bf16 v[52:55], v[240:243], v[136:139], v[52:55]
    buffer_load_dwordx4 v[136:139], v5, s[8:11], s50 offen offset:0 sc1
    s_waitcnt vmcnt(24)
    v_mfma_f32_16x16x32_bf16 v[56:59], a[24:27], v[140:143], v[56:59]
    v_mfma_f32_16x16x32_bf16 v[60:63], a[64:67], v[140:143], v[60:63]
    v_mfma_f32_16x16x32_bf16 v[64:67], a[104:107], v[140:143], v[64:67]
    v_mfma_f32_16x16x32_bf16 v[68:71], a[144:147], v[140:143], v[68:71]
    v_mfma_f32_16x16x32_bf16 v[72:75], a[184:187], v[140:143], v[72:75]
    v_mfma_f32_16x16x32_bf16 v[76:79], a[224:227], v[140:143], v[76:79]
    v_mfma_f32_16x16x32_bf16 v[80:83], v[200:203], v[140:143], v[80:83]
    v_mfma_f32_16x16x32_bf16 v[84:87], v[240:243], v[140:143], v[84:87]
    buffer_load_dwordx4 v[140:143], v5, s[8:11], s50 offen offset:1024 sc1
    s_waitcnt vmcnt(24)
    v_mfma_f32_16x16x32_bf16 v[24:27], a[28:31], v[144:147], v[24:27]
    v_mfma_f32_16x16x32_bf16 v[28:31], a[68:71], v[144:147], v[28:31]
    v_mfma_f32_16x16x32_bf16 v[32:35], a[108:111], v[144:147], v[32:35]
    v_mfma_f32_16x16x32_bf16 v[36:39], a[148:151], v[144:147], v[36:39]
    v_mfma_f32_16x16x32_bf16 v[40:43], a[188:191], v[144:147], v[40:43]
    v_mfma_f32_16x16x32_bf16 v[44:47], a[228:231], v[144:147], v[44:47]
    v_mfma_f32_16x16x32_bf16 v[48:51], v[204:207], v[144:147], v[48:51]
    v_mfma_f32_16x16x32_bf16 v[52:55], v[244:247], v[144:147], v[52:55]
    buffer_load_dwordx4 v[144:147], v5, s[8:11], s50 offen offset:2048 sc1
    s_waitcnt vmcnt(24)
    v_mfma_f32_16x16x32_bf16 v[56:59], a[28:31], v[148:151], v[56:59]
    v_mfma_f32_16x16x32_bf16 v[60:63], a[68:71], v[148:151], v[60:63]
    v_mfma_f32_16x16x32_bf16 v[64:67], a[108:111], v[148:151], v[64:67]
    v_mfma_f32_16x16x32_bf16 v[68:71], a[148:151], v[148:151], v[68:71]
    v_mfma_f32_16x16x32_bf16 v[72:75], a[188:191], v[148:151], v[72:75]
    v_mfma_f32_16x16x32_bf16 v[76:79], a[228:231], v[148:151], v[76:79]
    v_mfma_f32_16x16x32_bf16 v[80:83], v[204:207], v[148:151], v[80:83]
    v_mfma_f32_16x16x32_bf16 v[84:87], v[244:247], v[148:151], v[84:87]
    buffer_load_dwordx4 v[148:151], v5, s[8:11], s50 offen offset:3072 sc1
    s_waitcnt vmcnt(24)
    v_mfma_f32_16x16x32_bf16 v[24:27], a[32:35], v[152:155], v[24:27]
    v_mfma_f32_16x16x32_bf16 v[28:31], a[72:75], v[152:155], v[28:31]
    v_mfma_f32_16x16x32_bf16 v[32:35], a[112:115], v[152:155], v[32:35]
    v_mfma_f32_16x16x32_bf16 v[36:39], a[152:155], v[152:155], v[36:39]
    v_mfma_f32_16x16x32_bf16 v[40:43], a[192:195], v[152:155], v[40:43]
    v_mfma_f32_16x16x32_bf16 v[44:47], a[232:235], v[152:155], v[44:47]
    v_mfma_f32_16x16x32_bf16 v[48:51], v[208:211], v[152:155], v[48:51]
    v_mfma_f32_16x16x32_bf16 v[52:55], v[248:251], v[152:155], v[52:55]
    buffer_load_dwordx4 v[152:155], v6, s[8:11], s50 offen offset:0 sc1
    s_waitcnt vmcnt(24)
    v_mfma_f32_16x16x32_bf16 v[56:59], a[32:35], v[156:159], v[56:59]
    v_mfma_f32_16x16x32_bf16 v[60:63], a[72:75], v[156:159], v[60:63]
    v_mfma_f32_16x16x32_bf16 v[64:67], a[112:115], v[156:159], v[64:67]
    v_mfma_f32_16x16x32_bf16 v[68:71], a[152:155], v[156:159], v[68:71]
    v_mfma_f32_16x16x32_bf16 v[72:75], a[192:195], v[156:159], v[72:75]
    v_mfma_f32_16x16x32_bf16 v[76:79], a[232:235], v[156:159], v[76:79]
    v_mfma_f32_16x16x32_bf16 v[80:83], v[208:211], v[156:159], v[80:83]
    v_mfma_f32_16x16x32_bf16 v[84:87], v[248:251], v[156:159], v[84:87]
    buffer_load_dwordx4 v[156:159], v6, s[8:11], s50 offen offset:1024 sc1
    s_waitcnt vmcnt(24)
    v_mfma_f32_16x16x32_bf16 v[24:27], a[36:39], v[160:163], v[24:27]
    v_mfma_f32_16x16x32_bf16 v[28:31], a[76:79], v[160:163], v[28:31]
    v_mfma_f32_16x16x32_bf16 v[32:35], a[116:119], v[160:163], v[32:35]
    v_mfma_f32_16x16x32_bf16 v[36:39], a[156:159], v[160:163], v[36:39]
    v_mfma_f32_16x16x32_bf16 v[40:43], a[196:199], v[160:163], v[40:43]
    v_mfma_f32_16x16x32_bf16 v[44:47], a[236:239], v[160:163], v[44:47]
    v_mfma_f32_16x16x32_bf16 v[48:51], v[212:215], v[160:163], v[48:51]
    v_mfma_f32_16x16x32_bf16 v[52:55], v[252:255], v[160:163], v[52:55]
    buffer_load_dwordx4 v[160:163], v6, s[8:11], s50 offen offset:2048 sc1
    s_waitcnt vmcnt(24)
    v_mfma_f32_16x16x32_bf16 v[56:59], a[36:39], v[164:167], v[56:59]
    v_mfma_f32_16x16x32_bf16 v[60:63], a[76:79], v[164:167], v[60:63]
    v_mfma_f32_16x16x32_bf16 v[64:67], a[116:119], v[164:167], v[64:67]
    v_mfma_f32_16x16x32_bf16 v[68:71], a[156:159], v[164:167], v[68:71]
    v_mfma_f32_16x16x32_bf16 v[72:75], a[196:199], v[164:167], v[72:75]
    v_mfma_f32_16x16x32_bf16 v[76:79], a[236:239], v[164:167], v[76:79]
    v_mfma_f32_16x16x32_bf16 v[80:83], v[212:215], v[164:167], v[80:83]
    v_mfma_f32_16x16x32_bf16 v[84:87], v[252:255], v[164:167], v[84:87]
    buffer_load_dwordx4 v[164:167], v6, s[8:11], s50 offen offset:3072 sc1
    s_waitcnt vmcnt(20)
    v_mov_b32 v16, s52
    s_mov_b64 exec, 1
    buffer_store_dword v16, v11, s[8:11], 0 offen sc1
    s_mov_b64 exec, -1
    v_add_u32 v16, s53, v8
    v_add_u32 v17, s53, v9
    ds_write_b128 v16, v[24:27] offset:0
    ds_write_b128 v16, v[28:31] offset:1024
    ds_write_b128 v16, v[32:35] offset:2048
    ds_write_b128 v16, v[36:39] offset:3072
    ds_write_b128 v16, v[40:43] offset:4096
    ds_write_b128 v16, v[44:47] offset:5120
    ds_write_b128 v16, v[48:51] offset:6144
    ds_write_b128 v16, v[52:55] offset:7168
    ds_write_b128 v16, v[56:59] offset:8192
    ds_write_b128 v16, v[60:63] offset:9216
    ds_write_b128 v16, v[64:67] offset:10240
    ds_write_b128 v16, v[68:71] offset:11264
    ds_write_b128 v16, v[72:75] offset:12288
    ds_write_b128 v16, v[76:79] offset:13312
    ds_write_b128 v16, v[80:83] offset:14336
    ds_write_b128 v16, v[84:87] offset:15360
    s_waitcnt lgkmcnt(0)
    s_barrier
    ds_read_b128 v[24:27], v17 offset:0
    ds_read_b128 v[28:31], v17 offset:16384
    ds_read_b128 v[32:35], v17 offset:32768
    ds_read_b128 v[36:39], v17 offset:49152
    ds_read_b128 v[40:43], v17 offset:1024
    ds_read_b128 v[44:47], v17 offset:17408
    ds_read_b128 v[48:51], v17 offset:33792
    ds_read_b128 v[52:55], v17 offset:50176
    ds_read_b128 v[56:59], v17 offset:2048
    ds_read_b128 v[60:63], v17 offset:18432
    ds_read_b128 v[64:67], v17 offset:34816
    ds_read_b128 v[68:71], v17 offset:51200
    ds_read_b128 v[72:75], v17 offset:3072
    ds_read_b128 v[76:79], v17 offset:19456
    ds_read_b128 v[80:83], v17 offset:35840
    ds_read_b128 v[84:87], v17 offset:52224
    s_waitcnt lgkmcnt(14)
    v_pk_add_f32 v[24:25], v[24:25], v[28:29]
    v_pk_add_f32 v[26:27], v[26:27], v[30:31]
    s_waitcnt lgkmcnt(12)
    v_pk_add_f32 v[32:33], v[32:33], v[36:37]
    v_pk_add_f32 v[34:35], v[34:35], v[38:39]
    v_pk_add_f32 v[24:25], v[24:25], v[32:33]
    v_pk_add_f32 v[26:27], v[26:27], v[34:35]
    buffer_store_dwordx4 v[24:27], v10, s[8:11], s51 offen offset:0 sc1
    s_waitcnt lgkmcnt(10)
    v_pk_add_f32 v[40:41], v[40:41], v[44:45]
    v_pk_add_f32 v[42:43], v[42:43], v[46:47]
    s_waitcnt lgkmcnt(8)
    v_pk_add_f32 v[48:49], v[48:49], v[52:53]
    v_pk_add_f32 v[50:51], v[50:51], v[54:55]
    v_pk_add_f32 v[40:41], v[40:41], v[48:49]
    v_pk_add_f32 v[42:43], v[42:43], v[50:51]
    buffer_store_dwordx4 v[40:43], v10, s[8:11], s51 offen offset:1024 sc1
    s_waitcnt lgkmcnt(6)
    v_pk_add_f32 v[56:57], v[56:57], v[60:61]
    v_pk_add_f32 v[58:59], v[58:59], v[62:63]
    s_waitcnt lgkmcnt(4)
    v_pk_add_f32 v[64:65], v[64:65], v[68:69]
    v_pk_add_f32 v[66:67], v[66:67], v[70:71]
    v_pk_add_f32 v[56:57], v[56:57], v[64:65]
    v_pk_add_f32 v[58:59], v[58:59], v[66:67]
    buffer_store_dwordx4 v[56:59], v10, s[8:11], s51 offen offset:2048 sc1
    s_waitcnt lgkmcnt(2)
    v_pk_add_f32 v[72:73], v[72:73], v[76:77]
    v_pk_add_f32 v[74:75], v[74:75], v[78:79]
    s_waitcnt lgkmcnt(0)
    v_pk_add_f32 v[80:81], v[80:81], v[84:85]
    v_pk_add_f32 v[82:83], v[82:83], v[86:87]
    v_pk_add_f32 v[72:73], v[72:73], v[80:81]
    v_pk_add_f32 v[74:75], v[74:75], v[82:83]
    buffer_store_dwordx4 v[72:75], v10, s[8:11], s51 offen offset:3072 sc1
    s_xor_b32 s53, s53, 65536
    s_add_u32 s50, s50, 163840
    s_add_u32 s51, s51, 163840
    s_add_u32 s52, s52, 2
    s_cmp_lt_u32 s52, 64
    s_cbranch_scc1 L_sb_loop
    s_waitcnt vmcnt(0)
    v_mov_b32 v16, s52
    s_mov_b64 exec, 1
    buffer_store_dword v16, v11, s[8:11], 0 offen sc1
    s_mov_b64 exec, -1
    s_barrier
    s_branch L_xc
.p2align 6
L_role_pj:
    s_sub_u32 s4, s2, 128
    s_load_dwordx2 s[64:65], s[0:1], 32
    s_load_dwordx2 s[66:67], s[0:1], 24
    s_load_dwordx2 s[68:69], s[0:1], 16
    s_load_dwordx2 s[12:13], s[0:1], 0
    s_mov_b32 s14, 2621440
    s_mov_b32 s15, 0x20000
    s_waitcnt lgkmcnt(0)
    s_lshl_b32 s4, s4, 1
    s_xor_b32 s5, s4, 4
    s_add_u32 s5, s5, 142
    s_sub_u32 s5, s5, s4
    s_add_u32 s30, s4, 0
    s_cmp_ge_u32 s30, 96
    s_cselect_b32 s72, s66, s64
    s_cselect_b32 s73, s67, s65
    s_cselect_b32 s31, 96, 0
    s_cmp_ge_u32 s30, 192
    s_cselect_b32 s72, s68, s72
    s_cselect_b32 s73, s69, s73
    s_cselect_b32 s31, 192, s31
    s_mov_b32 s74, 7864320
    s_mov_b32 s75, 0x20000
    s_sub_u32 s30, s30, s31
    s_lshl_b32 s44, s30, 7
    s_add_u32 s30, s4, 1
    s_cmp_ge_u32 s30, 96
    s_cselect_b32 s76, s66, s64
    s_cselect_b32 s77, s67, s65
    s_cselect_b32 s31, 96, 0
    s_cmp_ge_u32 s30, 192
    s_cselect_b32 s76, s68, s76
    s_cselect_b32 s77, s69, s77
    s_cselect_b32 s31, 192, s31
    s_mov_b32 s78, 7864320
    s_mov_b32 s79, 0x20000
    s_sub_u32 s30, s30, s31
    s_lshl_b32 s45, s30, 7
    s_add_u32 s30, s4, 2
    s_add_u32 s30, s30, s5
    s_cmp_ge_u32 s30, 96
    s_cselect_b32 s80, s66, s64
    s_cselect_b32 s81, s67, s65
    s_cselect_b32 s31, 96, 0
    s_cmp_ge_u32 s30, 192
    s_cselect_b32 s80, s68, s80
    s_cselect_b32 s81, s69, s81
    s_cselect_b32 s31, 192, s31
    s_mov_b32 s82, 7864320
    s_mov_b32 s83, 0x20000
    s_sub_u32 s30, s30, s31
    s_lshl_b32 s46, s30, 7
    s_add_u32 s30, s4, 3
    s_add_u32 s30, s30, s5
    s_cmp_ge_u32 s30, 96
    s_cselect_b32 s84, s66, s64
    s_cselect_b32 s85, s67, s65
    s_cselect_b32 s31, 96, 0
    s_cmp_ge_u32 s30, 192
    s_cselect_b32 s84, s68, s84
    s_cselect_b32 s85, s69, s85
    s_cselect_b32 s31, 192, s31
    s_mov_b32 s86, 7864320
    s_mov_b32 s87, 0x20000
    s_sub_u32 s30, s30, s31
    s_lshl_b32 s47, s30, 7
    s_cmp_lg_u32 s3, 0
    s_cbranch_scc1 Lar0_80
    v_bfe_u32 v14, v1, 1, 1
    v_mul_u32_u24 v14, s5, v14
    v_and_b32 v15, 3, v1
    v_add3_u32 v14, s4, v14, v15
    v_mul_u32_u24 v15, 21846, v14
    v_lshrrev_b32 v15, 16, v15
    v_mul_u32_u24 v16, 3, v15
    v_sub_u32 v16, v14, v16
    v_lshrrev_b32 v17, 5, v15
    v_sub_u32 v17, 2, v17
    v_and_b32 v15, 31, v15
    v_lshlrev_b32 v18, 12, v17
    v_lshl_add_u32 v18, v15, 7, v18
    v_lshl_add_u32 v18, v16, 2, v18
    v_add_u32 v18, 246448128, v18
    s_mov_b32 s30, 25165824
    v_mul_lo_u32 v19, v17, s30
    v_mul_u32_u24 v15, 12288, v15
    v_add_u32 v19, v19, v15
    v_lshl_add_u32 v19, v16, 11, v19
    v_mov_b32 v14, 0
    s_mov_b64 exec, 15
    buffer_store_dword v14, v18, s[8:11], 0 offen sc1
    s_mov_b64 exec, -1
    v_mov_b32 v14, 0
    v_lshlrev_b32 v15, 2, v1
    s_lshl_b32 s30, s2, 7
    s_add_u32 s30, s30, 246415360
    s_mov_b64 exec, 0xffffffff
    buffer_store_dword v14, v15, s[8:11], s30 offen sc1
    s_mov_b64 exec, -1
    s_waitcnt vmcnt(0)
    s_cmp_eq_u32 s3, 0
    s_cselect_b32 s30, 0, 2146435072
    v_mov_b32 v14, 0
    v_mov_b32 v15, 1
    s_mov_b64 exec, 1
    buffer_atomic_add v15, v14, s[24:27], s30 offen sc1
    s_mov_b64 exec, -1
Lar0_80:
    v_lshrrev_b32 v2, 3, v1
    v_and_b32 v4, 7, v1
    v_xor_b32 v4, v4, v2
    s_lshl_b32 s30, s3, 3
    v_add_u32 v2, s30, v2
    v_mul_u32_u24 v2, 1280, v2
    v_lshl_add_u32 v2, v4, 4, v2
    s_mul_i32 s40, s3, 10240
    v_and_b32 v4, 7, v1
    v_lshrrev_b32 v5, 4, v1
    v_xor_b32 v5, v5, v4
    v_lshlrev_b32 v5, 4, v5
    v_lshl_add_u32 v4, v4, 7, v5
    v_bfe_u32 v5, v1, 3, 1
    v_mul_u32_u24 v5, 10240, v5
    v_add_u32 v4, v4, v5
    v_xor_b32 v5, 64, v4
    s_mov_b32 s53, 0
    s_mov_b32 s54, s40
    s_add_u32 m0, s54, 0
    s_add_u32 s34, s53, 0
    buffer_load_dwordx4 v2, s[12:15], s34 offen lds
    s_add_u32 m0, s54, 1024
    s_add_u32 s34, s53, 128
    buffer_load_dwordx4 v2, s[12:15], s34 offen lds
    s_add_u32 m0, s54, 2048
    s_add_u32 s34, s53, 256
    buffer_load_dwordx4 v2, s[12:15], s34 offen lds
    s_add_u32 m0, s54, 3072
    s_add_u32 s34, s53, 384
    buffer_load_dwordx4 v2, s[12:15], s34 offen lds
    s_add_u32 m0, s54, 4096
    s_add_u32 s34, s53, 512
    buffer_load_dwordx4 v2, s[12:15], s34 offen lds
    s_add_u32 m0, s54, 5120
    s_add_u32 s34, s53, 640
    buffer_load_dwordx4 v2, s[12:15], s34 offen lds
    s_add_u32 m0, s54, 6144
    s_add_u32 s34, s53, 768
    buffer_load_dwordx4 v2, s[12:15], s34 offen lds
    s_add_u32 m0, s54, 7168
    s_add_u32 s34, s53, 896
    buffer_load_dwordx4 v2, s[12:15], s34 offen lds
    s_add_u32 m0, s54, 8192
    s_add_u32 s34, s53, 1024
    buffer_load_dwordx4 v2, s[12:15], s34 offen lds
    s_add_u32 m0, s54, 9216
    s_add_u32 s34, s53, 1152
    buffer_load_dwordx4 v2, s[12:15], s34 offen lds
    s_lshr_b32 s30, s3, 1
    s_mul_i32 s30, s30, s5
    s_add_u32 s30, s30, s3
    s_add_u32 s30, s30, s4
    v_mov_b32 v14, s30
    v_mul_u32_u24 v15, 21846, v14
    v_lshrrev_b32 v15, 16, v15
    v_mul_u32_u24 v16, 3, v15
    v_sub_u32 v16, v14, v16
    v_lshrrev_b32 v17, 5, v15
    v_sub_u32 v17, 2, v17
    v_and_b32 v15, 31, v15
    v_lshlrev_b32 v12, 12, v17
    v_lshl_add_u32 v12, v15, 7, v12
    v_lshl_add_u32 v12, v16, 2, v12
    v_add_u32 v12, 246448128, v12
    s_mov_b32 s30, 25165824
    v_mul_lo_u32 v13, v17, s30
    v_mul_u32_u24 v15, 12288, v15
    v_add_u32 v13, v13, v15
    v_lshl_add_u32 v13, v16, 11, v13
    s_nop 0
    v_readfirstlane_b32 s50, v13
    s_nop 0
    s_add_u32 s50, s50, 67108864
    v_lshlrev_b32 v10, 4, v1
    v_add_u32 v11, 6144, v10
    v_lshrrev_b32 v17, 3, v1
    v_and_b32 v18, 7, v1
    v_and_b32 v19, 6, v17
    v_xor_b32 v18, v18, v19
    v_and_b32 v19, 4, v17
    v_add_u32 v17, v17, v19
    s_lshr_b32 s30, s3, 1
    s_lshl_b32 s30, s30, 4
    s_and_b32 s31, s3, 1
    s_lshl_b32 s32, s31, 2
    s_add_u32 s30, s30, s32
    v_add_u32 v17, s30, v17
    v_mul_u32_u24 v17, 12288, v17
    v_lshl_add_u32 v14, v18, 4, v17
    v_bfe_u32 v17, v1, 2, 3
    v_lshrrev_b32 v16, 1, v17
    v_lshlrev_b32 v16, 5, v16
    v_lshlrev_b32 v15, 7, v17
    v_lshrrev_b32 v17, 5, v1
    v_lshl_add_u32 v15, v17, 11, v15
    v_and_b32 v17, 3, v1
    v_lshl_add_u32 v15, v17, 3, v15
    s_lshl_b32 s31, s31, 13
    s_add_u32 s31, s31, 81920
    v_add_u32 v15, s31, v15
    s_lshl_b32 s33, s3, 10
    s_add_u32 s33, s33, 81920
    s_lshr_b32 s48, s3, 1
    v_xor_b32 v18, 0, v16
    v_add_u32 v18, v18, v15
    v_xor_b32 v19, 32, v16
    v_add_u32 v19, v19, v15
    v_xor_b32 v20, 64, v16
    v_add_u32 v20, v20, v15
    v_xor_b32 v21, 96, v16
    v_add_u32 v21, v21, v15
    s_add_u32 m0, s33, 0
    s_add_u32 s34, s44, 0
    buffer_load_dwordx4 v14, s[72:75], s34 offen lds
    s_add_u32 m0, s33, 8192
    s_add_u32 s34, s45, 0
    buffer_load_dwordx4 v14, s[76:79], s34 offen lds
    s_add_u32 m0, s33, 4096
    s_add_u32 s34, s44, 393216
    buffer_load_dwordx4 v14, s[72:75], s34 offen lds
    s_add_u32 m0, s33, 12288
    s_add_u32 s34, s45, 393216
    buffer_load_dwordx4 v14, s[76:79], s34 offen lds
    s_add_u32 m0, s33, 16384
    s_add_u32 s34, s44, 786432
    buffer_load_dwordx4 v14, s[72:75], s34 offen lds
    s_add_u32 m0, s33, 24576
    s_add_u32 s34, s45, 786432
    buffer_load_dwordx4 v14, s[76:79], s34 offen lds
    s_add_u32 m0, s33, 20480
    s_add_u32 s34, s44, 1179648
    buffer_load_dwordx4 v14, s[72:75], s34 offen lds
    s_add_u32 m0, s33, 28672
    s_add_u32 s34, s45, 1179648
    buffer_load_dwordx4 v14, s[76:79], s34 offen lds
    s_add_u32 m0, s33, 32768
    s_add_u32 s34, s44, 1572864
    buffer_load_dwordx4 v14, s[72:75], s34 offen lds
    s_add_u32 m0, s33, 40960
    s_add_u32 s34, s45, 1572864
    buffer_load_dwordx4 v14, s[76:79], s34 offen lds
    s_add_u32 m0, s33, 36864
    s_add_u32 s34, s44, 1966080
    buffer_load_dwordx4 v14, s[72:75], s34 offen lds
    s_add_u32 m0, s33, 45056
    s_add_u32 s34, s45, 1966080
    buffer_load_dwordx4 v14, s[76:79], s34 offen lds
    s_add_u32 m0, s33, 49152
    s_add_u32 s34, s44, 2359296
    buffer_load_dwordx4 v14, s[72:75], s34 offen lds
    s_add_u32 m0, s33, 57344
    s_add_u32 s34, s45, 2359296
    buffer_load_dwordx4 v14, s[76:79], s34 offen lds
    s_add_u32 m0, s33, 53248
    s_add_u32 s34, s44, 2752512
    buffer_load_dwordx4 v14, s[72:75], s34 offen lds
    s_add_u32 m0, s33, 61440
    s_add_u32 s34, s45, 2752512
    buffer_load_dwordx4 v14, s[76:79], s34 offen lds
    s_waitcnt vmcnt(12) lgkmcnt(0)
    s_barrier
    s_add_u32 m0, s33, 65536
    s_add_u32 s34, s44, 3145728
    buffer_load_dwordx4 v14, s[72:75], s34 offen lds
    s_add_u32 m0, s33, 73728
    s_add_u32 s34, s45, 3145728
    buffer_load_dwordx4 v14, s[76:79], s34 offen lds
    s_add_u32 m0, s33, 69632
    s_add_u32 s34, s44, 3538944
    buffer_load_dwordx4 v14, s[72:75], s34 offen lds
    s_add_u32 m0, s33, 77824
    s_add_u32 s34, s45, 3538944
    buffer_load_dwordx4 v14, s[76:79], s34 offen lds
    s_cmp_lg_u32 s48, 0
    s_cbranch_scc1 Lpw_81
    ds_read_b128 v[24:27], v4 offset:0
    ds_read_b128 v[28:31], v4 offset:20480
    ds_read_b64_tr_b16 a[0:1], v18 offset:0
    ds_read_b64_tr_b16 a[2:3], v18 offset:1024
    ds_read_b64_tr_b16 a[80:81], v19 offset:0
    ds_read_b64_tr_b16 a[82:83], v19 offset:1024
    ds_read_b64_tr_b16 a[160:161], v20 offset:0
    ds_read_b64_tr_b16 a[162:163], v20 offset:1024
    ds_read_b64_tr_b16 a[240:241], v21 offset:0
    ds_read_b64_tr_b16 a[242:243], v21 offset:1024
    ds_read_b128 v[32:35], v5 offset:0
    ds_read_b128 v[36:39], v5 offset:20480
    ds_read_b64_tr_b16 a[4:5], v18 offset:4096
    ds_read_b64_tr_b16 a[6:7], v18 offset:5120
    ds_read_b64_tr_b16 a[84:85], v19 offset:4096
    ds_read_b64_tr_b16 a[86:87], v19 offset:5120
    ds_read_b64_tr_b16 a[164:165], v20 offset:4096
    ds_read_b64_tr_b16 a[166:167], v20 offset:5120
    ds_read_b64_tr_b16 a[244:245], v21 offset:4096
    ds_read_b64_tr_b16 a[246:247], v21 offset:5120
    s_waitcnt lgkmcnt(15)
    v_mfma_f32_16x16x32_bf16 v[56:59], a[0:3], v[24:27], 0
    v_mfma_f32_16x16x32_bf16 v[72:75], a[0:3], v[28:31], 0
    s_waitcnt lgkmcnt(14)
    v_mfma_f32_16x16x32_bf16 v[60:63], a[80:83], v[24:27], 0
    v_mfma_f32_16x16x32_bf16 v[76:79], a[80:83], v[28:31], 0
    s_waitcnt lgkmcnt(12)
    v_mfma_f32_16x16x32_bf16 v[64:67], a[160:163], v[24:27], 0
    v_mfma_f32_16x16x32_bf16 v[80:83], a[160:163], v[28:31], 0
    s_waitcnt lgkmcnt(10)
    v_mfma_f32_16x16x32_bf16 v[68:71], a[240:243], v[24:27], 0
    v_mfma_f32_16x16x32_bf16 v[84:87], a[240:243], v[28:31], 0
    s_waitcnt lgkmcnt(6)
    v_mfma_f32_16x16x32_bf16 v[56:59], a[4:7], v[32:35], v[56:59]
    v_mfma_f32_16x16x32_bf16 v[72:75], a[4:7], v[36:39], v[72:75]
    s_waitcnt lgkmcnt(4)
    v_mfma_f32_16x16x32_bf16 v[60:63], a[84:87], v[32:35], v[60:63]
    v_mfma_f32_16x16x32_bf16 v[76:79], a[84:87], v[36:39], v[76:79]
    s_waitcnt lgkmcnt(2)
    v_mfma_f32_16x16x32_bf16 v[64:67], a[164:167], v[32:35], v[64:67]
    v_mfma_f32_16x16x32_bf16 v[80:83], a[164:167], v[36:39], v[80:83]
    s_waitcnt lgkmcnt(0)
    v_mfma_f32_16x16x32_bf16 v[68:71], a[244:247], v[32:35], v[68:71]
    v_mfma_f32_16x16x32_bf16 v[84:87], a[244:247], v[36:39], v[84:87]
    s_nop 7
Lpw_81:
    s_waitcnt vmcnt(12) lgkmcnt(0)
    s_barrier
    s_add_u32 m0, s33, 0
    s_add_u32 s34, s44, 3932160
    buffer_load_dwordx4 v14, s[72:75], s34 offen lds
    s_add_u32 m0, s33, 8192
    s_add_u32 s34, s45, 3932160
    buffer_load_dwordx4 v14, s[76:79], s34 offen lds
    s_add_u32 m0, s33, 4096
    s_add_u32 s34, s44, 4325376
    buffer_load_dwordx4 v14, s[72:75], s34 offen lds
    s_add_u32 m0, s33, 12288
    s_add_u32 s34, s45, 4325376
    buffer_load_dwordx4 v14, s[76:79], s34 offen lds
    s_cmp_lg_u32 s48, 0
    s_cbranch_scc1 Lpw_83
    ds_read_b128 v[24:27], v4 offset:1024
    ds_read_b128 v[28:31], v4 offset:21504
    ds_read_b64_tr_b16 a[8:9], v18 offset:16384
    ds_read_b64_tr_b16 a[10:11], v18 offset:17408
    ds_read_b64_tr_b16 a[88:89], v19 offset:16384
    ds_read_b64_tr_b16 a[90:91], v19 offset:17408
    ds_read_b64_tr_b16 a[168:169], v20 offset:16384
    ds_read_b64_tr_b16 a[170:171], v20 offset:17408
    ds_read_b64_tr_b16 a[248:249], v21 offset:16384
    ds_read_b64_tr_b16 a[250:251], v21 offset:17408
    ds_read_b128 v[32:35], v5 offset:1024
    ds_read_b128 v[36:39], v5 offset:21504
    ds_read_b64_tr_b16 a[12:13], v18 offset:20480
    ds_read_b64_tr_b16 a[14:15], v18 offset:21504
    ds_read_b64_tr_b16 a[92:93], v19 offset:20480
    ds_read_b64_tr_b16 a[94:95], v19 offset:21504
    ds_read_b64_tr_b16 a[172:173], v20 offset:20480
    ds_read_b64_tr_b16 a[174:175], v20 offset:21504
    ds_read_b64_tr_b16 a[252:253], v21 offset:20480
    ds_read_b64_tr_b16 a[254:255], v21 offset:21504
    s_waitcnt lgkmcnt(15)
    v_mfma_f32_16x16x32_bf16 v[56:59], a[8:11], v[24:27], v[56:59]
    v_mfma_f32_16x16x32_bf16 v[72:75], a[8:11], v[28:31], v[72:75]
    s_waitcnt lgkmcnt(14)
    v_mfma_f32_16x16x32_bf16 v[60:63], a[88:91], v[24:27], v[60:63]
    v_mfma_f32_16x16x32_bf16 v[76:79], a[88:91], v[28:31], v[76:79]
    s_waitcnt lgkmcnt(12)
    v_mfma_f32_16x16x32_bf16 v[64:67], a[168:171], v[24:27], v[64:67]
    v_mfma_f32_16x16x32_bf16 v[80:83], a[168:171], v[28:31], v[80:83]
    s_waitcnt lgkmcnt(10)
    v_mfma_f32_16x16x32_bf16 v[68:71], a[248:251], v[24:27], v[68:71]
    v_mfma_f32_16x16x32_bf16 v[84:87], a[248:251], v[28:31], v[84:87]
    s_waitcnt lgkmcnt(6)
    v_mfma_f32_16x16x32_bf16 v[56:59], a[12:15], v[32:35], v[56:59]
    v_mfma_f32_16x16x32_bf16 v[72:75], a[12:15], v[36:39], v[72:75]
    s_waitcnt lgkmcnt(4)
    v_mfma_f32_16x16x32_bf16 v[60:63], a[92:95], v[32:35], v[60:63]
    v_mfma_f32_16x16x32_bf16 v[76:79], a[92:95], v[36:39], v[76:79]
    s_waitcnt lgkmcnt(2)
    v_mfma_f32_16x16x32_bf16 v[64:67], a[172:175], v[32:35], v[64:67]
    v_mfma_f32_16x16x32_bf16 v[80:83], a[172:175], v[36:39], v[80:83]
    s_waitcnt lgkmcnt(0)
    v_mfma_f32_16x16x32_bf16 v[68:71], a[252:255], v[32:35], v[68:71]
    v_mfma_f32_16x16x32_bf16 v[84:87], a[252:255], v[36:39], v[84:87]
    s_nop 7
Lpw_83:
    s_waitcnt vmcnt(12) lgkmcnt(0)
    s_barrier
    s_add_u32 m0, s33, 16384
    s_add_u32 s34, s44, 4718592
    buffer_load_dwordx4 v14, s[72:75], s34 offen lds
    s_add_u32 m0, s33, 24576
    s_add_u32 s34, s45, 4718592
    buffer_load_dwordx4 v14, s[76:79], s34 offen lds
    s_add_u32 m0, s33, 20480
    s_add_u32 s34, s44, 5111808
    buffer_load_dwordx4 v14, s[72:75], s34 offen lds
    s_add_u32 m0, s33, 28672
    s_add_u32 s34, s45, 5111808
    buffer_load_dwordx4 v14, s[76:79], s34 offen lds
    s_cmp_lg_u32 s48, 0
    s_cbranch_scc1 Lpw_85
    ds_read_b128 v[24:27], v4 offset:2048
    ds_read_b128 v[28:31], v4 offset:22528
    ds_read_b64_tr_b16 a[16:17], v18 offset:32768
    ds_read_b64_tr_b16 a[18:19], v18 offset:33792
    ds_read_b64_tr_b16 a[96:97], v19 offset:32768
    ds_read_b64_tr_b16 a[98:99], v19 offset:33792
    ds_read_b64_tr_b16 a[176:177], v20 offset:32768
    ds_read_b64_tr_b16 a[178:179], v20 offset:33792
    ds_read_b64_tr_b16 v[192:193], v21 offset:32768
    ds_read_b64_tr_b16 v[194:195], v21 offset:33792
    ds_read_b128 v[32:35], v5 offset:2048
    ds_read_b128 v[36:39], v5 offset:22528
    ds_read_b64_tr_b16 a[20:21], v18 offset:36864
    ds_read_b64_tr_b16 a[22:23], v18 offset:37888
    ds_read_b64_tr_b16 a[100:101], v19 offset:36864
    ds_read_b64_tr_b16 a[102:103], v19 offset:37888
    ds_read_b64_tr_b16 a[180:181], v20 offset:36864
    ds_read_b64_tr_b16 a[182:183], v20 offset:37888
    ds_read_b64_tr_b16 v[196:197], v21 offset:36864
    ds_read_b64_tr_b16 v[198:199], v21 offset:37888
    s_waitcnt lgkmcnt(15)
    v_mfma_f32_16x16x32_bf16 v[56:59], a[16:19], v[24:27], v[56:59]
    v_mfma_f32_16x16x32_bf16 v[72:75], a[16:19], v[28:31], v[72:75]
    s_waitcnt lgkmcnt(14)
    v_mfma_f32_16x16x32_bf16 v[60:63], a[96:99], v[24:27], v[60:63]
    v_mfma_f32_16x16x32_bf16 v[76:79], a[96:99], v[28:31], v[76:79]
    s_waitcnt lgkmcnt(12)
    v_mfma_f32_16x16x32_bf16 v[64:67], a[176:179], v[24:27], v[64:67]
    v_mfma_f32_16x16x32_bf16 v[80:83], a[176:179], v[28:31], v[80:83]
    s_waitcnt lgkmcnt(10)
    v_mfma_f32_16x16x32_bf16 v[68:71], v[192:195], v[24:27], v[68:71]
    v_mfma_f32_16x16x32_bf16 v[84:87], v[192:195], v[28:31], v[84:87]
    s_waitcnt lgkmcnt(6)
    v_mfma_f32_16x16x32_bf16 v[56:59], a[20:23], v[32:35], v[56:59]
    v_mfma_f32_16x16x32_bf16 v[72:75], a[20:23], v[36:39], v[72:75]
    s_waitcnt lgkmcnt(4)
    v_mfma_f32_16x16x32_bf16 v[60:63], a[100:103], v[32:35], v[60:63]
    v_mfma_f32_16x16x32_bf16 v[76:79], a[100:103], v[36:39], v[76:79]
    s_waitcnt lgkmcnt(2)
    v_mfma_f32_16x16x32_bf16 v[64:67], a[180:183], v[32:35], v[64:67]
    v_mfma_f32_16x16x32_bf16 v[80:83], a[180:183], v[36:39], v[80:83]
    s_waitcnt lgkmcnt(0)
    v_mfma_f32_16x16x32_bf16 v[68:71], v[196:199], v[32:35], v[68:71]
    v_mfma_f32_16x16x32_bf16 v[84:87], v[196:199], v[36:39], v[84:87]
    s_nop 7
Lpw_85:
    s_waitcnt vmcnt(12) lgkmcnt(0)
    s_barrier
    s_add_u32 m0, s33, 32768
    s_add_u32 s34, s44, 5505024
    buffer_load_dwordx4 v14, s[72:75], s34 offen lds
    s_add_u32 m0, s33, 40960
    s_add_u32 s34, s45, 5505024
    buffer_load_dwordx4 v14, s[76:79], s34 offen lds
    s_add_u32 m0, s33, 36864
    s_add_u32 s34, s44, 5898240
    buffer_load_dwordx4 v14, s[72:75], s34 offen lds
    s_add_u32 m0, s33, 45056
    s_add_u32 s34, s45, 5898240
    buffer_load_dwordx4 v14, s[76:79], s34 offen lds
    s_cmp_lg_u32 s48, 0
    s_cbranch_scc1 Lpw_87
    v_add_u32 v40, 49152, v18
    v_add_u32 v41, 49152, v19
    v_add_u32 v42, 49152, v20
    v_add_u32 v43, 49152, v21
    ds_read_b128 v[24:27], v4 offset:3072
    ds_read_b128 v[28:31], v4 offset:23552
    ds_read_b64_tr_b16 a[24:25], v40 offset:0
    ds_read_b64_tr_b16 a[26:27], v40 offset:1024
    ds_read_b64_tr_b16 a[104:105], v41 offset:0
    ds_read_b64_tr_b16 a[106:107], v41 offset:1024
    ds_read_b64_tr_b16 a[184:185], v42 offset:0
    ds_read_b64_tr_b16 a[186:187], v42 offset:1024
    ds_read_b64_tr_b16 v[200:201], v43 offset:0
    ds_read_b64_tr_b16 v[202:203], v43 offset:1024
    ds_read_b128 v[32:35], v5 offset:3072
    ds_read_b128 v[36:39], v5 offset:23552
    ds_read_b64_tr_b16 a[28:29], v40 offset:4096
    ds_read_b64_tr_b16 a[30:31], v40 offset:5120
    ds_read_b64_tr_b16 a[108:109], v41 offset:4096
    ds_read_b64_tr_b16 a[110:111], v41 offset:5120
    ds_read_b64_tr_b16 a[188:189], v42 offset:4096
    ds_read_b64_tr_b16 a[190:191], v42 offset:5120
    ds_read_b64_tr_b16 v[204:205], v43 offset:4096
    ds_read_b64_tr_b16 v[206:207], v43 offset:5120
    s_waitcnt lgkmcnt(15)
    v_mfma_f32_16x16x32_bf16 v[56:59], a[24:27], v[24:27], v[56:59]
    v_mfma_f32_16x16x32_bf16 v[72:75], a[24:27], v[28:31], v[72:75]
    s_waitcnt lgkmcnt(14)
    v_mfma_f32_16x16x32_bf16 v[60:63], a[104:107], v[24:27], v[60:63]
    v_mfma_f32_16x16x32_bf16 v[76:79], a[104:107], v[28:31], v[76:79]
    s_waitcnt lgkmcnt(12)
    v_mfma_f32_16x16x32_bf16 v[64:67], a[184:187], v[24:27], v[64:67]
    v_mfma_f32_16x16x32_bf16 v[80:83], a[184:187], v[28:31], v[80:83]
    s_waitcnt lgkmcnt(10)
    v_mfma_f32_16x16x32_bf16 v[68:71], v[200:203], v[24:27], v[68:71]
    v_mfma_f32_16x16x32_bf16 v[84:87], v[200:203], v[28:31], v[84:87]
    s_waitcnt lgkmcnt(6)
    v_mfma_f32_16x16x32_bf16 v[56:59], a[28:31], v[32:35], v[56:59]
    v_mfma_f32_16x16x32_bf16 v[72:75], a[28:31], v[36:39], v[72:75]
    s_waitcnt lgkmcnt(4)
    v_mfma_f32_16x16x32_bf16 v[60:63], a[108:111], v[32:35], v[60:63]
    v_mfma_f32_16x16x32_bf16 v[76:79], a[108:111], v[36:39], v[76:79]
    s_waitcnt lgkmcnt(2)
    v_mfma_f32_16x16x32_bf16 v[64:67], a[188:191], v[32:35], v[64:67]
    v_mfma_f32_16x16x32_bf16 v[80:83], a[188:191], v[36:39], v[80:83]
    s_waitcnt lgkmcnt(0)
    v_mfma_f32_16x16x32_bf16 v[68:71], v[204:207], v[32:35], v[68:71]
    v_mfma_f32_16x16x32_bf16 v[84:87], v[204:207], v[36:39], v[84:87]
    s_nop 7
Lpw_87:
    s_waitcnt vmcnt(12) lgkmcnt(0)
    s_barrier
    s_add_u32 m0, s33, 49152
    s_add_u32 s34, s44, 6291456
    buffer_load_dwordx4 v14, s[72:75], s34 offen lds
    s_add_u32 m0, s33, 57344
    s_add_u32 s34, s45, 6291456
    buffer_load_dwordx4 v14, s[76:79], s34 offen lds
    s_add_u32 m0, s33, 53248
    s_add_u32 s34, s44, 6684672
    buffer_load_dwordx4 v14, s[72:75], s34 offen lds
    s_add_u32 m0, s33, 61440
    s_add_u32 s34, s45, 6684672
    buffer_load_dwordx4 v14, s[76:79], s34 offen lds
    s_cmp_lg_u32 s48, 0
    s_cbranch_scc1 Lpw_89
    v_add_u32 v40, 49152, v18
    v_add_u32 v41, 49152, v19
    v_add_u32 v42, 49152, v20
    v_add_u32 v43, 49152, v21
    ds_read_b128 v[24:27], v4 offset:4096
    ds_read_b128 v[28:31], v4 offset:24576
    ds_read_b64_tr_b16 a[32:33], v40 offset:16384
    ds_read_b64_tr_b16 a[34:35], v40 offset:17408
    ds_read_b64_tr_b16 a[112:113], v41 offset:16384
    ds_read_b64_tr_b16 a[114:115], v41 offset:17408
    ds_read_b64_tr_b16 a[192:193], v42 offset:16384
    ds_read_b64_tr_b16 a[194:195], v42 offset:17408
    ds_read_b64_tr_b16 v[208:209], v43 offset:16384
    ds_read_b64_tr_b16 v[210:211], v43 offset:17408
    ds_read_b128 v[32:35], v5 offset:4096
    ds_read_b128 v[36:39], v5 offset:24576
    ds_read_b64_tr_b16 a[36:37], v40 offset:20480
    ds_read_b64_tr_b16 a[38:39], v40 offset:21504
    ds_read_b64_tr_b16 a[116:117], v41 offset:20480
    ds_read_b64_tr_b16 a[118:119], v41 offset:21504
    ds_read_b64_tr_b16 a[196:197], v42 offset:20480
    ds_read_b64_tr_b16 a[198:199], v42 offset:21504
    ds_read_b64_tr_b16 v[212:213], v43 offset:20480
    ds_read_b64_tr_b16 v[214:215], v43 offset:21504
    s_waitcnt lgkmcnt(15)
    v_mfma_f32_16x16x32_bf16 v[56:59], a[32:35], v[24:27], v[56:59]
    v_mfma_f32_16x16x32_bf16 v[72:75], a[32:35], v[28:31], v[72:75]
    s_waitcnt lgkmcnt(14)
    v_mfma_f32_16x16x32_bf16 v[60:63], a[112:115], v[24:27], v[60:63]
    v_mfma_f32_16x16x32_bf16 v[76:79], a[112:115], v[28:31], v[76:79]
    s_waitcnt lgkmcnt(12)
    v_mfma_f32_16x16x32_bf16 v[64:67], a[192:195], v[24:27], v[64:67]
    v_mfma_f32_16x16x32_bf16 v[80:83], a[192:195], v[28:31], v[80:83]
    s_waitcnt lgkmcnt(10)
    v_mfma_f32_16x16x32_bf16 v[68:71], v[208:211], v[24:27], v[68:71]
    v_mfma_f32_16x16x32_bf16 v[84:87], v[208:211], v[28:31], v[84:87]
    s_waitcnt lgkmcnt(6)
    v_mfma_f32_16x16x32_bf16 v[56:59], a[36:39], v[32:35], v[56:59]
    v_mfma_f32_16x16x32_bf16 v[72:75], a[36:39], v[36:39], v[72:75]
    s_waitcnt lgkmcnt(4)
    v_mfma_f32_16x16x32_bf16 v[60:63], a[116:119], v[32:35], v[60:63]
    v_mfma_f32_16x16x32_bf16 v[76:79], a[116:119], v[36:39], v[76:79]
    s_waitcnt lgkmcnt(2)
    v_mfma_f32_16x16x32_bf16 v[64:67], a[196:199], v[32:35], v[64:67]
    v_mfma_f32_16x16x32_bf16 v[80:83], a[196:199], v[36:39], v[80:83]
    s_waitcnt lgkmcnt(0)
    v_mfma_f32_16x16x32_bf16 v[68:71], v[212:215], v[32:35], v[68:71]
    v_mfma_f32_16x16x32_bf16 v[84:87], v[212:215], v[36:39], v[84:87]
    s_nop 7
Lpw_89:
    s_waitcnt vmcnt(12) lgkmcnt(0)
    s_barrier
    s_add_u32 m0, s33, 65536
    s_add_u32 s34, s44, 7077888
    buffer_load_dwordx4 v14, s[72:75], s34 offen lds
    s_add_u32 m0, s33, 73728
    s_add_u32 s34, s45, 7077888
    buffer_load_dwordx4 v14, s[76:79], s34 offen lds
    s_add_u32 m0, s33, 69632
    s_add_u32 s34, s44, 7471104
    buffer_load_dwordx4 v14, s[72:75], s34 offen lds
    s_add_u32 m0, s33, 77824
    s_add_u32 s34, s45, 7471104
    buffer_load_dwordx4 v14, s[76:79], s34 offen lds
    s_cmp_lg_u32 s48, 0
    s_cbranch_scc1 Lpw_91
    ds_read_b128 v[24:27], v4 offset:5120
    ds_read_b128 v[28:31], v4 offset:25600
    ds_read_b64_tr_b16 a[40:41], v18 offset:0
    ds_read_b64_tr_b16 a[42:43], v18 offset:1024
    ds_read_b64_tr_b16 a[120:121], v19 offset:0
    ds_read_b64_tr_b16 a[122:123], v19 offset:1024
    ds_read_b64_tr_b16 a[200:201], v20 offset:0
    ds_read_b64_tr_b16 a[202:203], v20 offset:1024
    ds_read_b64_tr_b16 v[216:217], v21 offset:0
    ds_read_b64_tr_b16 v[218:219], v21 offset:1024
    ds_read_b128 v[32:35], v5 offset:5120
    ds_read_b128 v[36:39], v5 offset:25600
    ds_read_b64_tr_b16 a[44:45], v18 offset:4096
    ds_read_b64_tr_b16 a[46:47], v18 offset:5120
    ds_read_b64_tr_b16 a[124:125], v19 offset:4096
    ds_read_b64_tr_b16 a[126:127], v19 offset:5120
    ds_read_b64_tr_b16 a[204:205], v20 offset:4096
    ds_read_b64_tr_b16 a[206:207], v20 offset:5120
    ds_read_b64_tr_b16 v[220:221], v21 offset:4096
    ds_read_b64_tr_b16 v[222:223], v21 offset:5120
    s_waitcnt lgkmcnt(15)
    v_mfma_f32_16x16x32_bf16 v[56:59], a[40:43], v[24:27], v[56:59]
    v_mfma_f32_16x16x32_bf16 v[72:75], a[40:43], v[28:31], v[72:75]
    s_waitcnt lgkmcnt(14)
    v_mfma_f32_16x16x32_bf16 v[60:63], a[120:123], v[24:27], v[60:63]
    v_mfma_f32_16x16x32_bf16 v[76:79], a[120:123], v[28:31], v[76:79]
    s_waitcnt lgkmcnt(12)
    v_mfma_f32_16x16x32_bf16 v[64:67], a[200:203], v[24:27], v[64:67]
    v_mfma_f32_16x16x32_bf16 v[80:83], a[200:203], v[28:31], v[80:83]
    s_waitcnt lgkmcnt(10)
    v_mfma_f32_16x16x32_bf16 v[68:71], v[216:219], v[24:27], v[68:71]
    v_mfma_f32_16x16x32_bf16 v[84:87], v[216:219], v[28:31], v[84:87]
    s_waitcnt lgkmcnt(6)
    v_mfma_f32_16x16x32_bf16 v[56:59], a[44:47], v[32:35], v[56:59]
    v_mfma_f32_16x16x32_bf16 v[72:75], a[44:47], v[36:39], v[72:75]
    s_waitcnt lgkmcnt(4)
    v_mfma_f32_16x16x32_bf16 v[60:63], a[124:127], v[32:35], v[60:63]
    v_mfma_f32_16x16x32_bf16 v[76:79], a[124:127], v[36:39], v[76:79]
    s_waitcnt lgkmcnt(2)
    v_mfma_f32_16x16x32_bf16 v[64:67], a[204:207], v[32:35], v[64:67]
    v_mfma_f32_16x16x32_bf16 v[80:83], a[204:207], v[36:39], v[80:83]
    s_waitcnt lgkmcnt(0)
    v_mfma_f32_16x16x32_bf16 v[68:71], v[220:223], v[32:35], v[68:71]
    v_mfma_f32_16x16x32_bf16 v[84:87], v[220:223], v[36:39], v[84:87]
    s_nop 7
Lpw_91:
    s_waitcnt vmcnt(12) lgkmcnt(0)
    s_barrier
    s_mov_b32 s53, 40960
    s_add_u32 s54, s40, 40960
    s_add_u32 m0, s54, 0
    s_add_u32 s34, s53, 0
    buffer_load_dwordx4 v2, s[12:15], s34 offen lds
    s_add_u32 m0, s54, 1024
    s_add_u32 s34, s53, 128
    buffer_load_dwordx4 v2, s[12:15], s34 offen lds
    s_add_u32 m0, s54, 2048
    s_add_u32 s34, s53, 256
    buffer_load_dwordx4 v2, s[12:15], s34 offen lds
    s_add_u32 m0, s54, 3072
    s_add_u32 s34, s53, 384
    buffer_load_dwordx4 v2, s[12:15], s34 offen lds
    s_add_u32 m0, s54, 4096
    s_add_u32 s34, s53, 512
    buffer_load_dwordx4 v2, s[12:15], s34 offen lds
    s_add_u32 m0, s54, 5120
    s_add_u32 s34, s53, 640
    buffer_load_dwordx4 v2, s[12:15], s34 offen lds
    s_add_u32 m0, s54, 6144
    s_add_u32 s34, s53, 768
    buffer_load_dwordx4 v2, s[12:15], s34 offen lds
    s_add_u32 m0, s54, 7168
    s_add_u32 s34, s53, 896
    buffer_load_dwordx4 v2, s[12:15], s34 offen lds
    s_add_u32 m0, s54, 8192
    s_add_u32 s34, s53, 1024
    buffer_load_dwordx4 v2, s[12:15], s34 offen lds
    s_add_u32 m0, s54, 9216
    s_add_u32 s34, s53, 1152
    buffer_load_dwordx4 v2, s[12:15], s34 offen lds
    s_add_u32 m0, s33, 0
    s_add_u32 s34, s46, 0
    buffer_load_dwordx4 v14, s[80:83], s34 offen lds
    s_add_u32 m0, s33, 8192
    s_add_u32 s34, s47, 0
    buffer_load_dwordx4 v14, s[84:87], s34 offen lds
    s_add_u32 m0, s33, 4096
    s_add_u32 s34, s46, 393216
    buffer_load_dwordx4 v14, s[80:83], s34 offen lds
    s_add_u32 m0, s33, 12288
    s_add_u32 s34, s47, 393216
    buffer_load_dwordx4 v14, s[84:87], s34 offen lds
    s_cmp_lg_u32 s48, 0
    s_cbranch_scc1 Lpw_93
    ds_read_b128 v[24:27], v4 offset:6144
    ds_read_b128 v[28:31], v4 offset:26624
    ds_read_b64_tr_b16 a[48:49], v18 offset:16384
    ds_read_b64_tr_b16 a[50:51], v18 offset:17408
    ds_read_b64_tr_b16 a[128:129], v19 offset:16384
    ds_read_b64_tr_b16 a[130:131], v19 offset:17408
    ds_read_b64_tr_b16 a[208:209], v20 offset:16384
    ds_read_b64_tr_b16 a[210:211], v20 offset:17408
    ds_read_b64_tr_b16 v[224:225], v21 offset:16384
    ds_read_b64_tr_b16 v[226:227], v21 offset:17408
    ds_read_b128 v[32:35], v5 offset:6144
    ds_read_b128 v[36:39], v5 offset:26624
    ds_read_b64_tr_b16 a[52:53], v18 offset:20480
    ds_read_b64_tr_b16 a[54:55], v18 offset:21504
    ds_read_b64_tr_b16 a[132:133], v19 offset:20480
    ds_read_b64_tr_b16 a[134:135], v19 offset:21504
    ds_read_b64_tr_b16 a[212:213], v20 offset:20480
    ds_read_b64_tr_b16 a[214:215], v20 offset:21504
    ds_read_b64_tr_b16 v[228:229], v21 offset:20480
    ds_read_b64_tr_b16 v[230:231], v21 offset:21504
    s_waitcnt lgkmcnt(15)
    v_mfma_f32_16x16x32_bf16 v[56:59], a[48:51], v[24:27], v[56:59]
    v_mfma_f32_16x16x32_bf16 v[72:75], a[48:51], v[28:31], v[72:75]
    s_waitcnt lgkmcnt(14)
    v_mfma_f32_16x16x32_bf16 v[60:63], a[128:131], v[24:27], v[60:63]
    v_mfma_f32_16x16x32_bf16 v[76:79], a[128:131], v[28:31], v[76:79]
    s_waitcnt lgkmcnt(12)
    v_mfma_f32_16x16x32_bf16 v[64:67], a[208:211], v[24:27], v[64:67]
    v_mfma_f32_16x16x32_bf16 v[80:83], a[208:211], v[28:31], v[80:83]
    s_waitcnt lgkmcnt(10)
    v_mfma_f32_16x16x32_bf16 v[68:71], v[224:227], v[24:27], v[68:71]
    v_mfma_f32_16x16x32_bf16 v[84:87], v[224:227], v[28:31], v[84:87]
    s_waitcnt lgkmcnt(6)
    v_mfma_f32_16x16x32_bf16 v[56:59], a[52:55], v[32:35], v[56:59]
    v_mfma_f32_16x16x32_bf16 v[72:75], a[52:55], v[36:39], v[72:75]
    s_waitcnt lgkmcnt(4)
    v_mfma_f32_16x16x32_bf16 v[60:63], a[132:135], v[32:35], v[60:63]
    v_mfma_f32_16x16x32_bf16 v[76:79], a[132:135], v[36:39], v[76:79]
    s_waitcnt lgkmcnt(2)
    v_mfma_f32_16x16x32_bf16 v[64:67], a[212:215], v[32:35], v[64:67]
    v_mfma_f32_16x16x32_bf16 v[80:83], a[212:215], v[36:39], v[80:83]
    s_waitcnt lgkmcnt(0)
    v_mfma_f32_16x16x32_bf16 v[68:71], v[228:231], v[32:35], v[68:71]
    v_mfma_f32_16x16x32_bf16 v[84:87], v[228:231], v[36:39], v[84:87]
    s_nop 7
Lpw_93:
    s_waitcnt vmcnt(22) lgkmcnt(0)
    s_barrier
    s_add_u32 m0, s33, 16384
    s_add_u32 s34, s46, 786432
    buffer_load_dwordx4 v14, s[80:83], s34 offen lds
    s_add_u32 m0, s33, 24576
    s_add_u32 s34, s47, 786432
    buffer_load_dwordx4 v14, s[84:87], s34 offen lds
    s_add_u32 m0, s33, 20480
    s_add_u32 s34, s46, 1179648
    buffer_load_dwordx4 v14, s[80:83], s34 offen lds
    s_add_u32 m0, s33, 28672
    s_add_u32 s34, s47, 1179648
    buffer_load_dwordx4 v14, s[84:87], s34 offen lds
    s_cmp_lg_u32 s48, 0
    s_cbranch_scc1 Lpw_95
    ds_read_b128 v[24:27], v4 offset:7168
    ds_read_b128 v[28:31], v4 offset:27648
    ds_read_b64_tr_b16 a[56:57], v18 offset:32768
    ds_read_b64_tr_b16 a[58:59], v18 offset:33792
    ds_read_b64_tr_b16 a[136:137], v19 offset:32768
    ds_read_b64_tr_b16 a[138:139], v19 offset:33792
    ds_read_b64_tr_b16 a[216:217], v20 offset:32768
    ds_read_b64_tr_b16 a[218:219], v20 offset:33792
    ds_read_b64_tr_b16 v[232:233], v21 offset:32768
    ds_read_b64_tr_b16 v[234:235], v21 offset:33792
    ds_read_b128 v[32:35], v5 offset:7168
    ds_read_b128 v[36:39], v5 offset:27648
    ds_read_b64_tr_b16 a[60:61], v18 offset:36864
    ds_read_b64_tr_b16 a[62:63], v18 offset:37888
    ds_read_b64_tr_b16 a[140:141], v19 offset:36864
    ds_read_b64_tr_b16 a[142:143], v19 offset:37888
    ds_read_b64_tr_b16 a[220:221], v20 offset:36864
    ds_read_b64_tr_b16 a[222:223], v20 offset:37888
    ds_read_b64_tr_b16 v[236:237], v21 offset:36864
    ds_read_b64_tr_b16 v[238:239], v21 offset:37888
    s_waitcnt lgkmcnt(15)
    v_mfma_f32_16x16x32_bf16 v[56:59], a[56:59], v[24:27], v[56:59]
    v_mfma_f32_16x16x32_bf16 v[72:75], a[56:59], v[28:31], v[72:75]
    s_waitcnt lgkmcnt(14)
    v_mfma_f32_16x16x32_bf16 v[60:63], a[136:139], v[24:27], v[60:63]
    v_mfma_f32_16x16x32_bf16 v[76:79], a[136:139], v[28:31], v[76:79]
    s_waitcnt lgkmcnt(12)
    v_mfma_f32_16x16x32_bf16 v[64:67], a[216:219], v[24:27], v[64:67]
    v_mfma_f32_16x16x32_bf16 v[80:83], a[216:219], v[28:31], v[80:83]
    s_waitcnt lgkmcnt(10)
    v_mfma_f32_16x16x32_bf16 v[68:71], v[232:235], v[24:27], v[68:71]
    v_mfma_f32_16x16x32_bf16 v[84:87], v[232:235], v[28:31], v[84:87]
    s_waitcnt lgkmcnt(6)
    v_mfma_f32_16x16x32_bf16 v[56:59], a[60:63], v[32:35], v[56:59]
    v_mfma_f32_16x16x32_bf16 v[72:75], a[60:63], v[36:39], v[72:75]
    s_waitcnt lgkmcnt(4)
    v_mfma_f32_16x16x32_bf16 v[60:63], a[140:143], v[32:35], v[60:63]
    v_mfma_f32_16x16x32_bf16 v[76:79], a[140:143], v[36:39], v[76:79]
    s_waitcnt lgkmcnt(2)
    v_mfma_f32_16x16x32_bf16 v[64:67], a[220:223], v[32:35], v[64:67]
    v_mfma_f32_16x16x32_bf16 v[80:83], a[220:223], v[36:39], v[80:83]
    s_waitcnt lgkmcnt(0)
    v_mfma_f32_16x16x32_bf16 v[68:71], v[236:239], v[32:35], v[68:71]
    v_mfma_f32_16x16x32_bf16 v[84:87], v[236:239], v[36:39], v[84:87]
    s_nop 7
Lpw_95:
    s_waitcnt vmcnt(22) lgkmcnt(0)
    s_barrier
    s_add_u32 m0, s33, 32768
    s_add_u32 s34, s46, 1572864
    buffer_load_dwordx4 v14, s[80:83], s34 offen lds
    s_add_u32 m0, s33, 40960
    s_add_u32 s34, s47, 1572864
    buffer_load_dwordx4 v14, s[84:87], s34 offen lds
    s_add_u32 m0, s33, 36864
    s_add_u32 s34, s46, 1966080
    buffer_load_dwordx4 v14, s[80:83], s34 offen lds
    s_add_u32 m0, s33, 45056
    s_add_u32 s34, s47, 1966080
    buffer_load_dwordx4 v14, s[84:87], s34 offen lds
    s_cmp_lg_u32 s48, 0
    s_cbranch_scc1 Lpw_97
    v_add_u32 v40, 49152, v18
    v_add_u32 v41, 49152, v19
    v_add_u32 v42, 49152, v20
    v_add_u32 v43, 49152, v21
    ds_read_b128 v[24:27], v4 offset:8192
    ds_read_b128 v[28:31], v4 offset:28672
    ds_read_b64_tr_b16 a[64:65], v40 offset:0
    ds_read_b64_tr_b16 a[66:67], v40 offset:1024
    ds_read_b64_tr_b16 a[144:145], v41 offset:0
    ds_read_b64_tr_b16 a[146:147], v41 offset:1024
    ds_read_b64_tr_b16 a[224:225], v42 offset:0
    ds_read_b64_tr_b16 a[226:227], v42 offset:1024
    ds_read_b64_tr_b16 v[240:241], v43 offset:0
    ds_read_b64_tr_b16 v[242:243], v43 offset:1024
    ds_read_b128 v[32:35], v5 offset:8192
    ds_read_b128 v[36:39], v5 offset:28672
    ds_read_b64_tr_b16 a[68:69], v40 offset:4096
    ds_read_b64_tr_b16 a[70:71], v40 offset:5120
    ds_read_b64_tr_b16 a[148:149], v41 offset:4096
    ds_read_b64_tr_b16 a[150:151], v41 offset:5120
    ds_read_b64_tr_b16 a[228:229], v42 offset:4096
    ds_read_b64_tr_b16 a[230:231], v42 offset:5120
    ds_read_b64_tr_b16 v[244:245], v43 offset:4096
    ds_read_b64_tr_b16 v[246:247], v43 offset:5120
    s_waitcnt lgkmcnt(15)
    v_mfma_f32_16x16x32_bf16 v[56:59], a[64:67], v[24:27], v[56:59]
    v_mfma_f32_16x16x32_bf16 v[72:75], a[64:67], v[28:31], v[72:75]
    s_waitcnt lgkmcnt(14)
    v_mfma_f32_16x16x32_bf16 v[60:63], a[144:147], v[24:27], v[60:63]
    v_mfma_f32_16x16x32_bf16 v[76:79], a[144:147], v[28:31], v[76:79]
    s_waitcnt lgkmcnt(12)
    v_mfma_f32_16x16x32_bf16 v[64:67], a[224:227], v[24:27], v[64:67]
    v_mfma_f32_16x16x32_bf16 v[80:83], a[224:227], v[28:31], v[80:83]
    s_waitcnt lgkmcnt(10)
    v_mfma_f32_16x16x32_bf16 v[68:71], v[240:243], v[24:27], v[68:71]
    v_mfma_f32_16x16x32_bf16 v[84:87], v[240:243], v[28:31], v[84:87]
    s_waitcnt lgkmcnt(6)
    v_mfma_f32_16x16x32_bf16 v[56:59], a[68:71], v[32:35], v[56:59]
    v_mfma_f32_16x16x32_bf16 v[72:75], a[68:71], v[36:39], v[72:75]
    s_waitcnt lgkmcnt(4)
    v_mfma_f32_16x16x32_bf16 v[60:63], a[148:151], v[32:35], v[60:63]
    v_mfma_f32_16x16x32_bf16 v[76:79], a[148:151], v[36:39], v[76:79]
    s_waitcnt lgkmcnt(2)
    v_mfma_f32_16x16x32_bf16 v[64:67], a[228:231], v[32:35], v[64:67]
    v_mfma_f32_16x16x32_bf16 v[80:83], a[228:231], v[36:39], v[80:83]
    s_waitcnt lgkmcnt(0)
    v_mfma_f32_16x16x32_bf16 v[68:71], v[244:247], v[32:35], v[68:71]
    v_mfma_f32_16x16x32_bf16 v[84:87], v[244:247], v[36:39], v[84:87]
    s_nop 7
Lpw_97:
    s_waitcnt vmcnt(22) lgkmcnt(0)
    s_barrier
    s_add_u32 m0, s33, 49152
    s_add_u32 s34, s46, 2359296
    buffer_load_dwordx4 v14, s[80:83], s34 offen lds
    s_add_u32 m0, s33, 57344
    s_add_u32 s34, s47, 2359296
    buffer_load_dwordx4 v14, s[84:87], s34 offen lds
    s_add_u32 m0, s33, 53248
    s_add_u32 s34, s46, 2752512
    buffer_load_dwordx4 v14, s[80:83], s34 offen lds
    s_add_u32 m0, s33, 61440
    s_add_u32 s34, s47, 2752512
    buffer_load_dwordx4 v14, s[84:87], s34 offen lds
    s_cmp_lg_u32 s48, 0
    s_cbranch_scc1 Lpw_99
    v_add_u32 v40, 49152, v18
    v_add_u32 v41, 49152, v19
    v_add_u32 v42, 49152, v20
    v_add_u32 v43, 49152, v21
    ds_read_b128 v[24:27], v4 offset:9216
    ds_read_b128 v[28:31], v4 offset:29696
    ds_read_b64_tr_b16 a[72:73], v40 offset:16384
    ds_read_b64_tr_b16 a[74:75], v40 offset:17408
    ds_read_b64_tr_b16 a[152:153], v41 offset:16384
    ds_read_b64_tr_b16 a[154:155], v41 offset:17408
    ds_read_b64_tr_b16 a[232:233], v42 offset:16384
    ds_read_b64_tr_b16 a[234:235], v42 offset:17408
    ds_read_b64_tr_b16 v[248:249], v43 offset:16384
    ds_read_b64_tr_b16 v[250:251], v43 offset:17408
    ds_read_b128 v[32:35], v5 offset:9216
    ds_read_b128 v[36:39], v5 offset:29696
    ds_read_b64_tr_b16 a[76:77], v40 offset:20480
    ds_read_b64_tr_b16 a[78:79], v40 offset:21504
    ds_read_b64_tr_b16 a[156:157], v41 offset:20480
    ds_read_b64_tr_b16 a[158:159], v41 offset:21504
    ds_read_b64_tr_b16 a[236:237], v42 offset:20480
    ds_read_b64_tr_b16 a[238:239], v42 offset:21504
    ds_read_b64_tr_b16 v[252:253], v43 offset:20480
    ds_read_b64_tr_b16 v[254:255], v43 offset:21504
    s_waitcnt lgkmcnt(15)
    v_mfma_f32_16x16x32_bf16 v[56:59], a[72:75], v[24:27], v[56:59]
    v_mfma_f32_16x16x32_bf16 v[72:75], a[72:75], v[28:31], v[72:75]
    s_waitcnt lgkmcnt(14)
    v_mfma_f32_16x16x32_bf16 v[60:63], a[152:155], v[24:27], v[60:63]
    v_mfma_f32_16x16x32_bf16 v[76:79], a[152:155], v[28:31], v[76:79]
    s_waitcnt lgkmcnt(12)
    v_mfma_f32_16x16x32_bf16 v[64:67], a[232:235], v[24:27], v[64:67]
    v_mfma_f32_16x16x32_bf16 v[80:83], a[232:235], v[28:31], v[80:83]
    s_waitcnt lgkmcnt(10)
    v_mfma_f32_16x16x32_bf16 v[68:71], v[248:251], v[24:27], v[68:71]
    v_mfma_f32_16x16x32_bf16 v[84:87], v[248:251], v[28:31], v[84:87]
    s_waitcnt lgkmcnt(6)
    v_mfma_f32_16x16x32_bf16 v[56:59], a[76:79], v[32:35], v[56:59]
    v_mfma_f32_16x16x32_bf16 v[72:75], a[76:79], v[36:39], v[72:75]
    s_waitcnt lgkmcnt(4)
    v_mfma_f32_16x16x32_bf16 v[60:63], a[156:159], v[32:35], v[60:63]
    v_mfma_f32_16x16x32_bf16 v[76:79], a[156:159], v[36:39], v[76:79]
    s_waitcnt lgkmcnt(2)
    v_mfma_f32_16x16x32_bf16 v[64:67], a[236:239], v[32:35], v[64:67]
    v_mfma_f32_16x16x32_bf16 v[80:83], a[236:239], v[36:39], v[80:83]
    s_waitcnt lgkmcnt(0)
    v_mfma_f32_16x16x32_bf16 v[68:71], v[252:255], v[32:35], v[68:71]
    v_mfma_f32_16x16x32_bf16 v[84:87], v[252:255], v[36:39], v[84:87]
    s_nop 7
Lpw_99:
    s_waitcnt vmcnt(12) lgkmcnt(0)
    s_barrier
    s_cmp_eq_u32 s48, 0
    s_cselect_b32 s35, s50, 2146435072
    s_cselect_b32 s49, 0, 2146435072
    v_cvt_pk_bf16_f32 v88, v56, v57
    v_cvt_pk_bf16_f32 v89, v58, v59
    v_cvt_pk_bf16_f32 v90, v60, v61
    v_cvt_pk_bf16_f32 v91, v62, v63
    v_cvt_pk_bf16_f32 v92, v64, v65
    v_cvt_pk_bf16_f32 v93, v66, v67
    v_cvt_pk_bf16_f32 v94, v68, v69
    v_cvt_pk_bf16_f32 v95, v70, v71
    buffer_store_dwordx4 v[88:91], v10, s[8:11], s35 offen offset:0 sc1
    buffer_store_dwordx4 v[92:95], v10, s[8:11], s35 offen offset:1024 sc1
    s_nop 0
    v_cvt_pk_bf16_f32 v88, v72, v73
    v_cvt_pk_bf16_f32 v89, v74, v75
    v_cvt_pk_bf16_f32 v90, v76, v77
    v_cvt_pk_bf16_f32 v91, v78, v79
    v_cvt_pk_bf16_f32 v92, v80, v81
    v_cvt_pk_bf16_f32 v93, v82, v83
    v_cvt_pk_bf16_f32 v94, v84, v85
    v_cvt_pk_bf16_f32 v95, v86, v87
    buffer_store_dwordx4 v[88:91], v11, s[8:11], s35 offen offset:0 sc1
    buffer_store_dwordx4 v[92:95], v11, s[8:11], s35 offen offset:1024 sc1
    s_add_u32 m0, s33, 65536
    s_add_u32 s34, s46, 3145728
    buffer_load_dwordx4 v14, s[80:83], s34 offen lds
    s_add_u32 m0, s33, 73728
    s_add_u32 s34, s47, 3145728
    buffer_load_dwordx4 v14, s[84:87], s34 offen lds
    s_add_u32 m0, s33, 69632
    s_add_u32 s34, s46, 3538944
    buffer_load_dwordx4 v14, s[80:83], s34 offen lds
    s_add_u32 m0, s33, 77824
    s_add_u32 s34, s47, 3538944
    buffer_load_dwordx4 v14, s[84:87], s34 offen lds
    s_cmp_eq_u32 s48, 0
    s_cselect_b32 s30, 40960, 0
    v_add_u32 v6, s30, v4
    v_add_u32 v7, s30, v5
    ds_read_b128 v[24:27], v6 offset:0
    ds_read_b128 v[28:31], v6 offset:20480
    ds_read_b128 v[32:35], v7 offset:0
    ds_read_b128 v[36:39], v7 offset:20480
    s_cmp_lg_u32 s48, 1
    s_cbranch_scc1 Lpm_102
    ds_read_b64_tr_b16 a[0:1], v18 offset:0
    ds_read_b64_tr_b16 a[2:3], v18 offset:1024
    ds_read_b64_tr_b16 a[80:81], v19 offset:0
    ds_read_b64_tr_b16 a[82:83], v19 offset:1024
    ds_read_b64_tr_b16 a[160:161], v20 offset:0
    ds_read_b64_tr_b16 a[162:163], v20 offset:1024
    ds_read_b64_tr_b16 a[240:241], v21 offset:0
    ds_read_b64_tr_b16 a[242:243], v21 offset:1024
    ds_read_b64_tr_b16 a[4:5], v18 offset:4096
    ds_read_b64_tr_b16 a[6:7], v18 offset:5120
    ds_read_b64_tr_b16 a[84:85], v19 offset:4096
    ds_read_b64_tr_b16 a[86:87], v19 offset:5120
    ds_read_b64_tr_b16 a[164:165], v20 offset:4096
    ds_read_b64_tr_b16 a[166:167], v20 offset:5120
    ds_read_b64_tr_b16 a[244:245], v21 offset:4096
    ds_read_b64_tr_b16 a[246:247], v21 offset:5120
    s_waitcnt lgkmcnt(0)
Lpm_102:
    s_waitcnt lgkmcnt(3)
    v_mfma_f32_16x16x32_bf16 v[56:59], a[0:3], v[24:27], 0
    s_waitcnt lgkmcnt(2)
    v_mfma_f32_16x16x32_bf16 v[72:75], a[0:3], v[28:31], 0
    v_mfma_f32_16x16x32_bf16 v[60:63], a[80:83], v[24:27], 0
    v_mfma_f32_16x16x32_bf16 v[76:79], a[80:83], v[28:31], 0
    v_mfma_f32_16x16x32_bf16 v[64:67], a[160:163], v[24:27], 0
    v_mfma_f32_16x16x32_bf16 v[80:83], a[160:163], v[28:31], 0
    v_mfma_f32_16x16x32_bf16 v[68:71], a[240:243], v[24:27], 0
    v_mfma_f32_16x16x32_bf16 v[84:87], a[240:243], v[28:31], 0
    s_waitcnt lgkmcnt(1)
    v_mfma_f32_16x16x32_bf16 v[56:59], a[4:7], v[32:35], v[56:59]
    s_waitcnt lgkmcnt(0)
    v_mfma_f32_16x16x32_bf16 v[72:75], a[4:7], v[36:39], v[72:75]
    v_mfma_f32_16x16x32_bf16 v[60:63], a[84:87], v[32:35], v[60:63]
    v_mfma_f32_16x16x32_bf16 v[76:79], a[84:87], v[36:39], v[76:79]
    v_mfma_f32_16x16x32_bf16 v[64:67], a[164:167], v[32:35], v[64:67]
    v_mfma_f32_16x16x32_bf16 v[80:83], a[164:167], v[36:39], v[80:83]
    v_mfma_f32_16x16x32_bf16 v[68:71], a[244:247], v[32:35], v[68:71]
    v_mfma_f32_16x16x32_bf16 v[84:87], a[244:247], v[36:39], v[84:87]
    s_waitcnt vmcnt(16) lgkmcnt(0)
    s_barrier
    s_add_u32 m0, s33, 0
    s_add_u32 s34, s46, 3932160
    buffer_load_dwordx4 v14, s[80:83], s34 offen lds
    s_add_u32 m0, s33, 8192
    s_add_u32 s34, s47, 3932160
    buffer_load_dwordx4 v14, s[84:87], s34 offen lds
    s_add_u32 m0, s33, 4096
    s_add_u32 s34, s46, 4325376
    buffer_load_dwordx4 v14, s[80:83], s34 offen lds
    s_add_u32 m0, s33, 12288
    s_add_u32 s34, s47, 4325376
    buffer_load_dwordx4 v14, s[84:87], s34 offen lds
    ds_read_b128 v[24:27], v6 offset:1024
    ds_read_b128 v[28:31], v6 offset:21504
    ds_read_b128 v[32:35], v7 offset:1024
    ds_read_b128 v[36:39], v7 offset:21504
    s_cmp_lg_u32 s48, 1
    s_cbranch_scc1 Lpm_104
    ds_read_b64_tr_b16 a[8:9], v18 offset:16384
    ds_read_b64_tr_b16 a[10:11], v18 offset:17408
    ds_read_b64_tr_b16 a[88:89], v19 offset:16384
    ds_read_b64_tr_b16 a[90:91], v19 offset:17408
    ds_read_b64_tr_b16 a[168:169], v20 offset:16384
    ds_read_b64_tr_b16 a[170:171], v20 offset:17408
    ds_read_b64_tr_b16 a[248:249], v21 offset:16384
    ds_read_b64_tr_b16 a[250:251], v21 offset:17408
    ds_read_b64_tr_b16 a[12:13], v18 offset:20480
    ds_read_b64_tr_b16 a[14:15], v18 offset:21504
    ds_read_b64_tr_b16 a[92:93], v19 offset:20480
    ds_read_b64_tr_b16 a[94:95], v19 offset:21504
    ds_read_b64_tr_b16 a[172:173], v20 offset:20480
    ds_read_b64_tr_b16 a[174:175], v20 offset:21504
    ds_read_b64_tr_b16 a[252:253], v21 offset:20480
    ds_read_b64_tr_b16 a[254:255], v21 offset:21504
    s_waitcnt lgkmcnt(0)
Lpm_104:
    s_waitcnt lgkmcnt(3)
    v_mfma_f32_16x16x32_bf16 v[56:59], a[8:11], v[24:27], v[56:59]
    s_waitcnt lgkmcnt(2)
    v_mfma_f32_16x16x32_bf16 v[72:75], a[8:11], v[28:31], v[72:75]
    v_mfma_f32_16x16x32_bf16 v[60:63], a[88:91], v[24:27], v[60:63]
    v_mfma_f32_16x16x32_bf16 v[76:79], a[88:91], v[28:31], v[76:79]
    v_mfma_f32_16x16x32_bf16 v[64:67], a[168:171], v[24:27], v[64:67]
    v_mfma_f32_16x16x32_bf16 v[80:83], a[168:171], v[28:31], v[80:83]
    v_mfma_f32_16x16x32_bf16 v[68:71], a[248:251], v[24:27], v[68:71]
    v_mfma_f32_16x16x32_bf16 v[84:87], a[248:251], v[28:31], v[84:87]
    s_waitcnt lgkmcnt(1)
    v_mfma_f32_16x16x32_bf16 v[56:59], a[12:15], v[32:35], v[56:59]
    s_waitcnt lgkmcnt(0)
    v_mfma_f32_16x16x32_bf16 v[72:75], a[12:15], v[36:39], v[72:75]
    v_mfma_f32_16x16x32_bf16 v[60:63], a[92:95], v[32:35], v[60:63]
    v_mfma_f32_16x16x32_bf16 v[76:79], a[92:95], v[36:39], v[76:79]
    v_mfma_f32_16x16x32_bf16 v[64:67], a[172:175], v[32:35], v[64:67]
    v_mfma_f32_16x16x32_bf16 v[80:83], a[172:175], v[36:39], v[80:83]
    v_mfma_f32_16x16x32_bf16 v[68:71], a[252:255], v[32:35], v[68:71]
    v_mfma_f32_16x16x32_bf16 v[84:87], a[252:255], v[36:39], v[84:87]
    s_waitcnt vmcnt(16) lgkmcnt(0)
    s_barrier
    s_add_u32 m0, s33, 16384
    s_add_u32 s34, s46, 4718592
    buffer_load_dwordx4 v14, s[80:83], s34 offen lds
    s_add_u32 m0, s33, 24576
    s_add_u32 s34, s47, 4718592
    buffer_load_dwordx4 v14, s[84:87], s34 offen lds
    s_add_u32 m0, s33, 20480
    s_add_u32 s34, s46, 5111808
    buffer_load_dwordx4 v14, s[80:83], s34 offen lds
    s_add_u32 m0, s33, 28672
    s_add_u32 s34, s47, 5111808
    buffer_load_dwordx4 v14, s[84:87], s34 offen lds
    ds_read_b128 v[24:27], v6 offset:2048
    ds_read_b128 v[28:31], v6 offset:22528
    ds_read_b128 v[32:35], v7 offset:2048
    ds_read_b128 v[36:39], v7 offset:22528
    s_cmp_lg_u32 s48, 1
    s_cbranch_scc1 Lpm_106
    ds_read_b64_tr_b16 a[16:17], v18 offset:32768
    ds_read_b64_tr_b16 a[18:19], v18 offset:33792
    ds_read_b64_tr_b16 a[96:97], v19 offset:32768
    ds_read_b64_tr_b16 a[98:99], v19 offset:33792
    ds_read_b64_tr_b16 a[176:177], v20 offset:32768
    ds_read_b64_tr_b16 a[178:179], v20 offset:33792
    ds_read_b64_tr_b16 v[192:193], v21 offset:32768
    ds_read_b64_tr_b16 v[194:195], v21 offset:33792
    ds_read_b64_tr_b16 a[20:21], v18 offset:36864
    ds_read_b64_tr_b16 a[22:23], v18 offset:37888
    ds_read_b64_tr_b16 a[100:101], v19 offset:36864
    ds_read_b64_tr_b16 a[102:103], v19 offset:37888
    ds_read_b64_tr_b16 a[180:181], v20 offset:36864
    ds_read_b64_tr_b16 a[182:183], v20 offset:37888
    ds_read_b64_tr_b16 v[196:197], v21 offset:36864
    ds_read_b64_tr_b16 v[198:199], v21 offset:37888
    s_waitcnt lgkmcnt(0)
Lpm_106:
    s_waitcnt lgkmcnt(3)
    v_mfma_f32_16x16x32_bf16 v[56:59], a[16:19], v[24:27], v[56:59]
    s_waitcnt lgkmcnt(2)
    v_mfma_f32_16x16x32_bf16 v[72:75], a[16:19], v[28:31], v[72:75]
    v_mfma_f32_16x16x32_bf16 v[60:63], a[96:99], v[24:27], v[60:63]
    v_mfma_f32_16x16x32_bf16 v[76:79], a[96:99], v[28:31], v[76:79]
    v_mfma_f32_16x16x32_bf16 v[64:67], a[176:179], v[24:27], v[64:67]
    v_mfma_f32_16x16x32_bf16 v[80:83], a[176:179], v[28:31], v[80:83]
    v_mfma_f32_16x16x32_bf16 v[68:71], v[192:195], v[24:27], v[68:71]
    v_mfma_f32_16x16x32_bf16 v[84:87], v[192:195], v[28:31], v[84:87]
    s_waitcnt lgkmcnt(1)
    v_mfma_f32_16x16x32_bf16 v[56:59], a[20:23], v[32:35], v[56:59]
    s_waitcnt lgkmcnt(0)
    v_mfma_f32_16x16x32_bf16 v[72:75], a[20:23], v[36:39], v[72:75]
    v_mfma_f32_16x16x32_bf16 v[60:63], a[100:103], v[32:35], v[60:63]
    v_mfma_f32_16x16x32_bf16 v[76:79], a[100:103], v[36:39], v[76:79]
    v_mfma_f32_16x16x32_bf16 v[64:67], a[180:183], v[32:35], v[64:67]
    v_mfma_f32_16x16x32_bf16 v[80:83], a[180:183], v[36:39], v[80:83]
    v_mfma_f32_16x16x32_bf16 v[68:71], v[196:199], v[32:35], v[68:71]
    v_mfma_f32_16x16x32_bf16 v[84:87], v[196:199], v[36:39], v[84:87]
    s_waitcnt vmcnt(16) lgkmcnt(0)
    s_barrier
    s_add_u32 m0, s33, 32768
    s_add_u32 s34, s46, 5505024
    buffer_load_dwordx4 v14, s[80:83], s34 offen lds
    s_add_u32 m0, s33, 40960
    s_add_u32 s34, s47, 5505024
    buffer_load_dwordx4 v14, s[84:87], s34 offen lds
    s_add_u32 m0, s33, 36864
    s_add_u32 s34, s46, 5898240
    buffer_load_dwordx4 v14, s[80:83], s34 offen lds
    s_add_u32 m0, s33, 45056
    s_add_u32 s34, s47, 5898240
    buffer_load_dwordx4 v14, s[84:87], s34 offen lds
    ds_read_b128 v[24:27], v6 offset:3072
    ds_read_b128 v[28:31], v6 offset:23552
    ds_read_b128 v[32:35], v7 offset:3072
    ds_read_b128 v[36:39], v7 offset:23552
    s_cmp_lg_u32 s48, 1
    s_cbranch_scc1 Lpm_108
    v_add_u32 v40, 49152, v18
    v_add_u32 v41, 49152, v19
    v_add_u32 v42, 49152, v20
    v_add_u32 v43, 49152, v21
    ds_read_b64_tr_b16 a[24:25], v40 offset:0
    ds_read_b64_tr_b16 a[26:27], v40 offset:1024
    ds_read_b64_tr_b16 a[104:105], v41 offset:0
    ds_read_b64_tr_b16 a[106:107], v41 offset:1024
    ds_read_b64_tr_b16 a[184:185], v42 offset:0
    ds_read_b64_tr_b16 a[186:187], v42 offset:1024
    ds_read_b64_tr_b16 v[200:201], v43 offset:0
    ds_read_b64_tr_b16 v[202:203], v43 offset:1024
    ds_read_b64_tr_b16 a[28:29], v40 offset:4096
    ds_read_b64_tr_b16 a[30:31], v40 offset:5120
    ds_read_b64_tr_b16 a[108:109], v41 offset:4096
    ds_read_b64_tr_b16 a[110:111], v41 offset:5120
    ds_read_b64_tr_b16 a[188:189], v42 offset:4096
    ds_read_b64_tr_b16 a[190:191], v42 offset:5120
    ds_read_b64_tr_b16 v[204:205], v43 offset:4096
    ds_read_b64_tr_b16 v[206:207], v43 offset:5120
    s_waitcnt lgkmcnt(0)
Lpm_108:
    s_waitcnt lgkmcnt(3)
    v_mfma_f32_16x16x32_bf16 v[56:59], a[24:27], v[24:27], v[56:59]
    s_waitcnt lgkmcnt(2)
    v_mfma_f32_16x16x32_bf16 v[72:75], a[24:27], v[28:31], v[72:75]
    v_mfma_f32_16x16x32_bf16 v[60:63], a[104:107], v[24:27], v[60:63]
    v_mfma_f32_16x16x32_bf16 v[76:79], a[104:107], v[28:31], v[76:79]
    v_mfma_f32_16x16x32_bf16 v[64:67], a[184:187], v[24:27], v[64:67]
    v_mfma_f32_16x16x32_bf16 v[80:83], a[184:187], v[28:31], v[80:83]
    v_mfma_f32_16x16x32_bf16 v[68:71], v[200:203], v[24:27], v[68:71]
    v_mfma_f32_16x16x32_bf16 v[84:87], v[200:203], v[28:31], v[84:87]
    s_waitcnt lgkmcnt(1)
    v_mfma_f32_16x16x32_bf16 v[56:59], a[28:31], v[32:35], v[56:59]
    s_waitcnt lgkmcnt(0)
    v_mfma_f32_16x16x32_bf16 v[72:75], a[28:31], v[36:39], v[72:75]
    v_mfma_f32_16x16x32_bf16 v[60:63], a[108:111], v[32:35], v[60:63]
    v_mfma_f32_16x16x32_bf16 v[76:79], a[108:111], v[36:39], v[76:79]
    v_mfma_f32_16x16x32_bf16 v[64:67], a[188:191], v[32:35], v[64:67]
    v_mfma_f32_16x16x32_bf16 v[80:83], a[188:191], v[36:39], v[80:83]
    v_mfma_f32_16x16x32_bf16 v[68:71], v[204:207], v[32:35], v[68:71]
    v_mfma_f32_16x16x32_bf16 v[84:87], v[204:207], v[36:39], v[84:87]
    s_waitcnt vmcnt(12) lgkmcnt(0)
    s_barrier
    v_mov_b32 v13, 1
    s_mov_b64 exec, 1
    buffer_store_dword v13, v12, s[8:11], s49 offen sc1
    s_mov_b64 exec, -1
    s_add_u32 m0, s33, 49152
    s_add_u32 s34, s46, 6291456
    buffer_load_dwordx4 v14, s[80:83], s34 offen lds
    s_add_u32 m0, s33, 57344
    s_add_u32 s34, s47, 6291456
    buffer_load_dwordx4 v14, s[84:87], s34 offen lds
    s_add_u32 m0, s33, 53248
    s_add_u32 s34, s46, 6684672
    buffer_load_dwordx4 v14, s[80:83], s34 offen lds
    s_add_u32 m0, s33, 61440
    s_add_u32 s34, s47, 6684672
    buffer_load_dwordx4 v14, s[84:87], s34 offen lds
    ds_read_b128 v[24:27], v6 offset:4096
    ds_read_b128 v[28:31], v6 offset:24576
    ds_read_b128 v[32:35], v7 offset:4096
    ds_read_b128 v[36:39], v7 offset:24576
    s_cmp_lg_u32 s48, 1
    s_cbranch_scc1 Lpm_110
    v_add_u32 v40, 49152, v18
    v_add_u32 v41, 49152, v19
    v_add_u32 v42, 49152, v20
    v_add_u32 v43, 49152, v21
    ds_read_b64_tr_b16 a[32:33], v40 offset:16384
    ds_read_b64_tr_b16 a[34:35], v40 offset:17408
    ds_read_b64_tr_b16 a[112:113], v41 offset:16384
    ds_read_b64_tr_b16 a[114:115], v41 offset:17408
    ds_read_b64_tr_b16 a[192:193], v42 offset:16384
    ds_read_b64_tr_b16 a[194:195], v42 offset:17408
    ds_read_b64_tr_b16 v[208:209], v43 offset:16384
    ds_read_b64_tr_b16 v[210:211], v43 offset:17408
    ds_read_b64_tr_b16 a[36:37], v40 offset:20480
    ds_read_b64_tr_b16 a[38:39], v40 offset:21504
    ds_read_b64_tr_b16 a[116:117], v41 offset:20480
    ds_read_b64_tr_b16 a[118:119], v41 offset:21504
    ds_read_b64_tr_b16 a[196:197], v42 offset:20480
    ds_read_b64_tr_b16 a[198:199], v42 offset:21504
    ds_read_b64_tr_b16 v[212:213], v43 offset:20480
    ds_read_b64_tr_b16 v[214:215], v43 offset:21504
    s_waitcnt lgkmcnt(0)
Lpm_110:
    s_waitcnt lgkmcnt(3)
    v_mfma_f32_16x16x32_bf16 v[56:59], a[32:35], v[24:27], v[56:59]
    s_waitcnt lgkmcnt(2)
    v_mfma_f32_16x16x32_bf16 v[72:75], a[32:35], v[28:31], v[72:75]
    v_mfma_f32_16x16x32_bf16 v[60:63], a[112:115], v[24:27], v[60:63]
    v_mfma_f32_16x16x32_bf16 v[76:79], a[112:115], v[28:31], v[76:79]
    v_mfma_f32_16x16x32_bf16 v[64:67], a[192:195], v[24:27], v[64:67]
    v_mfma_f32_16x16x32_bf16 v[80:83], a[192:195], v[28:31], v[80:83]
    v_mfma_f32_16x16x32_bf16 v[68:71], v[208:211], v[24:27], v[68:71]
    v_mfma_f32_16x16x32_bf16 v[84:87], v[208:211], v[28:31], v[84:87]
    s_waitcnt lgkmcnt(1)
    v_mfma_f32_16x16x32_bf16 v[56:59], a[36:39], v[32:35], v[56:59]
    s_waitcnt lgkmcnt(0)
    v_mfma_f32_16x16x32_bf16 v[72:75], a[36:39], v[36:39], v[72:75]
    v_mfma_f32_16x16x32_bf16 v[60:63], a[116:119], v[32:35], v[60:63]
    v_mfma_f32_16x16x32_bf16 v[76:79], a[116:119], v[36:39], v[76:79]
    v_mfma_f32_16x16x32_bf16 v[64:67], a[196:199], v[32:35], v[64:67]
    v_mfma_f32_16x16x32_bf16 v[80:83], a[196:199], v[36:39], v[80:83]
    v_mfma_f32_16x16x32_bf16 v[68:71], v[212:215], v[32:35], v[68:71]
    v_mfma_f32_16x16x32_bf16 v[84:87], v[212:215], v[36:39], v[84:87]
    s_waitcnt vmcnt(13) lgkmcnt(0)
    s_barrier
    s_add_u32 m0, s33, 65536
    s_add_u32 s34, s46, 7077888
    buffer_load_dwordx4 v14, s[80:83], s34 offen lds
    s_add_u32 m0, s33, 73728
    s_add_u32 s34, s47, 7077888
    buffer_load_dwordx4 v14, s[84:87], s34 offen lds
    s_add_u32 m0, s33, 69632
    s_add_u32 s34, s46, 7471104
    buffer_load_dwordx4 v14, s[80:83], s34 offen lds
    s_add_u32 m0, s33, 77824
    s_add_u32 s34, s47, 7471104
    buffer_load_dwordx4 v14, s[84:87], s34 offen lds
    ds_read_b128 v[24:27], v6 offset:5120
    ds_read_b128 v[28:31], v6 offset:25600
    ds_read_b128 v[32:35], v7 offset:5120
    ds_read_b128 v[36:39], v7 offset:25600
    s_cmp_lg_u32 s48, 1
    s_cbranch_scc1 Lpm_112
    ds_read_b64_tr_b16 a[40:41], v18 offset:0
    ds_read_b64_tr_b16 a[42:43], v18 offset:1024
    ds_read_b64_tr_b16 a[120:121], v19 offset:0
    ds_read_b64_tr_b16 a[122:123], v19 offset:1024
    ds_read_b64_tr_b16 a[200:201], v20 offset:0
    ds_read_b64_tr_b16 a[202:203], v20 offset:1024
    ds_read_b64_tr_b16 v[216:217], v21 offset:0
    ds_read_b64_tr_b16 v[218:219], v21 offset:1024
    ds_read_b64_tr_b16 a[44:45], v18 offset:4096
    ds_read_b64_tr_b16 a[46:47], v18 offset:5120
    ds_read_b64_tr_b16 a[124:125], v19 offset:4096
    ds_read_b64_tr_b16 a[126:127], v19 offset:5120
    ds_read_b64_tr_b16 a[204:205], v20 offset:4096
    ds_read_b64_tr_b16 a[206:207], v20 offset:5120
    ds_read_b64_tr_b16 v[220:221], v21 offset:4096
    ds_read_b64_tr_b16 v[222:223], v21 offset:5120
    s_waitcnt lgkmcnt(0)
Lpm_112:
    s_waitcnt lgkmcnt(3)
    v_mfma_f32_16x16x32_bf16 v[56:59], a[40:43], v[24:27], v[56:59]
    s_waitcnt lgkmcnt(2)
    v_mfma_f32_16x16x32_bf16 v[72:75], a[40:43], v[28:31], v[72:75]
    v_mfma_f32_16x16x32_bf16 v[60:63], a[120:123], v[24:27], v[60:63]
    v_mfma_f32_16x16x32_bf16 v[76:79], a[120:123], v[28:31], v[76:79]
    v_mfma_f32_16x16x32_bf16 v[64:67], a[200:203], v[24:27], v[64:67]
    v_mfma_f32_16x16x32_bf16 v[80:83], a[200:203], v[28:31], v[80:83]
    v_mfma_f32_16x16x32_bf16 v[68:71], v[216:219], v[24:27], v[68:71]
    v_mfma_f32_16x16x32_bf16 v[84:87], v[216:219], v[28:31], v[84:87]
    s_waitcnt lgkmcnt(1)
    v_mfma_f32_16x16x32_bf16 v[56:59], a[44:47], v[32:35], v[56:59]
    s_waitcnt lgkmcnt(0)
    v_mfma_f32_16x16x32_bf16 v[72:75], a[44:47], v[36:39], v[72:75]
    v_mfma_f32_16x16x32_bf16 v[60:63], a[124:127], v[32:35], v[60:63]
    v_mfma_f32_16x16x32_bf16 v[76:79], a[124:127], v[36:39], v[76:79]
    v_mfma_f32_16x16x32_bf16 v[64:67], a[204:207], v[32:35], v[64:67]
    v_mfma_f32_16x16x32_bf16 v[80:83], a[204:207], v[36:39], v[80:83]
    v_mfma_f32_16x16x32_bf16 v[68:71], v[220:223], v[32:35], v[68:71]
    v_mfma_f32_16x16x32_bf16 v[84:87], v[220:223], v[36:39], v[84:87]
    s_waitcnt vmcnt(13) lgkmcnt(0)
    s_barrier
    ds_read_b128 v[24:27], v6 offset:6144
    ds_read_b128 v[28:31], v6 offset:26624
    ds_read_b128 v[32:35], v7 offset:6144
    ds_read_b128 v[36:39], v7 offset:26624
    s_cmp_lg_u32 s48, 1
    s_cbranch_scc1 Lpm_114
    ds_read_b64_tr_b16 a[48:49], v18 offset:16384
    ds_read_b64_tr_b16 a[50:51], v18 offset:17408
    ds_read_b64_tr_b16 a[128:129], v19 offset:16384
    ds_read_b64_tr_b16 a[130:131], v19 offset:17408
    ds_read_b64_tr_b16 a[208:209], v20 offset:16384
    ds_read_b64_tr_b16 a[210:211], v20 offset:17408
    ds_read_b64_tr_b16 v[224:225], v21 offset:16384
    ds_read_b64_tr_b16 v[226:227], v21 offset:17408
    ds_read_b64_tr_b16 a[52:53], v18 offset:20480
    ds_read_b64_tr_b16 a[54:55], v18 offset:21504
    ds_read_b64_tr_b16 a[132:133], v19 offset:20480
    ds_read_b64_tr_b16 a[134:135], v19 offset:21504
    ds_read_b64_tr_b16 a[212:213], v20 offset:20480
    ds_read_b64_tr_b16 a[214:215], v20 offset:21504
    ds_read_b64_tr_b16 v[228:229], v21 offset:20480
    ds_read_b64_tr_b16 v[230:231], v21 offset:21504
    s_waitcnt lgkmcnt(0)
Lpm_114:
    s_waitcnt lgkmcnt(3)
    v_mfma_f32_16x16x32_bf16 v[56:59], a[48:51], v[24:27], v[56:59]
    s_waitcnt lgkmcnt(2)
    v_mfma_f32_16x16x32_bf16 v[72:75], a[48:51], v[28:31], v[72:75]
    v_mfma_f32_16x16x32_bf16 v[60:63], a[128:131], v[24:27], v[60:63]
    v_mfma_f32_16x16x32_bf16 v[76:79], a[128:131], v[28:31], v[76:79]
    v_mfma_f32_16x16x32_bf16 v[64:67], a[208:211], v[24:27], v[64:67]
    v_mfma_f32_16x16x32_bf16 v[80:83], a[208:211], v[28:31], v[80:83]
    v_mfma_f32_16x16x32_bf16 v[68:71], v[224:227], v[24:27], v[68:71]
    v_mfma_f32_16x16x32_bf16 v[84:87], v[224:227], v[28:31], v[84:87]
    s_waitcnt lgkmcnt(1)
    v_mfma_f32_16x16x32_bf16 v[56:59], a[52:55], v[32:35], v[56:59]
    s_waitcnt lgkmcnt(0)
    v_mfma_f32_16x16x32_bf16 v[72:75], a[52:55], v[36:39], v[72:75]
    v_mfma_f32_16x16x32_bf16 v[60:63], a[132:135], v[32:35], v[60:63]
    v_mfma_f32_16x16x32_bf16 v[76:79], a[132:135], v[36:39], v[76:79]
    v_mfma_f32_16x16x32_bf16 v[64:67], a[212:215], v[32:35], v[64:67]
    v_mfma_f32_16x16x32_bf16 v[80:83], a[212:215], v[36:39], v[80:83]
    v_mfma_f32_16x16x32_bf16 v[68:71], v[228:231], v[32:35], v[68:71]
    v_mfma_f32_16x16x32_bf16 v[84:87], v[228:231], v[36:39], v[84:87]
    s_waitcnt vmcnt(9) lgkmcnt(0)
    s_barrier
    ds_read_b128 v[24:27], v6 offset:7168
    ds_read_b128 v[28:31], v6 offset:27648
    ds_read_b128 v[32:35], v7 offset:7168
    ds_read_b128 v[36:39], v7 offset:27648
    s_cmp_lg_u32 s48, 1
    s_cbranch_scc1 Lpm_116
    ds_read_b64_tr_b16 a[56:57], v18 offset:32768
    ds_read_b64_tr_b16 a[58:59], v18 offset:33792
    ds_read_b64_tr_b16 a[136:137], v19 offset:32768
    ds_read_b64_tr_b16 a[138:139], v19 offset:33792
    ds_read_b64_tr_b16 a[216:217], v20 offset:32768
    ds_read_b64_tr_b16 a[218:219], v20 offset:33792
    ds_read_b64_tr_b16 v[232:233], v21 offset:32768
    ds_read_b64_tr_b16 v[234:235], v21 offset:33792
    ds_read_b64_tr_b16 a[60:61], v18 offset:36864
    ds_read_b64_tr_b16 a[62:63], v18 offset:37888
    ds_read_b64_tr_b16 a[140:141], v19 offset:36864
    ds_read_b64_tr_b16 a[142:143], v19 offset:37888
    ds_read_b64_tr_b16 a[220:221], v20 offset:36864
    ds_read_b64_tr_b16 a[222:223], v20 offset:37888
    ds_read_b64_tr_b16 v[236:237], v21 offset:36864
    ds_read_b64_tr_b16 v[238:239], v21 offset:37888
    s_waitcnt lgkmcnt(0)
Lpm_116:
    s_waitcnt lgkmcnt(3)
    v_mfma_f32_16x16x32_bf16 v[56:59], a[56:59], v[24:27], v[56:59]
    s_waitcnt lgkmcnt(2)
    v_mfma_f32_16x16x32_bf16 v[72:75], a[56:59], v[28:31], v[72:75]
    v_mfma_f32_16x16x32_bf16 v[60:63], a[136:139], v[24:27], v[60:63]
    v_mfma_f32_16x16x32_bf16 v[76:79], a[136:139], v[28:31], v[76:79]
    v_mfma_f32_16x16x32_bf16 v[64:67], a[216:219], v[24:27], v[64:67]
    v_mfma_f32_16x16x32_bf16 v[80:83], a[216:219], v[28:31], v[80:83]
    v_mfma_f32_16x16x32_bf16 v[68:71], v[232:235], v[24:27], v[68:71]
    v_mfma_f32_16x16x32_bf16 v[84:87], v[232:235], v[28:31], v[84:87]
    s_waitcnt lgkmcnt(1)
    v_mfma_f32_16x16x32_bf16 v[56:59], a[60:63], v[32:35], v[56:59]
    s_waitcnt lgkmcnt(0)
    v_mfma_f32_16x16x32_bf16 v[72:75], a[60:63], v[36:39], v[72:75]
    v_mfma_f32_16x16x32_bf16 v[60:63], a[140:143], v[32:35], v[60:63]
    v_mfma_f32_16x16x32_bf16 v[76:79], a[140:143], v[36:39], v[76:79]
    v_mfma_f32_16x16x32_bf16 v[64:67], a[220:223], v[32:35], v[64:67]
    v_mfma_f32_16x16x32_bf16 v[80:83], a[220:223], v[36:39], v[80:83]
    v_mfma_f32_16x16x32_bf16 v[68:71], v[236:239], v[32:35], v[68:71]
    v_mfma_f32_16x16x32_bf16 v[84:87], v[236:239], v[36:39], v[84:87]
    s_waitcnt vmcnt(4) lgkmcnt(0)
    s_barrier
    s_mov_b32 s53, 81920
    s_add_u32 s54, s40, 81920
    s_add_u32 m0, s54, 0
    s_add_u32 s34, s53, 0
    buffer_load_dwordx4 v2, s[12:15], s34 offen lds
    s_add_u32 m0, s54, 1024
    s_add_u32 s34, s53, 128
    buffer_load_dwordx4 v2, s[12:15], s34 offen lds
    s_add_u32 m0, s54, 2048
    s_add_u32 s34, s53, 256
    buffer_load_dwordx4 v2, s[12:15], s34 offen lds
    s_add_u32 m0, s54, 3072
    s_add_u32 s34, s53, 384
    buffer_load_dwordx4 v2, s[12:15], s34 offen lds
    s_add_u32 m0, s54, 4096
    s_add_u32 s34, s53, 512
    buffer_load_dwordx4 v2, s[12:15], s34 offen lds
    s_add_u32 m0, s54, 5120
    s_add_u32 s34, s53, 640
    buffer_load_dwordx4 v2, s[12:15], s34 offen lds
    s_add_u32 m0, s54, 6144
    s_add_u32 s34, s53, 768
    buffer_load_dwordx4 v2, s[12:15], s34 offen lds
    s_add_u32 m0, s54, 7168
    s_add_u32 s34, s53, 896
    buffer_load_dwordx4 v2, s[12:15], s34 offen lds
    s_add_u32 m0, s54, 8192
    s_add_u32 s34, s53, 1024
    buffer_load_dwordx4 v2, s[12:15], s34 offen lds
    s_add_u32 m0, s54, 9216
    s_add_u32 s34, s53, 1152
    buffer_load_dwordx4 v2, s[12:15], s34 offen lds
    ds_read_b128 v[24:27], v6 offset:8192
    ds_read_b128 v[28:31], v6 offset:28672
    ds_read_b128 v[32:35], v7 offset:8192
    ds_read_b128 v[36:39], v7 offset:28672
    s_cmp_lg_u32 s48, 1
    s_cbranch_scc1 Lpm_118
    v_add_u32 v40, 49152, v18
    v_add_u32 v41, 49152, v19
    v_add_u32 v42, 49152, v20
    v_add_u32 v43, 49152, v21
    ds_read_b64_tr_b16 a[64:65], v40 offset:0
    ds_read_b64_tr_b16 a[66:67], v40 offset:1024
    ds_read_b64_tr_b16 a[144:145], v41 offset:0
    ds_read_b64_tr_b16 a[146:147], v41 offset:1024
    ds_read_b64_tr_b16 a[224:225], v42 offset:0
    ds_read_b64_tr_b16 a[226:227], v42 offset:1024
    ds_read_b64_tr_b16 v[240:241], v43 offset:0
    ds_read_b64_tr_b16 v[242:243], v43 offset:1024
    ds_read_b64_tr_b16 a[68:69], v40 offset:4096
    ds_read_b64_tr_b16 a[70:71], v40 offset:5120
    ds_read_b64_tr_b16 a[148:149], v41 offset:4096
    ds_read_b64_tr_b16 a[150:151], v41 offset:5120
    ds_read_b64_tr_b16 a[228:229], v42 offset:4096
    ds_read_b64_tr_b16 a[230:231], v42 offset:5120
    ds_read_b64_tr_b16 v[244:245], v43 offset:4096
    ds_read_b64_tr_b16 v[246:247], v43 offset:5120
    s_waitcnt lgkmcnt(0)
Lpm_118:
    s_waitcnt lgkmcnt(3)
    v_mfma_f32_16x16x32_bf16 v[56:59], a[64:67], v[24:27], v[56:59]
    s_waitcnt lgkmcnt(2)
    v_mfma_f32_16x16x32_bf16 v[72:75], a[64:67], v[28:31], v[72:75]
    v_mfma_f32_16x16x32_bf16 v[60:63], a[144:147], v[24:27], v[60:63]
    v_mfma_f32_16x16x32_bf16 v[76:79], a[144:147], v[28:31], v[76:79]
    v_mfma_f32_16x16x32_bf16 v[64:67], a[224:227], v[24:27], v[64:67]
    v_mfma_f32_16x16x32_bf16 v[80:83], a[224:227], v[28:31], v[80:83]
    v_mfma_f32_16x16x32_bf16 v[68:71], v[240:243], v[24:27], v[68:71]
    v_mfma_f32_16x16x32_bf16 v[84:87], v[240:243], v[28:31], v[84:87]
    s_waitcnt lgkmcnt(1)
    v_mfma_f32_16x16x32_bf16 v[56:59], a[68:71], v[32:35], v[56:59]
    s_waitcnt lgkmcnt(0)
    v_mfma_f32_16x16x32_bf16 v[72:75], a[68:71], v[36:39], v[72:75]
    v_mfma_f32_16x16x32_bf16 v[60:63], a[148:151], v[32:35], v[60:63]
    v_mfma_f32_16x16x32_bf16 v[76:79], a[148:151], v[36:39], v[76:79]
    v_mfma_f32_16x16x32_bf16 v[64:67], a[228:231], v[32:35], v[64:67]
    v_mfma_f32_16x16x32_bf16 v[80:83], a[228:231], v[36:39], v[80:83]
    v_mfma_f32_16x16x32_bf16 v[68:71], v[244:247], v[32:35], v[68:71]
    v_mfma_f32_16x16x32_bf16 v[84:87], v[244:247], v[36:39], v[84:87]
    s_waitcnt vmcnt(10) lgkmcnt(0)
    s_barrier
    ds_read_b128 v[24:27], v6 offset:9216
    ds_read_b128 v[28:31], v6 offset:29696
    ds_read_b128 v[32:35], v7 offset:9216
    ds_read_b128 v[36:39], v7 offset:29696
    s_cmp_lg_u32 s48, 1
    s_cbranch_scc1 Lpm_120
    v_add_u32 v40, 49152, v18
    v_add_u32 v41, 49152, v19
    v_add_u32 v42, 49152, v20
    v_add_u32 v43, 49152, v21
    ds_read_b64_tr_b16 a[72:73], v40 offset:16384
    ds_read_b64_tr_b16 a[74:75], v40 offset:17408
    ds_read_b64_tr_b16 a[152:153], v41 offset:16384
    ds_read_b64_tr_b16 a[154:155], v41 offset:17408
    ds_read_b64_tr_b16 a[232:233], v42 offset:16384
    ds_read_b64_tr_b16 a[234:235], v42 offset:17408
    ds_read_b64_tr_b16 v[248:249], v43 offset:16384
    ds_read_b64_tr_b16 v[250:251], v43 offset:17408
    ds_read_b64_tr_b16 a[76:77], v40 offset:20480
    ds_read_b64_tr_b16 a[78:79], v40 offset:21504
    ds_read_b64_tr_b16 a[156:157], v41 offset:20480
    ds_read_b64_tr_b16 a[158:159], v41 offset:21504
    ds_read_b64_tr_b16 a[236:237], v42 offset:20480
    ds_read_b64_tr_b16 a[238:239], v42 offset:21504
    ds_read_b64_tr_b16 v[252:253], v43 offset:20480
    ds_read_b64_tr_b16 v[254:255], v43 offset:21504
    s_waitcnt lgkmcnt(0)
Lpm_120:
    s_waitcnt lgkmcnt(3)
    v_mfma_f32_16x16x32_bf16 v[56:59], a[72:75], v[24:27], v[56:59]
    s_waitcnt lgkmcnt(2)
    v_mfma_f32_16x16x32_bf16 v[72:75], a[72:75], v[28:31], v[72:75]
    v_mfma_f32_16x16x32_bf16 v[60:63], a[152:155], v[24:27], v[60:63]
    v_mfma_f32_16x16x32_bf16 v[76:79], a[152:155], v[28:31], v[76:79]
    v_mfma_f32_16x16x32_bf16 v[64:67], a[232:235], v[24:27], v[64:67]
    v_mfma_f32_16x16x32_bf16 v[80:83], a[232:235], v[28:31], v[80:83]
    v_mfma_f32_16x16x32_bf16 v[68:71], v[248:251], v[24:27], v[68:71]
    v_mfma_f32_16x16x32_bf16 v[84:87], v[248:251], v[28:31], v[84:87]
    s_waitcnt lgkmcnt(1)
    v_mfma_f32_16x16x32_bf16 v[56:59], a[76:79], v[32:35], v[56:59]
    s_waitcnt lgkmcnt(0)
    v_mfma_f32_16x16x32_bf16 v[72:75], a[76:79], v[36:39], v[72:75]
    v_mfma_f32_16x16x32_bf16 v[60:63], a[156:159], v[32:35], v[60:63]
    v_mfma_f32_16x16x32_bf16 v[76:79], a[156:159], v[36:39], v[76:79]
    v_mfma_f32_16x16x32_bf16 v[64:67], a[236:239], v[32:35], v[64:67]
    v_mfma_f32_16x16x32_bf16 v[80:83], a[236:239], v[36:39], v[80:83]
    v_mfma_f32_16x16x32_bf16 v[68:71], v[252:255], v[32:35], v[68:71]
    v_mfma_f32_16x16x32_bf16 v[84:87], v[252:255], v[36:39], v[84:87]
    s_waitcnt lgkmcnt(0)
    s_barrier
    s_add_u32 s35, s50, 393216
    s_cmp_eq_u32 s48, 1
    s_cselect_b32 s35, s50, s35
    s_cselect_b32 s57, 1, 2
    s_cselect_b32 s30, 1, 2
    s_mul_i32 s30, s30, 40960
    v_add_u32 v6, s30, v4
    v_add_u32 v7, s30, v5
    s_add_u32 s30, s30, 40960
    v_add_u32 v8, s30, v4
    v_add_u32 v9, s30, v5
    s_add_u32 s58, s30, 40960
    s_cmp_eq_u32 s58, 163840
    s_cselect_b32 s58, 0, s58
    s_mov_b32 s51, 2146435072
    s_mov_b32 s52, 1
    v_cvt_pk_bf16_f32 v88, v56, v57
    v_cvt_pk_bf16_f32 v89, v58, v59
    v_cvt_pk_bf16_f32 v90, v60, v61
    v_cvt_pk_bf16_f32 v91, v62, v63
    v_cvt_pk_bf16_f32 v92, v64, v65
    v_cvt_pk_bf16_f32 v93, v66, v67
    v_cvt_pk_bf16_f32 v94, v68, v69
    v_cvt_pk_bf16_f32 v95, v70, v71
    buffer_store_dwordx4 v[88:91], v10, s[8:11], s35 offen offset:0 sc1
    buffer_store_dwordx4 v[92:95], v10, s[8:11], s35 offen offset:1024 sc1
    s_nop 0
    v_cvt_pk_bf16_f32 v88, v72, v73
    v_cvt_pk_bf16_f32 v89, v74, v75
    v_cvt_pk_bf16_f32 v90, v76, v77
    v_cvt_pk_bf16_f32 v91, v78, v79
    v_cvt_pk_bf16_f32 v92, v80, v81
    v_cvt_pk_bf16_f32 v93, v82, v83
    v_cvt_pk_bf16_f32 v94, v84, v85
    v_cvt_pk_bf16_f32 v95, v86, v87
    buffer_store_dwordx4 v[88:91], v11, s[8:11], s35 offen offset:0 sc1
    buffer_store_dwordx4 v[92:95], v11, s[8:11], s35 offen offset:1024 sc1
    s_add_u32 s50, s35, 393216
    s_mov_b32 s53, 122880
    s_add_u32 s54, s40, 122880
    s_add_u32 m0, s54, 0
    s_add_u32 s34, s53, 0
    buffer_load_dwordx4 v2, s[12:15], s34 offen lds
    s_add_u32 m0, s54, 1024
    s_add_u32 s34, s53, 128
    buffer_load_dwordx4 v2, s[12:15], s34 offen lds
    s_add_u32 m0, s54, 2048
    s_add_u32 s34, s53, 256
    buffer_load_dwordx4 v2, s[12:15], s34 offen lds
    s_add_u32 m0, s54, 3072
    s_add_u32 s34, s53, 384
    buffer_load_dwordx4 v2, s[12:15], s34 offen lds
    s_add_u32 m0, s54, 4096
    s_add_u32 s34, s53, 512
    buffer_load_dwordx4 v2, s[12:15], s34 offen lds
    s_add_u32 m0, s54, 5120
    s_add_u32 s34, s53, 640
    buffer_load_dwordx4 v2, s[12:15], s34 offen lds
    s_add_u32 m0, s54, 6144
    s_add_u32 s34, s53, 768
    buffer_load_dwordx4 v2, s[12:15], s34 offen lds
    s_add_u32 m0, s54, 7168
    s_add_u32 s34, s53, 896
    buffer_load_dwordx4 v2, s[12:15], s34 offen lds
    s_add_u32 m0, s54, 8192
    s_add_u32 s34, s53, 1024
    buffer_load_dwordx4 v2, s[12:15], s34 offen lds
    s_add_u32 m0, s54, 9216
    s_add_u32 s34, s53, 1152
    buffer_load_dwordx4 v2, s[12:15], s34 offen lds
    s_waitcnt vmcnt(14)
    s_barrier
    s_mov_b32 s53, 163840
    s_mov_b32 s54, s40
    s_mov_b32 s55, 0
    ds_read_b128 v[24:27], v6 offset:0
    ds_read_b128 v[28:31], v7 offset:0
    ds_read_b128 v[32:35], v6 offset:1024
    ds_read_b128 v[36:39], v7 offset:1024
    ds_read_b128 v[40:43], v6 offset:2048
    s_waitcnt lgkmcnt(4)
L_pj_loop:
    v_mfma_f32_16x16x32_bf16 v[56:59], a[0:3], v[24:27], 0
    ds_read_b128 v[44:47], v7 offset:2048
    v_mfma_f32_16x16x32_bf16 v[60:63], a[80:83], v[24:27], 0
    s_waitcnt lgkmcnt(4)
    v_mfma_f32_16x16x32_bf16 v[64:67], a[160:163], v[24:27], 0
    s_barrier
    v_mfma_f32_16x16x32_bf16 v[68:71], a[240:243], v[24:27], 0
    v_mfma_f32_16x16x32_bf16 v[56:59], a[4:7], v[28:31], v[56:59]
    ds_read_b128 v[48:51], v6 offset:3072
    v_mfma_f32_16x16x32_bf16 v[60:63], a[84:87], v[28:31], v[60:63]
    s_waitcnt lgkmcnt(4)
    v_mfma_f32_16x16x32_bf16 v[64:67], a[164:167], v[28:31], v[64:67]
    s_add_u32 m0, s54, 0
    s_add_u32 s34, s53, 0
    buffer_load_dwordx4 v2, s[12:15], s34 offen lds
    v_mfma_f32_16x16x32_bf16 v[68:71], a[244:247], v[28:31], v[68:71]
    v_mfma_f32_16x16x32_bf16 v[56:59], a[8:11], v[32:35], v[56:59]
    ds_read_b128 v[52:55], v7 offset:3072
    v_mfma_f32_16x16x32_bf16 v[60:63], a[88:91], v[32:35], v[60:63]
    s_waitcnt lgkmcnt(4)
    v_mfma_f32_16x16x32_bf16 v[64:67], a[168:171], v[32:35], v[64:67]
    s_cmp_gt_u32 s52, 1
    s_cbranch_scc1 Lpje_121
    s_waitcnt vmcnt(11)
    v_mov_b32 v13, s57
    s_mov_b64 exec, 1
    buffer_store_dword v13, v12, s[8:11], 0 offen sc1
    s_mov_b64 exec, -1
Lpje_121:
    v_cvt_pk_bf16_f32 v88, v72, v73
    v_cvt_pk_bf16_f32 v89, v74, v75
    v_mfma_f32_16x16x32_bf16 v[68:71], a[248:251], v[32:35], v[68:71]
    v_cvt_pk_bf16_f32 v90, v76, v77
    v_cvt_pk_bf16_f32 v91, v78, v79
    v_mfma_f32_16x16x32_bf16 v[56:59], a[12:15], v[36:39], v[56:59]
    ds_read_b128 v[24:27], v6 offset:4096
    v_mfma_f32_16x16x32_bf16 v[60:63], a[92:95], v[36:39], v[60:63]
    s_waitcnt lgkmcnt(4)
    v_mfma_f32_16x16x32_bf16 v[64:67], a[172:175], v[36:39], v[64:67]
    v_cvt_pk_bf16_f32 v92, v80, v81
    v_cvt_pk_bf16_f32 v93, v82, v83
    v_mfma_f32_16x16x32_bf16 v[68:71], a[252:255], v[36:39], v[68:71]
    buffer_store_dwordx4 v[88:91], v11, s[8:11], s51 offen offset:0 sc1
    v_cvt_pk_bf16_f32 v94, v84, v85
    v_cvt_pk_bf16_f32 v95, v86, v87
    v_mfma_f32_16x16x32_bf16 v[56:59], a[16:19], v[40:43], v[56:59]
    ds_read_b128 v[28:31], v7 offset:4096
    v_mfma_f32_16x16x32_bf16 v[60:63], a[96:99], v[40:43], v[60:63]
    s_waitcnt lgkmcnt(4)
    v_mfma_f32_16x16x32_bf16 v[64:67], a[176:179], v[40:43], v[64:67]
    s_add_u32 m0, s54, 1024
    s_add_u32 s34, s53, 128
    buffer_load_dwordx4 v2, s[12:15], s34 offen lds
    v_mfma_f32_16x16x32_bf16 v[68:71], v[192:195], v[40:43], v[68:71]
    buffer_store_dwordx4 v[92:95], v11, s[8:11], s51 offen offset:1024 sc1
    v_mfma_f32_16x16x32_bf16 v[56:59], a[20:23], v[44:47], v[56:59]
    ds_read_b128 v[32:35], v6 offset:5120
    v_mfma_f32_16x16x32_bf16 v[60:63], a[100:103], v[44:47], v[60:63]
    s_waitcnt lgkmcnt(4)
    v_mfma_f32_16x16x32_bf16 v[64:67], a[180:183], v[44:47], v[64:67]
    v_mfma_f32_16x16x32_bf16 v[68:71], v[196:199], v[44:47], v[68:71]
    v_mfma_f32_16x16x32_bf16 v[56:59], a[24:27], v[48:51], v[56:59]
    ds_read_b128 v[36:39], v7 offset:5120
    v_mfma_f32_16x16x32_bf16 v[60:63], a[104:107], v[48:51], v[60:63]
    s_waitcnt lgkmcnt(4)
    v_mfma_f32_16x16x32_bf16 v[64:67], a[184:187], v[48:51], v[64:67]
    v_mfma_f32_16x16x32_bf16 v[68:71], v[200:203], v[48:51], v[68:71]
    v_mfma_f32_16x16x32_bf16 v[56:59], a[28:31], v[52:55], v[56:59]
    ds_read_b128 v[40:43], v6 offset:6144
    v_mfma_f32_16x16x32_bf16 v[60:63], a[108:111], v[52:55], v[60:63]
    s_waitcnt lgkmcnt(4)
    v_mfma_f32_16x16x32_bf16 v[64:67], a[188:191], v[52:55], v[64:67]
    s_add_u32 m0, s54, 2048
    s_add_u32 s34, s53, 256
    buffer_load_dwordx4 v2, s[12:15], s34 offen lds
    v_mfma_f32_16x16x32_bf16 v[68:71], v[204:207], v[52:55], v[68:71]
    v_mfma_f32_16x16x32_bf16 v[56:59], a[32:35], v[24:27], v[56:59]
    ds_read_b128 v[44:47], v7 offset:6144
    v_mfma_f32_16x16x32_bf16 v[60:63], a[112:115], v[24:27], v[60:63]
    s_waitcnt lgkmcnt(4)
    v_mfma_f32_16x16x32_bf16 v[64:67], a[192:195], v[24:27], v[64:67]
    v_mfma_f32_16x16x32_bf16 v[68:71], v[208:211], v[24:27], v[68:71]
    v_mfma_f32_16x16x32_bf16 v[56:59], a[36:39], v[28:31], v[56:59]
    ds_read_b128 v[48:51], v6 offset:7168
    v_mfma_f32_16x16x32_bf16 v[60:63], a[116:119], v[28:31], v[60:63]
    s_waitcnt lgkmcnt(4)
    v_mfma_f32_16x16x32_bf16 v[64:67], a[196:199], v[28:31], v[64:67]
    v_mfma_f32_16x16x32_bf16 v[68:71], v[212:215], v[28:31], v[68:71]
    v_mfma_f32_16x16x32_bf16 v[56:59], a[40:43], v[32:35], v[56:59]
    ds_read_b128 v[52:55], v7 offset:7168
    v_mfma_f32_16x16x32_bf16 v[60:63], a[120:123], v[32:35], v[60:63]
    s_waitcnt lgkmcnt(4)
    v_mfma_f32_16x16x32_bf16 v[64:67], a[200:203], v[32:35], v[64:67]
    s_add_u32 m0, s54, 3072
    s_add_u32 s34, s53, 384
    buffer_load_dwordx4 v2, s[12:15], s34 offen lds
    v_mfma_f32_16x16x32_bf16 v[68:71], v[216:219], v[32:35], v[68:71]
    v_mfma_f32_16x16x32_bf16 v[56:59], a[44:47], v[36:39], v[56:59]
    ds_read_b128 v[24:27], v6 offset:8192
    v_mfma_f32_16x16x32_bf16 v[60:63], a[124:127], v[36:39], v[60:63]
    s_waitcnt lgkmcnt(4)
    v_mfma_f32_16x16x32_bf16 v[64:67], a[204:207], v[36:39], v[64:67]
    v_mfma_f32_16x16x32_bf16 v[68:71], v[220:223], v[36:39], v[68:71]
    v_mfma_f32_16x16x32_bf16 v[56:59], a[48:51], v[40:43], v[56:59]
    ds_read_b128 v[28:31], v7 offset:8192
    v_mfma_f32_16x16x32_bf16 v[60:63], a[128:131], v[40:43], v[60:63]
    s_waitcnt lgkmcnt(4)
    v_mfma_f32_16x16x32_bf16 v[64:67], a[208:211], v[40:43], v[64:67]
    s_cmp_gt_u32 s52, 3
    s_cbranch_scc1 Lpje_122
    s_waitcnt vmcnt(2)
    v_mov_b32 v13, s57
    s_mov_b64 exec, 1
    buffer_store_dword v13, v12, s[8:11], 0 offen sc1
    s_mov_b64 exec, -1
Lpje_122:
    v_mfma_f32_16x16x32_bf16 v[68:71], v[224:227], v[40:43], v[68:71]
    v_mfma_f32_16x16x32_bf16 v[56:59], a[52:55], v[44:47], v[56:59]
    ds_read_b128 v[32:35], v6 offset:9216
    v_mfma_f32_16x16x32_bf16 v[60:63], a[132:135], v[44:47], v[60:63]
    s_waitcnt lgkmcnt(4)
    v_mfma_f32_16x16x32_bf16 v[64:67], a[212:215], v[44:47], v[64:67]
    s_add_u32 m0, s54, 4096
    s_add_u32 s34, s53, 512
    buffer_load_dwordx4 v2, s[12:15], s34 offen lds
    v_mfma_f32_16x16x32_bf16 v[68:71], v[228:231], v[44:47], v[68:71]
    v_mfma_f32_16x16x32_bf16 v[56:59], a[56:59], v[48:51], v[56:59]
    ds_read_b128 v[36:39], v7 offset:9216
    v_mfma_f32_16x16x32_bf16 v[60:63], a[136:139], v[48:51], v[60:63]
    s_waitcnt lgkmcnt(4)
    v_mfma_f32_16x16x32_bf16 v[64:67], a[216:219], v[48:51], v[64:67]
    v_mfma_f32_16x16x32_bf16 v[68:71], v[232:235], v[48:51], v[68:71]
    v_mfma_f32_16x16x32_bf16 v[56:59], a[60:63], v[52:55], v[56:59]
    ds_read_b128 v[40:43], v6 offset:20480
    v_mfma_f32_16x16x32_bf16 v[60:63], a[140:143], v[52:55], v[60:63]
    s_waitcnt lgkmcnt(4)
    v_mfma_f32_16x16x32_bf16 v[64:67], a[220:223], v[52:55], v[64:67]
    v_mfma_f32_16x16x32_bf16 v[68:71], v[236:239], v[52:55], v[68:71]
    v_mfma_f32_16x16x32_bf16 v[56:59], a[64:67], v[24:27], v[56:59]
    ds_read_b128 v[44:47], v7 offset:20480
    v_mfma_f32_16x16x32_bf16 v[60:63], a[144:147], v[24:27], v[60:63]
    s_waitcnt lgkmcnt(4)
    v_mfma_f32_16x16x32_bf16 v[64:67], a[224:227], v[24:27], v[64:67]
    s_add_u32 m0, s54, 5120
    s_add_u32 s34, s53, 640
    buffer_load_dwordx4 v2, s[12:15], s34 offen lds
    v_mfma_f32_16x16x32_bf16 v[68:71], v[240:243], v[24:27], v[68:71]
    v_mfma_f32_16x16x32_bf16 v[56:59], a[68:71], v[28:31], v[56:59]
    ds_read_b128 v[48:51], v6 offset:21504
    v_mfma_f32_16x16x32_bf16 v[60:63], a[148:151], v[28:31], v[60:63]
    s_waitcnt lgkmcnt(4)
    v_mfma_f32_16x16x32_bf16 v[64:67], a[228:231], v[28:31], v[64:67]
    v_mfma_f32_16x16x32_bf16 v[68:71], v[244:247], v[28:31], v[68:71]
    v_mfma_f32_16x16x32_bf16 v[56:59], a[72:75], v[32:35], v[56:59]
    ds_read_b128 v[52:55], v7 offset:21504
    v_mfma_f32_16x16x32_bf16 v[60:63], a[152:155], v[32:35], v[60:63]
    s_waitcnt lgkmcnt(4)
    v_mfma_f32_16x16x32_bf16 v[64:67], a[232:235], v[32:35], v[64:67]
    v_mfma_f32_16x16x32_bf16 v[68:71], v[248:251], v[32:35], v[68:71]
    v_mfma_f32_16x16x32_bf16 v[56:59], a[76:79], v[36:39], v[56:59]
    ds_read_b128 v[24:27], v6 offset:22528
    v_mfma_f32_16x16x32_bf16 v[60:63], a[156:159], v[36:39], v[60:63]
    s_waitcnt lgkmcnt(4)
    v_mfma_f32_16x16x32_bf16 v[64:67], a[236:239], v[36:39], v[64:67]
    s_add_u32 m0, s54, 6144
    s_add_u32 s34, s53, 768
    buffer_load_dwordx4 v2, s[12:15], s34 offen lds
    v_mfma_f32_16x16x32_bf16 v[68:71], v[252:255], v[36:39], v[68:71]
    v_mfma_f32_16x16x32_bf16 v[72:75], a[0:3], v[40:43], 0
    ds_read_b128 v[28:31], v7 offset:22528
    v_mfma_f32_16x16x32_bf16 v[76:79], a[80:83], v[40:43], 0
    s_waitcnt lgkmcnt(4)
    v_mfma_f32_16x16x32_bf16 v[80:83], a[160:163], v[40:43], 0
    v_mfma_f32_16x16x32_bf16 v[84:87], a[240:243], v[40:43], 0
    v_mfma_f32_16x16x32_bf16 v[72:75], a[4:7], v[44:47], v[72:75]
    ds_read_b128 v[32:35], v6 offset:23552
    v_mfma_f32_16x16x32_bf16 v[76:79], a[84:87], v[44:47], v[76:79]
    s_waitcnt lgkmcnt(4)
    v_mfma_f32_16x16x32_bf16 v[80:83], a[164:167], v[44:47], v[80:83]
    v_mfma_f32_16x16x32_bf16 v[84:87], a[244:247], v[44:47], v[84:87]
    v_mfma_f32_16x16x32_bf16 v[72:75], a[8:11], v[48:51], v[72:75]
    ds_read_b128 v[36:39], v7 offset:23552
    v_mfma_f32_16x16x32_bf16 v[76:79], a[88:91], v[48:51], v[76:79]
    s_waitcnt lgkmcnt(4)
    v_mfma_f32_16x16x32_bf16 v[80:83], a[168:171], v[48:51], v[80:83]
    s_add_u32 m0, s54, 7168
    s_add_u32 s34, s53, 896
    buffer_load_dwordx4 v2, s[12:15], s34 offen lds
    v_mfma_f32_16x16x32_bf16 v[84:87], a[248:251], v[48:51], v[84:87]
    v_cvt_pk_bf16_f32 v88, v56, v57
    v_cvt_pk_bf16_f32 v89, v58, v59
    v_mfma_f32_16x16x32_bf16 v[72:75], a[12:15], v[52:55], v[72:75]
    ds_read_b128 v[40:43], v6 offset:24576
    v_mfma_f32_16x16x32_bf16 v[76:79], a[92:95], v[52:55], v[76:79]
    s_waitcnt lgkmcnt(4)
    v_mfma_f32_16x16x32_bf16 v[80:83], a[172:175], v[52:55], v[80:83]
    v_cvt_pk_bf16_f32 v90, v60, v61
    v_cvt_pk_bf16_f32 v91, v62, v63
    v_mfma_f32_16x16x32_bf16 v[84:87], a[252:255], v[52:55], v[84:87]
    v_cvt_pk_bf16_f32 v92, v64, v65
    v_cvt_pk_bf16_f32 v93, v66, v67
    v_mfma_f32_16x16x32_bf16 v[72:75], a[16:19], v[24:27], v[72:75]
    ds_read_b128 v[44:47], v7 offset:24576
    v_mfma_f32_16x16x32_bf16 v[76:79], a[96:99], v[24:27], v[76:79]
    s_waitcnt lgkmcnt(4)
    v_mfma_f32_16x16x32_bf16 v[80:83], a[176:179], v[24:27], v[80:83]
    buffer_store_dwordx4 v[88:91], v10, s[8:11], s50 offen offset:0 sc1
    v_cvt_pk_bf16_f32 v94, v68, v69
    v_cvt_pk_bf16_f32 v95, v70, v71
    v_mfma_f32_16x16x32_bf16 v[84:87], v[192:195], v[24:27], v[84:87]
    v_mfma_f32_16x16x32_bf16 v[72:75], a[20:23], v[28:31], v[72:75]
    ds_read_b128 v[48:51], v6 offset:25600
    v_mfma_f32_16x16x32_bf16 v[76:79], a[100:103], v[28:31], v[76:79]
    s_waitcnt lgkmcnt(4)
    v_mfma_f32_16x16x32_bf16 v[80:83], a[180:183], v[28:31], v[80:83]
    s_add_u32 m0, s54, 8192
    s_add_u32 s34, s53, 1024
    buffer_load_dwordx4 v2, s[12:15], s34 offen lds
    v_mfma_f32_16x16x32_bf16 v[84:87], v[196:199], v[28:31], v[84:87]
    buffer_store_dwordx4 v[92:95], v10, s[8:11], s50 offen offset:1024 sc1
    v_mfma_f32_16x16x32_bf16 v[72:75], a[24:27], v[32:35], v[72:75]
    ds_read_b128 v[52:55], v7 offset:25600
    v_mfma_f32_16x16x32_bf16 v[76:79], a[104:107], v[32:35], v[76:79]
    s_waitcnt lgkmcnt(4)
    v_mfma_f32_16x16x32_bf16 v[80:83], a[184:187], v[32:35], v[80:83]
    v_mfma_f32_16x16x32_bf16 v[84:87], v[200:203], v[32:35], v[84:87]
    v_mfma_f32_16x16x32_bf16 v[72:75], a[28:31], v[36:39], v[72:75]
    ds_read_b128 v[24:27], v6 offset:26624
    v_mfma_f32_16x16x32_bf16 v[76:79], a[108:111], v[36:39], v[76:79]
    s_waitcnt lgkmcnt(4)
    v_mfma_f32_16x16x32_bf16 v[80:83], a[188:191], v[36:39], v[80:83]
    v_mfma_f32_16x16x32_bf16 v[84:87], v[204:207], v[36:39], v[84:87]
    v_mfma_f32_16x16x32_bf16 v[72:75], a[32:35], v[40:43], v[72:75]
    ds_read_b128 v[28:31], v7 offset:26624
    v_mfma_f32_16x16x32_bf16 v[76:79], a[112:115], v[40:43], v[76:79]
    s_waitcnt lgkmcnt(4)
    v_mfma_f32_16x16x32_bf16 v[80:83], a[192:195], v[40:43], v[80:83]
    s_add_u32 m0, s54, 9216
    s_add_u32 s34, s53, 1152
    buffer_load_dwordx4 v2, s[12:15], s34 offen lds
    v_mfma_f32_16x16x32_bf16 v[84:87], v[208:211], v[40:43], v[84:87]
    v_mfma_f32_16x16x32_bf16 v[72:75], a[36:39], v[44:47], v[72:75]
    ds_read_b128 v[32:35], v6 offset:27648
    v_mfma_f32_16x16x32_bf16 v[76:79], a[116:119], v[44:47], v[76:79]
    s_waitcnt lgkmcnt(4)
    v_mfma_f32_16x16x32_bf16 v[80:83], a[196:199], v[44:47], v[80:83]
    v_mfma_f32_16x16x32_bf16 v[84:87], v[212:215], v[44:47], v[84:87]
    v_mfma_f32_16x16x32_bf16 v[72:75], a[40:43], v[48:51], v[72:75]
    ds_read_b128 v[36:39], v7 offset:27648
    v_mfma_f32_16x16x32_bf16 v[76:79], a[120:123], v[48:51], v[76:79]
    s_waitcnt lgkmcnt(4)
    v_mfma_f32_16x16x32_bf16 v[80:83], a[200:203], v[48:51], v[80:83]
    v_mfma_f32_16x16x32_bf16 v[84:87], v[216:219], v[48:51], v[84:87]
    v_mfma_f32_16x16x32_bf16 v[72:75], a[44:47], v[52:55], v[72:75]
    ds_read_b128 v[40:43], v6 offset:28672
    v_mfma_f32_16x16x32_bf16 v[76:79], a[124:127], v[52:55], v[76:79]
    s_waitcnt lgkmcnt(4)
    v_mfma_f32_16x16x32_bf16 v[80:83], a[204:207], v[52:55], v[80:83]
    v_mfma_f32_16x16x32_bf16 v[84:87], v[220:223], v[52:55], v[84:87]
    v_mfma_f32_16x16x32_bf16 v[72:75], a[48:51], v[24:27], v[72:75]
    ds_read_b128 v[44:47], v7 offset:28672
    v_mfma_f32_16x16x32_bf16 v[76:79], a[128:131], v[24:27], v[76:79]
    s_waitcnt lgkmcnt(4)
    v_mfma_f32_16x16x32_bf16 v[80:83], a[208:211], v[24:27], v[80:83]
    v_mov_b32 v13, s57
    v_mfma_f32_16x16x32_bf16 v[84:87], v[224:227], v[24:27], v[84:87]
    v_mfma_f32_16x16x32_bf16 v[72:75], a[52:55], v[28:31], v[72:75]
    ds_read_b128 v[48:51], v6 offset:29696
    v_mfma_f32_16x16x32_bf16 v[76:79], a[132:135], v[28:31], v[76:79]
    s_waitcnt lgkmcnt(4)
    v_mfma_f32_16x16x32_bf16 v[80:83], a[212:215], v[28:31], v[80:83]
    s_waitcnt vmcnt(10)
    s_barrier
    s_mov_b64 exec, 1
    buffer_store_dword v13, v12, s[8:11], 0 offen sc1
    s_mov_b64 exec, -1
    v_mfma_f32_16x16x32_bf16 v[84:87], v[228:231], v[28:31], v[84:87]
    v_mfma_f32_16x16x32_bf16 v[72:75], a[56:59], v[32:35], v[72:75]
    ds_read_b128 v[52:55], v7 offset:29696
    v_mfma_f32_16x16x32_bf16 v[76:79], a[136:139], v[32:35], v[76:79]
    s_waitcnt lgkmcnt(4)
    v_mfma_f32_16x16x32_bf16 v[80:83], a[216:219], v[32:35], v[80:83]
    v_mfma_f32_16x16x32_bf16 v[84:87], v[232:235], v[32:35], v[84:87]
    s_add_u32 s57, s57, 1
    s_min_u32 s57, s57, 64
    v_mfma_f32_16x16x32_bf16 v[72:75], a[60:63], v[36:39], v[72:75]
    ds_read_b128 v[24:27], v8 offset:0
    v_mfma_f32_16x16x32_bf16 v[76:79], a[140:143], v[36:39], v[76:79]
    s_waitcnt lgkmcnt(4)
    v_mfma_f32_16x16x32_bf16 v[80:83], a[220:223], v[36:39], v[80:83]
    v_mfma_f32_16x16x32_bf16 v[84:87], v[236:239], v[36:39], v[84:87]
    s_mov_b32 s51, s50
    s_add_u32 s50, s50, 393216
    s_cmp_lt_u32 s57, 64
    s_cselect_b32 s50, s50, 2146435072
    v_mfma_f32_16x16x32_bf16 v[72:75], a[64:67], v[40:43], v[72:75]
    ds_read_b128 v[28:31], v9 offset:0
    v_mfma_f32_16x16x32_bf16 v[76:79], a[144:147], v[40:43], v[76:79]
    s_waitcnt lgkmcnt(4)
    v_mfma_f32_16x16x32_bf16 v[80:83], a[224:227], v[40:43], v[80:83]
    v_mfma_f32_16x16x32_bf16 v[84:87], v[240:243], v[40:43], v[84:87]
    s_add_u32 s53, s53, 40960
    s_add_u32 s52, s52, 1
    v_mfma_f32_16x16x32_bf16 v[72:75], a[68:71], v[44:47], v[72:75]
    ds_read_b128 v[32:35], v8 offset:1024
    v_mfma_f32_16x16x32_bf16 v[76:79], a[148:151], v[44:47], v[76:79]
    s_waitcnt lgkmcnt(4)
    v_mfma_f32_16x16x32_bf16 v[80:83], a[228:231], v[44:47], v[80:83]
    v_mfma_f32_16x16x32_bf16 v[84:87], v[244:247], v[44:47], v[84:87]
    v_mov_b32 v6, v8
    v_mov_b32 v7, v9
    v_mfma_f32_16x16x32_bf16 v[72:75], a[72:75], v[48:51], v[72:75]
    ds_read_b128 v[36:39], v9 offset:1024
    v_mfma_f32_16x16x32_bf16 v[76:79], a[152:155], v[48:51], v[76:79]
    s_waitcnt lgkmcnt(4)
    v_mfma_f32_16x16x32_bf16 v[80:83], a[232:235], v[48:51], v[80:83]
    v_mfma_f32_16x16x32_bf16 v[84:87], v[248:251], v[48:51], v[84:87]
    s_add_u32 s55, s55, 40960
    s_cmp_eq_u32 s55, 163840
    s_cselect_b32 s55, 0, s55
    s_add_u32 s54, s55, s40
    v_mfma_f32_16x16x32_bf16 v[72:75], a[76:79], v[52:55], v[72:75]
    ds_read_b128 v[40:43], v8 offset:2048
    v_mfma_f32_16x16x32_bf16 v[76:79], a[156:159], v[52:55], v[76:79]
    s_waitcnt lgkmcnt(4)
    v_mfma_f32_16x16x32_bf16 v[80:83], a[236:239], v[52:55], v[80:83]
    v_mfma_f32_16x16x32_bf16 v[84:87], v[252:255], v[52:55], v[84:87]
    v_add_u32 v8, s58, v4
    v_add_u32 v9, s58, v5
    s_add_u32 s58, s58, 40960
    s_cmp_eq_u32 s58, 163840
    s_cselect_b32 s58, 0, s58
    s_cmp_lt_u32 s52, 64
    s_cbranch_scc1 L_pj_loop
    v_cvt_pk_bf16_f32 v88, v72, v73
    v_cvt_pk_bf16_f32 v89, v74, v75
    v_cvt_pk_bf16_f32 v90, v76, v77
    v_cvt_pk_bf16_f32 v91, v78, v79
    v_cvt_pk_bf16_f32 v92, v80, v81
    v_cvt_pk_bf16_f32 v93, v82, v83
    v_cvt_pk_bf16_f32 v94, v84, v85
    v_cvt_pk_bf16_f32 v95, v86, v87
    buffer_store_dwordx4 v[88:91], v11, s[8:11], s51 offen offset:0 sc1
    buffer_store_dwordx4 v[92:95], v11, s[8:11], s51 offen offset:1024 sc1
    s_waitcnt vmcnt(0) lgkmcnt(0)
    v_mov_b32 v13, s52
    s_mov_b64 exec, 1
    buffer_store_dword v13, v12, s[8:11], 0 offen sc1
    s_mov_b64 exec, -1
    s_barrier
    s_branch L_xc
.p2align 6
L_role_vo:
    s_sub_u32 s4, s2, 200
    s_load_dwordx2 s[16:17], s[0:1], 40
    s_mov_b32 s18, 7864320
    s_mov_b32 s19, 0x20000
    s_waitcnt lgkmcnt(0)
    s_mul_i32 s41, s4, 245760
    s_cmp_lg_u32 s3, 0
    s_cbranch_scc1 Lar0_123
    v_mov_b32 v4, 0
    v_lshlrev_b32 v5, 2, v1
    s_lshl_b32 s30, s2, 7
    s_add_u32 s30, s30, 246415360
    s_mov_b64 exec, 0xffffffff
    buffer_store_dword v4, v5, s[8:11], s30 offen sc1
    s_mov_b64 exec, -1
    s_waitcnt vmcnt(0)
    s_cmp_eq_u32 s3, 0
    s_cselect_b32 s30, 0, 2146435072
    v_mov_b32 v4, 0
    v_mov_b32 v5, 1
    s_mov_b64 exec, 1
    buffer_atomic_add v5, v4, s[24:27], s30 offen sc1
    s_mov_b64 exec, -1
Lar0_123:
    s_lshr_b32 s30, s3, 1
    s_and_b32 s31, s3, 1
    s_lshl_b32 s30, s30, 3
    s_lshl_b32 s31, s31, 4
    s_add_u32 s30, s30, s31
    s_mov_b32 s32, 1280
    v_add_u32 v8, 0, v1
    v_mul_u32_u24 v9, 820, v8
    v_lshrrev_b32 v9, 16, v9
    v_mul_u32_u24 v10, 80, v9
    v_sub_u32 v8, v8, v10
    v_lshrrev_b32 v10, 0, v9
    v_lshlrev_b32 v10, 1, v10
    v_xor_b32 v8, v8, v10
    v_add_u32 v9, s30, v9
    v_mul_lo_u32 v9, v9, s32
    v_lshl_add_u32 v12, v8, 4, v9
    v_add_u32 v8, 64, v1
    v_mul_u32_u24 v9, 820, v8
    v_lshrrev_b32 v9, 16, v9
    v_mul_u32_u24 v10, 80, v9
    v_sub_u32 v8, v8, v10
    v_lshrrev_b32 v10, 0, v9
    v_lshlrev_b32 v10, 1, v10
    v_xor_b32 v8, v8, v10
    v_add_u32 v9, s30, v9
    v_mul_lo_u32 v9, v9, s32
    v_lshl_add_u32 v13, v8, 4, v9
    v_add_u32 v8, 128, v1
    v_mul_u32_u24 v9, 820, v8
    v_lshrrev_b32 v9, 16, v9
    v_mul_u32_u24 v10, 80, v9
    v_sub_u32 v8, v8, v10
    v_lshrrev_b32 v10, 0, v9
    v_lshlrev_b32 v10, 1, v10
    v_xor_b32 v8, v8, v10
    v_add_u32 v9, s30, v9
    v_mul_lo_u32 v9, v9, s32
    v_lshl_add_u32 v14, v8, 4, v9
    v_add_u32 v8, 192, v1
    v_mul_u32_u24 v9, 820, v8
    v_lshrrev_b32 v9, 16, v9
    v_mul_u32_u24 v10, 80, v9
    v_sub_u32 v8, v8, v10
    v_lshrrev_b32 v10, 0, v9
    v_lshlrev_b32 v10, 1, v10
    v_xor_b32 v8, v8, v10
    v_add_u32 v9, s30, v9
    v_mul_lo_u32 v9, v9, s32
    v_lshl_add_u32 v15, v8, 4, v9
    v_add_u32 v8, 256, v1
    v_mul_u32_u24 v9, 820, v8
    v_lshrrev_b32 v9, 16, v9
    v_mul_u32_u24 v10, 80, v9
    v_sub_u32 v8, v8, v10
    v_lshrrev_b32 v10, 0, v9
    v_lshlrev_b32 v10, 1, v10
    v_xor_b32 v8, v8, v10
    v_add_u32 v9, s30, v9
    v_mul_lo_u32 v9, v9, s32
    v_lshl_add_u32 v16, v8, 4, v9
    v_add_u32 v8, 320, v1
    v_mul_u32_u24 v9, 820, v8
    v_lshrrev_b32 v9, 16, v9
    v_mul_u32_u24 v10, 80, v9
    v_sub_u32 v8, v8, v10
    v_lshrrev_b32 v10, 0, v9
    v_lshlrev_b32 v10, 1, v10
    v_xor_b32 v8, v8, v10
    v_add_u32 v9, s30, v9
    v_mul_lo_u32 v9, v9, s32
    v_lshl_add_u32 v17, v8, 4, v9
    v_add_u32 v8, 384, v1
    v_mul_u32_u24 v9, 820, v8
    v_lshrrev_b32 v9, 16, v9
    v_mul_u32_u24 v10, 80, v9
    v_sub_u32 v8, v8, v10
    v_lshrrev_b32 v10, 0, v9
    v_lshlrev_b32 v10, 1, v10
    v_xor_b32 v8, v8, v10
    v_add_u32 v9, s30, v9
    v_mul_lo_u32 v9, v9, s32
    v_lshl_add_u32 v18, v8, 4, v9
    v_add_u32 v8, 448, v1
    v_mul_u32_u24 v9, 820, v8
    v_lshrrev_b32 v9, 16, v9
    v_mul_u32_u24 v10, 80, v9
    v_sub_u32 v8, v8, v10
    v_lshrrev_b32 v10, 0, v9
    v_lshlrev_b32 v10, 1, v10
    v_xor_b32 v8, v8, v10
    v_add_u32 v9, s30, v9
    v_mul_lo_u32 v9, v9, s32
    v_lshl_add_u32 v19, v8, 4, v9
    v_add_u32 v8, 512, v1
    v_mul_u32_u24 v9, 820, v8
    v_lshrrev_b32 v9, 16, v9
    v_mul_u32_u24 v10, 80, v9
    v_sub_u32 v8, v8, v10
    v_lshrrev_b32 v10, 0, v9
    v_lshlrev_b32 v10, 1, v10
    v_xor_b32 v8, v8, v10
    v_add_u32 v9, s30, v9
    v_mul_lo_u32 v9, v9, s32
    v_lshl_add_u32 v20, v8, 4, v9
    v_add_u32 v8, 576, v1
    v_mul_u32_u24 v9, 820, v8
    v_lshrrev_b32 v9, 16, v9
    v_mul_u32_u24 v10, 80, v9
    v_sub_u32 v8, v8, v10
    v_lshrrev_b32 v10, 0, v9
    v_lshlrev_b32 v10, 1, v10
    v_xor_b32 v8, v8, v10
    v_add_u32 v9, s30, v9
    v_mul_lo_u32 v9, v9, s32
    v_lshl_add_u32 v21, v8, 4, v9
    v_bfe_u32 v8, v1, 2, 3
    v_lshrrev_b32 v23, 0, v8
    v_mul_u32_u24 v22, 1280, v8
    v_lshrrev_b32 v8, 5, v1
    v_mul_u32_u24 v8, 20480, v8
    v_add_u32 v22, v22, v8
    v_and_b32 v8, 3, v1
    v_lshl_add_u32 v22, v8, 3, v22
    s_mul_i32 s33, s3, 10240
    s_add_u32 s34, s41, 0
    s_add_u32 m0, s33, 0
    s_nop 0
    buffer_load_dwordx4 v12, s[16:19], s34 offen lds
    s_add_u32 m0, s33, 1024
    s_nop 0
    buffer_load_dwordx4 v13, s[16:19], s34 offen lds
    s_add_u32 m0, s33, 2048
    s_nop 0
    buffer_load_dwordx4 v14, s[16:19], s34 offen lds
    s_add_u32 m0, s33, 3072
    s_nop 0
    buffer_load_dwordx4 v15, s[16:19], s34 offen lds
    s_add_u32 m0, s33, 4096
    s_nop 0
    buffer_load_dwordx4 v16, s[16:19], s34 offen lds
    s_add_u32 m0, s33, 5120
    s_nop 0
    buffer_load_dwordx4 v17, s[16:19], s34 offen lds
    s_add_u32 m0, s33, 6144
    s_nop 0
    buffer_load_dwordx4 v18, s[16:19], s34 offen lds
    s_add_u32 m0, s33, 7168
    s_nop 0
    buffer_load_dwordx4 v19, s[16:19], s34 offen lds
    s_add_u32 m0, s33, 8192
    s_nop 0
    buffer_load_dwordx4 v20, s[16:19], s34 offen lds
    s_add_u32 m0, s33, 9216
    s_nop 0
    buffer_load_dwordx4 v21, s[16:19], s34 offen lds
    s_mul_i32 s33, s3, 10240
    s_add_u32 s34, s41, 40960
    s_add_u32 m0, s33, 40960
    s_nop 0
    buffer_load_dwordx4 v12, s[16:19], s34 offen lds
    s_add_u32 m0, s33, 41984
    s_nop 0
    buffer_load_dwordx4 v13, s[16:19], s34 offen lds
    s_add_u32 m0, s33, 43008
    s_nop 0
    buffer_load_dwordx4 v14, s[16:19], s34 offen lds
    s_add_u32 m0, s33, 44032
    s_nop 0
    buffer_load_dwordx4 v15, s[16:19], s34 offen lds
    s_add_u32 m0, s33, 45056
    s_nop 0
    buffer_load_dwordx4 v16, s[16:19], s34 offen lds
    s_add_u32 m0, s33, 46080
    s_nop 0
    buffer_load_dwordx4 v17, s[16:19], s34 offen lds
    s_add_u32 m0, s33, 47104
    s_nop 0
    buffer_load_dwordx4 v18, s[16:19], s34 offen lds
    s_add_u32 m0, s33, 48128
    s_nop 0
    buffer_load_dwordx4 v19, s[16:19], s34 offen lds
    s_add_u32 m0, s33, 49152
    s_nop 0
    buffer_load_dwordx4 v20, s[16:19], s34 offen lds
    s_add_u32 m0, s33, 50176
    s_nop 0
    buffer_load_dwordx4 v21, s[16:19], s34 offen lds
    s_mul_i32 s33, s3, 10240
    s_add_u32 s34, s41, 81920
    s_add_u32 m0, s33, 81920
    s_nop 0
    buffer_load_dwordx4 v12, s[16:19], s34 offen lds
    s_add_u32 m0, s33, 82944
    s_nop 0
    buffer_load_dwordx4 v13, s[16:19], s34 offen lds
    s_add_u32 m0, s33, 83968
    s_nop 0
    buffer_load_dwordx4 v14, s[16:19], s34 offen lds
    s_add_u32 m0, s33, 84992
    s_nop 0
    buffer_load_dwordx4 v15, s[16:19], s34 offen lds
    s_add_u32 m0, s33, 86016
    s_nop 0
    buffer_load_dwordx4 v16, s[16:19], s34 offen lds
    s_add_u32 m0, s33, 87040
    s_nop 0
    buffer_load_dwordx4 v17, s[16:19], s34 offen lds
    s_add_u32 m0, s33, 88064
    s_nop 0
    buffer_load_dwordx4 v18, s[16:19], s34 offen lds
    s_add_u32 m0, s33, 89088
    s_nop 0
    buffer_load_dwordx4 v19, s[16:19], s34 offen lds
    s_add_u32 m0, s33, 90112
    s_nop 0
    buffer_load_dwordx4 v20, s[16:19], s34 offen lds
    s_add_u32 m0, s33, 91136
    s_nop 0
    buffer_load_dwordx4 v21, s[16:19], s34 offen lds
    s_mul_i32 s33, s3, 10240
    s_add_u32 s34, s41, 122880
    s_add_u32 m0, s33, 122880
    s_nop 0
    buffer_load_dwordx4 v12, s[16:19], s34 offen lds
    s_add_u32 m0, s33, 123904
    s_nop 0
    buffer_load_dwordx4 v13, s[16:19], s34 offen lds
    s_add_u32 m0, s33, 124928
    s_nop 0
    buffer_load_dwordx4 v14, s[16:19], s34 offen lds
    s_add_u32 m0, s33, 125952
    s_nop 0
    buffer_load_dwordx4 v15, s[16:19], s34 offen lds
    s_add_u32 m0, s33, 126976
    s_nop 0
    buffer_load_dwordx4 v16, s[16:19], s34 offen lds
    s_add_u32 m0, s33, 128000
    s_nop 0
    buffer_load_dwordx4 v17, s[16:19], s34 offen lds
    s_add_u32 m0, s33, 129024
    s_nop 0
    buffer_load_dwordx4 v18, s[16:19], s34 offen lds
    s_add_u32 m0, s33, 130048
    s_nop 0
    buffer_load_dwordx4 v19, s[16:19], s34 offen lds
    s_add_u32 m0, s33, 131072
    s_nop 0
    buffer_load_dwordx4 v20, s[16:19], s34 offen lds
    s_add_u32 m0, s33, 132096
    s_nop 0
    buffer_load_dwordx4 v21, s[16:19], s34 offen lds
    s_waitcnt vmcnt(30) lgkmcnt(0)
    s_barrier
    v_add_u32 v10, 0, v22
    s_mul_i32 s35, s3, 10
    v_xor_b32 v8, s35, v23
    v_lshl_add_u32 v8, v8, 5, v10
    ds_read_b64_tr_b16 a[0:1], v8 offset:0
    ds_read_b64_tr_b16 a[2:3], v8 offset:10240
    s_mul_i32 s35, s3, 10
    s_add_u32 s35, s35, 1
    v_xor_b32 v9, s35, v23
    v_lshl_add_u32 v9, v9, 5, v10
    ds_read_b64_tr_b16 a[24:25], v9 offset:0
    ds_read_b64_tr_b16 a[26:27], v9 offset:10240
    s_mul_i32 s35, s3, 10
    s_add_u32 s35, s35, 2
    v_xor_b32 v8, s35, v23
    v_lshl_add_u32 v8, v8, 5, v10
    ds_read_b64_tr_b16 a[48:49], v8 offset:0
    ds_read_b64_tr_b16 a[50:51], v8 offset:10240
    s_mul_i32 s35, s3, 10
    s_add_u32 s35, s35, 3
    v_xor_b32 v9, s35, v23
    v_lshl_add_u32 v9, v9, 5, v10
    ds_read_b64_tr_b16 a[72:73], v9 offset:0
    ds_read_b64_tr_b16 a[74:75], v9 offset:10240
    s_mul_i32 s35, s3, 10
    s_add_u32 s35, s35, 4
    v_xor_b32 v8, s35, v23
    v_lshl_add_u32 v8, v8, 5, v10
    ds_read_b64_tr_b16 a[96:97], v8 offset:0
    ds_read_b64_tr_b16 a[98:99], v8 offset:10240
    s_mul_i32 s35, s3, 10
    s_add_u32 s35, s35, 5
    v_xor_b32 v9, s35, v23
    v_lshl_add_u32 v9, v9, 5, v10
    ds_read_b64_tr_b16 a[120:121], v9 offset:0
    ds_read_b64_tr_b16 a[122:123], v9 offset:10240
    s_mul_i32 s35, s3, 10
    s_add_u32 s35, s35, 6
    v_xor_b32 v8, s35, v23
    v_lshl_add_u32 v8, v8, 5, v10
    ds_read_b64_tr_b16 a[144:145], v8 offset:0
    ds_read_b64_tr_b16 a[146:147], v8 offset:10240
    s_mul_i32 s35, s3, 10
    s_add_u32 s35, s35, 7
    v_xor_b32 v9, s35, v23
    v_lshl_add_u32 v9, v9, 5, v10
    ds_read_b64_tr_b16 a[168:169], v9 offset:0
    ds_read_b64_tr_b16 a[170:171], v9 offset:10240
    s_mul_i32 s35, s3, 10
    s_add_u32 s35, s35, 8
    v_xor_b32 v8, s35, v23
    v_lshl_add_u32 v8, v8, 5, v10
    ds_read_b64_tr_b16 a[192:193], v8 offset:0
    ds_read_b64_tr_b16 a[194:195], v8 offset:10240
    s_mul_i32 s35, s3, 10
    s_add_u32 s35, s35, 9
    v_xor_b32 v9, s35, v23
    v_lshl_add_u32 v9, v9, 5, v10
    ds_read_b64_tr_b16 a[216:217], v9 offset:0
    ds_read_b64_tr_b16 a[218:219], v9 offset:10240
    s_waitcnt vmcnt(20) lgkmcnt(0)
    s_barrier
    s_mul_i32 s33, s3, 10240
    s_add_u32 s34, s41, 163840
    s_add_u32 m0, s33, 0
    s_nop 0
    buffer_load_dwordx4 v12, s[16:19], s34 offen lds
    s_add_u32 m0, s33, 1024
    s_nop 0
    buffer_load_dwordx4 v13, s[16:19], s34 offen lds
    s_add_u32 m0, s33, 2048
    s_nop 0
    buffer_load_dwordx4 v14, s[16:19], s34 offen lds
    s_add_u32 m0, s33, 3072
    s_nop 0
    buffer_load_dwordx4 v15, s[16:19], s34 offen lds
    s_add_u32 m0, s33, 4096
    s_nop 0
    buffer_load_dwordx4 v16, s[16:19], s34 offen lds
    s_add_u32 m0, s33, 5120
    s_nop 0
    buffer_load_dwordx4 v17, s[16:19], s34 offen lds
    s_add_u32 m0, s33, 6144
    s_nop 0
    buffer_load_dwordx4 v18, s[16:19], s34 offen lds
    s_add_u32 m0, s33, 7168
    s_nop 0
    buffer_load_dwordx4 v19, s[16:19], s34 offen lds
    s_add_u32 m0, s33, 8192
    s_nop 0
    buffer_load_dwordx4 v20, s[16:19], s34 offen lds
    s_add_u32 m0, s33, 9216
    s_nop 0
    buffer_load_dwordx4 v21, s[16:19], s34 offen lds
    v_add_u32 v10, 40960, v22
    s_mul_i32 s35, s3, 10
    v_xor_b32 v8, s35, v23
    v_lshl_add_u32 v8, v8, 5, v10
    ds_read_b64_tr_b16 a[4:5], v8 offset:0
    ds_read_b64_tr_b16 a[6:7], v8 offset:10240
    s_mul_i32 s35, s3, 10
    s_add_u32 s35, s35, 1
    v_xor_b32 v9, s35, v23
    v_lshl_add_u32 v9, v9, 5, v10
    ds_read_b64_tr_b16 a[28:29], v9 offset:0
    ds_read_b64_tr_b16 a[30:31], v9 offset:10240
    s_mul_i32 s35, s3, 10
    s_add_u32 s35, s35, 2
    v_xor_b32 v8, s35, v23
    v_lshl_add_u32 v8, v8, 5, v10
    ds_read_b64_tr_b16 a[52:53], v8 offset:0
    ds_read_b64_tr_b16 a[54:55], v8 offset:10240
    s_mul_i32 s35, s3, 10
    s_add_u32 s35, s35, 3
    v_xor_b32 v9, s35, v23
    v_lshl_add_u32 v9, v9, 5, v10
    ds_read_b64_tr_b16 a[76:77], v9 offset:0
    ds_read_b64_tr_b16 a[78:79], v9 offset:10240
    s_mul_i32 s35, s3, 10
    s_add_u32 s35, s35, 4
    v_xor_b32 v8, s35, v23
    v_lshl_add_u32 v8, v8, 5, v10
    ds_read_b64_tr_b16 a[100:101], v8 offset:0
    ds_read_b64_tr_b16 a[102:103], v8 offset:10240
    s_mul_i32 s35, s3, 10
    s_add_u32 s35, s35, 5
    v_xor_b32 v9, s35, v23
    v_lshl_add_u32 v9, v9, 5, v10
    ds_read_b64_tr_b16 a[124:125], v9 offset:0
    ds_read_b64_tr_b16 a[126:127], v9 offset:10240
    s_mul_i32 s35, s3, 10
    s_add_u32 s35, s35, 6
    v_xor_b32 v8, s35, v23
    v_lshl_add_u32 v8, v8, 5, v10
    ds_read_b64_tr_b16 a[148:149], v8 offset:0
    ds_read_b64_tr_b16 a[150:151], v8 offset:10240
    s_mul_i32 s35, s3, 10
    s_add_u32 s35, s35, 7
    v_xor_b32 v9, s35, v23
    v_lshl_add_u32 v9, v9, 5, v10
    ds_read_b64_tr_b16 a[172:173], v9 offset:0
    ds_read_b64_tr_b16 a[174:175], v9 offset:10240
    s_mul_i32 s35, s3, 10
    s_add_u32 s35, s35, 8
    v_xor_b32 v8, s35, v23
    v_lshl_add_u32 v8, v8, 5, v10
    ds_read_b64_tr_b16 a[196:197], v8 offset:0
    ds_read_b64_tr_b16 a[198:199], v8 offset:10240
    s_mul_i32 s35, s3, 10
    s_add_u32 s35, s35, 9
    v_xor_b32 v9, s35, v23
    v_lshl_add_u32 v9, v9, 5, v10
    ds_read_b64_tr_b16 a[220:221], v9 offset:0
    ds_read_b64_tr_b16 a[222:223], v9 offset:10240
    s_waitcnt vmcnt(20) lgkmcnt(0)
    s_barrier
    s_mul_i32 s33, s3, 10240
    s_add_u32 s34, s41, 204800
    s_add_u32 m0, s33, 40960
    s_nop 0
    buffer_load_dwordx4 v12, s[16:19], s34 offen lds
    s_add_u32 m0, s33, 41984
    s_nop 0
    buffer_load_dwordx4 v13, s[16:19], s34 offen lds
    s_add_u32 m0, s33, 43008
    s_nop 0
    buffer_load_dwordx4 v14, s[16:19], s34 offen lds
    s_add_u32 m0, s33, 44032
    s_nop 0
    buffer_load_dwordx4 v15, s[16:19], s34 offen lds
    s_add_u32 m0, s33, 45056
    s_nop 0
    buffer_load_dwordx4 v16, s[16:19], s34 offen lds
    s_add_u32 m0, s33, 46080
    s_nop 0
    buffer_load_dwordx4 v17, s[16:19], s34 offen lds
    s_add_u32 m0, s33, 47104
    s_nop 0
    buffer_load_dwordx4 v18, s[16:19], s34 offen lds
    s_add_u32 m0, s33, 48128
    s_nop 0
    buffer_load_dwordx4 v19, s[16:19], s34 offen lds
    s_add_u32 m0, s33, 49152
    s_nop 0
    buffer_load_dwordx4 v20, s[16:19], s34 offen lds
    s_add_u32 m0, s33, 50176
    s_nop 0
    buffer_load_dwordx4 v21, s[16:19], s34 offen lds
    v_add_u32 v10, 81920, v22
    s_mul_i32 s35, s3, 10
    v_xor_b32 v8, s35, v23
    v_lshl_add_u32 v8, v8, 5, v10
    ds_read_b64_tr_b16 a[8:9], v8 offset:0
    ds_read_b64_tr_b16 a[10:11], v8 offset:10240
    s_mul_i32 s35, s3, 10
    s_add_u32 s35, s35, 1
    v_xor_b32 v9, s35, v23
    v_lshl_add_u32 v9, v9, 5, v10
    ds_read_b64_tr_b16 a[32:33], v9 offset:0
    ds_read_b64_tr_b16 a[34:35], v9 offset:10240
    s_mul_i32 s35, s3, 10
    s_add_u32 s35, s35, 2
    v_xor_b32 v8, s35, v23
    v_lshl_add_u32 v8, v8, 5, v10
    ds_read_b64_tr_b16 a[56:57], v8 offset:0
    ds_read_b64_tr_b16 a[58:59], v8 offset:10240
    s_mul_i32 s35, s3, 10
    s_add_u32 s35, s35, 3
    v_xor_b32 v9, s35, v23
    v_lshl_add_u32 v9, v9, 5, v10
    ds_read_b64_tr_b16 a[80:81], v9 offset:0
    ds_read_b64_tr_b16 a[82:83], v9 offset:10240
    s_mul_i32 s35, s3, 10
    s_add_u32 s35, s35, 4
    v_xor_b32 v8, s35, v23
    v_lshl_add_u32 v8, v8, 5, v10
    ds_read_b64_tr_b16 a[104:105], v8 offset:0
    ds_read_b64_tr_b16 a[106:107], v8 offset:10240
    s_mul_i32 s35, s3, 10
    s_add_u32 s35, s35, 5
    v_xor_b32 v9, s35, v23
    v_lshl_add_u32 v9, v9, 5, v10
    ds_read_b64_tr_b16 a[128:129], v9 offset:0
    ds_read_b64_tr_b16 a[130:131], v9 offset:10240
    s_mul_i32 s35, s3, 10
    s_add_u32 s35, s35, 6
    v_xor_b32 v8, s35, v23
    v_lshl_add_u32 v8, v8, 5, v10
    ds_read_b64_tr_b16 a[152:153], v8 offset:0
    ds_read_b64_tr_b16 a[154:155], v8 offset:10240
    s_mul_i32 s35, s3, 10
    s_add_u32 s35, s35, 7
    v_xor_b32 v9, s35, v23
    v_lshl_add_u32 v9, v9, 5, v10
    ds_read_b64_tr_b16 a[176:177], v9 offset:0
    ds_read_b64_tr_b16 a[178:179], v9 offset:10240
    s_mul_i32 s35, s3, 10
    s_add_u32 s35, s35, 8
    v_xor_b32 v8, s35, v23
    v_lshl_add_u32 v8, v8, 5, v10
    ds_read_b64_tr_b16 a[200:201], v8 offset:0
    ds_read_b64_tr_b16 a[202:203], v8 offset:10240
    s_mul_i32 s35, s3, 10
    s_add_u32 s35, s35, 9
    v_xor_b32 v9, s35, v23
    v_lshl_add_u32 v9, v9, 5, v10
    ds_read_b64_tr_b16 a[224:225], v9 offset:0
    ds_read_b64_tr_b16 a[226:227], v9 offset:10240
    s_waitcnt vmcnt(20) lgkmcnt(0)
    s_barrier
    v_add_u32 v10, 122880, v22
    s_mul_i32 s35, s3, 10
    v_xor_b32 v8, s35, v23
    v_lshl_add_u32 v8, v8, 5, v10
    ds_read_b64_tr_b16 a[12:13], v8 offset:0
    ds_read_b64_tr_b16 a[14:15], v8 offset:10240
    s_mul_i32 s35, s3, 10
    s_add_u32 s35, s35, 1
    v_xor_b32 v9, s35, v23
    v_lshl_add_u32 v9, v9, 5, v10
    ds_read_b64_tr_b16 a[36:37], v9 offset:0
    ds_read_b64_tr_b16 a[38:39], v9 offset:10240
    s_mul_i32 s35, s3, 10
    s_add_u32 s35, s35, 2
    v_xor_b32 v8, s35, v23
    v_lshl_add_u32 v8, v8, 5, v10
    ds_read_b64_tr_b16 a[60:61], v8 offset:0
    ds_read_b64_tr_b16 a[62:63], v8 offset:10240
    s_mul_i32 s35, s3, 10
    s_add_u32 s35, s35, 3
    v_xor_b32 v9, s35, v23
    v_lshl_add_u32 v9, v9, 5, v10
    ds_read_b64_tr_b16 a[84:85], v9 offset:0
    ds_read_b64_tr_b16 a[86:87], v9 offset:10240
    s_mul_i32 s35, s3, 10
    s_add_u32 s35, s35, 4
    v_xor_b32 v8, s35, v23
    v_lshl_add_u32 v8, v8, 5, v10
    ds_read_b64_tr_b16 a[108:109], v8 offset:0
    ds_read_b64_tr_b16 a[110:111], v8 offset:10240
    s_mul_i32 s35, s3, 10
    s_add_u32 s35, s35, 5
    v_xor_b32 v9, s35, v23
    v_lshl_add_u32 v9, v9, 5, v10
    ds_read_b64_tr_b16 a[132:133], v9 offset:0
    ds_read_b64_tr_b16 a[134:135], v9 offset:10240
    s_mul_i32 s35, s3, 10
    s_add_u32 s35, s35, 6
    v_xor_b32 v8, s35, v23
    v_lshl_add_u32 v8, v8, 5, v10
    ds_read_b64_tr_b16 a[156:157], v8 offset:0
    ds_read_b64_tr_b16 a[158:159], v8 offset:10240
    s_mul_i32 s35, s3, 10
    s_add_u32 s35, s35, 7
    v_xor_b32 v9, s35, v23
    v_lshl_add_u32 v9, v9, 5, v10
    ds_read_b64_tr_b16 a[180:181], v9 offset:0
    ds_read_b64_tr_b16 a[182:183], v9 offset:10240
    s_mul_i32 s35, s3, 10
    s_add_u32 s35, s35, 8
    v_xor_b32 v8, s35, v23
    v_lshl_add_u32 v8, v8, 5, v10
    ds_read_b64_tr_b16 a[204:205], v8 offset:0
    ds_read_b64_tr_b16 a[206:207], v8 offset:10240
    s_mul_i32 s35, s3, 10
    s_add_u32 s35, s35, 9
    v_xor_b32 v9, s35, v23
    v_lshl_add_u32 v9, v9, 5, v10
    ds_read_b64_tr_b16 a[228:229], v9 offset:0
    ds_read_b64_tr_b16 a[230:231], v9 offset:10240
    s_waitcnt vmcnt(10) lgkmcnt(0)
    s_barrier
    v_add_u32 v10, 0, v22
    s_mul_i32 s35, s3, 10
    v_xor_b32 v8, s35, v23
    v_lshl_add_u32 v8, v8, 5, v10
    ds_read_b64_tr_b16 a[16:17], v8 offset:0
    ds_read_b64_tr_b16 a[18:19], v8 offset:10240
    s_mul_i32 s35, s3, 10
    s_add_u32 s35, s35, 1
    v_xor_b32 v9, s35, v23
    v_lshl_add_u32 v9, v9, 5, v10
    ds_read_b64_tr_b16 a[40:41], v9 offset:0
    ds_read_b64_tr_b16 a[42:43], v9 offset:10240
    s_mul_i32 s35, s3, 10
    s_add_u32 s35, s35, 2
    v_xor_b32 v8, s35, v23
    v_lshl_add_u32 v8, v8, 5, v10
    ds_read_b64_tr_b16 a[64:65], v8 offset:0
    ds_read_b64_tr_b16 a[66:67], v8 offset:10240
    s_mul_i32 s35, s3, 10
    s_add_u32 s35, s35, 3
    v_xor_b32 v9, s35, v23
    v_lshl_add_u32 v9, v9, 5, v10
    ds_read_b64_tr_b16 a[88:89], v9 offset:0
    ds_read_b64_tr_b16 a[90:91], v9 offset:10240
    s_mul_i32 s35, s3, 10
    s_add_u32 s35, s35, 4
    v_xor_b32 v8, s35, v23
    v_lshl_add_u32 v8, v8, 5, v10
    ds_read_b64_tr_b16 a[112:113], v8 offset:0
    ds_read_b64_tr_b16 a[114:115], v8 offset:10240
    s_mul_i32 s35, s3, 10
    s_add_u32 s35, s35, 5
    v_xor_b32 v9, s35, v23
    v_lshl_add_u32 v9, v9, 5, v10
    ds_read_b64_tr_b16 a[136:137], v9 offset:0
    ds_read_b64_tr_b16 a[138:139], v9 offset:10240
    s_mul_i32 s35, s3, 10
    s_add_u32 s35, s35, 6
    v_xor_b32 v8, s35, v23
    v_lshl_add_u32 v8, v8, 5, v10
    ds_read_b64_tr_b16 a[160:161], v8 offset:0
    ds_read_b64_tr_b16 a[162:163], v8 offset:10240
    s_mul_i32 s35, s3, 10
    s_add_u32 s35, s35, 7
    v_xor_b32 v9, s35, v23
    v_lshl_add_u32 v9, v9, 5, v10
    ds_read_b64_tr_b16 a[184:185], v9 offset:0
    ds_read_b64_tr_b16 a[186:187], v9 offset:10240
    s_mul_i32 s35, s3, 10
    s_add_u32 s35, s35, 8
    v_xor_b32 v8, s35, v23
    v_lshl_add_u32 v8, v8, 5, v10
    ds_read_b64_tr_b16 a[208:209], v8 offset:0
    ds_read_b64_tr_b16 a[210:211], v8 offset:10240
    s_mul_i32 s35, s3, 10
    s_add_u32 s35, s35, 9
    v_xor_b32 v9, s35, v23
    v_lshl_add_u32 v9, v9, 5, v10
    ds_read_b64_tr_b16 a[232:233], v9 offset:0
    ds_read_b64_tr_b16 a[234:235], v9 offset:10240
    s_waitcnt vmcnt(0) lgkmcnt(0)
    s_barrier
    v_add_u32 v10, 40960, v22
    s_mul_i32 s35, s3, 10
    v_xor_b32 v8, s35, v23
    v_lshl_add_u32 v8, v8, 5, v10
    ds_read_b64_tr_b16 a[20:21], v8 offset:0
    ds_read_b64_tr_b16 a[22:23], v8 offset:10240
    s_mul_i32 s35, s3, 10
    s_add_u32 s35, s35, 1
    v_xor_b32 v9, s35, v23
    v_lshl_add_u32 v9, v9, 5, v10
    ds_read_b64_tr_b16 a[44:45], v9 offset:0
    ds_read_b64_tr_b16 a[46:47], v9 offset:10240
    s_mul_i32 s35, s3, 10
    s_add_u32 s35, s35, 2
    v_xor_b32 v8, s35, v23
    v_lshl_add_u32 v8, v8, 5, v10
    ds_read_b64_tr_b16 a[68:69], v8 offset:0
    ds_read_b64_tr_b16 a[70:71], v8 offset:10240
    s_mul_i32 s35, s3, 10
    s_add_u32 s35, s35, 3
    v_xor_b32 v9, s35, v23
    v_lshl_add_u32 v9, v9, 5, v10
    ds_read_b64_tr_b16 a[92:93], v9 offset:0
    ds_read_b64_tr_b16 a[94:95], v9 offset:10240
    s_mul_i32 s35, s3, 10
    s_add_u32 s35, s35, 4
    v_xor_b32 v8, s35, v23
    v_lshl_add_u32 v8, v8, 5, v10
    ds_read_b64_tr_b16 a[116:117], v8 offset:0
    ds_read_b64_tr_b16 a[118:119], v8 offset:10240
    s_mul_i32 s35, s3, 10
    s_add_u32 s35, s35, 5
    v_xor_b32 v9, s35, v23
    v_lshl_add_u32 v9, v9, 5, v10
    ds_read_b64_tr_b16 a[140:141], v9 offset:0
    ds_read_b64_tr_b16 a[142:143], v9 offset:10240
    s_mul_i32 s35, s3, 10
    s_add_u32 s35, s35, 6
    v_xor_b32 v8, s35, v23
    v_lshl_add_u32 v8, v8, 5, v10
    ds_read_b64_tr_b16 a[164:165], v8 offset:0
    ds_read_b64_tr_b16 a[166:167], v8 offset:10240
    s_mul_i32 s35, s3, 10
    s_add_u32 s35, s35, 7
    v_xor_b32 v9, s35, v23
    v_lshl_add_u32 v9, v9, 5, v10
    ds_read_b64_tr_b16 a[188:189], v9 offset:0
    ds_read_b64_tr_b16 a[190:191], v9 offset:10240
    s_mul_i32 s35, s3, 10
    s_add_u32 s35, s35, 8
    v_xor_b32 v8, s35, v23
    v_lshl_add_u32 v8, v8, 5, v10
    ds_read_b64_tr_b16 a[212:213], v8 offset:0
    ds_read_b64_tr_b16 a[214:215], v8 offset:10240
    s_mul_i32 s35, s3, 10
    s_add_u32 s35, s35, 9
    v_xor_b32 v9, s35, v23
    v_lshl_add_u32 v9, v9, 5, v10
    ds_read_b64_tr_b16 a[236:237], v9 offset:0
    ds_read_b64_tr_b16 a[238:239], v9 offset:10240
    s_waitcnt lgkmcnt(0)
    s_barrier
    s_mov_b32 s31, 0
Lwa_124:
    v_lshlrev_b32 v9, 2, v1
    buffer_load_dword v8, v9, s[24:27], 0 offen offset:192 sc1
    s_add_u32 s31, s31, 1
    s_cmp_gt_u32 s31, 400000
    s_cbranch_scc1 L_abort
    s_sleep 2
    s_waitcnt vmcnt(0)
    v_readfirstlane_b32 s30, v8
    s_nop 0
    s_cmp_lt_u32 s30, 1
    s_nop 1
    s_cbranch_scc1 Lwa_124
    v_lshlrev_b32 v2, 4, v1
    v_add_u32 v3, 4096, v2
    v_add_u32 v4, 8192, v2
    s_mul_i32 s30, s3, 327680
    s_lshl_b32 s31, s4, 10
    s_add_u32 s30, s30, s31
    v_add_u32 v5, s30, v2
    s_lshl_b32 s30, s2, 7
    s_lshl_b32 s31, s3, 2
    s_add_u32 s30, s30, s31
    s_add_u32 s30, s30, 246415360
    v_mov_b32 v6, s30
    v_mov_b32 v8, 0
    s_lshl_b32 s56, s4, 7
    s_add_u32 s56, s56, 246456320
    s_mul_i32 s50, s4, 12288
    s_add_u32 s50, s50, 117440512
    s_mov_b32 s51, 142606336
    s_mov_b32 s52, 0
    s_mov_b32 s57, 0
    s_mov_b32 s61, s50
    s_add_u32 s50, s50, 393216
    s_mov_b32 s31, 0
Lvpl_126:
    buffer_load_dwordx4 v[12:15], v8, s[8:11], s56 offen sc1
    s_add_u32 s31, s31, 1
    s_cmp_gt_u32 s31, 400000
    s_cbranch_scc1 L_abort
    s_waitcnt vmcnt(0)
    v_min3_u32 v12, v12, v13, v14
    s_nop 0
    v_readfirstlane_b32 s57, v12
    s_nop 0
    s_cmp_le_u32 s57, s52
    s_nop 1
    s_cbranch_scc1 Lvpl_126
    s_mov_b32 s59, s61
    buffer_load_dwordx4 v[48:51], v2, s[8:11], s59 offen offset:0 sc1
    buffer_load_dwordx4 v[52:55], v2, s[8:11], s59 offen offset:1024 sc1
    buffer_load_dwordx4 v[56:59], v2, s[8:11], s59 offen offset:2048 sc1
    buffer_load_dwordx4 v[60:63], v2, s[8:11], s59 offen offset:3072 sc1
    buffer_load_dwordx4 v[64:67], v3, s[8:11], s59 offen offset:0 sc1
    buffer_load_dwordx4 v[68:71], v3, s[8:11], s59 offen offset:1024 sc1
    buffer_load_dwordx4 v[72:75], v3, s[8:11], s59 offen offset:2048 sc1
    buffer_load_dwordx4 v[76:79], v3, s[8:11], s59 offen offset:3072 sc1
    buffer_load_dwordx4 v[80:83], v4, s[8:11], s59 offen offset:0 sc1
    buffer_load_dwordx4 v[84:87], v4, s[8:11], s59 offen offset:1024 sc1
    buffer_load_dwordx4 v[88:91], v4, s[8:11], s59 offen offset:2048 sc1
    buffer_load_dwordx4 v[92:95], v4, s[8:11], s59 offen offset:3072 sc1
    s_waitcnt vmcnt(0)
L_vo_loop:
    s_waitcnt vmcnt(14)
    v_mfma_f32_16x16x32_bf16 v[16:19], v[48:51], a[0:3], 0
    s_waitcnt vmcnt(8)
    v_mfma_f32_16x16x32_bf16 v[20:23], v[72:75], a[0:3], 0
    v_mfma_f32_16x16x32_bf16 v[16:19], v[52:55], a[4:7], v[16:19]
    s_waitcnt vmcnt(7)
    v_mfma_f32_16x16x32_bf16 v[20:23], v[76:79], a[4:7], v[20:23]
    v_mfma_f32_16x16x32_bf16 v[16:19], v[56:59], a[8:11], v[16:19]
    s_waitcnt vmcnt(6)
    v_mfma_f32_16x16x32_bf16 v[20:23], v[80:83], a[8:11], v[20:23]
    v_mfma_f32_16x16x32_bf16 v[16:19], v[60:63], a[12:15], v[16:19]
    s_waitcnt vmcnt(5)
    v_mfma_f32_16x16x32_bf16 v[20:23], v[84:87], a[12:15], v[20:23]
    v_mfma_f32_16x16x32_bf16 v[16:19], v[64:67], a[16:19], v[16:19]
    s_waitcnt vmcnt(4)
    v_mfma_f32_16x16x32_bf16 v[20:23], v[88:91], a[16:19], v[20:23]
    v_mfma_f32_16x16x32_bf16 v[16:19], v[68:71], a[20:23], v[16:19]
    s_waitcnt vmcnt(3)
    v_mfma_f32_16x16x32_bf16 v[20:23], v[92:95], a[20:23], v[20:23]
    v_mfma_f32_16x16x32_bf16 v[24:27], v[48:51], a[24:27], 0
    v_mfma_f32_16x16x32_bf16 v[28:31], v[72:75], a[24:27], 0
    v_mfma_f32_16x16x32_bf16 v[24:27], v[52:55], a[28:31], v[24:27]
    v_mfma_f32_16x16x32_bf16 v[28:31], v[76:79], a[28:31], v[28:31]
    v_mfma_f32_16x16x32_bf16 v[24:27], v[56:59], a[32:35], v[24:27]
    v_mfma_f32_16x16x32_bf16 v[28:31], v[80:83], a[32:35], v[28:31]
    v_mfma_f32_16x16x32_bf16 v[24:27], v[60:63], a[36:39], v[24:27]
    v_mfma_f32_16x16x32_bf16 v[28:31], v[84:87], a[36:39], v[28:31]
    v_cvt_pk_bf16_f32 v32, v16, v17
    v_cvt_pk_bf16_f32 v33, v18, v19
    v_mfma_f32_16x16x32_bf16 v[24:27], v[64:67], a[40:43], v[24:27]
    v_mfma_f32_16x16x32_bf16 v[28:31], v[88:91], a[40:43], v[28:31]
    v_cvt_pk_bf16_f32 v34, v20, v21
    v_cvt_pk_bf16_f32 v35, v22, v23
    v_mfma_f32_16x16x32_bf16 v[24:27], v[68:71], a[44:47], v[24:27]
    v_mfma_f32_16x16x32_bf16 v[28:31], v[92:95], a[44:47], v[28:31]
    s_add_u32 s34, s51, 0
    buffer_store_dwordx4 v[32:35], v5, s[8:11], s34 offen sc1
    v_mfma_f32_16x16x32_bf16 v[16:19], v[48:51], a[48:51], 0
    v_mfma_f32_16x16x32_bf16 v[20:23], v[72:75], a[48:51], 0
    buffer_load_dwordx4 v[12:15], v8, s[8:11], s56 offen sc1
    v_mfma_f32_16x16x32_bf16 v[16:19], v[52:55], a[52:55], v[16:19]
    v_mfma_f32_16x16x32_bf16 v[20:23], v[76:79], a[52:55], v[20:23]
    v_mfma_f32_16x16x32_bf16 v[16:19], v[56:59], a[56:59], v[16:19]
    v_mfma_f32_16x16x32_bf16 v[20:23], v[80:83], a[56:59], v[20:23]
    v_mfma_f32_16x16x32_bf16 v[16:19], v[60:63], a[60:63], v[16:19]
    v_mfma_f32_16x16x32_bf16 v[20:23], v[84:87], a[60:63], v[20:23]
    v_cvt_pk_bf16_f32 v36, v24, v25
    v_cvt_pk_bf16_f32 v37, v26, v27
    v_mfma_f32_16x16x32_bf16 v[16:19], v[64:67], a[64:67], v[16:19]
    v_mfma_f32_16x16x32_bf16 v[20:23], v[88:91], a[64:67], v[20:23]
    v_cvt_pk_bf16_f32 v38, v28, v29
    v_cvt_pk_bf16_f32 v39, v30, v31
    v_mfma_f32_16x16x32_bf16 v[16:19], v[68:71], a[68:71], v[16:19]
    v_mfma_f32_16x16x32_bf16 v[20:23], v[92:95], a[68:71], v[20:23]
    s_add_u32 s34, s51, 32768
    buffer_store_dwordx4 v[36:39], v5, s[8:11], s34 offen sc1
    v_mfma_f32_16x16x32_bf16 v[24:27], v[48:51], a[72:75], 0
    v_mfma_f32_16x16x32_bf16 v[28:31], v[72:75], a[72:75], 0
    v_mfma_f32_16x16x32_bf16 v[24:27], v[52:55], a[76:79], v[24:27]
    v_mfma_f32_16x16x32_bf16 v[28:31], v[76:79], a[76:79], v[28:31]
    v_mfma_f32_16x16x32_bf16 v[24:27], v[56:59], a[80:83], v[24:27]
    v_mfma_f32_16x16x32_bf16 v[28:31], v[80:83], a[80:83], v[28:31]
    s_waitcnt vmcnt(3)
    v_mov_b32 v7, s52
    s_mov_b64 exec, 1
    buffer_store_dword v7, v6, s[8:11], 0 offen sc1
    s_mov_b64 exec, -1
    v_mfma_f32_16x16x32_bf16 v[24:27], v[60:63], a[84:87], v[24:27]
    v_mfma_f32_16x16x32_bf16 v[28:31], v[84:87], a[84:87], v[28:31]
    v_cvt_pk_bf16_f32 v32, v16, v17
    v_cvt_pk_bf16_f32 v33, v18, v19
    v_mfma_f32_16x16x32_bf16 v[24:27], v[64:67], a[88:91], v[24:27]
    v_mfma_f32_16x16x32_bf16 v[28:31], v[88:91], a[88:91], v[28:31]
    v_cvt_pk_bf16_f32 v34, v20, v21
    v_cvt_pk_bf16_f32 v35, v22, v23
    v_mfma_f32_16x16x32_bf16 v[24:27], v[68:71], a[92:95], v[24:27]
    v_mfma_f32_16x16x32_bf16 v[28:31], v[92:95], a[92:95], v[28:31]
    s_add_u32 s34, s51, 65536
    buffer_store_dwordx4 v[32:35], v5, s[8:11], s34 offen sc1
    v_mfma_f32_16x16x32_bf16 v[16:19], v[48:51], a[96:99], 0
    v_mfma_f32_16x16x32_bf16 v[20:23], v[72:75], a[96:99], 0
    v_mfma_f32_16x16x32_bf16 v[16:19], v[52:55], a[100:103], v[16:19]
    v_mfma_f32_16x16x32_bf16 v[20:23], v[76:79], a[100:103], v[20:23]
    s_waitcnt vmcnt(3)
    v_min3_u32 v12, v12, v13, v14
    s_nop 0
    v_readfirstlane_b32 s57, v12
    s_add_u32 s30, s52, 1
    s_cmp_le_u32 s57, s30
    s_cselect_b32 s58, 1, 0
    s_cselect_b32 s59, 2146435072, s50
    s_cmp_ge_u32 s30, 64
    s_cselect_b32 s58, 0, s58
    v_mfma_f32_16x16x32_bf16 v[16:19], v[56:59], a[104:107], v[16:19]
    v_mfma_f32_16x16x32_bf16 v[20:23], v[80:83], a[104:107], v[20:23]
    buffer_load_dwordx4 v[96:99], v2, s[8:11], s59 offen offset:0 sc1
    v_mfma_f32_16x16x32_bf16 v[16:19], v[60:63], a[108:111], v[16:19]
    v_mfma_f32_16x16x32_bf16 v[20:23], v[84:87], a[108:111], v[20:23]
    v_cvt_pk_bf16_f32 v36, v24, v25
    v_cvt_pk_bf16_f32 v37, v26, v27
    v_mfma_f32_16x16x32_bf16 v[16:19], v[64:67], a[112:115], v[16:19]
    v_mfma_f32_16x16x32_bf16 v[20:23], v[88:91], a[112:115], v[20:23]
    v_cvt_pk_bf16_f32 v38, v28, v29
    v_cvt_pk_bf16_f32 v39, v30, v31
    buffer_load_dwordx4 v[100:103], v2, s[8:11], s59 offen offset:1024 sc1
    v_mfma_f32_16x16x32_bf16 v[16:19], v[68:71], a[116:119], v[16:19]
    v_mfma_f32_16x16x32_bf16 v[20:23], v[92:95], a[116:119], v[20:23]
    s_add_u32 s34, s51, 98304
    buffer_store_dwordx4 v[36:39], v5, s[8:11], s34 offen sc1
    v_mfma_f32_16x16x32_bf16 v[24:27], v[48:51], a[120:123], 0
    v_mfma_f32_16x16x32_bf16 v[28:31], v[72:75], a[120:123], 0
    buffer_load_dwordx4 v[104:107], v2, s[8:11], s59 offen offset:2048 sc1
    v_mfma_f32_16x16x32_bf16 v[24:27], v[52:55], a[124:127], v[24:27]
    v_mfma_f32_16x16x32_bf16 v[28:31], v[76:79], a[124:127], v[28:31]
    v_mfma_f32_16x16x32_bf16 v[24:27], v[56:59], a[128:131], v[24:27]
    v_mfma_f32_16x16x32_bf16 v[28:31], v[80:83], a[128:131], v[28:31]
    buffer_load_dwordx4 v[108:111], v2, s[8:11], s59 offen offset:3072 sc1
    v_mfma_f32_16x16x32_bf16 v[24:27], v[60:63], a[132:135], v[24:27]
    v_mfma_f32_16x16x32_bf16 v[28:31], v[84:87], a[132:135], v[28:31]
    v_cvt_pk_bf16_f32 v32, v16, v17
    v_cvt_pk_bf16_f32 v33, v18, v19
    v_mfma_f32_16x16x32_bf16 v[24:27], v[64:67], a[136:139], v[24:27]
    v_mfma_f32_16x16x32_bf16 v[28:31], v[88:91], a[136:139], v[28:31]
    v_cvt_pk_bf16_f32 v34, v20, v21
    v_cvt_pk_bf16_f32 v35, v22, v23
    buffer_load_dwordx4 v[112:115], v3, s[8:11], s59 offen offset:0 sc1
    v_mfma_f32_16x16x32_bf16 v[24:27], v[68:71], a[140:143], v[24:27]
    v_mfma_f32_16x16x32_bf16 v[28:31], v[92:95], a[140:143], v[28:31]
    s_add_u32 s34, s51, 131072
    buffer_store_dwordx4 v[32:35], v5, s[8:11], s34 offen sc1
    v_mfma_f32_16x16x32_bf16 v[16:19], v[48:51], a[144:147], 0
    v_mfma_f32_16x16x32_bf16 v[20:23], v[72:75], a[144:147], 0
    buffer_load_dwordx4 v[116:119], v3, s[8:11], s59 offen offset:1024 sc1
    v_mfma_f32_16x16x32_bf16 v[16:19], v[52:55], a[148:151], v[16:19]
    v_mfma_f32_16x16x32_bf16 v[20:23], v[76:79], a[148:151], v[20:23]
    v_mfma_f32_16x16x32_bf16 v[16:19], v[56:59], a[152:155], v[16:19]
    v_mfma_f32_16x16x32_bf16 v[20:23], v[80:83], a[152:155], v[20:23]
    buffer_load_dwordx4 v[120:123], v3, s[8:11], s59 offen offset:2048 sc1
    v_mfma_f32_16x16x32_bf16 v[16:19], v[60:63], a[156:159], v[16:19]
    v_mfma_f32_16x16x32_bf16 v[20:23], v[84:87], a[156:159], v[20:23]
    v_cvt_pk_bf16_f32 v36, v24, v25
    v_cvt_pk_bf16_f32 v37, v26, v27
    v_mfma_f32_16x16x32_bf16 v[16:19], v[64:67], a[160:163], v[16:19]
    v_mfma_f32_16x16x32_bf16 v[20:23], v[88:91], a[160:163], v[20:23]
    v_cvt_pk_bf16_f32 v38, v28, v29
    v_cvt_pk_bf16_f32 v39, v30, v31
    buffer_load_dwordx4 v[124:127], v3, s[8:11], s59 offen offset:3072 sc1
    v_mfma_f32_16x16x32_bf16 v[16:19], v[68:71], a[164:167], v[16:19]
    v_mfma_f32_16x16x32_bf16 v[20:23], v[92:95], a[164:167], v[20:23]
    s_add_u32 s34, s51, 163840
    buffer_store_dwordx4 v[36:39], v5, s[8:11], s34 offen sc1
    v_mfma_f32_16x16x32_bf16 v[24:27], v[48:51], a[168:171], 0
    v_mfma_f32_16x16x32_bf16 v[28:31], v[72:75], a[168:171], 0
    buffer_load_dwordx4 v[128:131], v4, s[8:11], s59 offen offset:0 sc1
    v_mfma_f32_16x16x32_bf16 v[24:27], v[52:55], a[172:175], v[24:27]
    v_mfma_f32_16x16x32_bf16 v[28:31], v[76:79], a[172:175], v[28:31]
    v_mfma_f32_16x16x32_bf16 v[24:27], v[56:59], a[176:179], v[24:27]
    v_mfma_f32_16x16x32_bf16 v[28:31], v[80:83], a[176:179], v[28:31]
    buffer_load_dwordx4 v[132:135], v4, s[8:11], s59 offen offset:1024 sc1
    v_mfma_f32_16x16x32_bf16 v[24:27], v[60:63], a[180:183], v[24:27]
    v_mfma_f32_16x16x32_bf16 v[28:31], v[84:87], a[180:183], v[28:31]
    v_cvt_pk_bf16_f32 v32, v16, v17
    v_cvt_pk_bf16_f32 v33, v18, v19
    v_mfma_f32_16x16x32_bf16 v[24:27], v[64:67], a[184:187], v[24:27]
    v_mfma_f32_16x16x32_bf16 v[28:31], v[88:91], a[184:187], v[28:31]
    v_cvt_pk_bf16_f32 v34, v20, v21
    v_cvt_pk_bf16_f32 v35, v22, v23
    buffer_load_dwordx4 v[136:139], v4, s[8:11], s59 offen offset:2048 sc1
    v_mfma_f32_16x16x32_bf16 v[24:27], v[68:71], a[188:191], v[24:27]
    v_mfma_f32_16x16x32_bf16 v[28:31], v[92:95], a[188:191], v[28:31]
    s_add_u32 s34, s51, 196608
    buffer_store_dwordx4 v[32:35], v5, s[8:11], s34 offen sc1
    v_mfma_f32_16x16x32_bf16 v[16:19], v[48:51], a[192:195], 0
    v_mfma_f32_16x16x32_bf16 v[20:23], v[72:75], a[192:195], 0
    buffer_load_dwordx4 v[140:143], v4, s[8:11], s59 offen offset:3072 sc1
    v_mfma_f32_16x16x32_bf16 v[16:19], v[52:55], a[196:199], v[16:19]
    v_mfma_f32_16x16x32_bf16 v[20:23], v[76:79], a[196:199], v[20:23]
    v_mfma_f32_16x16x32_bf16 v[16:19], v[56:59], a[200:203], v[16:19]
    v_mfma_f32_16x16x32_bf16 v[20:23], v[80:83], a[200:203], v[20:23]
    v_mfma_f32_16x16x32_bf16 v[16:19], v[60:63], a[204:207], v[16:19]
    v_mfma_f32_16x16x32_bf16 v[20:23], v[84:87], a[204:207], v[20:23]
    v_cvt_pk_bf16_f32 v36, v24, v25
    v_cvt_pk_bf16_f32 v37, v26, v27
    v_mfma_f32_16x16x32_bf16 v[16:19], v[64:67], a[208:211], v[16:19]
    v_mfma_f32_16x16x32_bf16 v[20:23], v[88:91], a[208:211], v[20:23]
    v_cvt_pk_bf16_f32 v38, v28, v29
    v_cvt_pk_bf16_f32 v39, v30, v31
    v_mfma_f32_16x16x32_bf16 v[16:19], v[68:71], a[212:215], v[16:19]
    v_mfma_f32_16x16x32_bf16 v[20:23], v[92:95], a[212:215], v[20:23]
    s_add_u32 s34, s51, 229376
    buffer_store_dwordx4 v[36:39], v5, s[8:11], s34 offen sc1
    v_mfma_f32_16x16x32_bf16 v[24:27], v[48:51], a[216:219], 0
    v_mfma_f32_16x16x32_bf16 v[28:31], v[72:75], a[216:219], 0
    v_mfma_f32_16x16x32_bf16 v[24:27], v[52:55], a[220:223], v[24:27]
    v_mfma_f32_16x16x32_bf16 v[28:31], v[76:79], a[220:223], v[28:31]
    v_mfma_f32_16x16x32_bf16 v[24:27], v[56:59], a[224:227], v[24:27]
    v_mfma_f32_16x16x32_bf16 v[28:31], v[80:83], a[224:227], v[28:31]
    v_mfma_f32_16x16x32_bf16 v[24:27], v[60:63], a[228:231], v[24:27]
    v_mfma_f32_16x16x32_bf16 v[28:31], v[84:87], a[228:231], v[28:31]
    v_cvt_pk_bf16_f32 v32, v16, v17
    v_cvt_pk_bf16_f32 v33, v18, v19
    v_mfma_f32_16x16x32_bf16 v[24:27], v[64:67], a[232:235], v[24:27]
    v_mfma_f32_16x16x32_bf16 v[28:31], v[88:91], a[232:235], v[28:31]
    v_cvt_pk_bf16_f32 v34, v20, v21
    v_cvt_pk_bf16_f32 v35, v22, v23
    v_mfma_f32_16x16x32_bf16 v[24:27], v[68:71], a[236:239], v[24:27]
    v_mfma_f32_16x16x32_bf16 v[28:31], v[92:95], a[236:239], v[28:31]
    s_add_u32 s34, s51, 262144
    buffer_store_dwordx4 v[32:35], v5, s[8:11], s34 offen sc1
    s_nop 4
    v_cvt_pk_bf16_f32 v36, v24, v25
    v_cvt_pk_bf16_f32 v37, v26, v27
    v_cvt_pk_bf16_f32 v38, v28, v29
    v_cvt_pk_bf16_f32 v39, v30, v31
    s_add_u32 s34, s51, 294912
    buffer_store_dwordx4 v[36:39], v5, s[8:11], s34 offen sc1
    s_mov_b32 s61, s50
    s_add_u32 s50, s50, 393216
    s_add_u32 s51, s51, 1310720
    s_add_u32 s52, s52, 1
    s_add_u32 s33, s52, 1
    s_cmp_eq_u32 s58, 0
    s_cbranch_scc1 Lvnf_128
    s_mov_b32 s31, 0
    buffer_load_dwordx4 v[12:15], v8, s[8:11], s56 offen sc1
    s_waitcnt vmcnt(0)
    v_mov_b32 v7, s52
    s_mov_b64 exec, 1
    buffer_store_dword v7, v6, s[8:11], 0 offen sc1
    s_mov_b64 exec, -1
    v_min3_u32 v12, v12, v13, v14
    s_nop 0
    v_readfirstlane_b32 s57, v12
    s_nop 0
    s_cmp_gt_u32 s57, s52
    s_nop 1
    s_cbranch_scc1 Lvok_130
Lvpl_129:
    buffer_load_dwordx4 v[12:15], v8, s[8:11], s56 offen sc1
    s_add_u32 s31, s31, 1
    s_cmp_gt_u32 s31, 400000
    s_cbranch_scc1 L_abort
    s_waitcnt vmcnt(0)
    v_min3_u32 v12, v12, v13, v14
    s_nop 0
    v_readfirstlane_b32 s57, v12
    s_nop 0
    s_cmp_le_u32 s57, s52
    s_nop 1
    s_cbranch_scc1 Lvpl_129
Lvok_130:
    s_mov_b32 s59, s61
    buffer_load_dwordx4 v[96:99], v2, s[8:11], s59 offen offset:0 sc1
    buffer_load_dwordx4 v[100:103], v2, s[8:11], s59 offen offset:1024 sc1
    buffer_load_dwordx4 v[104:107], v2, s[8:11], s59 offen offset:2048 sc1
    buffer_load_dwordx4 v[108:111], v2, s[8:11], s59 offen offset:3072 sc1
    buffer_load_dwordx4 v[112:115], v3, s[8:11], s59 offen offset:0 sc1
    buffer_load_dwordx4 v[116:119], v3, s[8:11], s59 offen offset:1024 sc1
    buffer_load_dwordx4 v[120:123], v3, s[8:11], s59 offen offset:2048 sc1
    buffer_load_dwordx4 v[124:127], v3, s[8:11], s59 offen offset:3072 sc1
    buffer_load_dwordx4 v[128:131], v4, s[8:11], s59 offen offset:0 sc1
    buffer_load_dwordx4 v[132:135], v4, s[8:11], s59 offen offset:1024 sc1
    buffer_load_dwordx4 v[136:139], v4, s[8:11], s59 offen offset:2048 sc1
    buffer_load_dwordx4 v[140:143], v4, s[8:11], s59 offen offset:3072 sc1
    s_waitcnt vmcnt(0)
Lvnf_128:
    s_waitcnt vmcnt(14)
    v_mfma_f32_16x16x32_bf16 v[16:19], v[96:99], a[0:3], 0
    s_waitcnt vmcnt(8)
    v_mfma_f32_16x16x32_bf16 v[20:23], v[120:123], a[0:3], 0
    v_mfma_f32_16x16x32_bf16 v[16:19], v[100:103], a[4:7], v[16:19]
    s_waitcnt vmcnt(7)
    v_mfma_f32_16x16x32_bf16 v[20:23], v[124:127], a[4:7], v[20:23]
    v_mfma_f32_16x16x32_bf16 v[16:19], v[104:107], a[8:11], v[16:19]
    s_waitcnt vmcnt(6)
    v_mfma_f32_16x16x32_bf16 v[20:23], v[128:131], a[8:11], v[20:23]
    v_mfma_f32_16x16x32_bf16 v[16:19], v[108:111], a[12:15], v[16:19]
    s_waitcnt vmcnt(5)
    v_mfma_f32_16x16x32_bf16 v[20:23], v[132:135], a[12:15], v[20:23]
    v_mfma_f32_16x16x32_bf16 v[16:19], v[112:115], a[16:19], v[16:19]
    s_waitcnt vmcnt(4)
    v_mfma_f32_16x16x32_bf16 v[20:23], v[136:139], a[16:19], v[20:23]
    v_mfma_f32_16x16x32_bf16 v[16:19], v[116:119], a[20:23], v[16:19]
    s_waitcnt vmcnt(3)
    v_mfma_f32_16x16x32_bf16 v[20:23], v[140:143], a[20:23], v[20:23]
    v_mfma_f32_16x16x32_bf16 v[24:27], v[96:99], a[24:27], 0
    v_mfma_f32_16x16x32_bf16 v[28:31], v[120:123], a[24:27], 0
    v_mfma_f32_16x16x32_bf16 v[24:27], v[100:103], a[28:31], v[24:27]
    v_mfma_f32_16x16x32_bf16 v[28:31], v[124:127], a[28:31], v[28:31]
    v_mfma_f32_16x16x32_bf16 v[24:27], v[104:107], a[32:35], v[24:27]
    v_mfma_f32_16x16x32_bf16 v[28:31], v[128:131], a[32:35], v[28:31]
    v_mfma_f32_16x16x32_bf16 v[24:27], v[108:111], a[36:39], v[24:27]
    v_mfma_f32_16x16x32_bf16 v[28:31], v[132:135], a[36:39], v[28:31]
    v_cvt_pk_bf16_f32 v32, v16, v17
    v_cvt_pk_bf16_f32 v33, v18, v19
    v_mfma_f32_16x16x32_bf16 v[24:27], v[112:115], a[40:43], v[24:27]
    v_mfma_f32_16x16x32_bf16 v[28:31], v[136:139], a[40:43], v[28:31]
    v_cvt_pk_bf16_f32 v34, v20, v21
    v_cvt_pk_bf16_f32 v35, v22, v23
    v_mfma_f32_16x16x32_bf16 v[24:27], v[116:119], a[44:47], v[24:27]
    v_mfma_f32_16x16x32_bf16 v[28:31], v[140:143], a[44:47], v[28:31]
    s_add_u32 s34, s51, 0
    buffer_store_dwordx4 v[32:35], v5, s[8:11], s34 offen sc1
    v_mfma_f32_16x16x32_bf16 v[16:19], v[96:99], a[48:51], 0
    v_mfma_f32_16x16x32_bf16 v[20:23], v[120:123], a[48:51], 0
    buffer_load_dwordx4 v[12:15], v8, s[8:11], s56 offen sc1
    v_mfma_f32_16x16x32_bf16 v[16:19], v[100:103], a[52:55], v[16:19]
    v_mfma_f32_16x16x32_bf16 v[20:23], v[124:127], a[52:55], v[20:23]
    v_mfma_f32_16x16x32_bf16 v[16:19], v[104:107], a[56:59], v[16:19]
    v_mfma_f32_16x16x32_bf16 v[20:23], v[128:131], a[56:59], v[20:23]
    v_mfma_f32_16x16x32_bf16 v[16:19], v[108:111], a[60:63], v[16:19]
    v_mfma_f32_16x16x32_bf16 v[20:23], v[132:135], a[60:63], v[20:23]
    v_cvt_pk_bf16_f32 v36, v24, v25
    v_cvt_pk_bf16_f32 v37, v26, v27
    v_mfma_f32_16x16x32_bf16 v[16:19], v[112:115], a[64:67], v[16:19]
    v_mfma_f32_16x16x32_bf16 v[20:23], v[136:139], a[64:67], v[20:23]
    v_cvt_pk_bf16_f32 v38, v28, v29
    v_cvt_pk_bf16_f32 v39, v30, v31
    v_mfma_f32_16x16x32_bf16 v[16:19], v[116:119], a[68:71], v[16:19]
    v_mfma_f32_16x16x32_bf16 v[20:23], v[140:143], a[68:71], v[20:23]
    s_add_u32 s34, s51, 32768
    buffer_store_dwordx4 v[36:39], v5, s[8:11], s34 offen sc1
    v_mfma_f32_16x16x32_bf16 v[24:27], v[96:99], a[72:75], 0
    v_mfma_f32_16x16x32_bf16 v[28:31], v[120:123], a[72:75], 0
    v_mfma_f32_16x16x32_bf16 v[24:27], v[100:103], a[76:79], v[24:27]
    v_mfma_f32_16x16x32_bf16 v[28:31], v[124:127], a[76:79], v[28:31]
    v_mfma_f32_16x16x32_bf16 v[24:27], v[104:107], a[80:83], v[24:27]
    v_mfma_f32_16x16x32_bf16 v[28:31], v[128:131], a[80:83], v[28:31]
    s_waitcnt vmcnt(3)
    v_mov_b32 v7, s52
    s_mov_b64 exec, 1
    buffer_store_dword v7, v6, s[8:11], 0 offen sc1
    s_mov_b64 exec, -1
    v_mfma_f32_16x16x32_bf16 v[24:27], v[108:111], a[84:87], v[24:27]
    v_mfma_f32_16x16x32_bf16 v[28:31], v[132:135], a[84:87], v[28:31]
    v_cvt_pk_bf16_f32 v32, v16, v17
    v_cvt_pk_bf16_f32 v33, v18, v19
    v_mfma_f32_16x16x32_bf16 v[24:27], v[112:115], a[88:91], v[24:27]
    v_mfma_f32_16x16x32_bf16 v[28:31], v[136:139], a[88:91], v[28:31]
    v_cvt_pk_bf16_f32 v34, v20, v21
    v_cvt_pk_bf16_f32 v35, v22, v23
    v_mfma_f32_16x16x32_bf16 v[24:27], v[116:119], a[92:95], v[24:27]
    v_mfma_f32_16x16x32_bf16 v[28:31], v[140:143], a[92:95], v[28:31]
    s_add_u32 s34, s51, 65536
    buffer_store_dwordx4 v[32:35], v5, s[8:11], s34 offen sc1
    v_mfma_f32_16x16x32_bf16 v[16:19], v[96:99], a[96:99], 0
    v_mfma_f32_16x16x32_bf16 v[20:23], v[120:123], a[96:99], 0
    v_mfma_f32_16x16x32_bf16 v[16:19], v[100:103], a[100:103], v[16:19]
    v_mfma_f32_16x16x32_bf16 v[20:23], v[124:127], a[100:103], v[20:23]
    s_waitcnt vmcnt(3)
    v_min3_u32 v12, v12, v13, v14
    s_nop 0
    v_readfirstlane_b32 s57, v12
    s_add_u32 s30, s52, 1
    s_cmp_le_u32 s57, s30
    s_cselect_b32 s58, 1, 0
    s_cselect_b32 s59, 2146435072, s50
    s_cmp_ge_u32 s30, 64
    s_cselect_b32 s58, 0, s58
    v_mfma_f32_16x16x32_bf16 v[16:19], v[104:107], a[104:107], v[16:19]
    v_mfma_f32_16x16x32_bf16 v[20:23], v[128:131], a[104:107], v[20:23]
    buffer_load_dwordx4 v[48:51], v2, s[8:11], s59 offen offset:0 sc1
    v_mfma_f32_16x16x32_bf16 v[16:19], v[108:111], a[108:111], v[16:19]
    v_mfma_f32_16x16x32_bf16 v[20:23], v[132:135], a[108:111], v[20:23]
    v_cvt_pk_bf16_f32 v36, v24, v25
    v_cvt_pk_bf16_f32 v37, v26, v27
    v_mfma_f32_16x16x32_bf16 v[16:19], v[112:115], a[112:115], v[16:19]
    v_mfma_f32_16x16x32_bf16 v[20:23], v[136:139], a[112:115], v[20:23]
    v_cvt_pk_bf16_f32 v38, v28, v29
    v_cvt_pk_bf16_f32 v39, v30, v31
    buffer_load_dwordx4 v[52:55], v2, s[8:11], s59 offen offset:1024 sc1
    v_mfma_f32_16x16x32_bf16 v[16:19], v[116:119], a[116:119], v[16:19]
    v_mfma_f32_16x16x32_bf16 v[20:23], v[140:143], a[116:119], v[20:23]
    s_add_u32 s34, s51, 98304
    buffer_store_dwordx4 v[36:39], v5, s[8:11], s34 offen sc1
    v_mfma_f32_16x16x32_bf16 v[24:27], v[96:99], a[120:123], 0
    v_mfma_f32_16x16x32_bf16 v[28:31], v[120:123], a[120:123], 0
    buffer_load_dwordx4 v[56:59], v2, s[8:11], s59 offen offset:2048 sc1
    v_mfma_f32_16x16x32_bf16 v[24:27], v[100:103], a[124:127], v[24:27]
    v_mfma_f32_16x16x32_bf16 v[28:31], v[124:127], a[124:127], v[28:31]
    v_mfma_f32_16x16x32_bf16 v[24:27], v[104:107], a[128:131], v[24:27]
    v_mfma_f32_16x16x32_bf16 v[28:31], v[128:131], a[128:131], v[28:31]
    buffer_load_dwordx4 v[60:63], v2, s[8:11], s59 offen offset:3072 sc1
    v_mfma_f32_16x16x32_bf16 v[24:27], v[108:111], a[132:135], v[24:27]
    v_mfma_f32_16x16x32_bf16 v[28:31], v[132:135], a[132:135], v[28:31]
    v_cvt_pk_bf16_f32 v32, v16, v17
    v_cvt_pk_bf16_f32 v33, v18, v19
    v_mfma_f32_16x16x32_bf16 v[24:27], v[112:115], a[136:139], v[24:27]
    v_mfma_f32_16x16x32_bf16 v[28:31], v[136:139], a[136:139], v[28:31]
    v_cvt_pk_bf16_f32 v34, v20, v21
    v_cvt_pk_bf16_f32 v35, v22, v23
    buffer_load_dwordx4 v[64:67], v3, s[8:11], s59 offen offset:0 sc1
    v_mfma_f32_16x16x32_bf16 v[24:27], v[116:119], a[140:143], v[24:27]
    v_mfma_f32_16x16x32_bf16 v[28:31], v[140:143], a[140:143], v[28:31]
    s_add_u32 s34, s51, 131072
    buffer_store_dwordx4 v[32:35], v5, s[8:11], s34 offen sc1
    v_mfma_f32_16x16x32_bf16 v[16:19], v[96:99], a[144:147], 0
    v_mfma_f32_16x16x32_bf16 v[20:23], v[120:123], a[144:147], 0
    buffer_load_dwordx4 v[68:71], v3, s[8:11], s59 offen offset:1024 sc1
    v_mfma_f32_16x16x32_bf16 v[16:19], v[100:103], a[148:151], v[16:19]
    v_mfma_f32_16x16x32_bf16 v[20:23], v[124:127], a[148:151], v[20:23]
    v_mfma_f32_16x16x32_bf16 v[16:19], v[104:107], a[152:155], v[16:19]
    v_mfma_f32_16x16x32_bf16 v[20:23], v[128:131], a[152:155], v[20:23]
    buffer_load_dwordx4 v[72:75], v3, s[8:11], s59 offen offset:2048 sc1
    v_mfma_f32_16x16x32_bf16 v[16:19], v[108:111], a[156:159], v[16:19]
    v_mfma_f32_16x16x32_bf16 v[20:23], v[132:135], a[156:159], v[20:23]
    v_cvt_pk_bf16_f32 v36, v24, v25
    v_cvt_pk_bf16_f32 v37, v26, v27
    v_mfma_f32_16x16x32_bf16 v[16:19], v[112:115], a[160:163], v[16:19]
    v_mfma_f32_16x16x32_bf16 v[20:23], v[136:139], a[160:163], v[20:23]
    v_cvt_pk_bf16_f32 v38, v28, v29
    v_cvt_pk_bf16_f32 v39, v30, v31
    buffer_load_dwordx4 v[76:79], v3, s[8:11], s59 offen offset:3072 sc1
    v_mfma_f32_16x16x32_bf16 v[16:19], v[116:119], a[164:167], v[16:19]
    v_mfma_f32_16x16x32_bf16 v[20:23], v[140:143], a[164:167], v[20:23]
    s_add_u32 s34, s51, 163840
    buffer_store_dwordx4 v[36:39], v5, s[8:11], s34 offen sc1
    v_mfma_f32_16x16x32_bf16 v[24:27], v[96:99], a[168:171], 0
    v_mfma_f32_16x16x32_bf16 v[28:31], v[120:123], a[168:171], 0
    buffer_load_dwordx4 v[80:83], v4, s[8:11], s59 offen offset:0 sc1
    v_mfma_f32_16x16x32_bf16 v[24:27], v[100:103], a[172:175], v[24:27]
    v_mfma_f32_16x16x32_bf16 v[28:31], v[124:127], a[172:175], v[28:31]
    v_mfma_f32_16x16x32_bf16 v[24:27], v[104:107], a[176:179], v[24:27]
    v_mfma_f32_16x16x32_bf16 v[28:31], v[128:131], a[176:179], v[28:31]
    buffer_load_dwordx4 v[84:87], v4, s[8:11], s59 offen offset:1024 sc1
    v_mfma_f32_16x16x32_bf16 v[24:27], v[108:111], a[180:183], v[24:27]
    v_mfma_f32_16x16x32_bf16 v[28:31], v[132:135], a[180:183], v[28:31]
    v_cvt_pk_bf16_f32 v32, v16, v17
    v_cvt_pk_bf16_f32 v33, v18, v19
    v_mfma_f32_16x16x32_bf16 v[24:27], v[112:115], a[184:187], v[24:27]
    v_mfma_f32_16x16x32_bf16 v[28:31], v[136:139], a[184:187], v[28:31]
    v_cvt_pk_bf16_f32 v34, v20, v21
    v_cvt_pk_bf16_f32 v35, v22, v23
    buffer_load_dwordx4 v[88:91], v4, s[8:11], s59 offen offset:2048 sc1
    v_mfma_f32_16x16x32_bf16 v[24:27], v[116:119], a[188:191], v[24:27]
    v_mfma_f32_16x16x32_bf16 v[28:31], v[140:143], a[188:191], v[28:31]
    s_add_u32 s34, s51, 196608
    buffer_store_dwordx4 v[32:35], v5, s[8:11], s34 offen sc1
    v_mfma_f32_16x16x32_bf16 v[16:19], v[96:99], a[192:195], 0
    v_mfma_f32_16x16x32_bf16 v[20:23], v[120:123], a[192:195], 0
    buffer_load_dwordx4 v[92:95], v4, s[8:11], s59 offen offset:3072 sc1
    v_mfma_f32_16x16x32_bf16 v[16:19], v[100:103], a[196:199], v[16:19]
    v_mfma_f32_16x16x32_bf16 v[20:23], v[124:127], a[196:199], v[20:23]
    v_mfma_f32_16x16x32_bf16 v[16:19], v[104:107], a[200:203], v[16:19]
    v_mfma_f32_16x16x32_bf16 v[20:23], v[128:131], a[200:203], v[20:23]
    v_mfma_f32_16x16x32_bf16 v[16:19], v[108:111], a[204:207], v[16:19]
    v_mfma_f32_16x16x32_bf16 v[20:23], v[132:135], a[204:207], v[20:23]
    v_cvt_pk_bf16_f32 v36, v24, v25
    v_cvt_pk_bf16_f32 v37, v26, v27
    v_mfma_f32_16x16x32_bf16 v[16:19], v[112:115], a[208:211], v[16:19]
    v_mfma_f32_16x16x32_bf16 v[20:23], v[136:139], a[208:211], v[20:23]
    v_cvt_pk_bf16_f32 v38, v28, v29
    v_cvt_pk_bf16_f32 v39, v30, v31
    v_mfma_f32_16x16x32_bf16 v[16:19], v[116:119], a[212:215], v[16:19]
    v_mfma_f32_16x16x32_bf16 v[20:23], v[140:143], a[212:215], v[20:23]
    s_add_u32 s34, s51, 229376
    buffer_store_dwordx4 v[36:39], v5, s[8:11], s34 offen sc1
    v_mfma_f32_16x16x32_bf16 v[24:27], v[96:99], a[216:219], 0
    v_mfma_f32_16x16x32_bf16 v[28:31], v[120:123], a[216:219], 0
    v_mfma_f32_16x16x32_bf16 v[24:27], v[100:103], a[220:223], v[24:27]
    v_mfma_f32_16x16x32_bf16 v[28:31], v[124:127], a[220:223], v[28:31]
    v_mfma_f32_16x16x32_bf16 v[24:27], v[104:107], a[224:227], v[24:27]
    v_mfma_f32_16x16x32_bf16 v[28:31], v[128:131], a[224:227], v[28:31]
    v_mfma_f32_16x16x32_bf16 v[24:27], v[108:111], a[228:231], v[24:27]
    v_mfma_f32_16x16x32_bf16 v[28:31], v[132:135], a[228:231], v[28:31]
    v_cvt_pk_bf16_f32 v32, v16, v17
    v_cvt_pk_bf16_f32 v33, v18, v19
    v_mfma_f32_16x16x32_bf16 v[24:27], v[112:115], a[232:235], v[24:27]
    v_mfma_f32_16x16x32_bf16 v[28:31], v[136:139], a[232:235], v[28:31]
    v_cvt_pk_bf16_f32 v34, v20, v21
    v_cvt_pk_bf16_f32 v35, v22, v23
    v_mfma_f32_16x16x32_bf16 v[24:27], v[116:119], a[236:239], v[24:27]
    v_mfma_f32_16x16x32_bf16 v[28:31], v[140:143], a[236:239], v[28:31]
    s_add_u32 s34, s51, 262144
    buffer_store_dwordx4 v[32:35], v5, s[8:11], s34 offen sc1
    s_nop 4
    v_cvt_pk_bf16_f32 v36, v24, v25
    v_cvt_pk_bf16_f32 v37, v26, v27
    v_cvt_pk_bf16_f32 v38, v28, v29
    v_cvt_pk_bf16_f32 v39, v30, v31
    s_add_u32 s34, s51, 294912
    buffer_store_dwordx4 v[36:39], v5, s[8:11], s34 offen sc1
    s_mov_b32 s61, s50
    s_add_u32 s50, s50, 393216
    s_add_u32 s51, s51, 1310720
    s_add_u32 s52, s52, 1
    s_add_u32 s33, s52, 1
    s_cmp_eq_u32 s58, 0
    s_cbranch_scc1 Lvnf_131
    s_mov_b32 s31, 0
    buffer_load_dwordx4 v[12:15], v8, s[8:11], s56 offen sc1
    s_waitcnt vmcnt(0)
    v_mov_b32 v7, s52
    s_mov_b64 exec, 1
    buffer_store_dword v7, v6, s[8:11], 0 offen sc1
    s_mov_b64 exec, -1
    v_min3_u32 v12, v12, v13, v14
    s_nop 0
    v_readfirstlane_b32 s57, v12
    s_nop 0
    s_cmp_gt_u32 s57, s52
    s_nop 1
    s_cbranch_scc1 Lvok_133
Lvpl_132:
    buffer_load_dwordx4 v[12:15], v8, s[8:11], s56 offen sc1
    s_add_u32 s31, s31, 1
    s_cmp_gt_u32 s31, 400000
    s_cbranch_scc1 L_abort
    s_waitcnt vmcnt(0)
    v_min3_u32 v12, v12, v13, v14
    s_nop 0
    v_readfirstlane_b32 s57, v12
    s_nop 0
    s_cmp_le_u32 s57, s52
    s_nop 1
    s_cbranch_scc1 Lvpl_132
Lvok_133:
    s_mov_b32 s59, s61
    buffer_load_dwordx4 v[48:51], v2, s[8:11], s59 offen offset:0 sc1
    buffer_load_dwordx4 v[52:55], v2, s[8:11], s59 offen offset:1024 sc1
    buffer_load_dwordx4 v[56:59], v2, s[8:11], s59 offen offset:2048 sc1
    buffer_load_dwordx4 v[60:63], v2, s[8:11], s59 offen offset:3072 sc1
    buffer_load_dwordx4 v[64:67], v3, s[8:11], s59 offen offset:0 sc1
    buffer_load_dwordx4 v[68:71], v3, s[8:11], s59 offen offset:1024 sc1
    buffer_load_dwordx4 v[72:75], v3, s[8:11], s59 offen offset:2048 sc1
    buffer_load_dwordx4 v[76:79], v3, s[8:11], s59 offen offset:3072 sc1
    buffer_load_dwordx4 v[80:83], v4, s[8:11], s59 offen offset:0 sc1
    buffer_load_dwordx4 v[84:87], v4, s[8:11], s59 offen offset:1024 sc1
    buffer_load_dwordx4 v[88:91], v4, s[8:11], s59 offen offset:2048 sc1
    buffer_load_dwordx4 v[92:95], v4, s[8:11], s59 offen offset:3072 sc1
    s_waitcnt vmcnt(0)
Lvnf_131:
    s_cmp_lt_u32 s52, 64
    s_cbranch_scc1 L_vo_loop
    s_waitcnt vmcnt(0)
    v_mov_b32 v7, s52
    s_mov_b64 exec, 1
    buffer_store_dword v7, v6, s[8:11], 0 offen sc1
    s_mov_b64 exec, -1
    s_barrier
    s_branch L_xc
L_role_sp:
    v_mov_b32 v8, 0
    v_lshlrev_b32 v9, 2, v1
    s_lshl_b32 s30, s2, 7
    s_add_u32 s30, s30, 246415360
    s_mov_b64 exec, 0xffffffff
    buffer_store_dword v8, v9, s[8:11], s30 offen sc1
    s_mov_b64 exec, -1
    s_waitcnt vmcnt(0)
    s_barrier
    s_cmp_eq_u32 s3, 0
    s_cselect_b32 s30, 0, 2146435072
    v_mov_b32 v8, 0
    v_mov_b32 v9, 1
    s_mov_b64 exec, 1
    buffer_atomic_add v9, v8, s[24:27], s30 offen sc1
    s_mov_b64 exec, -1
    s_lshl_b32 s30, s2, 2
    s_add_u32 s30, s30, s3
    s_cmp_lg_u32 s30, 416
    s_cbranch_scc1 L_nogo
    v_mov_b32 v9, 0
    s_mov_b32 s31, 0
    s_nop 0
Lrg_134:
    buffer_load_dword v8, v9, s[24:27], 0 offen offset:0 sc1
    s_add_u32 s31, s31, 1
    s_cmp_gt_u32 s31, 400000
    s_cbranch_scc1 L_abort
    s_sleep 4
    s_waitcnt vmcnt(0)
    v_readfirstlane_b32 s30, v8
    s_nop 0
    s_cmp_lt_u32 s30, 256
    s_nop 1
    s_cbranch_scc1 Lrg_134
    v_mov_b32 v8, 1
    v_mov_b32 v9, 0
    s_mov_b64 exec, 1
    buffer_store_dword v8, v9, s[24:27], 0 offen offset:192 sc1
    s_mov_b64 exec, -1
    s_waitcnt vmcnt(0)
    v_mov_b32 v9, 0
    s_mov_b32 s31, 0
    s_nop 0
Lrg_135:
    buffer_load_dword v8, v9, s[24:27], 0 offen offset:12 sc1
    s_add_u32 s31, s31, 1
    s_cmp_gt_u32 s31, 400000
    s_cbranch_scc1 L_abort
    s_sleep 4
    s_waitcnt vmcnt(0)
    v_readfirstlane_b32 s30, v8
    s_nop 0
    s_cmp_lt_u32 s30, 32
    s_nop 1
    s_cbranch_scc1 Lrg_135
    v_and_b32 v8, 31, v1
    v_lshlrev_b32 v8, 5, v8
    s_mov_b32 s30, 246480896
    buffer_load_dwordx4 v[16:19], v8, s[8:11], s30 offen sc1
    buffer_load_dwordx4 v[20:23], v8, s[8:11], s30 offen offset:16 sc1
    s_waitcnt vmcnt(0)
    v_min3_u32 v24, v16, v18, v20
    v_min3_u32 v25, v17, v19, v21
    v_min_u32 v24, v24, v22
    v_min_u32 v25, v25, v23
    v_cmp_lt_u32 s[40:41], v25, v24
    v_min_u32 v26, v24, v25
    v_max_u32 v27, v24, v25
    v_mul_u32_u24 v28, 5, v26
    v_lshlrev_b32 v27, 2, v27
    v_cmp_lt_u32 s[42:43], v28, v27
    v_cmp_gt_u32 vcc, 760, v26
    s_nop 0
    s_and_b32 s42, s42, vcc_lo
    s_xor_b32 s31, s40, 0xaaaaaaaa
    s_and_b32 s31, s31, s42
    s_bcnt1_i32_b32 s31, s31
    s_lshl_b32 s31, s31, 1
    s_bcnt1_i32_b32 s32, s42
    s_cmp_gt_u32 s31, s32
    s_mov_b32 s31, 0xaaaaaaaa
    s_cselect_b32 s31, 0x55555555, s31
    s_and_b32 s40, s40, s42
    s_andn2_b32 s31, s31, s42
    s_or_b32 s40, s40, s31
    s_mov_b32 s41, s40
    s_mov_b32 s33, 700
    v_cndmask_b32 v16, v16, v17, s[40:41]
    v_min_u32 v16, s33, v16
    v_cndmask_b32 v17, v18, v19, s[40:41]
    v_min_u32 v17, s33, v17
    v_cndmask_b32 v18, v20, v21, s[40:41]
    v_min_u32 v18, s33, v18
    v_cndmask_b32 v19, v22, v23, s[40:41]
    v_min_u32 v19, s33, v19
    v_sub_u32 v20, v16, v19
    v_sub_u32 v21, v18, v17
    v_add_u32 v22, v20, v21
    v_sub_u32 v23, v20, v21
    s_nop 0
    v_add_u32_dpp v22, v22, v22 row_ror:8 row_mask:0xf bank_mask:0xf
    v_add_u32_dpp v23, v23, v23 row_ror:8 row_mask:0xf bank_mask:0xf
    s_nop 0
    v_add_u32_dpp v22, v22, v22 row_ror:4 row_mask:0xf bank_mask:0xf
    v_add_u32_dpp v23, v23, v23 row_ror:4 row_mask:0xf bank_mask:0xf
    s_nop 0
    v_add_u32_dpp v22, v22, v22 row_ror:2 row_mask:0xf bank_mask:0xf
    v_add_u32_dpp v23, v23, v23 row_ror:2 row_mask:0xf bank_mask:0xf
    s_nop 0
    v_add_u32_dpp v22, v22, v22 row_ror:1 row_mask:0xf bank_mask:0xf
    v_add_u32_dpp v23, v23, v23 row_ror:1 row_mask:0xf bank_mask:0xf
    v_readlane_b32 s30, v22, 0
    v_readlane_b32 s31, v22, 16
    v_readlane_b32 s32, v23, 0
    v_readlane_b32 s33, v23, 16
    v_mov_b32 v24, s30
    v_mov_b32 v25, s31
    v_mov_b32 v26, s32
    v_mov_b32 v27, s33
    s_add_i32 s30, s30, s31
    s_add_i32 s32, s32, s33
    s_cmp_gt_i32 s30, 0
    s_cselect_b32 s42, -1, 0
    s_cmp_gt_i32 s32, 0
    s_cselect_b32 s43, -1, 0
    v_mov_b32 v16, s40
    v_mov_b32 v17, s42
    v_mov_b32 v18, s43
    v_mov_b32 v9, 0
    s_mov_b64 exec, 1
    buffer_store_dwordx3 v[16:18], v9, s[24:27], 0 offen offset:196 sc1
    s_mov_b64 exec, -1
    s_waitcnt vmcnt(0)
    v_mov_b32 v8, 2
    v_mov_b32 v9, 0
    s_mov_b64 exec, 1
    buffer_store_dword v8, v9, s[24:27], 0 offen offset:192 sc1
    s_mov_b64 exec, -1
    s_waitcnt vmcnt(0)
    s_and_b32 s50, s40, 31
    s_and_b32 s51, s42, 31
    s_and_b32 s52, s43, 31
    v_mov_b32 v9, 0
    s_mov_b32 s31, 0
    s_nop 0
Lrg_136:
    buffer_load_dword v8, v9, s[24:27], 0 offen offset:24 sc1
    s_add_u32 s31, s31, 1
    s_cmp_gt_u32 s31, 400000
    s_cbranch_scc1 L_abort
    s_sleep 4
    s_waitcnt vmcnt(0)
    v_readfirstlane_b32 s30, v8
    s_nop 0
    s_cmp_lt_u32 s30, 32
    s_nop 1
    s_cbranch_scc1 Lrg_136
    v_and_b32 v8, 31, v1
    v_lshlrev_b32 v8, 5, v8
    s_mov_b32 s30, 246481920
    buffer_load_dwordx4 v[16:19], v8, s[8:11], s30 offen sc1
    buffer_load_dwordx4 v[20:23], v8, s[8:11], s30 offen offset:16 sc1
    s_waitcnt vmcnt(0)
    v_min3_u32 v24, v16, v18, v20
    v_min3_u32 v25, v17, v19, v21
    v_min_u32 v24, v24, v22
    v_min_u32 v25, v25, v23
    v_cmp_lt_u32 s[40:41], v25, v24
    v_min_u32 v26, v24, v25
    v_max_u32 v27, v24, v25
    v_mul_u32_u24 v28, 5, v26
    v_lshlrev_b32 v27, 2, v27
    v_cmp_lt_u32 s[42:43], v28, v27
    v_cmp_gt_u32 vcc, 760, v26
    s_nop 0
    s_and_b32 s42, s42, vcc_lo
    s_xor_b32 s31, s40, 0xaaaaaaaa
    s_and_b32 s31, s31, s42
    s_bcnt1_i32_b32 s31, s31
    s_lshl_b32 s31, s31, 1
    s_bcnt1_i32_b32 s32, s42
    s_cmp_gt_u32 s31, s32
    s_mov_b32 s31, 0xaaaaaaaa
    s_cselect_b32 s31, 0x55555555, s31
    s_and_b32 s40, s40, s42
    s_andn2_b32 s31, s31, s42
    s_or_b32 s40, s40, s31
    s_mov_b32 s41, s40
    s_mov_b32 s33, 700
    v_cndmask_b32 v16, v16, v17, s[40:41]
    v_min_u32 v16, s33, v16
    v_cndmask_b32 v17, v18, v19, s[40:41]
    v_min_u32 v17, s33, v17
    v_cndmask_b32 v18, v20, v21, s[40:41]
    v_min_u32 v18, s33, v18
    v_cndmask_b32 v19, v22, v23, s[40:41]
    v_min_u32 v19, s33, v19
    v_sub_u32 v20, v16, v19
    v_sub_u32 v21, v18, v17
    v_add_u32 v22, v20, v21
    v_sub_u32 v23, v20, v21
    s_nop 0
    v_add_u32_dpp v22, v22, v22 row_ror:8 row_mask:0xf bank_mask:0xf
    v_add_u32_dpp v23, v23, v23 row_ror:8 row_mask:0xf bank_mask:0xf
    s_nop 0
    v_add_u32_dpp v22, v22, v22 row_ror:4 row_mask:0xf bank_mask:0xf
    v_add_u32_dpp v23, v23, v23 row_ror:4 row_mask:0xf bank_mask:0xf
    s_nop 0
    v_add_u32_dpp v22, v22, v22 row_ror:2 row_mask:0xf bank_mask:0xf
    v_add_u32_dpp v23, v23, v23 row_ror:2 row_mask:0xf bank_mask:0xf
    s_nop 0
    v_add_u32_dpp v22, v22, v22 row_ror:1 row_mask:0xf bank_mask:0xf
    v_add_u32_dpp v23, v23, v23 row_ror:1 row_mask:0xf bank_mask:0xf
    v_readlane_b32 s30, v22, 0
    v_readlane_b32 s31, v22, 16
    v_readlane_b32 s32, v23, 0
    v_readlane_b32 s33, v23, 16
    v_mov_b32 v24, s30
    v_mov_b32 v25, s31
    v_mov_b32 v26, s32
    v_mov_b32 v27, s33
    s_add_i32 s30, s30, s31
    s_add_i32 s32, s32, s33
    s_cmp_gt_i32 s30, 0
    s_cselect_b32 s42, -1, 0
    s_cmp_gt_i32 s32, 0
    s_cselect_b32 s43, -1, 0
    s_andn2_b32 s40, s40, 31
    s_or_b32 s40, s40, s50
    s_andn2_b32 s42, s42, 31
    s_or_b32 s42, s42, s51
    s_andn2_b32 s43, s43, 31
    s_or_b32 s43, s43, s52
    v_mov_b32 v16, s40
    v_mov_b32 v17, s42
    v_mov_b32 v18, s43
    v_mov_b32 v9, 0
    s_mov_b64 exec, 1
    buffer_store_dwordx3 v[16:18], v9, s[24:27], 0 offen offset:208 sc1
    s_mov_b64 exec, -1
    s_waitcnt vmcnt(0)
    v_mov_b32 v8, 3
    v_mov_b32 v9, 0
    s_mov_b64 exec, 1
    buffer_store_dword v8, v9, s[24:27], 0 offen offset:192 sc1
    s_mov_b64 exec, -1
    s_waitcnt vmcnt(0)
L_nogo:
    s_sub_u32 s30, s2, 112
    s_cmp_ge_u32 s30, 16
    s_cbranch_scc1 L_noprobe
    s_mov_b32 s31, 0
Lwa_137:
    v_lshlrev_b32 v9, 2, v1
    buffer_load_dword v8, v9, s[24:27], 0 offen offset:192 sc1
    s_add_u32 s31, s31, 1
    s_cmp_gt_u32 s31, 400000
    s_cbranch_scc1 L_abort
    s_sleep 2
    s_waitcnt vmcnt(0)
    v_readfirstlane_b32 s30, v8
    s_nop 0
    s_cmp_lt_u32 s30, 1
    s_nop 1
    s_cbranch_scc1 Lwa_137
    s_and_b32 s30, s2, 31
    s_lshl_b32 s30, s30, 7
    s_add_u32 s30, s30, 246415360
    v_mov_b32 v9, s30
    s_mov_b32 s31, 0
    s_nop 0
Lacs_139:
    buffer_load_dword v8, v9, s[8:11], 0 offen sc1
    s_add_u32 s31, s31, 1
    s_cmp_gt_u32 s31, 400000
    s_cbranch_scc1 L_abort
    s_sleep 8
    s_waitcnt vmcnt(0)
    v_readfirstlane_b32 s30, v8
    s_nop 0
    s_cmp_eq_u32 s30, 0
    s_nop 1
    s_cbranch_scc1 Lacs_139
    s_sub_u32 s4, s2, 112
    s_lshr_b32 s76, s4, 2
    s_xor_b32 s76, s76, s3
    s_and_b32 s76, s76, 3
    s_xor_b32 s32, s4, s76
    s_mov_b32 s30, 31
    s_lshr_b32 s31, s30, 3
    s_xor_b32 s31, s31, s32
    s_lshl_b32 s64, s30, 16
    s_bitcmp1_b32 s31, 0
    s_cselect_b32 s30, 16384, 0
    s_add_u32 s64, s64, s30
    s_bitcmp1_b32 s31, 1
    s_cselect_b32 s30, 4096, 0
    s_add_u32 s64, s64, s30
    s_and_b32 s30, s4, 31
    s_lshl_b32 s30, s30, 21
    s_add_u32 s64, s64, s30
    s_add_u32 s65, s64, 8192
    v_mov_b32 v8, 0
    s_mov_b64 exec, 1
    buffer_atomic_add v8, v8, s[8:11], s64 offen sc1
    buffer_atomic_add v8, v8, s[8:11], s65 offen sc1
    s_mov_b64 exec, -1
    s_cmp_ge_u32 s4, 32
    s_cbranch_scc1 Lcal_140
    s_mov_b32 s66, -1
    s_mov_b32 s67, -1
    s_mov_b32 s68, 0
    v_mov_b32 v8, 0
    s_mov_b64 exec, 1
    s_waitcnt vmcnt(0)
Lcalp_141:
    v_mov_b32 v9, 0
    s_memtime s[70:71]
    s_waitcnt lgkmcnt(0)
    buffer_atomic_add v9, v8, s[8:11], s64 offen sc0 sc1
    s_waitcnt vmcnt(0)
    s_memtime s[72:73]
    s_waitcnt lgkmcnt(0)
    s_sub_u32 s70, s72, s70
    s_min_u32 s66, s66, s70
    v_mov_b32 v9, 0
    s_memtime s[70:71]
    s_waitcnt lgkmcnt(0)
    buffer_atomic_add v9, v8, s[8:11], s65 offen sc0 sc1
    s_waitcnt vmcnt(0)
    s_memtime s[72:73]
    s_waitcnt lgkmcnt(0)
    s_sub_u32 s70, s72, s70
    s_min_u32 s67, s67, s70
    s_add_u32 s68, s68, 1
    s_cmp_lt_u32 s68, 4
    s_cbranch_scc1 Lcalp_141
    s_lshl_b32 s30, s4, 5
    s_lshl_b32 s31, s76, 3
    s_add_u32 s30, s30, s31
    s_add_u32 s30, s30, 246481920
    v_mov_b32 v10, s66
    v_mov_b32 v11, s67
    buffer_store_dwordx2 v[10:11], v8, s[8:11], s30 offen sc1
    s_mov_b64 exec, -1
    s_waitcnt vmcnt(0)
    s_barrier
    s_cmp_eq_u32 s3, 0
    s_cselect_b32 s30, 0, 2146435072
    v_mov_b32 v8, 24
    v_mov_b32 v9, 1
    s_mov_b64 exec, 1
    buffer_atomic_add v9, v8, s[24:27], s30 offen sc1
    s_mov_b64 exec, -1
Lcal_140:
    s_sub_u32 s4, s2, 96
    s_lshr_b32 s76, s4, 2
    s_xor_b32 s76, s76, s3
    s_and_b32 s76, s76, 3
    s_xor_b32 s32, s4, s76
    s_mov_b32 s30, 31
    s_lshr_b32 s31, s30, 3
    s_xor_b32 s31, s31, s32
    s_lshl_b32 s64, s30, 16
    s_bitcmp1_b32 s31, 0
    s_cselect_b32 s30, 16384, 0
    s_add_u32 s64, s64, s30
    s_bitcmp1_b32 s31, 1
    s_cselect_b32 s30, 4096, 0
    s_add_u32 s64, s64, s30
    s_and_b32 s30, s4, 31
    s_lshl_b32 s30, s30, 21
    s_add_u32 s64, s64, s30
    s_add_u32 s65, s64, 8192
    v_mov_b32 v8, 0
    s_mov_b64 exec, 1
    buffer_atomic_add v8, v8, s[8:11], s64 offen sc1
    buffer_atomic_add v8, v8, s[8:11], s65 offen sc1
    s_mov_b64 exec, -1
    s_cmp_ge_u32 s4, 32
    s_cbranch_scc1 Lcal_142
    s_mov_b32 s66, -1
    s_mov_b32 s67, -1
    s_mov_b32 s68, 0
    v_mov_b32 v8, 0
    s_mov_b64 exec, 1
    s_waitcnt vmcnt(0)
Lcalp_143:
    v_mov_b32 v9, 0
    s_memtime s[70:71]
    s_waitcnt lgkmcnt(0)
    buffer_atomic_add v9, v8, s[8:11], s64 offen sc0 sc1
    s_waitcnt vmcnt(0)
    s_memtime s[72:73]
    s_waitcnt lgkmcnt(0)
    s_sub_u32 s70, s72, s70
    s_min_u32 s66, s66, s70
    v_mov_b32 v9, 0
    s_memtime s[70:71]
    s_waitcnt lgkmcnt(0)
    buffer_atomic_add v9, v8, s[8:11], s65 offen sc0 sc1
    s_waitcnt vmcnt(0)
    s_memtime s[72:73]
    s_waitcnt lgkmcnt(0)
    s_sub_u32 s70, s72, s70
    s_min_u32 s67, s67, s70
    s_add_u32 s68, s68, 1
    s_cmp_lt_u32 s68, 4
    s_cbranch_scc1 Lcalp_143
    s_lshl_b32 s30, s4, 5
    s_lshl_b32 s31, s76, 3
    s_add_u32 s30, s30, s31
    s_add_u32 s30, s30, 246481920
    v_mov_b32 v10, s66
    v_mov_b32 v11, s67
    buffer_store_dwordx2 v[10:11], v8, s[8:11], s30 offen sc1
    s_mov_b64 exec, -1
    s_waitcnt vmcnt(0)
    s_barrier
    s_cmp_eq_u32 s3, 0
    s_cselect_b32 s30, 0, 2146435072
    v_mov_b32 v8, 24
    v_mov_b32 v9, 1
    s_mov_b64 exec, 1
    buffer_atomic_add v9, v8, s[24:27], s30 offen sc1
    s_mov_b64 exec, -1
Lcal_142:
L_noprobe:
    s_cmp_lt_u32 s2, 128
    s_cbranch_scc1 L_end
    s_cmp_lt_u32 s2, 252
    s_cbranch_scc1 L_xc
    s_load_dwordx2 s[12:13], s[0:1], 0
    s_mov_b32 s14, 2621440
    s_mov_b32 s15, 0x20000
    s_load_dwordx2 s[16:17], s[0:1], 128
    s_mov_b32 s18, 1280
    s_mov_b32 s19, 0x20000
    s_waitcnt lgkmcnt(0)
    v_and_b32 v8, 15, v1
    v_lshlrev_b32 v8, 4, v8
    v_lshrrev_b32 v9, 4, v1
    s_sub_u32 s30, s2, 252
    s_lshl_b32 s30, s30, 2
    s_add_u32 s30, s30, s3
    s_lshl_b32 s30, s30, 7
    v_add_u32 v9, s30, v9
    v_mul_u32_u24 v2, 1280, v9
    v_add_u32 v2, v2, v8
    v_lshlrev_b32 v3, 3, v9
    s_mov_b32 s52, 0
    s_mov_b32 s53, 245366784
    s_mov_b32 s44, 0xffff0000
    buffer_load_dwordx4 v[16:19], v8, s[16:19], 0 offen offset:0
    buffer_load_dwordx4 v[20:23], v8, s[16:19], 0 offen offset:256
    buffer_load_dwordx4 v[24:27], v8, s[16:19], 0 offen offset:512
    buffer_load_dwordx4 v[28:31], v8, s[16:19], 0 offen offset:768
    buffer_load_dwordx4 v[32:35], v8, s[16:19], 0 offen offset:1024
    s_waitcnt vmcnt(4)
    v_lshlrev_b32 v40, 16, v16
    v_and_b32 v41, s44, v16
    v_lshlrev_b32 v42, 16, v17
    v_and_b32 v43, s44, v17
    v_lshlrev_b32 v44, 16, v18
    v_and_b32 v45, s44, v18
    v_lshlrev_b32 v46, 16, v19
    v_and_b32 v47, s44, v19
    s_waitcnt vmcnt(3)
    v_lshlrev_b32 v48, 16, v20
    v_and_b32 v49, s44, v20
    v_lshlrev_b32 v50, 16, v21
    v_and_b32 v51, s44, v21
    v_lshlrev_b32 v52, 16, v22
    v_and_b32 v53, s44, v22
    v_lshlrev_b32 v54, 16, v23
    v_and_b32 v55, s44, v23
    s_waitcnt vmcnt(2)
    v_lshlrev_b32 v56, 16, v24
    v_and_b32 v57, s44, v24
    v_lshlrev_b32 v58, 16, v25
    v_and_b32 v59, s44, v25
    v_lshlrev_b32 v60, 16, v26
    v_and_b32 v61, s44, v26
    v_lshlrev_b32 v62, 16, v27
    v_and_b32 v63, s44, v27
    s_waitcnt vmcnt(1)
    v_lshlrev_b32 v64, 16, v28
    v_and_b32 v65, s44, v28
    v_lshlrev_b32 v66, 16, v29
    v_and_b32 v67, s44, v29
    v_lshlrev_b32 v68, 16, v30
    v_and_b32 v69, s44, v30
    v_lshlrev_b32 v70, 16, v31
    v_and_b32 v71, s44, v31
    s_waitcnt vmcnt(0)
    v_lshlrev_b32 v72, 16, v32
    v_and_b32 v73, s44, v32
    v_lshlrev_b32 v74, 16, v33
    v_and_b32 v75, s44, v33
    v_lshlrev_b32 v76, 16, v34
    v_and_b32 v77, s44, v34
    v_lshlrev_b32 v78, 16, v35
    v_and_b32 v79, s44, v35
    s_lshl_b32 s30, s2, 7
    s_lshl_b32 s31, s3, 2
    s_add_u32 s30, s30, s31
    s_add_u32 s30, s30, 246415360
    v_mov_b32 v4, s30
    buffer_load_dwordx4 v[96:99], v2, s[12:15], s52 offen offset:0
    buffer_load_dwordx4 v[100:103], v2, s[12:15], s52 offen offset:256
    buffer_load_dwordx4 v[104:107], v2, s[12:15], s52 offen offset:512
    buffer_load_dwordx4 v[108:111], v2, s[12:15], s52 offen offset:768
    buffer_load_dwordx4 v[112:115], v2, s[12:15], s52 offen offset:1024
    s_add_u32 s52, s52, 5120
    buffer_load_dwordx4 v[116:119], v2, s[12:15], s52 offen offset:0
    buffer_load_dwordx4 v[120:123], v2, s[12:15], s52 offen offset:256
    buffer_load_dwordx4 v[124:127], v2, s[12:15], s52 offen offset:512
    buffer_load_dwordx4 v[128:131], v2, s[12:15], s52 offen offset:768
    buffer_load_dwordx4 v[132:135], v2, s[12:15], s52 offen offset:1024
    s_add_u32 s52, s52, 5120
    buffer_load_dwordx4 v[136:139], v2, s[12:15], s52 offen offset:0
    buffer_load_dwordx4 v[140:143], v2, s[12:15], s52 offen offset:256
    buffer_load_dwordx4 v[144:147], v2, s[12:15], s52 offen offset:512
    buffer_load_dwordx4 v[148:151], v2, s[12:15], s52 offen offset:768
    buffer_load_dwordx4 v[152:155], v2, s[12:15], s52 offen offset:1024
    s_add_u32 s52, s52, 5120
    s_waitcnt vmcnt(0)
    s_mov_b32 s54, 0
L_g_loop:
    buffer_load_dwordx4 v[156:159], v2, s[12:15], s52 offen offset:0
    buffer_load_dwordx4 v[160:163], v2, s[12:15], s52 offen offset:256
    buffer_load_dwordx4 v[164:167], v2, s[12:15], s52 offen offset:512
    buffer_load_dwordx4 v[168:171], v2, s[12:15], s52 offen offset:768
    buffer_load_dwordx4 v[172:175], v2, s[12:15], s52 offen offset:1024
    s_add_u32 s52, s52, 5120
    v_mov_b32 v80, 0
    v_mov_b32 v81, 0
    s_waitcnt vmcnt(22)
    v_lshlrev_b32 v8, 16, v96
    v_and_b32 v9, s44, v96
    v_mul_f32 v8, v8, v40
    v_mul_f32 v9, v9, v41
    v_cvt_pk_bf16_f32 v8, v8, v9
    v_and_b32 v9, s44, v8
    v_lshlrev_b32 v8, 16, v8
    v_add_f32 v81, v81, v9
    v_add_f32 v80, v80, v8
    v_lshlrev_b32 v8, 16, v97
    v_and_b32 v9, s44, v97
    v_mul_f32 v8, v8, v42
    v_mul_f32 v9, v9, v43
    v_cvt_pk_bf16_f32 v8, v8, v9
    v_and_b32 v9, s44, v8
    v_lshlrev_b32 v8, 16, v8
    v_add_f32 v81, v81, v9
    v_add_f32 v80, v80, v8
    v_lshlrev_b32 v8, 16, v98
    v_and_b32 v9, s44, v98
    v_mul_f32 v8, v8, v44
    v_mul_f32 v9, v9, v45
    v_cvt_pk_bf16_f32 v8, v8, v9
    v_and_b32 v9, s44, v8
    v_lshlrev_b32 v8, 16, v8
    v_add_f32 v81, v81, v9
    v_add_f32 v80, v80, v8
    v_lshlrev_b32 v8, 16, v99
    v_and_b32 v9, s44, v99
    v_mul_f32 v8, v8, v46
    v_mul_f32 v9, v9, v47
    v_cvt_pk_bf16_f32 v8, v8, v9
    v_and_b32 v9, s44, v8
    v_lshlrev_b32 v8, 16, v8
    v_add_f32 v81, v81, v9
    v_add_f32 v80, v80, v8
    s_waitcnt vmcnt(21)
    v_lshlrev_b32 v8, 16, v100
    v_and_b32 v9, s44, v100
    v_mul_f32 v8, v8, v48
    v_mul_f32 v9, v9, v49
    v_cvt_pk_bf16_f32 v8, v8, v9
    v_and_b32 v9, s44, v8
    v_lshlrev_b32 v8, 16, v8
    v_add_f32 v81, v81, v9
    v_add_f32 v80, v80, v8
    v_lshlrev_b32 v8, 16, v101
    v_and_b32 v9, s44, v101
    v_mul_f32 v8, v8, v50
    v_mul_f32 v9, v9, v51
    v_cvt_pk_bf16_f32 v8, v8, v9
    v_and_b32 v9, s44, v8
    v_lshlrev_b32 v8, 16, v8
    v_add_f32 v81, v81, v9
    v_add_f32 v80, v80, v8
    v_lshlrev_b32 v8, 16, v102
    v_and_b32 v9, s44, v102
    v_mul_f32 v8, v8, v52
    v_mul_f32 v9, v9, v53
    v_cvt_pk_bf16_f32 v8, v8, v9
    v_and_b32 v9, s44, v8
    v_lshlrev_b32 v8, 16, v8
    v_add_f32 v81, v81, v9
    v_add_f32 v80, v80, v8
    v_lshlrev_b32 v8, 16, v103
    v_and_b32 v9, s44, v103
    v_mul_f32 v8, v8, v54
    v_mul_f32 v9, v9, v55
    v_cvt_pk_bf16_f32 v8, v8, v9
    v_and_b32 v9, s44, v8
    v_lshlrev_b32 v8, 16, v8
    v_add_f32 v81, v81, v9
    v_add_f32 v80, v80, v8
    s_waitcnt vmcnt(20)
    v_lshlrev_b32 v8, 16, v104
    v_and_b32 v9, s44, v104
    v_mul_f32 v8, v8, v56
    v_mul_f32 v9, v9, v57
    v_cvt_pk_bf16_f32 v8, v8, v9
    v_and_b32 v9, s44, v8
    v_lshlrev_b32 v8, 16, v8
    v_add_f32 v81, v81, v9
    v_add_f32 v80, v80, v8
    v_lshlrev_b32 v8, 16, v105
    v_and_b32 v9, s44, v105
    v_mul_f32 v8, v8, v58
    v_mul_f32 v9, v9, v59
    v_cvt_pk_bf16_f32 v8, v8, v9
    v_and_b32 v9, s44, v8
    v_lshlrev_b32 v8, 16, v8
    v_add_f32 v81, v81, v9
    v_add_f32 v80, v80, v8
    v_lshlrev_b32 v8, 16, v106
    v_and_b32 v9, s44, v106
    v_mul_f32 v8, v8, v60
    v_mul_f32 v9, v9, v61
    v_cvt_pk_bf16_f32 v8, v8, v9
    v_and_b32 v9, s44, v8
    v_lshlrev_b32 v8, 16, v8
    v_add_f32 v81, v81, v9
    v_add_f32 v80, v80, v8
    v_lshlrev_b32 v8, 16, v107
    v_and_b32 v9, s44, v107
    v_mul_f32 v8, v8, v62
    v_mul_f32 v9, v9, v63
    v_cvt_pk_bf16_f32 v8, v8, v9
    v_and_b32 v9, s44, v8
    v_lshlrev_b32 v8, 16, v8
    v_add_f32 v81, v81, v9
    v_add_f32 v80, v80, v8
    s_waitcnt vmcnt(19)
    v_lshlrev_b32 v8, 16, v108
    v_and_b32 v9, s44, v108
    v_mul_f32 v8, v8, v64
    v_mul_f32 v9, v9, v65
    v_cvt_pk_bf16_f32 v8, v8, v9
    v_and_b32 v9, s44, v8
    v_lshlrev_b32 v8, 16, v8
    v_add_f32 v81, v81, v9
    v_add_f32 v80, v80, v8
    v_lshlrev_b32 v8, 16, v109
    v_and_b32 v9, s44, v109
    v_mul_f32 v8, v8, v66
    v_mul_f32 v9, v9, v67
    v_cvt_pk_bf16_f32 v8, v8, v9
    v_and_b32 v9, s44, v8
    v_lshlrev_b32 v8, 16, v8
    v_add_f32 v81, v81, v9
    v_add_f32 v80, v80, v8
    v_lshlrev_b32 v8, 16, v110
    v_and_b32 v9, s44, v110
    v_mul_f32 v8, v8, v68
    v_mul_f32 v9, v9, v69
    v_cvt_pk_bf16_f32 v8, v8, v9
    v_and_b32 v9, s44, v8
    v_lshlrev_b32 v8, 16, v8
    v_add_f32 v81, v81, v9
    v_add_f32 v80, v80, v8
    v_lshlrev_b32 v8, 16, v111
    v_and_b32 v9, s44, v111
    v_mul_f32 v8, v8, v70
    v_mul_f32 v9, v9, v71
    v_cvt_pk_bf16_f32 v8, v8, v9
    v_and_b32 v9, s44, v8
    v_lshlrev_b32 v8, 16, v8
    v_add_f32 v81, v81, v9
    v_add_f32 v80, v80, v8
    s_waitcnt vmcnt(18)
    v_lshlrev_b32 v8, 16, v112
    v_and_b32 v9, s44, v112
    v_mul_f32 v8, v8, v72
    v_mul_f32 v9, v9, v73
    v_cvt_pk_bf16_f32 v8, v8, v9
    v_and_b32 v9, s44, v8
    v_lshlrev_b32 v8, 16, v8
    v_add_f32 v81, v81, v9
    v_add_f32 v80, v80, v8
    v_lshlrev_b32 v8, 16, v113
    v_and_b32 v9, s44, v113
    v_mul_f32 v8, v8, v74
    v_mul_f32 v9, v9, v75
    v_cvt_pk_bf16_f32 v8, v8, v9
    v_and_b32 v9, s44, v8
    v_lshlrev_b32 v8, 16, v8
    v_add_f32 v81, v81, v9
    v_add_f32 v80, v80, v8
    v_lshlrev_b32 v8, 16, v114
    v_and_b32 v9, s44, v114
    v_mul_f32 v8, v8, v76
    v_mul_f32 v9, v9, v77
    v_cvt_pk_bf16_f32 v8, v8, v9
    v_and_b32 v9, s44, v8
    v_lshlrev_b32 v8, 16, v8
    v_add_f32 v81, v81, v9
    v_add_f32 v80, v80, v8
    v_lshlrev_b32 v8, 16, v115
    v_and_b32 v9, s44, v115
    v_mul_f32 v8, v8, v78
    v_mul_f32 v9, v9, v79
    v_cvt_pk_bf16_f32 v8, v8, v9
    v_and_b32 v9, s44, v8
    v_lshlrev_b32 v8, 16, v8
    v_add_f32 v81, v81, v9
    v_add_f32 v80, v80, v8
    v_add_f32 v80, v80, v81
    s_nop 1
    v_add_f32_dpp v80, v80, v80 row_ror:8 row_mask:0xf bank_mask:0xf
    s_nop 1
    v_add_f32_dpp v80, v80, v80 row_ror:4 row_mask:0xf bank_mask:0xf
    s_nop 1
    v_add_f32_dpp v80, v80, v80 row_ror:2 row_mask:0xf bank_mask:0xf
    s_nop 1
    v_add_f32_dpp v80, v80, v80 row_ror:1 row_mask:0xf bank_mask:0xf
    v_cvt_pk_bf16_f32 v80, v80, v80
    v_lshlrev_b32 v80, 16, v80
    v_mul_f32 v80, 0xbfb8aa3b, v80
    v_exp_f32 v80, v80
    s_nop 0
    v_add_f32 v80, 1.0, v80
    v_rcp_f32 v80, v80
    s_nop 0
    v_cvt_pk_bf16_f32 v80, v80, v80
    v_lshlrev_b32 v80, 16, v80
    v_sub_f32 v81, 1.0, v80
    v_cvt_pk_bf16_f32 v81, v81, v81
    v_lshlrev_b32 v81, 16, v81
    s_mov_b32 exec_lo, 0x00010001
    s_mov_b32 exec_hi, 0x00010001
    buffer_store_dwordx2 v[80:81], v3, s[8:11], s53 offen sc1
    s_mov_b64 exec, -1
    s_add_u32 s53, s53, 32
    buffer_load_dwordx4 v[96:99], v2, s[12:15], s52 offen offset:0
    buffer_load_dwordx4 v[100:103], v2, s[12:15], s52 offen offset:256
    buffer_load_dwordx4 v[104:107], v2, s[12:15], s52 offen offset:512
    buffer_load_dwordx4 v[108:111], v2, s[12:15], s52 offen offset:768
    buffer_load_dwordx4 v[112:115], v2, s[12:15], s52 offen offset:1024
    s_add_u32 s52, s52, 5120
    v_mov_b32 v80, 0
    v_mov_b32 v81, 0
    s_waitcnt vmcnt(22)
    v_lshlrev_b32 v8, 16, v116
    v_and_b32 v9, s44, v116
    v_mul_f32 v8, v8, v40
    v_mul_f32 v9, v9, v41
    v_cvt_pk_bf16_f32 v8, v8, v9
    v_and_b32 v9, s44, v8
    v_lshlrev_b32 v8, 16, v8
    v_add_f32 v81, v81, v9
    v_add_f32 v80, v80, v8
    v_lshlrev_b32 v8, 16, v117
    v_and_b32 v9, s44, v117
    v_mul_f32 v8, v8, v42
    v_mul_f32 v9, v9, v43
    v_cvt_pk_bf16_f32 v8, v8, v9
    v_and_b32 v9, s44, v8
    v_lshlrev_b32 v8, 16, v8
    v_add_f32 v81, v81, v9
    v_add_f32 v80, v80, v8
    v_lshlrev_b32 v8, 16, v118
    v_and_b32 v9, s44, v118
    v_mul_f32 v8, v8, v44
    v_mul_f32 v9, v9, v45
    v_cvt_pk_bf16_f32 v8, v8, v9
    v_and_b32 v9, s44, v8
    v_lshlrev_b32 v8, 16, v8
    v_add_f32 v81, v81, v9
    v_add_f32 v80, v80, v8
    v_lshlrev_b32 v8, 16, v119
    v_and_b32 v9, s44, v119
    v_mul_f32 v8, v8, v46
    v_mul_f32 v9, v9, v47
    v_cvt_pk_bf16_f32 v8, v8, v9
    v_and_b32 v9, s44, v8
    v_lshlrev_b32 v8, 16, v8
    v_add_f32 v81, v81, v9
    v_add_f32 v80, v80, v8
    s_waitcnt vmcnt(21)
    v_lshlrev_b32 v8, 16, v120
    v_and_b32 v9, s44, v120
    v_mul_f32 v8, v8, v48
    v_mul_f32 v9, v9, v49
    v_cvt_pk_bf16_f32 v8, v8, v9
    v_and_b32 v9, s44, v8
    v_lshlrev_b32 v8, 16, v8
    v_add_f32 v81, v81, v9
    v_add_f32 v80, v80, v8
    v_lshlrev_b32 v8, 16, v121
    v_and_b32 v9, s44, v121
    v_mul_f32 v8, v8, v50
    v_mul_f32 v9, v9, v51
    v_cvt_pk_bf16_f32 v8, v8, v9
    v_and_b32 v9, s44, v8
    v_lshlrev_b32 v8, 16, v8
    v_add_f32 v81, v81, v9
    v_add_f32 v80, v80, v8
    v_lshlrev_b32 v8, 16, v122
    v_and_b32 v9, s44, v122
    v_mul_f32 v8, v8, v52
    v_mul_f32 v9, v9, v53
    v_cvt_pk_bf16_f32 v8, v8, v9
    v_and_b32 v9, s44, v8
    v_lshlrev_b32 v8, 16, v8
    v_add_f32 v81, v81, v9
    v_add_f32 v80, v80, v8
    v_lshlrev_b32 v8, 16, v123
    v_and_b32 v9, s44, v123
    v_mul_f32 v8, v8, v54
    v_mul_f32 v9, v9, v55
    v_cvt_pk_bf16_f32 v8, v8, v9
    v_and_b32 v9, s44, v8
    v_lshlrev_b32 v8, 16, v8
    v_add_f32 v81, v81, v9
    v_add_f32 v80, v80, v8
    s_waitcnt vmcnt(20)
    v_lshlrev_b32 v8, 16, v124
    v_and_b32 v9, s44, v124
    v_mul_f32 v8, v8, v56
    v_mul_f32 v9, v9, v57
    v_cvt_pk_bf16_f32 v8, v8, v9
    v_and_b32 v9, s44, v8
    v_lshlrev_b32 v8, 16, v8
    v_add_f32 v81, v81, v9
    v_add_f32 v80, v80, v8
    v_lshlrev_b32 v8, 16, v125
    v_and_b32 v9, s44, v125
    v_mul_f32 v8, v8, v58
    v_mul_f32 v9, v9, v59
    v_cvt_pk_bf16_f32 v8, v8, v9
    v_and_b32 v9, s44, v8
    v_lshlrev_b32 v8, 16, v8
    v_add_f32 v81, v81, v9
    v_add_f32 v80, v80, v8
    v_lshlrev_b32 v8, 16, v126
    v_and_b32 v9, s44, v126
    v_mul_f32 v8, v8, v60
    v_mul_f32 v9, v9, v61
    v_cvt_pk_bf16_f32 v8, v8, v9
    v_and_b32 v9, s44, v8
    v_lshlrev_b32 v8, 16, v8
    v_add_f32 v81, v81, v9
    v_add_f32 v80, v80, v8
    v_lshlrev_b32 v8, 16, v127
    v_and_b32 v9, s44, v127
    v_mul_f32 v8, v8, v62
    v_mul_f32 v9, v9, v63
    v_cvt_pk_bf16_f32 v8, v8, v9
    v_and_b32 v9, s44, v8
    v_lshlrev_b32 v8, 16, v8
    v_add_f32 v81, v81, v9
    v_add_f32 v80, v80, v8
    s_waitcnt vmcnt(19)
    v_lshlrev_b32 v8, 16, v128
    v_and_b32 v9, s44, v128
    v_mul_f32 v8, v8, v64
    v_mul_f32 v9, v9, v65
    v_cvt_pk_bf16_f32 v8, v8, v9
    v_and_b32 v9, s44, v8
    v_lshlrev_b32 v8, 16, v8
    v_add_f32 v81, v81, v9
    v_add_f32 v80, v80, v8
    v_lshlrev_b32 v8, 16, v129
    v_and_b32 v9, s44, v129
    v_mul_f32 v8, v8, v66
    v_mul_f32 v9, v9, v67
    v_cvt_pk_bf16_f32 v8, v8, v9
    v_and_b32 v9, s44, v8
    v_lshlrev_b32 v8, 16, v8
    v_add_f32 v81, v81, v9
    v_add_f32 v80, v80, v8
    v_lshlrev_b32 v8, 16, v130
    v_and_b32 v9, s44, v130
    v_mul_f32 v8, v8, v68
    v_mul_f32 v9, v9, v69
    v_cvt_pk_bf16_f32 v8, v8, v9
    v_and_b32 v9, s44, v8
    v_lshlrev_b32 v8, 16, v8
    v_add_f32 v81, v81, v9
    v_add_f32 v80, v80, v8
    v_lshlrev_b32 v8, 16, v131
    v_and_b32 v9, s44, v131
    v_mul_f32 v8, v8, v70
    v_mul_f32 v9, v9, v71
    v_cvt_pk_bf16_f32 v8, v8, v9
    v_and_b32 v9, s44, v8
    v_lshlrev_b32 v8, 16, v8
    v_add_f32 v81, v81, v9
    v_add_f32 v80, v80, v8
    s_waitcnt vmcnt(18)
    v_lshlrev_b32 v8, 16, v132
    v_and_b32 v9, s44, v132
    v_mul_f32 v8, v8, v72
    v_mul_f32 v9, v9, v73
    v_cvt_pk_bf16_f32 v8, v8, v9
    v_and_b32 v9, s44, v8
    v_lshlrev_b32 v8, 16, v8
    v_add_f32 v81, v81, v9
    v_add_f32 v80, v80, v8
    v_lshlrev_b32 v8, 16, v133
    v_and_b32 v9, s44, v133
    v_mul_f32 v8, v8, v74
    v_mul_f32 v9, v9, v75
    v_cvt_pk_bf16_f32 v8, v8, v9
    v_and_b32 v9, s44, v8
    v_lshlrev_b32 v8, 16, v8
    v_add_f32 v81, v81, v9
    v_add_f32 v80, v80, v8
    v_lshlrev_b32 v8, 16, v134
    v_and_b32 v9, s44, v134
    v_mul_f32 v8, v8, v76
    v_mul_f32 v9, v9, v77
    v_cvt_pk_bf16_f32 v8, v8, v9
    v_and_b32 v9, s44, v8
    v_lshlrev_b32 v8, 16, v8
    v_add_f32 v81, v81, v9
    v_add_f32 v80, v80, v8
    v_lshlrev_b32 v8, 16, v135
    v_and_b32 v9, s44, v135
    v_mul_f32 v8, v8, v78
    v_mul_f32 v9, v9, v79
    v_cvt_pk_bf16_f32 v8, v8, v9
    v_and_b32 v9, s44, v8
    v_lshlrev_b32 v8, 16, v8
    v_add_f32 v81, v81, v9
    v_add_f32 v80, v80, v8
    v_add_f32 v80, v80, v81
    s_nop 1
    v_add_f32_dpp v80, v80, v80 row_ror:8 row_mask:0xf bank_mask:0xf
    s_nop 1
    v_add_f32_dpp v80, v80, v80 row_ror:4 row_mask:0xf bank_mask:0xf
    s_nop 1
    v_add_f32_dpp v80, v80, v80 row_ror:2 row_mask:0xf bank_mask:0xf
    s_nop 1
    v_add_f32_dpp v80, v80, v80 row_ror:1 row_mask:0xf bank_mask:0xf
    v_cvt_pk_bf16_f32 v80, v80, v80
    v_lshlrev_b32 v80, 16, v80
    v_mul_f32 v80, 0xbfb8aa3b, v80
    v_exp_f32 v80, v80
    s_nop 0
    v_add_f32 v80, 1.0, v80
    v_rcp_f32 v80, v80
    s_nop 0
    v_cvt_pk_bf16_f32 v80, v80, v80
    v_lshlrev_b32 v80, 16, v80
    v_sub_f32 v81, 1.0, v80
    v_cvt_pk_bf16_f32 v81, v81, v81
    v_lshlrev_b32 v81, 16, v81
    s_mov_b32 exec_lo, 0x00010001
    s_mov_b32 exec_hi, 0x00010001
    buffer_store_dwordx2 v[80:81], v3, s[8:11], s53 offen sc1
    s_mov_b64 exec, -1
    s_add_u32 s53, s53, 32
    buffer_load_dwordx4 v[116:119], v2, s[12:15], s52 offen offset:0
    buffer_load_dwordx4 v[120:123], v2, s[12:15], s52 offen offset:256
    buffer_load_dwordx4 v[124:127], v2, s[12:15], s52 offen offset:512
    buffer_load_dwordx4 v[128:131], v2, s[12:15], s52 offen offset:768
    buffer_load_dwordx4 v[132:135], v2, s[12:15], s52 offen offset:1024
    s_add_u32 s52, s52, 5120
    v_mov_b32 v80, 0
    v_mov_b32 v81, 0
    s_waitcnt vmcnt(22)
    v_lshlrev_b32 v8, 16, v136
    v_and_b32 v9, s44, v136
    v_mul_f32 v8, v8, v40
    v_mul_f32 v9, v9, v41
    v_cvt_pk_bf16_f32 v8, v8, v9
    v_and_b32 v9, s44, v8
    v_lshlrev_b32 v8, 16, v8
    v_add_f32 v81, v81, v9
    v_add_f32 v80, v80, v8
    v_lshlrev_b32 v8, 16, v137
    v_and_b32 v9, s44, v137
    v_mul_f32 v8, v8, v42
    v_mul_f32 v9, v9, v43
    v_cvt_pk_bf16_f32 v8, v8, v9
    v_and_b32 v9, s44, v8
    v_lshlrev_b32 v8, 16, v8
    v_add_f32 v81, v81, v9
    v_add_f32 v80, v80, v8
    v_lshlrev_b32 v8, 16, v138
    v_and_b32 v9, s44, v138
    v_mul_f32 v8, v8, v44
    v_mul_f32 v9, v9, v45
    v_cvt_pk_bf16_f32 v8, v8, v9
    v_and_b32 v9, s44, v8
    v_lshlrev_b32 v8, 16, v8
    v_add_f32 v81, v81, v9
    v_add_f32 v80, v80, v8
    v_lshlrev_b32 v8, 16, v139
    v_and_b32 v9, s44, v139
    v_mul_f32 v8, v8, v46
    v_mul_f32 v9, v9, v47
    v_cvt_pk_bf16_f32 v8, v8, v9
    v_and_b32 v9, s44, v8
    v_lshlrev_b32 v8, 16, v8
    v_add_f32 v81, v81, v9
    v_add_f32 v80, v80, v8
    s_waitcnt vmcnt(21)
    v_lshlrev_b32 v8, 16, v140
    v_and_b32 v9, s44, v140
    v_mul_f32 v8, v8, v48
    v_mul_f32 v9, v9, v49
    v_cvt_pk_bf16_f32 v8, v8, v9
    v_and_b32 v9, s44, v8
    v_lshlrev_b32 v8, 16, v8
    v_add_f32 v81, v81, v9
    v_add_f32 v80, v80, v8
    v_lshlrev_b32 v8, 16, v141
    v_and_b32 v9, s44, v141
    v_mul_f32 v8, v8, v50
    v_mul_f32 v9, v9, v51
    v_cvt_pk_bf16_f32 v8, v8, v9
    v_and_b32 v9, s44, v8
    v_lshlrev_b32 v8, 16, v8
    v_add_f32 v81, v81, v9
    v_add_f32 v80, v80, v8
    v_lshlrev_b32 v8, 16, v142
    v_and_b32 v9, s44, v142
    v_mul_f32 v8, v8, v52
    v_mul_f32 v9, v9, v53
    v_cvt_pk_bf16_f32 v8, v8, v9
    v_and_b32 v9, s44, v8
    v_lshlrev_b32 v8, 16, v8
    v_add_f32 v81, v81, v9
    v_add_f32 v80, v80, v8
    v_lshlrev_b32 v8, 16, v143
    v_and_b32 v9, s44, v143
    v_mul_f32 v8, v8, v54
    v_mul_f32 v9, v9, v55
    v_cvt_pk_bf16_f32 v8, v8, v9
    v_and_b32 v9, s44, v8
    v_lshlrev_b32 v8, 16, v8
    v_add_f32 v81, v81, v9
    v_add_f32 v80, v80, v8
    s_waitcnt vmcnt(20)
    v_lshlrev_b32 v8, 16, v144
    v_and_b32 v9, s44, v144
    v_mul_f32 v8, v8, v56
    v_mul_f32 v9, v9, v57
    v_cvt_pk_bf16_f32 v8, v8, v9
    v_and_b32 v9, s44, v8
    v_lshlrev_b32 v8, 16, v8
    v_add_f32 v81, v81, v9
    v_add_f32 v80, v80, v8
    v_lshlrev_b32 v8, 16, v145
    v_and_b32 v9, s44, v145
    v_mul_f32 v8, v8, v58
    v_mul_f32 v9, v9, v59
    v_cvt_pk_bf16_f32 v8, v8, v9
    v_and_b32 v9, s44, v8
    v_lshlrev_b32 v8, 16, v8
    v_add_f32 v81, v81, v9
    v_add_f32 v80, v80, v8
    v_lshlrev_b32 v8, 16, v146
    v_and_b32 v9, s44, v146
    v_mul_f32 v8, v8, v60
    v_mul_f32 v9, v9, v61
    v_cvt_pk_bf16_f32 v8, v8, v9
    v_and_b32 v9, s44, v8
    v_lshlrev_b32 v8, 16, v8
    v_add_f32 v81, v81, v9
    v_add_f32 v80, v80, v8
    v_lshlrev_b32 v8, 16, v147
    v_and_b32 v9, s44, v147
    v_mul_f32 v8, v8, v62
    v_mul_f32 v9, v9, v63
    v_cvt_pk_bf16_f32 v8, v8, v9
    v_and_b32 v9, s44, v8
    v_lshlrev_b32 v8, 16, v8
    v_add_f32 v81, v81, v9
    v_add_f32 v80, v80, v8
    s_waitcnt vmcnt(19)
    v_lshlrev_b32 v8, 16, v148
    v_and_b32 v9, s44, v148
    v_mul_f32 v8, v8, v64
    v_mul_f32 v9, v9, v65
    v_cvt_pk_bf16_f32 v8, v8, v9
    v_and_b32 v9, s44, v8
    v_lshlrev_b32 v8, 16, v8
    v_add_f32 v81, v81, v9
    v_add_f32 v80, v80, v8
    v_lshlrev_b32 v8, 16, v149
    v_and_b32 v9, s44, v149
    v_mul_f32 v8, v8, v66
    v_mul_f32 v9, v9, v67
    v_cvt_pk_bf16_f32 v8, v8, v9
    v_and_b32 v9, s44, v8
    v_lshlrev_b32 v8, 16, v8
    v_add_f32 v81, v81, v9
    v_add_f32 v80, v80, v8
    v_lshlrev_b32 v8, 16, v150
    v_and_b32 v9, s44, v150
    v_mul_f32 v8, v8, v68
    v_mul_f32 v9, v9, v69
    v_cvt_pk_bf16_f32 v8, v8, v9
    v_and_b32 v9, s44, v8
    v_lshlrev_b32 v8, 16, v8
    v_add_f32 v81, v81, v9
    v_add_f32 v80, v80, v8
    v_lshlrev_b32 v8, 16, v151
    v_and_b32 v9, s44, v151
    v_mul_f32 v8, v8, v70
    v_mul_f32 v9, v9, v71
    v_cvt_pk_bf16_f32 v8, v8, v9
    v_and_b32 v9, s44, v8
    v_lshlrev_b32 v8, 16, v8
    v_add_f32 v81, v81, v9
    v_add_f32 v80, v80, v8
    s_waitcnt vmcnt(18)
    v_lshlrev_b32 v8, 16, v152
    v_and_b32 v9, s44, v152
    v_mul_f32 v8, v8, v72
    v_mul_f32 v9, v9, v73
    v_cvt_pk_bf16_f32 v8, v8, v9
    v_and_b32 v9, s44, v8
    v_lshlrev_b32 v8, 16, v8
    v_add_f32 v81, v81, v9
    v_add_f32 v80, v80, v8
    v_lshlrev_b32 v8, 16, v153
    v_and_b32 v9, s44, v153
    v_mul_f32 v8, v8, v74
    v_mul_f32 v9, v9, v75
    v_cvt_pk_bf16_f32 v8, v8, v9
    v_and_b32 v9, s44, v8
    v_lshlrev_b32 v8, 16, v8
    v_add_f32 v81, v81, v9
    v_add_f32 v80, v80, v8
    v_lshlrev_b32 v8, 16, v154
    v_and_b32 v9, s44, v154
    v_mul_f32 v8, v8, v76
    v_mul_f32 v9, v9, v77
    v_cvt_pk_bf16_f32 v8, v8, v9
    v_and_b32 v9, s44, v8
    v_lshlrev_b32 v8, 16, v8
    v_add_f32 v81, v81, v9
    v_add_f32 v80, v80, v8
    v_lshlrev_b32 v8, 16, v155
    v_and_b32 v9, s44, v155
    v_mul_f32 v8, v8, v78
    v_mul_f32 v9, v9, v79
    v_cvt_pk_bf16_f32 v8, v8, v9
    v_and_b32 v9, s44, v8
    v_lshlrev_b32 v8, 16, v8
    v_add_f32 v81, v81, v9
    v_add_f32 v80, v80, v8
    v_add_f32 v80, v80, v81
    s_nop 1
    v_add_f32_dpp v80, v80, v80 row_ror:8 row_mask:0xf bank_mask:0xf
    s_nop 1
    v_add_f32_dpp v80, v80, v80 row_ror:4 row_mask:0xf bank_mask:0xf
    s_nop 1
    v_add_f32_dpp v80, v80, v80 row_ror:2 row_mask:0xf bank_mask:0xf
    s_nop 1
    v_add_f32_dpp v80, v80, v80 row_ror:1 row_mask:0xf bank_mask:0xf
    v_cvt_pk_bf16_f32 v80, v80, v80
    v_lshlrev_b32 v80, 16, v80
    v_mul_f32 v80, 0xbfb8aa3b, v80
    v_exp_f32 v80, v80
    s_nop 0
    v_add_f32 v80, 1.0, v80
    v_rcp_f32 v80, v80
    s_nop 0
    v_cvt_pk_bf16_f32 v80, v80, v80
    v_lshlrev_b32 v80, 16, v80
    v_sub_f32 v81, 1.0, v80
    v_cvt_pk_bf16_f32 v81, v81, v81
    v_lshlrev_b32 v81, 16, v81
    s_mov_b32 exec_lo, 0x00010001
    s_mov_b32 exec_hi, 0x00010001
    buffer_store_dwordx2 v[80:81], v3, s[8:11], s53 offen sc1
    s_mov_b64 exec, -1
    s_add_u32 s53, s53, 32
    buffer_load_dwordx4 v[136:139], v2, s[12:15], s52 offen offset:0
    buffer_load_dwordx4 v[140:143], v2, s[12:15], s52 offen offset:256
    buffer_load_dwordx4 v[144:147], v2, s[12:15], s52 offen offset:512
    buffer_load_dwordx4 v[148:151], v2, s[12:15], s52 offen offset:768
    buffer_load_dwordx4 v[152:155], v2, s[12:15], s52 offen offset:1024
    s_add_u32 s52, s52, 5120
    v_mov_b32 v80, 0
    v_mov_b32 v81, 0
    s_waitcnt vmcnt(22)
    v_lshlrev_b32 v8, 16, v156
    v_and_b32 v9, s44, v156
    v_mul_f32 v8, v8, v40
    v_mul_f32 v9, v9, v41
    v_cvt_pk_bf16_f32 v8, v8, v9
    v_and_b32 v9, s44, v8
    v_lshlrev_b32 v8, 16, v8
    v_add_f32 v81, v81, v9
    v_add_f32 v80, v80, v8
    v_lshlrev_b32 v8, 16, v157
    v_and_b32 v9, s44, v157
    v_mul_f32 v8, v8, v42
    v_mul_f32 v9, v9, v43
    v_cvt_pk_bf16_f32 v8, v8, v9
    v_and_b32 v9, s44, v8
    v_lshlrev_b32 v8, 16, v8
    v_add_f32 v81, v81, v9
    v_add_f32 v80, v80, v8
    v_lshlrev_b32 v8, 16, v158
    v_and_b32 v9, s44, v158
    v_mul_f32 v8, v8, v44
    v_mul_f32 v9, v9, v45
    v_cvt_pk_bf16_f32 v8, v8, v9
    v_and_b32 v9, s44, v8
    v_lshlrev_b32 v8, 16, v8
    v_add_f32 v81, v81, v9
    v_add_f32 v80, v80, v8
    v_lshlrev_b32 v8, 16, v159
    v_and_b32 v9, s44, v159
    v_mul_f32 v8, v8, v46
    v_mul_f32 v9, v9, v47
    v_cvt_pk_bf16_f32 v8, v8, v9
    v_and_b32 v9, s44, v8
    v_lshlrev_b32 v8, 16, v8
    v_add_f32 v81, v81, v9
    v_add_f32 v80, v80, v8
    s_waitcnt vmcnt(21)
    v_lshlrev_b32 v8, 16, v160
    v_and_b32 v9, s44, v160
    v_mul_f32 v8, v8, v48
    v_mul_f32 v9, v9, v49
    v_cvt_pk_bf16_f32 v8, v8, v9
    v_and_b32 v9, s44, v8
    v_lshlrev_b32 v8, 16, v8
    v_add_f32 v81, v81, v9
    v_add_f32 v80, v80, v8
    v_lshlrev_b32 v8, 16, v161
    v_and_b32 v9, s44, v161
    v_mul_f32 v8, v8, v50
    v_mul_f32 v9, v9, v51
    v_cvt_pk_bf16_f32 v8, v8, v9
    v_and_b32 v9, s44, v8
    v_lshlrev_b32 v8, 16, v8
    v_add_f32 v81, v81, v9
    v_add_f32 v80, v80, v8
    v_lshlrev_b32 v8, 16, v162
    v_and_b32 v9, s44, v162
    v_mul_f32 v8, v8, v52
    v_mul_f32 v9, v9, v53
    v_cvt_pk_bf16_f32 v8, v8, v9
    v_and_b32 v9, s44, v8
    v_lshlrev_b32 v8, 16, v8
    v_add_f32 v81, v81, v9
    v_add_f32 v80, v80, v8
    v_lshlrev_b32 v8, 16, v163
    v_and_b32 v9, s44, v163
    v_mul_f32 v8, v8, v54
    v_mul_f32 v9, v9, v55
    v_cvt_pk_bf16_f32 v8, v8, v9
    v_and_b32 v9, s44, v8
    v_lshlrev_b32 v8, 16, v8
    v_add_f32 v81, v81, v9
    v_add_f32 v80, v80, v8
    s_waitcnt vmcnt(20)
    v_lshlrev_b32 v8, 16, v164
    v_and_b32 v9, s44, v164
    v_mul_f32 v8, v8, v56
    v_mul_f32 v9, v9, v57
    v_cvt_pk_bf16_f32 v8, v8, v9
    v_and_b32 v9, s44, v8
    v_lshlrev_b32 v8, 16, v8
    v_add_f32 v81, v81, v9
    v_add_f32 v80, v80, v8
    v_lshlrev_b32 v8, 16, v165
    v_and_b32 v9, s44, v165
    v_mul_f32 v8, v8, v58
    v_mul_f32 v9, v9, v59
    v_cvt_pk_bf16_f32 v8, v8, v9
    v_and_b32 v9, s44, v8
    v_lshlrev_b32 v8, 16, v8
    v_add_f32 v81, v81, v9
    v_add_f32 v80, v80, v8
    v_lshlrev_b32 v8, 16, v166
    v_and_b32 v9, s44, v166
    v_mul_f32 v8, v8, v60
    v_mul_f32 v9, v9, v61
    v_cvt_pk_bf16_f32 v8, v8, v9
    v_and_b32 v9, s44, v8
    v_lshlrev_b32 v8, 16, v8
    v_add_f32 v81, v81, v9
    v_add_f32 v80, v80, v8
    v_lshlrev_b32 v8, 16, v167
    v_and_b32 v9, s44, v167
    v_mul_f32 v8, v8, v62
    v_mul_f32 v9, v9, v63
    v_cvt_pk_bf16_f32 v8, v8, v9
    v_and_b32 v9, s44, v8
    v_lshlrev_b32 v8, 16, v8
    v_add_f32 v81, v81, v9
    v_add_f32 v80, v80, v8
    s_waitcnt vmcnt(19)
    v_lshlrev_b32 v8, 16, v168
    v_and_b32 v9, s44, v168
    v_mul_f32 v8, v8, v64
    v_mul_f32 v9, v9, v65
    v_cvt_pk_bf16_f32 v8, v8, v9
    v_and_b32 v9, s44, v8
    v_lshlrev_b32 v8, 16, v8
    v_add_f32 v81, v81, v9
    v_add_f32 v80, v80, v8
    v_lshlrev_b32 v8, 16, v169
    v_and_b32 v9, s44, v169
    v_mul_f32 v8, v8, v66
    v_mul_f32 v9, v9, v67
    v_cvt_pk_bf16_f32 v8, v8, v9
    v_and_b32 v9, s44, v8
    v_lshlrev_b32 v8, 16, v8
    v_add_f32 v81, v81, v9
    v_add_f32 v80, v80, v8
    v_lshlrev_b32 v8, 16, v170
    v_and_b32 v9, s44, v170
    v_mul_f32 v8, v8, v68
    v_mul_f32 v9, v9, v69
    v_cvt_pk_bf16_f32 v8, v8, v9
    v_and_b32 v9, s44, v8
    v_lshlrev_b32 v8, 16, v8
    v_add_f32 v81, v81, v9
    v_add_f32 v80, v80, v8
    v_lshlrev_b32 v8, 16, v171
    v_and_b32 v9, s44, v171
    v_mul_f32 v8, v8, v70
    v_mul_f32 v9, v9, v71
    v_cvt_pk_bf16_f32 v8, v8, v9
    v_and_b32 v9, s44, v8
    v_lshlrev_b32 v8, 16, v8
    v_add_f32 v81, v81, v9
    v_add_f32 v80, v80, v8
    s_waitcnt vmcnt(18)
    v_lshlrev_b32 v8, 16, v172
    v_and_b32 v9, s44, v172
    v_mul_f32 v8, v8, v72
    v_mul_f32 v9, v9, v73
    v_cvt_pk_bf16_f32 v8, v8, v9
    v_and_b32 v9, s44, v8
    v_lshlrev_b32 v8, 16, v8
    v_add_f32 v81, v81, v9
    v_add_f32 v80, v80, v8
    v_lshlrev_b32 v8, 16, v173
    v_and_b32 v9, s44, v173
    v_mul_f32 v8, v8, v74
    v_mul_f32 v9, v9, v75
    v_cvt_pk_bf16_f32 v8, v8, v9
    v_and_b32 v9, s44, v8
    v_lshlrev_b32 v8, 16, v8
    v_add_f32 v81, v81, v9
    v_add_f32 v80, v80, v8
    v_lshlrev_b32 v8, 16, v174
    v_and_b32 v9, s44, v174
    v_mul_f32 v8, v8, v76
    v_mul_f32 v9, v9, v77
    v_cvt_pk_bf16_f32 v8, v8, v9
    v_and_b32 v9, s44, v8
    v_lshlrev_b32 v8, 16, v8
    v_add_f32 v81, v81, v9
    v_add_f32 v80, v80, v8
    v_lshlrev_b32 v8, 16, v175
    v_and_b32 v9, s44, v175
    v_mul_f32 v8, v8, v78
    v_mul_f32 v9, v9, v79
    v_cvt_pk_bf16_f32 v8, v8, v9
    v_and_b32 v9, s44, v8
    v_lshlrev_b32 v8, 16, v8
    v_add_f32 v81, v81, v9
    v_add_f32 v80, v80, v8
    v_add_f32 v80, v80, v81
    s_nop 1
    v_add_f32_dpp v80, v80, v80 row_ror:8 row_mask:0xf bank_mask:0xf
    s_nop 1
    v_add_f32_dpp v80, v80, v80 row_ror:4 row_mask:0xf bank_mask:0xf
    s_nop 1
    v_add_f32_dpp v80, v80, v80 row_ror:2 row_mask:0xf bank_mask:0xf
    s_nop 1
    v_add_f32_dpp v80, v80, v80 row_ror:1 row_mask:0xf bank_mask:0xf
    v_cvt_pk_bf16_f32 v80, v80, v80
    v_lshlrev_b32 v80, 16, v80
    v_mul_f32 v80, 0xbfb8aa3b, v80
    v_exp_f32 v80, v80
    s_nop 0
    v_add_f32 v80, 1.0, v80
    v_rcp_f32 v80, v80
    s_nop 0
    v_cvt_pk_bf16_f32 v80, v80, v80
    v_lshlrev_b32 v80, 16, v80
    v_sub_f32 v81, 1.0, v80
    v_cvt_pk_bf16_f32 v81, v81, v81
    v_lshlrev_b32 v81, 16, v81
    s_mov_b32 exec_lo, 0x00010001
    s_mov_b32 exec_hi, 0x00010001
    buffer_store_dwordx2 v[80:81], v3, s[8:11], s53 offen sc1
    s_mov_b64 exec, -1
    s_add_u32 s53, s53, 32
    s_add_u32 s54, s54, 1
    s_cmp_lt_u32 s54, 8
    s_cbranch_scc1 L_g_loop
    s_waitcnt vmcnt(0)
    v_mov_b32 v8, 64
    s_mov_b64 exec, 1
    buffer_store_dword v8, v4, s[8:11], 0 offen sc1
    s_mov_b64 exec, -1
    s_branch L_xc
L_xc:
    s_sub_u32 s30, s2, 164
    s_cmp_lt_u32 s30, 68
    s_cbranch_scc1 L_end
    s_load_dwordx2 s[12:13], s[0:1], 136
    s_mov_b32 s14, 5242880
    s_mov_b32 s15, 0x20000
    s_load_dwordx2 s[16:17], s[0:1], 0
    s_mov_b32 s18, 2621440
    s_mov_b32 s19, 0x20000
    s_load_dwordx2 s[20:21], s[0:1], 120
    s_mov_b32 s22, 1280
    s_mov_b32 s23, 0x20000
    s_waitcnt vmcnt(0) lgkmcnt(0)
    s_mov_b32 s31, 0
Lwa_144:
    v_lshlrev_b32 v13, 2, v1
    buffer_load_dword v12, v13, s[24:27], 0 offen offset:192 sc1
    s_add_u32 s31, s31, 1
    s_cmp_gt_u32 s31, 400000
    s_cbranch_scc1 L_abort
    s_sleep 2
    s_waitcnt vmcnt(0)
    v_readfirstlane_b32 s30, v12
    s_nop 0
    s_cmp_lt_u32 s30, 3
    s_nop 1
    s_cbranch_scc1 Lwa_144
    v_readlane_b32 s60, v12, 4
    v_readlane_b32 s7, v12, 5
    v_readlane_b32 s28, v12, 6
    v_lshlrev_b32 v2, 4, v1
    v_and_b32 v12, 15, v1
    v_lshrrev_b32 v13, 4, v1
    v_mul_u32_u24 v3, 2560, v13
    v_lshl_add_u32 v3, v12, 4, v3
    s_lshl_b32 s30, s3, 10
    s_add_u32 s30, s30, 246440960
    v_and_b32 v14, 7, v1
    v_lshl_add_u32 v4, v14, 7, s30
    s_mov_b32 s44, 0xffff0000
    v_add_u32 v12, 234, v1
    v_lshlrev_b32 v12, 7, v12
    v_add_u32 v12, 246415360, v12
    v_cmp_gt_u32 vcc, 8, v1
    s_nop 1
    v_cndmask_b32 v16, v12, v4, vcc
    v_mov_b32 v12, 246419456
    v_cmp_gt_u32 s[46:47], 18, v1
    s_nop 1
    v_cndmask_b32 v16, v12, v16, s[46:47]
    s_mov_b32 s58, 0
    s_cmp_eq_u32 s3, 0
    s_cselect_b32 s59, 0, 2146435072
    s_cselect_b32 s48, 1, 0
    s_mov_b32 s49, 0
    v_mov_b32 v18, 16
    v_mov_b32 v19, 65536
    v_and_b32 v5, 3, v1
    v_lshlrev_b32 v5, 7, v5
    v_add_u32 v5, 246447616, v5
    s_mov_b32 s52, 63
    s_mov_b32 s31, 0
Lxp_146:
    buffer_load_dwordx4 v[12:15], v5, s[8:11], 0 offen sc1
    s_add_u32 s31, s31, 1
    s_cmp_gt_u32 s31, 400000
    s_cbranch_scc1 L_abort
    s_waitcnt vmcnt(0)
    v_min_u32 v12, v12, v13
    v_min3_u32 v12, v12, v14, v15
    v_cmp_ge_u32 vcc, s52, v12
    s_nop 0
    s_cbranch_vccz Lxo_147
    s_sleep 4
    s_branch Lxp_146
Lxo_147:
    v_mov_b32 v17, 1
    s_mov_b64 exec, 1
    buffer_atomic_add v17, v18, s[24:27], s59 offen sc0 sc1
    s_mov_b64 exec, -1
    s_waitcnt vmcnt(0)
    s_cmp_lg_u32 s3, 0
    s_cbranch_scc1 Lxk_148
    s_mov_b64 exec, 1
    ds_write_b32 v19, v17
    s_mov_b64 exec, -1
Lxk_148:
    s_waitcnt lgkmcnt(0)
    s_barrier
L_xc_loop:
    ds_read_b32 v13, v19
    s_waitcnt lgkmcnt(0)
    v_readfirstlane_b32 s50, v13
    s_barrier
    s_cmp_ge_u32 s50, 340
    s_nop 1
    s_cbranch_scc1 L_end
    s_cmp_ge_u32 s50, 300
    s_cbranch_scc1 L_xc_narrow
    s_sub_u32 s53, s50, 0
    s_mul_i32 s52, s53, 209716
    s_lshr_b32 s52, s52, 20
    s_mul_i32 s30, s52, 5
    s_sub_u32 s53, s53, s30
    s_add_u32 s52, s52, 0
    s_lshl_b32 s30, s3, 14
    v_add_u32 v6, s30, v2
    s_lshl_b32 s30, s3, 12
    v_add_u32 v7, s30, v2
    s_cmp_lt_u32 s52, s58
    s_cbranch_scc1 Lxf1_149
    s_mov_b32 s31, 0
Lxp_151:
    buffer_load_dwordx4 v[12:15], v4, s[8:11], 0 offen sc1
    s_add_u32 s31, s31, 1
    s_cmp_gt_u32 s31, 400000
    s_cbranch_scc1 L_abort
    s_waitcnt vmcnt(0)
    v_min_u32 v12, v12, v13
    v_min3_u32 v12, v12, v14, v15
    v_cmp_ge_u32 vcc, s52, v12
    s_nop 0
    s_cbranch_vccz Lxo_152
    s_sleep 4
    s_branch Lxp_151
Lxo_152:
Lxf1_149:
    s_mul_i32 s54, s52, 1310720
    s_lshl_b32 s30, s53, 18
    s_add_u32 s54, s54, s30
    s_lshl_b32 s30, s3, 13
    s_add_u32 s54, s54, s30
    s_add_u32 s54, s54, 142606336
    s_add_u32 s34, s54, 0
    buffer_load_dwordx4 a[0:3], v2, s[8:11], s34 offen offset:0 sc1
    buffer_load_dwordx4 a[4:7], v2, s[8:11], s34 offen offset:1024 sc1
    buffer_load_dwordx4 a[8:11], v2, s[8:11], s34 offen offset:2048 sc1
    buffer_load_dwordx4 a[12:15], v2, s[8:11], s34 offen offset:3072 sc1
    s_add_u32 s34, s54, 4096
    buffer_load_dwordx4 a[16:19], v2, s[8:11], s34 offen offset:0 sc1
    buffer_load_dwordx4 a[20:23], v2, s[8:11], s34 offen offset:1024 sc1
    buffer_load_dwordx4 a[24:27], v2, s[8:11], s34 offen offset:2048 sc1
    buffer_load_dwordx4 a[28:31], v2, s[8:11], s34 offen offset:3072 sc1
    s_add_u32 s34, s54, 32768
    buffer_load_dwordx4 a[32:35], v2, s[8:11], s34 offen offset:0 sc1
    buffer_load_dwordx4 a[36:39], v2, s[8:11], s34 offen offset:1024 sc1
    buffer_load_dwordx4 a[40:43], v2, s[8:11], s34 offen offset:2048 sc1
    buffer_load_dwordx4 a[44:47], v2, s[8:11], s34 offen offset:3072 sc1
    s_add_u32 s34, s54, 36864
    buffer_load_dwordx4 a[48:51], v2, s[8:11], s34 offen offset:0 sc1
    buffer_load_dwordx4 a[52:55], v2, s[8:11], s34 offen offset:1024 sc1
    buffer_load_dwordx4 a[56:59], v2, s[8:11], s34 offen offset:2048 sc1
    buffer_load_dwordx4 a[60:63], v2, s[8:11], s34 offen offset:3072 sc1
    s_add_u32 s34, s54, 65536
    buffer_load_dwordx4 a[64:67], v2, s[8:11], s34 offen offset:0 sc1
    buffer_load_dwordx4 a[68:71], v2, s[8:11], s34 offen offset:1024 sc1
    buffer_load_dwordx4 a[72:75], v2, s[8:11], s34 offen offset:2048 sc1
    buffer_load_dwordx4 a[76:79], v2, s[8:11], s34 offen offset:3072 sc1
    s_add_u32 s34, s54, 69632
    buffer_load_dwordx4 a[80:83], v2, s[8:11], s34 offen offset:0 sc1
    buffer_load_dwordx4 a[84:87], v2, s[8:11], s34 offen offset:1024 sc1
    buffer_load_dwordx4 a[88:91], v2, s[8:11], s34 offen offset:2048 sc1
    buffer_load_dwordx4 a[92:95], v2, s[8:11], s34 offen offset:3072 sc1
    s_add_u32 s34, s54, 98304
    buffer_load_dwordx4 a[96:99], v2, s[8:11], s34 offen offset:0 sc1
    buffer_load_dwordx4 a[100:103], v2, s[8:11], s34 offen offset:1024 sc1
    buffer_load_dwordx4 a[104:107], v2, s[8:11], s34 offen offset:2048 sc1
    buffer_load_dwordx4 a[108:111], v2, s[8:11], s34 offen offset:3072 sc1
    s_add_u32 s34, s54, 102400
    buffer_load_dwordx4 a[112:115], v2, s[8:11], s34 offen offset:0 sc1
    buffer_load_dwordx4 a[116:119], v2, s[8:11], s34 offen offset:1024 sc1
    buffer_load_dwordx4 a[120:123], v2, s[8:11], s34 offen offset:2048 sc1
    buffer_load_dwordx4 a[124:127], v2, s[8:11], s34 offen offset:3072 sc1
    s_add_u32 s34, s54, 131072
    buffer_load_dwordx4 a[128:131], v2, s[8:11], s34 offen offset:0 sc1
    buffer_load_dwordx4 a[132:135], v2, s[8:11], s34 offen offset:1024 sc1
    buffer_load_dwordx4 a[136:139], v2, s[8:11], s34 offen offset:2048 sc1
    buffer_load_dwordx4 a[140:143], v2, s[8:11], s34 offen offset:3072 sc1
    s_add_u32 s34, s54, 135168
    buffer_load_dwordx4 a[144:147], v2, s[8:11], s34 offen offset:0 sc1
    buffer_load_dwordx4 a[148:151], v2, s[8:11], s34 offen offset:1024 sc1
    buffer_load_dwordx4 a[152:155], v2, s[8:11], s34 offen offset:2048 sc1
    buffer_load_dwordx4 a[156:159], v2, s[8:11], s34 offen offset:3072 sc1
    s_add_u32 s34, s54, 163840
    buffer_load_dwordx4 a[160:163], v2, s[8:11], s34 offen offset:0 sc1
    buffer_load_dwordx4 a[164:167], v2, s[8:11], s34 offen offset:1024 sc1
    buffer_load_dwordx4 a[168:171], v2, s[8:11], s34 offen offset:2048 sc1
    buffer_load_dwordx4 a[172:175], v2, s[8:11], s34 offen offset:3072 sc1
    s_add_u32 s34, s54, 167936
    buffer_load_dwordx4 a[176:179], v2, s[8:11], s34 offen offset:0 sc1
    buffer_load_dwordx4 a[180:183], v2, s[8:11], s34 offen offset:1024 sc1
    buffer_load_dwordx4 a[184:187], v2, s[8:11], s34 offen offset:2048 sc1
    buffer_load_dwordx4 a[188:191], v2, s[8:11], s34 offen offset:3072 sc1
    s_add_u32 s34, s54, 196608
    buffer_load_dwordx4 a[192:195], v2, s[8:11], s34 offen offset:0 sc1
    buffer_load_dwordx4 a[196:199], v2, s[8:11], s34 offen offset:1024 sc1
    buffer_load_dwordx4 a[200:203], v2, s[8:11], s34 offen offset:2048 sc1
    buffer_load_dwordx4 a[204:207], v2, s[8:11], s34 offen offset:3072 sc1
    s_add_u32 s34, s54, 200704
    buffer_load_dwordx4 a[208:211], v2, s[8:11], s34 offen offset:0 sc1
    buffer_load_dwordx4 a[212:215], v2, s[8:11], s34 offen offset:1024 sc1
    buffer_load_dwordx4 a[216:219], v2, s[8:11], s34 offen offset:2048 sc1
    buffer_load_dwordx4 a[220:223], v2, s[8:11], s34 offen offset:3072 sc1
    s_add_u32 s34, s54, 229376
    buffer_load_dwordx4 a[224:227], v2, s[8:11], s34 offen offset:0 sc1
    buffer_load_dwordx4 a[228:231], v2, s[8:11], s34 offen offset:1024 sc1
    buffer_load_dwordx4 a[232:235], v2, s[8:11], s34 offen offset:2048 sc1
    buffer_load_dwordx4 a[236:239], v2, s[8:11], s34 offen offset:3072 sc1
    s_add_u32 s34, s54, 233472
    buffer_load_dwordx4 a[240:243], v2, s[8:11], s34 offen offset:0 sc1
    buffer_load_dwordx4 a[244:247], v2, s[8:11], s34 offen offset:1024 sc1
    buffer_load_dwordx4 a[248:251], v2, s[8:11], s34 offen offset:2048 sc1
    buffer_load_dwordx4 a[252:255], v2, s[8:11], s34 offen offset:3072 sc1
    s_lshl_b32 s30, s3, 3
    v_and_b32 v12, 7, v1
    v_add_u32 v12, s30, v12
    v_and_b32 v13, 8, v1
    v_lshl_add_u32 v12, v13, 2, v12
    s_lshl_b32 s30, s53, 3
    s_lshr_b32 s30, s30, 3
    s_and_b32 s31, s52, 1
    s_mul_i32 s31, s31, 5
    s_add_u32 s30, s30, s31
    s_add_u32 s30, s30, 242
    v_mov_b32 v13, s30
    v_cmp_gt_u32 vcc, 16, v1
    s_nop 1
    v_cndmask_b32 v12, v13, v12, vcc
    s_cmp_lt_u32 s52, 62
    s_cselect_b32 s30, 16, 0
    v_cmp_le_u32 vcc, s30, v1
    s_nop 1
    v_cndmask_b32 v12, v13, v12, vcc
    v_lshlrev_b32 v5, 7, v12
    v_add_u32 v5, 246415360, v5
    s_lshr_b32 s30, s3, 1
    s_lshl_b32 s31, s52, 1
    s_add_u32 s31, s31, s30
    s_lshl_b32 s32, s53, 3
    s_and_b32 s33, s3, 1
    s_lshl_b32 s33, s33, 2
    s_add_u32 s32, s32, s33
    s_mul_i32 s55, s31, 40
    s_add_u32 s55, s55, s32
    s_lshl_b32 s55, s55, 10
    s_add_u32 s55, s55, 239075328
    s_lshl_b32 s31, s31, 4
    v_and_b32 v12, 15, v1
    v_add_u32 v12, s31, v12
    v_lshrrev_b32 v13, 4, v1
    s_lshl_b32 s32, s32, 5
    v_lshl_add_u32 v8, v13, 3, s32
    v_mul_u32_u24 v9, 1280, v12
    v_add_u32 v9, v9, v8
    v_lshlrev_b32 v10, 1, v9
    v_lshlrev_b32 v11, 3, v12
    v_add_u32 v11, 245366784, v11
    buffer_load_dwordx2 v[232:233], v9, s[16:19], 0 offen offset:0
    buffer_load_dwordx2 v[240:241], v8, s[20:23], 0 offen offset:0
    buffer_load_dwordx2 v[234:235], v9, s[16:19], 0 offen offset:32
    buffer_load_dwordx2 v[242:243], v8, s[20:23], 0 offen offset:32
    buffer_load_dwordx2 v[236:237], v9, s[16:19], 0 offen offset:64
    buffer_load_dwordx2 v[244:245], v8, s[20:23], 0 offen offset:64
    buffer_load_dwordx2 v[238:239], v9, s[16:19], 0 offen offset:96
    buffer_load_dwordx2 v[246:247], v8, s[20:23], 0 offen offset:96
    s_cmp_lt_u32 s52, s58
    s_cbranch_scc1 Lxf2_150
    s_mov_b32 s31, 0
    v_mov_b32 v13, 246419456
    s_add_u32 s33, s52, 2
    s_cmp_lt_u32 s52, 62
    s_cselect_b32 s33, s33, 62
Lxcw_153:
    buffer_load_dword v12, v13, s[8:11], 0 offen sc1
    s_add_u32 s31, s31, 1
    s_cmp_gt_u32 s31, 400000
    s_cbranch_scc1 L_abort
    s_waitcnt vmcnt(0)
    v_readfirstlane_b32 s30, v12
    s_nop 0
    s_cmp_ge_u32 s30, s33
    s_nop 1
    s_cbranch_scc1 Lxcok_154
    s_sleep 12
    s_branch Lxcw_153
Lxcok_154:
    s_mov_b32 s31, 0
Lxp_155:
    buffer_load_dwordx4 v[12:15], v5, s[8:11], 0 offen sc1
    s_add_u32 s31, s31, 1
    s_cmp_gt_u32 s31, 400000
    s_cbranch_scc1 L_abort
    s_waitcnt vmcnt(0)
    v_min_u32 v12, v12, v13
    v_min3_u32 v12, v12, v14, v15
    v_cmp_ge_u32 vcc, s52, v12
    s_nop 0
    s_cbranch_vccz Lxo_156
    s_sleep 4
    s_branch Lxp_155
Lxo_156:
Lxf2_150:
    s_lshr_b32 s37, s52, 1
    s_bitcmp1_b32 s7, s37
    s_cselect_b32 s29, 16384, 0
    s_bitcmp1_b32 s28, s37
    s_cselect_b32 s62, 4096, 0
    s_or_b32 s29, s29, s62
    s_lshl_b32 s62, s37, 21
    s_lshr_b32 s37, s60, s37
    s_and_b32 s37, s37, 1
    s_lshl_b32 s37, s37, 13
    s_add_u32 s62, s62, s37
    s_and_b32 s37, s52, 1
    s_lshl_b32 s37, s37, 15
    s_add_u32 s62, s62, s37
    s_mul_i32 s56, s52, 81920
    s_mul_i32 s30, s3, 20480
    s_add_u32 s56, s56, s30
    s_add_u32 s56, s56, 226492416
    s_and_b32 s30, s3, 1
    s_lshl_b32 s30, s30, 11
    s_add_u32 s57, s62, s30
    s_add_u32 s34, s56, 0
    buffer_load_dwordx4 v[88:91], v2, s[8:11], s34 offen offset:0 sc1
    buffer_load_dwordx4 v[92:95], v2, s[8:11], s34 offen offset:1024 sc1
    s_add_u32 s34, s56, 2560
    buffer_load_dwordx4 v[96:99], v2, s[8:11], s34 offen offset:0 sc1
    buffer_load_dwordx4 v[100:103], v2, s[8:11], s34 offen offset:1024 sc1
    s_add_u32 s34, s56, 5120
    buffer_load_dwordx4 v[104:107], v2, s[8:11], s34 offen offset:0 sc1
    buffer_load_dwordx4 v[108:111], v2, s[8:11], s34 offen offset:1024 sc1
    s_add_u32 s34, s56, 7680
    buffer_load_dwordx4 v[112:115], v2, s[8:11], s34 offen offset:0 sc1
    buffer_load_dwordx4 v[116:119], v2, s[8:11], s34 offen offset:1024 sc1
    s_add_u32 s34, s56, 10240
    buffer_load_dwordx4 v[120:123], v2, s[8:11], s34 offen offset:0 sc1
    buffer_load_dwordx4 v[124:127], v2, s[8:11], s34 offen offset:1024 sc1
    s_add_u32 s34, s56, 12800
    buffer_load_dwordx4 v[128:131], v2, s[8:11], s34 offen offset:0 sc1
    buffer_load_dwordx4 v[132:135], v2, s[8:11], s34 offen offset:1024 sc1
    s_add_u32 s34, s56, 15360
    buffer_load_dwordx4 v[136:139], v2, s[8:11], s34 offen offset:0 sc1
    buffer_load_dwordx4 v[140:143], v2, s[8:11], s34 offen offset:1024 sc1
    s_add_u32 s34, s56, 17920
    buffer_load_dwordx4 v[144:147], v2, s[8:11], s34 offen offset:0 sc1
    buffer_load_dwordx4 v[148:151], v2, s[8:11], s34 offen offset:1024 sc1
    s_add_u32 s34, s56, 0
    buffer_load_dwordx4 v[152:155], v3, s[8:11], s34 offen offset:2048 sc1
    buffer_load_dwordx4 v[156:159], v3, s[8:11], s34 offen offset:2304 sc1
    s_add_u32 s34, s56, 10240
    buffer_load_dwordx4 v[160:163], v3, s[8:11], s34 offen offset:2048 sc1
    buffer_load_dwordx4 v[164:167], v3, s[8:11], s34 offen offset:2304 sc1
    s_lshl_b32 s32, s53, 3
    s_add_u32 s32, s32, 0
    s_lshr_b32 s30, s32, 2
    s_lshl_b32 s30, s30, 1
    s_lshr_b32 s31, s3, 1
    s_add_u32 s30, s30, s31
    s_add_u32 s30, s30, 3
    s_lshr_b32 s31, s30, 3
    s_xor_b32 s31, s31, s32
    s_lshl_b32 s34, s30, 16
    s_bitcmp1_b32 s31, 0
    s_cselect_b32 s30, 16384, 0
    s_add_u32 s34, s34, s30
    s_bitcmp1_b32 s31, 1
    s_cselect_b32 s30, 4096, 0
    s_add_u32 s34, s34, s30
    s_xor_b32 s34, s34, s29
    s_add_u32 s34, s34, s57
    buffer_load_dwordx4 v[168:171], v2, s[8:11], s34 offen offset:0 sc1
    buffer_load_dwordx4 v[172:175], v2, s[8:11], s34 offen offset:1024 sc1
    s_lshl_b32 s32, s53, 3
    s_add_u32 s32, s32, 1
    s_lshr_b32 s30, s32, 2
    s_lshl_b32 s30, s30, 1
    s_lshr_b32 s31, s3, 1
    s_add_u32 s30, s30, s31
    s_add_u32 s30, s30, 3
    s_lshr_b32 s31, s30, 3
    s_xor_b32 s31, s31, s32
    s_lshl_b32 s34, s30, 16
    s_bitcmp1_b32 s31, 0
    s_cselect_b32 s30, 16384, 0
    s_add_u32 s34, s34, s30
    s_bitcmp1_b32 s31, 1
    s_cselect_b32 s30, 4096, 0
    s_add_u32 s34, s34, s30
    s_xor_b32 s34, s34, s29
    s_add_u32 s34, s34, s57
    buffer_load_dwordx4 v[176:179], v2, s[8:11], s34 offen offset:0 sc1
    buffer_load_dwordx4 v[180:183], v2, s[8:11], s34 offen offset:1024 sc1
    s_lshl_b32 s32, s53, 3
    s_add_u32 s32, s32, 2
    s_lshr_b32 s30, s32, 2
    s_lshl_b32 s30, s30, 1
    s_lshr_b32 s31, s3, 1
    s_add_u32 s30, s30, s31
    s_add_u32 s30, s30, 3
    s_lshr_b32 s31, s30, 3
    s_xor_b32 s31, s31, s32
    s_lshl_b32 s34, s30, 16
    s_bitcmp1_b32 s31, 0
    s_cselect_b32 s30, 16384, 0
    s_add_u32 s34, s34, s30
    s_bitcmp1_b32 s31, 1
    s_cselect_b32 s30, 4096, 0
    s_add_u32 s34, s34, s30
    s_xor_b32 s34, s34, s29
    s_add_u32 s34, s34, s57
    buffer_load_dwordx4 v[184:187], v2, s[8:11], s34 offen offset:0 sc1
    buffer_load_dwordx4 v[188:191], v2, s[8:11], s34 offen offset:1024 sc1
    s_lshl_b32 s32, s53, 3
    s_add_u32 s32, s32, 3
    s_lshr_b32 s30, s32, 2
    s_lshl_b32 s30, s30, 1
    s_lshr_b32 s31, s3, 1
    s_add_u32 s30, s30, s31
    s_add_u32 s30, s30, 3
    s_lshr_b32 s31, s30, 3
    s_xor_b32 s31, s31, s32
    s_lshl_b32 s34, s30, 16
    s_bitcmp1_b32 s31, 0
    s_cselect_b32 s30, 16384, 0
    s_add_u32 s34, s34, s30
    s_bitcmp1_b32 s31, 1
    s_cselect_b32 s30, 4096, 0
    s_add_u32 s34, s34, s30
    s_xor_b32 s34, s34, s29
    s_add_u32 s34, s34, s57
    buffer_load_dwordx4 v[192:195], v2, s[8:11], s34 offen offset:0 sc1
    buffer_load_dwordx4 v[196:199], v2, s[8:11], s34 offen offset:1024 sc1
    s_lshl_b32 s32, s53, 3
    s_add_u32 s32, s32, 4
    s_lshr_b32 s30, s32, 2
    s_lshl_b32 s30, s30, 1
    s_lshr_b32 s31, s3, 1
    s_add_u32 s30, s30, s31
    s_add_u32 s30, s30, 3
    s_lshr_b32 s31, s30, 3
    s_xor_b32 s31, s31, s32
    s_lshl_b32 s34, s30, 16
    s_bitcmp1_b32 s31, 0
    s_cselect_b32 s30, 16384, 0
    s_add_u32 s34, s34, s30
    s_bitcmp1_b32 s31, 1
    s_cselect_b32 s30, 4096, 0
    s_add_u32 s34, s34, s30
    s_xor_b32 s34, s34, s29
    s_add_u32 s34, s34, s57
    buffer_load_dwordx4 v[200:203], v2, s[8:11], s34 offen offset:0 sc1
    buffer_load_dwordx4 v[204:207], v2, s[8:11], s34 offen offset:1024 sc1
    s_lshl_b32 s32, s53, 3
    s_add_u32 s32, s32, 5
    s_lshr_b32 s30, s32, 2
    s_lshl_b32 s30, s30, 1
    s_lshr_b32 s31, s3, 1
    s_add_u32 s30, s30, s31
    s_add_u32 s30, s30, 3
    s_lshr_b32 s31, s30, 3
    s_xor_b32 s31, s31, s32
    s_lshl_b32 s34, s30, 16
    s_bitcmp1_b32 s31, 0
    s_cselect_b32 s30, 16384, 0
    s_add_u32 s34, s34, s30
    s_bitcmp1_b32 s31, 1
    s_cselect_b32 s30, 4096, 0
    s_add_u32 s34, s34, s30
    s_xor_b32 s34, s34, s29
    s_add_u32 s34, s34, s57
    buffer_load_dwordx4 v[208:211], v2, s[8:11], s34 offen offset:0 sc1
    buffer_load_dwordx4 v[212:215], v2, s[8:11], s34 offen offset:1024 sc1
    s_lshl_b32 s32, s53, 3
    s_add_u32 s32, s32, 6
    s_lshr_b32 s30, s32, 2
    s_lshl_b32 s30, s30, 1
    s_lshr_b32 s31, s3, 1
    s_add_u32 s30, s30, s31
    s_add_u32 s30, s30, 3
    s_lshr_b32 s31, s30, 3
    s_xor_b32 s31, s31, s32
    s_lshl_b32 s34, s30, 16
    s_bitcmp1_b32 s31, 0
    s_cselect_b32 s30, 16384, 0
    s_add_u32 s34, s34, s30
    s_bitcmp1_b32 s31, 1
    s_cselect_b32 s30, 4096, 0
    s_add_u32 s34, s34, s30
    s_xor_b32 s34, s34, s29
    s_add_u32 s34, s34, s57
    buffer_load_dwordx4 v[216:219], v2, s[8:11], s34 offen offset:0 sc1
    buffer_load_dwordx4 v[220:223], v2, s[8:11], s34 offen offset:1024 sc1
    s_lshl_b32 s32, s53, 3
    s_add_u32 s32, s32, 7
    s_lshr_b32 s30, s32, 2
    s_lshl_b32 s30, s30, 1
    s_lshr_b32 s31, s3, 1
    s_add_u32 s30, s30, s31
    s_add_u32 s30, s30, 3
    s_lshr_b32 s31, s30, 3
    s_xor_b32 s31, s31, s32
    s_lshl_b32 s34, s30, 16
    s_bitcmp1_b32 s31, 0
    s_cselect_b32 s30, 16384, 0
    s_add_u32 s34, s34, s30
    s_bitcmp1_b32 s31, 1
    s_cselect_b32 s30, 4096, 0
    s_add_u32 s34, s34, s30
    s_xor_b32 s34, s34, s29
    s_add_u32 s34, s34, s57
    buffer_load_dwordx4 v[224:227], v2, s[8:11], s34 offen offset:0 sc1
    buffer_load_dwordx4 v[228:231], v2, s[8:11], s34 offen offset:1024 sc1
    buffer_load_dwordx2 v[248:249], v11, s[8:11], 0 offen sc1
    v_mov_b32 v17, 1
    s_mov_b64 exec, 1
    buffer_atomic_add v17, v18, s[24:27], s59 offen sc0 sc1
    s_mov_b64 exec, -1
    buffer_load_dwordx4 v[20:23], v16, s[8:11], 0 offen sc1
    s_waitcnt vmcnt(38)
    v_mfma_f32_16x16x32_bf16 v[24:27], a[0:3], v[88:91], 0
    v_mfma_f32_16x16x32_bf16 v[28:31], a[32:35], v[88:91], 0
    v_mfma_f32_16x16x32_bf16 v[32:35], a[64:67], v[88:91], 0
    v_mfma_f32_16x16x32_bf16 v[36:39], a[96:99], v[88:91], 0
    v_mfma_f32_16x16x32_bf16 v[40:43], a[128:131], v[88:91], 0
    v_mfma_f32_16x16x32_bf16 v[44:47], a[160:163], v[88:91], 0
    v_mfma_f32_16x16x32_bf16 v[48:51], a[192:195], v[88:91], 0
    v_mfma_f32_16x16x32_bf16 v[52:55], a[224:227], v[88:91], 0
    s_waitcnt vmcnt(37)
    v_mfma_f32_16x16x32_bf16 v[56:59], a[0:3], v[92:95], 0
    v_mfma_f32_16x16x32_bf16 v[60:63], a[32:35], v[92:95], 0
    v_mfma_f32_16x16x32_bf16 v[64:67], a[64:67], v[92:95], 0
    v_mfma_f32_16x16x32_bf16 v[68:71], a[96:99], v[92:95], 0
    v_mfma_f32_16x16x32_bf16 v[72:75], a[128:131], v[92:95], 0
    v_mfma_f32_16x16x32_bf16 v[76:79], a[160:163], v[92:95], 0
    v_mfma_f32_16x16x32_bf16 v[80:83], a[192:195], v[92:95], 0
    v_mfma_f32_16x16x32_bf16 v[84:87], a[224:227], v[92:95], 0
    s_waitcnt vmcnt(36)
    v_mfma_f32_16x16x32_bf16 v[24:27], a[4:7], v[96:99], v[24:27]
    v_mfma_f32_16x16x32_bf16 v[28:31], a[36:39], v[96:99], v[28:31]
    v_mfma_f32_16x16x32_bf16 v[32:35], a[68:71], v[96:99], v[32:35]
    v_mfma_f32_16x16x32_bf16 v[36:39], a[100:103], v[96:99], v[36:39]
    v_mfma_f32_16x16x32_bf16 v[40:43], a[132:135], v[96:99], v[40:43]
    v_mfma_f32_16x16x32_bf16 v[44:47], a[164:167], v[96:99], v[44:47]
    v_mfma_f32_16x16x32_bf16 v[48:51], a[196:199], v[96:99], v[48:51]
    v_mfma_f32_16x16x32_bf16 v[52:55], a[228:231], v[96:99], v[52:55]
    s_waitcnt vmcnt(35)
    v_mfma_f32_16x16x32_bf16 v[56:59], a[4:7], v[100:103], v[56:59]
    v_mfma_f32_16x16x32_bf16 v[60:63], a[36:39], v[100:103], v[60:63]
    v_mfma_f32_16x16x32_bf16 v[64:67], a[68:71], v[100:103], v[64:67]
    v_mfma_f32_16x16x32_bf16 v[68:71], a[100:103], v[100:103], v[68:71]
    v_mfma_f32_16x16x32_bf16 v[72:75], a[132:135], v[100:103], v[72:75]
    v_mfma_f32_16x16x32_bf16 v[76:79], a[164:167], v[100:103], v[76:79]
    v_mfma_f32_16x16x32_bf16 v[80:83], a[196:199], v[100:103], v[80:83]
    v_mfma_f32_16x16x32_bf16 v[84:87], a[228:231], v[100:103], v[84:87]
    s_waitcnt vmcnt(34)
    v_mfma_f32_16x16x32_bf16 v[24:27], a[8:11], v[104:107], v[24:27]
    v_mfma_f32_16x16x32_bf16 v[28:31], a[40:43], v[104:107], v[28:31]
    v_mfma_f32_16x16x32_bf16 v[32:35], a[72:75], v[104:107], v[32:35]
    v_mfma_f32_16x16x32_bf16 v[36:39], a[104:107], v[104:107], v[36:39]
    v_mfma_f32_16x16x32_bf16 v[40:43], a[136:139], v[104:107], v[40:43]
    v_mfma_f32_16x16x32_bf16 v[44:47], a[168:171], v[104:107], v[44:47]
    v_mfma_f32_16x16x32_bf16 v[48:51], a[200:203], v[104:107], v[48:51]
    v_mfma_f32_16x16x32_bf16 v[52:55], a[232:235], v[104:107], v[52:55]
    s_waitcnt vmcnt(33)
    v_mfma_f32_16x16x32_bf16 v[56:59], a[8:11], v[108:111], v[56:59]
    v_mfma_f32_16x16x32_bf16 v[60:63], a[40:43], v[108:111], v[60:63]
    v_mfma_f32_16x16x32_bf16 v[64:67], a[72:75], v[108:111], v[64:67]
    v_mfma_f32_16x16x32_bf16 v[68:71], a[104:107], v[108:111], v[68:71]
    v_mfma_f32_16x16x32_bf16 v[72:75], a[136:139], v[108:111], v[72:75]
    v_mfma_f32_16x16x32_bf16 v[76:79], a[168:171], v[108:111], v[76:79]
    v_mfma_f32_16x16x32_bf16 v[80:83], a[200:203], v[108:111], v[80:83]
    v_mfma_f32_16x16x32_bf16 v[84:87], a[232:235], v[108:111], v[84:87]
    s_waitcnt vmcnt(32)
    v_mfma_f32_16x16x32_bf16 v[24:27], a[12:15], v[112:115], v[24:27]
    v_mfma_f32_16x16x32_bf16 v[28:31], a[44:47], v[112:115], v[28:31]
    v_mfma_f32_16x16x32_bf16 v[32:35], a[76:79], v[112:115], v[32:35]
    v_mfma_f32_16x16x32_bf16 v[36:39], a[108:111], v[112:115], v[36:39]
    v_mfma_f32_16x16x32_bf16 v[40:43], a[140:143], v[112:115], v[40:43]
    v_mfma_f32_16x16x32_bf16 v[44:47], a[172:175], v[112:115], v[44:47]
    v_mfma_f32_16x16x32_bf16 v[48:51], a[204:207], v[112:115], v[48:51]
    v_mfma_f32_16x16x32_bf16 v[52:55], a[236:239], v[112:115], v[52:55]
    s_waitcnt vmcnt(31)
    v_mfma_f32_16x16x32_bf16 v[56:59], a[12:15], v[116:119], v[56:59]
    v_mfma_f32_16x16x32_bf16 v[60:63], a[44:47], v[116:119], v[60:63]
    v_mfma_f32_16x16x32_bf16 v[64:67], a[76:79], v[116:119], v[64:67]
    v_mfma_f32_16x16x32_bf16 v[68:71], a[108:111], v[116:119], v[68:71]
    v_mfma_f32_16x16x32_bf16 v[72:75], a[140:143], v[116:119], v[72:75]
    v_mfma_f32_16x16x32_bf16 v[76:79], a[172:175], v[116:119], v[76:79]
    v_mfma_f32_16x16x32_bf16 v[80:83], a[204:207], v[116:119], v[80:83]
    v_mfma_f32_16x16x32_bf16 v[84:87], a[236:239], v[116:119], v[84:87]
    s_waitcnt vmcnt(30)
    v_mfma_f32_16x16x32_bf16 v[24:27], a[16:19], v[120:123], v[24:27]
    v_mfma_f32_16x16x32_bf16 v[28:31], a[48:51], v[120:123], v[28:31]
    v_mfma_f32_16x16x32_bf16 v[32:35], a[80:83], v[120:123], v[32:35]
    v_mfma_f32_16x16x32_bf16 v[36:39], a[112:115], v[120:123], v[36:39]
    v_mfma_f32_16x16x32_bf16 v[40:43], a[144:147], v[120:123], v[40:43]
    v_mfma_f32_16x16x32_bf16 v[44:47], a[176:179], v[120:123], v[44:47]
    v_mfma_f32_16x16x32_bf16 v[48:51], a[208:211], v[120:123], v[48:51]
    v_mfma_f32_16x16x32_bf16 v[52:55], a[240:243], v[120:123], v[52:55]
    s_waitcnt vmcnt(29)
    v_mfma_f32_16x16x32_bf16 v[56:59], a[16:19], v[124:127], v[56:59]
    v_mfma_f32_16x16x32_bf16 v[60:63], a[48:51], v[124:127], v[60:63]
    v_mfma_f32_16x16x32_bf16 v[64:67], a[80:83], v[124:127], v[64:67]
    v_mfma_f32_16x16x32_bf16 v[68:71], a[112:115], v[124:127], v[68:71]
    v_mfma_f32_16x16x32_bf16 v[72:75], a[144:147], v[124:127], v[72:75]
    v_mfma_f32_16x16x32_bf16 v[76:79], a[176:179], v[124:127], v[76:79]
    v_mfma_f32_16x16x32_bf16 v[80:83], a[208:211], v[124:127], v[80:83]
    v_mfma_f32_16x16x32_bf16 v[84:87], a[240:243], v[124:127], v[84:87]
    s_waitcnt vmcnt(28)
    v_mfma_f32_16x16x32_bf16 v[24:27], a[20:23], v[128:131], v[24:27]
    v_mfma_f32_16x16x32_bf16 v[28:31], a[52:55], v[128:131], v[28:31]
    v_mfma_f32_16x16x32_bf16 v[32:35], a[84:87], v[128:131], v[32:35]
    v_mfma_f32_16x16x32_bf16 v[36:39], a[116:119], v[128:131], v[36:39]
    v_mfma_f32_16x16x32_bf16 v[40:43], a[148:151], v[128:131], v[40:43]
    v_mfma_f32_16x16x32_bf16 v[44:47], a[180:183], v[128:131], v[44:47]
    v_mfma_f32_16x16x32_bf16 v[48:51], a[212:215], v[128:131], v[48:51]
    v_mfma_f32_16x16x32_bf16 v[52:55], a[244:247], v[128:131], v[52:55]
    s_waitcnt vmcnt(27)
    v_mfma_f32_16x16x32_bf16 v[56:59], a[20:23], v[132:135], v[56:59]
    v_mfma_f32_16x16x32_bf16 v[60:63], a[52:55], v[132:135], v[60:63]
    v_mfma_f32_16x16x32_bf16 v[64:67], a[84:87], v[132:135], v[64:67]
    v_mfma_f32_16x16x32_bf16 v[68:71], a[116:119], v[132:135], v[68:71]
    v_mfma_f32_16x16x32_bf16 v[72:75], a[148:151], v[132:135], v[72:75]
    v_mfma_f32_16x16x32_bf16 v[76:79], a[180:183], v[132:135], v[76:79]
    v_mfma_f32_16x16x32_bf16 v[80:83], a[212:215], v[132:135], v[80:83]
    v_mfma_f32_16x16x32_bf16 v[84:87], a[244:247], v[132:135], v[84:87]
    s_waitcnt vmcnt(26)
    v_mfma_f32_16x16x32_bf16 v[24:27], a[24:27], v[136:139], v[24:27]
    v_mfma_f32_16x16x32_bf16 v[28:31], a[56:59], v[136:139], v[28:31]
    v_mfma_f32_16x16x32_bf16 v[32:35], a[88:91], v[136:139], v[32:35]
    v_mfma_f32_16x16x32_bf16 v[36:39], a[120:123], v[136:139], v[36:39]
    v_mfma_f32_16x16x32_bf16 v[40:43], a[152:155], v[136:139], v[40:43]
    v_mfma_f32_16x16x32_bf16 v[44:47], a[184:187], v[136:139], v[44:47]
    v_mfma_f32_16x16x32_bf16 v[48:51], a[216:219], v[136:139], v[48:51]
    v_mfma_f32_16x16x32_bf16 v[52:55], a[248:251], v[136:139], v[52:55]
    s_waitcnt vmcnt(25)
    v_mfma_f32_16x16x32_bf16 v[56:59], a[24:27], v[140:143], v[56:59]
    v_mfma_f32_16x16x32_bf16 v[60:63], a[56:59], v[140:143], v[60:63]
    v_mfma_f32_16x16x32_bf16 v[64:67], a[88:91], v[140:143], v[64:67]
    v_mfma_f32_16x16x32_bf16 v[68:71], a[120:123], v[140:143], v[68:71]
    v_mfma_f32_16x16x32_bf16 v[72:75], a[152:155], v[140:143], v[72:75]
    v_mfma_f32_16x16x32_bf16 v[76:79], a[184:187], v[140:143], v[76:79]
    v_mfma_f32_16x16x32_bf16 v[80:83], a[216:219], v[140:143], v[80:83]
    v_mfma_f32_16x16x32_bf16 v[84:87], a[248:251], v[140:143], v[84:87]
    s_waitcnt vmcnt(24)
    v_mfma_f32_16x16x32_bf16 v[24:27], a[28:31], v[144:147], v[24:27]
    v_mfma_f32_16x16x32_bf16 v[28:31], a[60:63], v[144:147], v[28:31]
    v_mfma_f32_16x16x32_bf16 v[32:35], a[92:95], v[144:147], v[32:35]
    v_mfma_f32_16x16x32_bf16 v[36:39], a[124:127], v[144:147], v[36:39]
    v_mfma_f32_16x16x32_bf16 v[40:43], a[156:159], v[144:147], v[40:43]
    v_mfma_f32_16x16x32_bf16 v[44:47], a[188:191], v[144:147], v[44:47]
    v_mfma_f32_16x16x32_bf16 v[48:51], a[220:223], v[144:147], v[48:51]
    v_mfma_f32_16x16x32_bf16 v[52:55], a[252:255], v[144:147], v[52:55]
    s_waitcnt vmcnt(23)
    v_mfma_f32_16x16x32_bf16 v[56:59], a[28:31], v[148:151], v[56:59]
    v_mfma_f32_16x16x32_bf16 v[60:63], a[60:63], v[148:151], v[60:63]
    v_mfma_f32_16x16x32_bf16 v[64:67], a[92:95], v[148:151], v[64:67]
    v_mfma_f32_16x16x32_bf16 v[68:71], a[124:127], v[148:151], v[68:71]
    v_mfma_f32_16x16x32_bf16 v[72:75], a[156:159], v[148:151], v[72:75]
    v_mfma_f32_16x16x32_bf16 v[76:79], a[188:191], v[148:151], v[76:79]
    v_mfma_f32_16x16x32_bf16 v[80:83], a[220:223], v[148:151], v[80:83]
    v_mfma_f32_16x16x32_bf16 v[84:87], a[252:255], v[148:151], v[84:87]
    buffer_load_dwordx4 v[88:91], v2, s[8:11], s55 offen offset:0 sc1
    buffer_load_dwordx4 v[92:95], v2, s[8:11], s55 offen offset:1024 sc1
    buffer_load_dwordx4 v[96:99], v2, s[8:11], s55 offen offset:2048 sc1
    buffer_load_dwordx4 v[100:103], v2, s[8:11], s55 offen offset:3072 sc1
    s_waitcnt vmcnt(22)
    v_mfma_f32_16x16x32_bf16 v[24:27], v[168:171], v[152:155], v[24:27]
    v_mfma_f32_16x16x32_bf16 v[56:59], v[168:171], v[156:159], v[56:59]
    s_waitcnt vmcnt(21)
    v_mfma_f32_16x16x32_bf16 v[24:27], v[172:175], v[160:163], v[24:27]
    v_mfma_f32_16x16x32_bf16 v[56:59], v[172:175], v[164:167], v[56:59]
    s_waitcnt vmcnt(20)
    v_mfma_f32_16x16x32_bf16 v[28:31], v[176:179], v[152:155], v[28:31]
    v_mfma_f32_16x16x32_bf16 v[60:63], v[176:179], v[156:159], v[60:63]
    s_waitcnt vmcnt(19)
    v_mfma_f32_16x16x32_bf16 v[28:31], v[180:183], v[160:163], v[28:31]
    v_mfma_f32_16x16x32_bf16 v[60:63], v[180:183], v[164:167], v[60:63]
    s_waitcnt vmcnt(18)
    v_mfma_f32_16x16x32_bf16 v[32:35], v[184:187], v[152:155], v[32:35]
    v_mfma_f32_16x16x32_bf16 v[64:67], v[184:187], v[156:159], v[64:67]
    s_waitcnt vmcnt(17)
    v_mfma_f32_16x16x32_bf16 v[32:35], v[188:191], v[160:163], v[32:35]
    v_mfma_f32_16x16x32_bf16 v[64:67], v[188:191], v[164:167], v[64:67]
    s_waitcnt vmcnt(16)
    v_mfma_f32_16x16x32_bf16 v[36:39], v[192:195], v[152:155], v[36:39]
    v_mfma_f32_16x16x32_bf16 v[68:71], v[192:195], v[156:159], v[68:71]
    s_waitcnt vmcnt(15)
    v_mfma_f32_16x16x32_bf16 v[36:39], v[196:199], v[160:163], v[36:39]
    v_mfma_f32_16x16x32_bf16 v[68:71], v[196:199], v[164:167], v[68:71]
    s_waitcnt vmcnt(14)
    v_mfma_f32_16x16x32_bf16 v[40:43], v[200:203], v[152:155], v[40:43]
    v_mfma_f32_16x16x32_bf16 v[72:75], v[200:203], v[156:159], v[72:75]
    s_waitcnt vmcnt(13)
    v_mfma_f32_16x16x32_bf16 v[40:43], v[204:207], v[160:163], v[40:43]
    v_mfma_f32_16x16x32_bf16 v[72:75], v[204:207], v[164:167], v[72:75]
    s_waitcnt vmcnt(12)
    v_mfma_f32_16x16x32_bf16 v[44:47], v[208:211], v[152:155], v[44:47]
    v_mfma_f32_16x16x32_bf16 v[76:79], v[208:211], v[156:159], v[76:79]
    s_waitcnt vmcnt(11)
    v_mfma_f32_16x16x32_bf16 v[44:47], v[212:215], v[160:163], v[44:47]
    v_mfma_f32_16x16x32_bf16 v[76:79], v[212:215], v[164:167], v[76:79]
    s_waitcnt vmcnt(10)
    v_mfma_f32_16x16x32_bf16 v[48:51], v[216:219], v[152:155], v[48:51]
    v_mfma_f32_16x16x32_bf16 v[80:83], v[216:219], v[156:159], v[80:83]
    s_waitcnt vmcnt(9)
    v_mfma_f32_16x16x32_bf16 v[48:51], v[220:223], v[160:163], v[48:51]
    v_mfma_f32_16x16x32_bf16 v[80:83], v[220:223], v[164:167], v[80:83]
    s_waitcnt vmcnt(8)
    v_mfma_f32_16x16x32_bf16 v[52:55], v[224:227], v[152:155], v[52:55]
    v_mfma_f32_16x16x32_bf16 v[84:87], v[224:227], v[156:159], v[84:87]
    s_waitcnt vmcnt(7)
    v_mfma_f32_16x16x32_bf16 v[52:55], v[228:231], v[160:163], v[52:55]
    v_mfma_f32_16x16x32_bf16 v[84:87], v[228:231], v[164:167], v[84:87]
    ds_write_b128 v6, v[24:27] offset:0
    ds_write_b128 v6, v[28:31] offset:1024
    ds_write_b128 v6, v[32:35] offset:2048
    ds_write_b128 v6, v[36:39] offset:3072
    ds_write_b128 v6, v[40:43] offset:4096
    ds_write_b128 v6, v[44:47] offset:5120
    ds_write_b128 v6, v[48:51] offset:6144
    ds_write_b128 v6, v[52:55] offset:7168
    ds_write_b128 v6, v[56:59] offset:8192
    ds_write_b128 v6, v[60:63] offset:9216
    ds_write_b128 v6, v[64:67] offset:10240
    ds_write_b128 v6, v[68:71] offset:11264
    ds_write_b128 v6, v[72:75] offset:12288
    ds_write_b128 v6, v[76:79] offset:13312
    ds_write_b128 v6, v[80:83] offset:14336
    ds_write_b128 v6, v[84:87] offset:15360
    s_waitcnt vmcnt(5)
    s_cmp_lg_u32 s3, 0
    s_cbranch_scc1 Lxk_157
    s_mov_b64 exec, 1
    ds_write_b32 v19, v17
    s_mov_b64 exec, -1
Lxk_157:
    s_waitcnt vmcnt(4)
    v_min_u32 v21, v20, v21
    v_min3_u32 v21, v21, v22, v23
    v_max_u32 v20, 1, v20
    v_add_u32 v20, -1, v20
    v_cndmask_b32 v20, v20, v21, s[46:47]
    s_nop 1
    v_min_u32_dpp v20, v20, v20 row_ror:8 row_mask:0xf bank_mask:0xf
    s_nop 1
    v_min_u32_dpp v20, v20, v20 row_ror:4 row_mask:0xf bank_mask:0xf
    s_nop 1
    v_min_u32_dpp v20, v20, v20 row_ror:2 row_mask:0xf bank_mask:0xf
    s_nop 1
    v_min_u32_dpp v20, v20, v20 row_ror:1 row_mask:0xf bank_mask:0xf
    s_nop 0
    v_readlane_b32 s58, v20, 0
    v_readlane_b32 s30, v20, 16
    s_nop 0
    s_min_u32 s58, s58, s30
    s_min_u32 s58, s58, 62
    s_waitcnt lgkmcnt(0)
    s_barrier
    ds_read_b128 v[24:27], v7 offset:0
    ds_read_b128 v[28:31], v7 offset:16384
    ds_read_b128 v[32:35], v7 offset:32768
    ds_read_b128 v[36:39], v7 offset:49152
    ds_read_b128 v[40:43], v7 offset:1024
    ds_read_b128 v[44:47], v7 offset:17408
    ds_read_b128 v[48:51], v7 offset:33792
    ds_read_b128 v[52:55], v7 offset:50176
    ds_read_b128 v[56:59], v7 offset:2048
    ds_read_b128 v[60:63], v7 offset:18432
    ds_read_b128 v[64:67], v7 offset:34816
    ds_read_b128 v[68:71], v7 offset:51200
    ds_read_b128 v[72:75], v7 offset:3072
    ds_read_b128 v[76:79], v7 offset:19456
    ds_read_b128 v[80:83], v7 offset:35840
    ds_read_b128 v[84:87], v7 offset:52224
    s_waitcnt lgkmcnt(14)
    v_add_f32 v24, v24, v28
    v_add_f32 v25, v25, v29
    v_add_f32 v26, v26, v30
    v_add_f32 v27, v27, v31
    s_waitcnt lgkmcnt(12)
    v_add_f32 v32, v32, v36
    v_add_f32 v33, v33, v37
    v_add_f32 v34, v34, v38
    v_add_f32 v35, v35, v39
    v_add_f32 v24, v24, v32
    v_add_f32 v25, v25, v33
    v_add_f32 v26, v26, v34
    v_add_f32 v27, v27, v35
    v_cvt_pk_bf16_f32 v32, v24, v25
    v_lshlrev_b32 v24, 16, v32
    v_and_b32 v25, s44, v32
    v_mul_f32 v24, v24, v248
    v_mul_f32 v25, v25, v248
    v_cvt_pk_bf16_f32 v32, v24, v25
    v_lshlrev_b32 v24, 16, v32
    v_and_b32 v25, s44, v32
    v_lshlrev_b32 v28, 16, v232
    v_and_b32 v29, s44, v232
    v_lshlrev_b32 v30, 16, v240
    v_and_b32 v31, s44, v240
    v_mul_f32 v28, v28, v30
    v_mul_f32 v29, v29, v31
    v_cvt_pk_bf16_f32 v32, v28, v29
    v_lshlrev_b32 v28, 16, v32
    v_and_b32 v29, s44, v32
    s_waitcnt vmcnt(3)
    v_add_f32 v28, v28, v88
    v_add_f32 v29, v29, v89
    v_mul_f32 v28, v28, v249
    v_mul_f32 v29, v29, v249
    v_add_f32 v24, v24, v28
    v_add_f32 v25, v25, v29
    v_cvt_pk_bf16_f32 v32, v26, v27
    v_lshlrev_b32 v26, 16, v32
    v_and_b32 v27, s44, v32
    v_mul_f32 v26, v26, v248
    v_mul_f32 v27, v27, v248
    v_cvt_pk_bf16_f32 v32, v26, v27
    v_lshlrev_b32 v26, 16, v32
    v_and_b32 v27, s44, v32
    v_lshlrev_b32 v28, 16, v233
    v_and_b32 v29, s44, v233
    v_lshlrev_b32 v30, 16, v241
    v_and_b32 v31, s44, v241
    v_mul_f32 v28, v28, v30
    v_mul_f32 v29, v29, v31
    v_cvt_pk_bf16_f32 v32, v28, v29
    v_lshlrev_b32 v28, 16, v32
    v_and_b32 v29, s44, v32
    v_add_f32 v28, v28, v90
    v_add_f32 v29, v29, v91
    v_mul_f32 v28, v28, v249
    v_mul_f32 v29, v29, v249
    v_add_f32 v26, v26, v28
    v_add_f32 v27, v27, v29
    buffer_store_dwordx4 v[24:27], v10, s[12:15], 0 offen offset:0
    s_waitcnt lgkmcnt(10)
    v_add_f32 v40, v40, v44
    v_add_f32 v41, v41, v45
    v_add_f32 v42, v42, v46
    v_add_f32 v43, v43, v47
    s_waitcnt lgkmcnt(8)
    v_add_f32 v48, v48, v52
    v_add_f32 v49, v49, v53
    v_add_f32 v50, v50, v54
    v_add_f32 v51, v51, v55
    v_add_f32 v40, v40, v48
    v_add_f32 v41, v41, v49
    v_add_f32 v42, v42, v50
    v_add_f32 v43, v43, v51
    v_cvt_pk_bf16_f32 v48, v40, v41
    v_lshlrev_b32 v40, 16, v48
    v_and_b32 v41, s44, v48
    v_mul_f32 v40, v40, v248
    v_mul_f32 v41, v41, v248
    v_cvt_pk_bf16_f32 v48, v40, v41
    v_lshlrev_b32 v40, 16, v48
    v_and_b32 v41, s44, v48
    v_lshlrev_b32 v44, 16, v234
    v_and_b32 v45, s44, v234
    v_lshlrev_b32 v46, 16, v242
    v_and_b32 v47, s44, v242
    v_mul_f32 v44, v44, v46
    v_mul_f32 v45, v45, v47
    v_cvt_pk_bf16_f32 v48, v44, v45
    v_lshlrev_b32 v44, 16, v48
    v_and_b32 v45, s44, v48
    s_waitcnt vmcnt(3)
    v_add_f32 v44, v44, v92
    v_add_f32 v45, v45, v93
    v_mul_f32 v44, v44, v249
    v_mul_f32 v45, v45, v249
    v_add_f32 v40, v40, v44
    v_add_f32 v41, v41, v45
    v_cvt_pk_bf16_f32 v48, v42, v43
    v_lshlrev_b32 v42, 16, v48
    v_and_b32 v43, s44, v48
    v_mul_f32 v42, v42, v248
    v_mul_f32 v43, v43, v248
    v_cvt_pk_bf16_f32 v48, v42, v43
    v_lshlrev_b32 v42, 16, v48
    v_and_b32 v43, s44, v48
    v_lshlrev_b32 v44, 16, v235
    v_and_b32 v45, s44, v235
    v_lshlrev_b32 v46, 16, v243
    v_and_b32 v47, s44, v243
    v_mul_f32 v44, v44, v46
    v_mul_f32 v45, v45, v47
    v_cvt_pk_bf16_f32 v48, v44, v45
    v_lshlrev_b32 v44, 16, v48
    v_and_b32 v45, s44, v48
    v_add_f32 v44, v44, v94
    v_add_f32 v45, v45, v95
    v_mul_f32 v44, v44, v249
    v_mul_f32 v45, v45, v249
    v_add_f32 v42, v42, v44
    v_add_f32 v43, v43, v45
    buffer_store_dwordx4 v[40:43], v10, s[12:15], 0 offen offset:64
    s_waitcnt lgkmcnt(6)
    v_add_f32 v56, v56, v60
    v_add_f32 v57, v57, v61
    v_add_f32 v58, v58, v62
    v_add_f32 v59, v59, v63
    s_waitcnt lgkmcnt(4)
    v_add_f32 v64, v64, v68
    v_add_f32 v65, v65, v69
    v_add_f32 v66, v66, v70
    v_add_f32 v67, v67, v71
    v_add_f32 v56, v56, v64
    v_add_f32 v57, v57, v65
    v_add_f32 v58, v58, v66
    v_add_f32 v59, v59, v67
    v_cvt_pk_bf16_f32 v64, v56, v57
    v_lshlrev_b32 v56, 16, v64
    v_and_b32 v57, s44, v64
    v_mul_f32 v56, v56, v248
    v_mul_f32 v57, v57, v248
    v_cvt_pk_bf16_f32 v64, v56, v57
    v_lshlrev_b32 v56, 16, v64
    v_and_b32 v57, s44, v64
    v_lshlrev_b32 v60, 16, v236
    v_and_b32 v61, s44, v236
    v_lshlrev_b32 v62, 16, v244
    v_and_b32 v63, s44, v244
    v_mul_f32 v60, v60, v62
    v_mul_f32 v61, v61, v63
    v_cvt_pk_bf16_f32 v64, v60, v61
    v_lshlrev_b32 v60, 16, v64
    v_and_b32 v61, s44, v64
    s_waitcnt vmcnt(3)
    v_add_f32 v60, v60, v96
    v_add_f32 v61, v61, v97
    v_mul_f32 v60, v60, v249
    v_mul_f32 v61, v61, v249
    v_add_f32 v56, v56, v60
    v_add_f32 v57, v57, v61
    v_cvt_pk_bf16_f32 v64, v58, v59
    v_lshlrev_b32 v58, 16, v64
    v_and_b32 v59, s44, v64
    v_mul_f32 v58, v58, v248
    v_mul_f32 v59, v59, v248
    v_cvt_pk_bf16_f32 v64, v58, v59
    v_lshlrev_b32 v58, 16, v64
    v_and_b32 v59, s44, v64
    v_lshlrev_b32 v60, 16, v237
    v_and_b32 v61, s44, v237
    v_lshlrev_b32 v62, 16, v245
    v_and_b32 v63, s44, v245
    v_mul_f32 v60, v60, v62
    v_mul_f32 v61, v61, v63
    v_cvt_pk_bf16_f32 v64, v60, v61
    v_lshlrev_b32 v60, 16, v64
    v_and_b32 v61, s44, v64
    v_add_f32 v60, v60, v98
    v_add_f32 v61, v61, v99
    v_mul_f32 v60, v60, v249
    v_mul_f32 v61, v61, v249
    v_add_f32 v58, v58, v60
    v_add_f32 v59, v59, v61
    buffer_store_dwordx4 v[56:59], v10, s[12:15], 0 offen offset:128
    s_waitcnt lgkmcnt(2)
    v_add_f32 v72, v72, v76
    v_add_f32 v73, v73, v77
    v_add_f32 v74, v74, v78
    v_add_f32 v75, v75, v79
    s_waitcnt lgkmcnt(0)
    v_add_f32 v80, v80, v84
    v_add_f32 v81, v81, v85
    v_add_f32 v82, v82, v86
    v_add_f32 v83, v83, v87
    v_add_f32 v72, v72, v80
    v_add_f32 v73, v73, v81
    v_add_f32 v74, v74, v82
    v_add_f32 v75, v75, v83
    v_cvt_pk_bf16_f32 v80, v72, v73
    v_lshlrev_b32 v72, 16, v80
    v_and_b32 v73, s44, v80
    v_mul_f32 v72, v72, v248
    v_mul_f32 v73, v73, v248
    v_cvt_pk_bf16_f32 v80, v72, v73
    v_lshlrev_b32 v72, 16, v80
    v_and_b32 v73, s44, v80
    v_lshlrev_b32 v76, 16, v238
    v_and_b32 v77, s44, v238
    v_lshlrev_b32 v78, 16, v246
    v_and_b32 v79, s44, v246
    v_mul_f32 v76, v76, v78
    v_mul_f32 v77, v77, v79
    v_cvt_pk_bf16_f32 v80, v76, v77
    v_lshlrev_b32 v76, 16, v80
    v_and_b32 v77, s44, v80
    s_waitcnt vmcnt(3)
    v_add_f32 v76, v76, v100
    v_add_f32 v77, v77, v101
    v_mul_f32 v76, v76, v249
    v_mul_f32 v77, v77, v249
    v_add_f32 v72, v72, v76
    v_add_f32 v73, v73, v77
    v_cvt_pk_bf16_f32 v80, v74, v75
    v_lshlrev_b32 v74, 16, v80
    v_and_b32 v75, s44, v80
    v_mul_f32 v74, v74, v248
    v_mul_f32 v75, v75, v248
    v_cvt_pk_bf16_f32 v80, v74, v75
    v_lshlrev_b32 v74, 16, v80
    v_and_b32 v75, s44, v80
    v_lshlrev_b32 v76, 16, v239
    v_and_b32 v77, s44, v239
    v_lshlrev_b32 v78, 16, v247
    v_and_b32 v79, s44, v247
    v_mul_f32 v76, v76, v78
    v_mul_f32 v77, v77, v79
    v_cvt_pk_bf16_f32 v80, v76, v77
    v_lshlrev_b32 v76, 16, v80
    v_and_b32 v77, s44, v80
    v_add_f32 v76, v76, v102
    v_add_f32 v77, v77, v103
    v_mul_f32 v76, v76, v249
    v_mul_f32 v77, v77, v249
    v_add_f32 v74, v74, v76
    v_add_f32 v75, v75, v77
    buffer_store_dwordx4 v[72:75], v10, s[12:15], 0 offen offset:192
    s_nop 0
    s_branch L_xc_loop
L_xc_narrow:
    s_sub_u32 s53, s50, 300
    s_mul_i32 s52, s53, 104858
    s_lshr_b32 s52, s52, 20
    s_mul_i32 s30, s52, 10
    s_sub_u32 s53, s53, s30
    s_add_u32 s52, s52, 60
    s_lshl_b32 s30, s3, 13
    v_add_u32 v6, s30, v2
    s_lshl_b32 s30, s3, 11
    v_add_u32 v7, s30, v2
    s_cmp_lt_u32 s52, s58
    s_cbranch_scc1 Lxf1_158
    s_mov_b32 s31, 0
Lxp_160:
    buffer_load_dwordx4 v[12:15], v4, s[8:11], 0 offen sc1
    s_add_u32 s31, s31, 1
    s_cmp_gt_u32 s31, 400000
    s_cbranch_scc1 L_abort
    s_waitcnt vmcnt(0)
    v_min_u32 v12, v12, v13
    v_min3_u32 v12, v12, v14, v15
    v_cmp_ge_u32 vcc, s52, v12
    s_nop 0
    s_cbranch_vccz Lxo_161
    s_sleep 4
    s_branch Lxp_160
Lxo_161:
Lxf1_158:
    s_mul_i32 s54, s52, 1310720
    s_lshl_b32 s30, s53, 17
    s_add_u32 s54, s54, s30
    s_lshl_b32 s30, s3, 13
    s_add_u32 s54, s54, s30
    s_add_u32 s54, s54, 142606336
    s_add_u32 s34, s54, 0
    buffer_load_dwordx4 a[0:3], v2, s[8:11], s34 offen offset:0 sc1
    buffer_load_dwordx4 a[4:7], v2, s[8:11], s34 offen offset:1024 sc1
    buffer_load_dwordx4 a[8:11], v2, s[8:11], s34 offen offset:2048 sc1
    buffer_load_dwordx4 a[12:15], v2, s[8:11], s34 offen offset:3072 sc1
    s_add_u32 s34, s54, 4096
    buffer_load_dwordx4 a[16:19], v2, s[8:11], s34 offen offset:0 sc1
    buffer_load_dwordx4 a[20:23], v2, s[8:11], s34 offen offset:1024 sc1
    buffer_load_dwordx4 a[24:27], v2, s[8:11], s34 offen offset:2048 sc1
    buffer_load_dwordx4 a[28:31], v2, s[8:11], s34 offen offset:3072 sc1
    s_add_u32 s34, s54, 32768
    buffer_load_dwordx4 a[32:35], v2, s[8:11], s34 offen offset:0 sc1
    buffer_load_dwordx4 a[36:39], v2, s[8:11], s34 offen offset:1024 sc1
    buffer_load_dwordx4 a[40:43], v2, s[8:11], s34 offen offset:2048 sc1
    buffer_load_dwordx4 a[44:47], v2, s[8:11], s34 offen offset:3072 sc1
    s_add_u32 s34, s54, 36864
    buffer_load_dwordx4 a[48:51], v2, s[8:11], s34 offen offset:0 sc1
    buffer_load_dwordx4 a[52:55], v2, s[8:11], s34 offen offset:1024 sc1
    buffer_load_dwordx4 a[56:59], v2, s[8:11], s34 offen offset:2048 sc1
    buffer_load_dwordx4 a[60:63], v2, s[8:11], s34 offen offset:3072 sc1
    s_add_u32 s34, s54, 65536
    buffer_load_dwordx4 a[64:67], v2, s[8:11], s34 offen offset:0 sc1
    buffer_load_dwordx4 a[68:71], v2, s[8:11], s34 offen offset:1024 sc1
    buffer_load_dwordx4 a[72:75], v2, s[8:11], s34 offen offset:2048 sc1
    buffer_load_dwordx4 a[76:79], v2, s[8:11], s34 offen offset:3072 sc1
    s_add_u32 s34, s54, 69632
    buffer_load_dwordx4 a[80:83], v2, s[8:11], s34 offen offset:0 sc1
    buffer_load_dwordx4 a[84:87], v2, s[8:11], s34 offen offset:1024 sc1
    buffer_load_dwordx4 a[88:91], v2, s[8:11], s34 offen offset:2048 sc1
    buffer_load_dwordx4 a[92:95], v2, s[8:11], s34 offen offset:3072 sc1
    s_add_u32 s34, s54, 98304
    buffer_load_dwordx4 a[96:99], v2, s[8:11], s34 offen offset:0 sc1
    buffer_load_dwordx4 a[100:103], v2, s[8:11], s34 offen offset:1024 sc1
    buffer_load_dwordx4 a[104:107], v2, s[8:11], s34 offen offset:2048 sc1
    buffer_load_dwordx4 a[108:111], v2, s[8:11], s34 offen offset:3072 sc1
    s_add_u32 s34, s54, 102400
    buffer_load_dwordx4 a[112:115], v2, s[8:11], s34 offen offset:0 sc1
    buffer_load_dwordx4 a[116:119], v2, s[8:11], s34 offen offset:1024 sc1
    buffer_load_dwordx4 a[120:123], v2, s[8:11], s34 offen offset:2048 sc1
    buffer_load_dwordx4 a[124:127], v2, s[8:11], s34 offen offset:3072 sc1
    s_lshl_b32 s30, s3, 3
    v_and_b32 v12, 7, v1
    v_add_u32 v12, s30, v12
    v_and_b32 v13, 8, v1
    v_lshl_add_u32 v12, v13, 2, v12
    s_lshl_b32 s30, s53, 2
    s_lshr_b32 s30, s30, 3
    s_and_b32 s31, s52, 1
    s_mul_i32 s31, s31, 5
    s_add_u32 s30, s30, s31
    s_add_u32 s30, s30, 242
    v_mov_b32 v13, s30
    v_cmp_gt_u32 vcc, 16, v1
    s_nop 1
    v_cndmask_b32 v12, v13, v12, vcc
    s_cmp_lt_u32 s52, 62
    s_cselect_b32 s30, 16, 0
    v_cmp_le_u32 vcc, s30, v1
    s_nop 1
    v_cndmask_b32 v12, v13, v12, vcc
    v_lshlrev_b32 v5, 7, v12
    v_add_u32 v5, 246415360, v5
    s_lshr_b32 s30, s3, 1
    s_lshl_b32 s31, s52, 1
    s_add_u32 s31, s31, s30
    s_lshl_b32 s32, s53, 2
    s_and_b32 s33, s3, 1
    s_lshl_b32 s33, s33, 1
    s_add_u32 s32, s32, s33
    s_mul_i32 s55, s31, 40
    s_add_u32 s55, s55, s32
    s_lshl_b32 s55, s55, 10
    s_add_u32 s55, s55, 239075328
    s_lshl_b32 s31, s31, 4
    v_and_b32 v12, 15, v1
    v_add_u32 v12, s31, v12
    v_lshrrev_b32 v13, 4, v1
    s_lshl_b32 s32, s32, 5
    v_lshl_add_u32 v8, v13, 3, s32
    v_mul_u32_u24 v9, 1280, v12
    v_add_u32 v9, v9, v8
    v_lshlrev_b32 v10, 1, v9
    v_lshlrev_b32 v11, 3, v12
    v_add_u32 v11, 245366784, v11
    buffer_load_dwordx2 v[232:233], v9, s[16:19], 0 offen offset:0
    buffer_load_dwordx2 v[240:241], v8, s[20:23], 0 offen offset:0
    buffer_load_dwordx2 v[234:235], v9, s[16:19], 0 offen offset:32
    buffer_load_dwordx2 v[242:243], v8, s[20:23], 0 offen offset:32
    s_cmp_lt_u32 s52, s58
    s_cbranch_scc1 Lxf2_159
    s_mov_b32 s31, 0
    v_mov_b32 v13, 246419456
    s_add_u32 s33, s52, 2
    s_cmp_lt_u32 s52, 62
    s_cselect_b32 s33, s33, 62
Lxcw_162:
    buffer_load_dword v12, v13, s[8:11], 0 offen sc1
    s_add_u32 s31, s31, 1
    s_cmp_gt_u32 s31, 400000
    s_cbranch_scc1 L_abort
    s_waitcnt vmcnt(0)
    v_readfirstlane_b32 s30, v12
    s_nop 0
    s_cmp_ge_u32 s30, s33
    s_nop 1
    s_cbranch_scc1 Lxcok_163
    s_sleep 12
    s_branch Lxcw_162
Lxcok_163:
    s_mov_b32 s31, 0
Lxp_164:
    buffer_load_dwordx4 v[12:15], v5, s[8:11], 0 offen sc1
    s_add_u32 s31, s31, 1
    s_cmp_gt_u32 s31, 400000
    s_cbranch_scc1 L_abort
    s_waitcnt vmcnt(0)
    v_min_u32 v12, v12, v13
    v_min3_u32 v12, v12, v14, v15
    v_cmp_ge_u32 vcc, s52, v12
    s_nop 0
    s_cbranch_vccz Lxo_165
    s_sleep 4
    s_branch Lxp_164
Lxo_165:
Lxf2_159:
    s_lshr_b32 s37, s52, 1
    s_bitcmp1_b32 s7, s37
    s_cselect_b32 s29, 16384, 0
    s_bitcmp1_b32 s28, s37
    s_cselect_b32 s62, 4096, 0
    s_or_b32 s29, s29, s62
    s_lshl_b32 s62, s37, 21
    s_lshr_b32 s37, s60, s37
    s_and_b32 s37, s37, 1
    s_lshl_b32 s37, s37, 13
    s_add_u32 s62, s62, s37
    s_and_b32 s37, s52, 1
    s_lshl_b32 s37, s37, 15
    s_add_u32 s62, s62, s37
    s_mul_i32 s56, s52, 81920
    s_mul_i32 s30, s3, 20480
    s_add_u32 s56, s56, s30
    s_add_u32 s56, s56, 226492416
    s_and_b32 s30, s3, 1
    s_lshl_b32 s30, s30, 11
    s_add_u32 s57, s62, s30
    s_add_u32 s34, s56, 0
    buffer_load_dwordx4 v[88:91], v2, s[8:11], s34 offen offset:0 sc1
    buffer_load_dwordx4 v[92:95], v2, s[8:11], s34 offen offset:1024 sc1
    s_add_u32 s34, s56, 2560
    buffer_load_dwordx4 v[96:99], v2, s[8:11], s34 offen offset:0 sc1
    buffer_load_dwordx4 v[100:103], v2, s[8:11], s34 offen offset:1024 sc1
    s_add_u32 s34, s56, 5120
    buffer_load_dwordx4 v[104:107], v2, s[8:11], s34 offen offset:0 sc1
    buffer_load_dwordx4 v[108:111], v2, s[8:11], s34 offen offset:1024 sc1
    s_add_u32 s34, s56, 7680
    buffer_load_dwordx4 v[112:115], v2, s[8:11], s34 offen offset:0 sc1
    buffer_load_dwordx4 v[116:119], v2, s[8:11], s34 offen offset:1024 sc1
    s_add_u32 s34, s56, 10240
    buffer_load_dwordx4 v[120:123], v2, s[8:11], s34 offen offset:0 sc1
    buffer_load_dwordx4 v[124:127], v2, s[8:11], s34 offen offset:1024 sc1
    s_add_u32 s34, s56, 12800
    buffer_load_dwordx4 v[128:131], v2, s[8:11], s34 offen offset:0 sc1
    buffer_load_dwordx4 v[132:135], v2, s[8:11], s34 offen offset:1024 sc1
    s_add_u32 s34, s56, 15360
    buffer_load_dwordx4 v[136:139], v2, s[8:11], s34 offen offset:0 sc1
    buffer_load_dwordx4 v[140:143], v2, s[8:11], s34 offen offset:1024 sc1
    s_add_u32 s34, s56, 17920
    buffer_load_dwordx4 v[144:147], v2, s[8:11], s34 offen offset:0 sc1
    buffer_load_dwordx4 v[148:151], v2, s[8:11], s34 offen offset:1024 sc1
    s_add_u32 s34, s56, 0
    buffer_load_dwordx4 v[152:155], v3, s[8:11], s34 offen offset:2048 sc1
    buffer_load_dwordx4 v[156:159], v3, s[8:11], s34 offen offset:2304 sc1
    s_add_u32 s34, s56, 10240
    buffer_load_dwordx4 v[160:163], v3, s[8:11], s34 offen offset:2048 sc1
    buffer_load_dwordx4 v[164:167], v3, s[8:11], s34 offen offset:2304 sc1
    s_lshl_b32 s32, s53, 2
    s_add_u32 s32, s32, 0
    s_lshr_b32 s30, s32, 2
    s_lshl_b32 s30, s30, 1
    s_lshr_b32 s31, s3, 1
    s_add_u32 s30, s30, s31
    s_add_u32 s30, s30, 3
    s_lshr_b32 s31, s30, 3
    s_xor_b32 s31, s31, s32
    s_lshl_b32 s34, s30, 16
    s_bitcmp1_b32 s31, 0
    s_cselect_b32 s30, 16384, 0
    s_add_u32 s34, s34, s30
    s_bitcmp1_b32 s31, 1
    s_cselect_b32 s30, 4096, 0
    s_add_u32 s34, s34, s30
    s_xor_b32 s34, s34, s29
    s_add_u32 s34, s34, s57
    buffer_load_dwordx4 v[168:171], v2, s[8:11], s34 offen offset:0 sc1
    buffer_load_dwordx4 v[172:175], v2, s[8:11], s34 offen offset:1024 sc1
    s_lshl_b32 s32, s53, 2
    s_add_u32 s32, s32, 1
    s_lshr_b32 s30, s32, 2
    s_lshl_b32 s30, s30, 1
    s_lshr_b32 s31, s3, 1
    s_add_u32 s30, s30, s31
    s_add_u32 s30, s30, 3
    s_lshr_b32 s31, s30, 3
    s_xor_b32 s31, s31, s32
    s_lshl_b32 s34, s30, 16
    s_bitcmp1_b32 s31, 0
    s_cselect_b32 s30, 16384, 0
    s_add_u32 s34, s34, s30
    s_bitcmp1_b32 s31, 1
    s_cselect_b32 s30, 4096, 0
    s_add_u32 s34, s34, s30
    s_xor_b32 s34, s34, s29
    s_add_u32 s34, s34, s57
    buffer_load_dwordx4 v[176:179], v2, s[8:11], s34 offen offset:0 sc1
    buffer_load_dwordx4 v[180:183], v2, s[8:11], s34 offen offset:1024 sc1
    s_lshl_b32 s32, s53, 2
    s_add_u32 s32, s32, 2
    s_lshr_b32 s30, s32, 2
    s_lshl_b32 s30, s30, 1
    s_lshr_b32 s31, s3, 1
    s_add_u32 s30, s30, s31
    s_add_u32 s30, s30, 3
    s_lshr_b32 s31, s30, 3
    s_xor_b32 s31, s31, s32
    s_lshl_b32 s34, s30, 16
    s_bitcmp1_b32 s31, 0
    s_cselect_b32 s30, 16384, 0
    s_add_u32 s34, s34, s30
    s_bitcmp1_b32 s31, 1
    s_cselect_b32 s30, 4096, 0
    s_add_u32 s34, s34, s30
    s_xor_b32 s34, s34, s29
    s_add_u32 s34, s34, s57
    buffer_load_dwordx4 v[184:187], v2, s[8:11], s34 offen offset:0 sc1
    buffer_load_dwordx4 v[188:191], v2, s[8:11], s34 offen offset:1024 sc1
    s_lshl_b32 s32, s53, 2
    s_add_u32 s32, s32, 3
    s_lshr_b32 s30, s32, 2
    s_lshl_b32 s30, s30, 1
    s_lshr_b32 s31, s3, 1
    s_add_u32 s30, s30, s31
    s_add_u32 s30, s30, 3
    s_lshr_b32 s31, s30, 3
    s_xor_b32 s31, s31, s32
    s_lshl_b32 s34, s30, 16
    s_bitcmp1_b32 s31, 0
    s_cselect_b32 s30, 16384, 0
    s_add_u32 s34, s34, s30
    s_bitcmp1_b32 s31, 1
    s_cselect_b32 s30, 4096, 0
    s_add_u32 s34, s34, s30
    s_xor_b32 s34, s34, s29
    s_add_u32 s34, s34, s57
    buffer_load_dwordx4 v[192:195], v2, s[8:11], s34 offen offset:0 sc1
    buffer_load_dwordx4 v[196:199], v2, s[8:11], s34 offen offset:1024 sc1
    buffer_load_dwordx2 v[248:249], v11, s[8:11], 0 offen sc1
    buffer_load_dwordx4 v[200:203], v2, s[8:11], s55 offen offset:0 sc1
    buffer_load_dwordx4 v[204:207], v2, s[8:11], s55 offen offset:1024 sc1
    v_mov_b32 v17, 1
    s_mov_b64 exec, 1
    buffer_atomic_add v17, v18, s[24:27], s59 offen sc0 sc1
    s_mov_b64 exec, -1
    buffer_load_dwordx4 v[20:23], v16, s[8:11], 0 offen sc1
    s_waitcnt vmcnt(32)
    v_mfma_f32_16x16x32_bf16 v[24:27], a[0:3], v[88:91], 0
    v_mfma_f32_16x16x32_bf16 v[28:31], a[32:35], v[88:91], 0
    v_mfma_f32_16x16x32_bf16 v[32:35], a[64:67], v[88:91], 0
    v_mfma_f32_16x16x32_bf16 v[36:39], a[96:99], v[88:91], 0
    s_waitcnt vmcnt(31)
    v_mfma_f32_16x16x32_bf16 v[40:43], a[0:3], v[92:95], 0
    v_mfma_f32_16x16x32_bf16 v[44:47], a[32:35], v[92:95], 0
    v_mfma_f32_16x16x32_bf16 v[48:51], a[64:67], v[92:95], 0
    v_mfma_f32_16x16x32_bf16 v[52:55], a[96:99], v[92:95], 0
    s_waitcnt vmcnt(30)
    v_mfma_f32_16x16x32_bf16 v[24:27], a[4:7], v[96:99], v[24:27]
    v_mfma_f32_16x16x32_bf16 v[28:31], a[36:39], v[96:99], v[28:31]
    v_mfma_f32_16x16x32_bf16 v[32:35], a[68:71], v[96:99], v[32:35]
    v_mfma_f32_16x16x32_bf16 v[36:39], a[100:103], v[96:99], v[36:39]
    s_waitcnt vmcnt(29)
    v_mfma_f32_16x16x32_bf16 v[40:43], a[4:7], v[100:103], v[40:43]
    v_mfma_f32_16x16x32_bf16 v[44:47], a[36:39], v[100:103], v[44:47]
    v_mfma_f32_16x16x32_bf16 v[48:51], a[68:71], v[100:103], v[48:51]
    v_mfma_f32_16x16x32_bf16 v[52:55], a[100:103], v[100:103], v[52:55]
    s_waitcnt vmcnt(28)
    v_mfma_f32_16x16x32_bf16 v[24:27], a[8:11], v[104:107], v[24:27]
    v_mfma_f32_16x16x32_bf16 v[28:31], a[40:43], v[104:107], v[28:31]
    v_mfma_f32_16x16x32_bf16 v[32:35], a[72:75], v[104:107], v[32:35]
    v_mfma_f32_16x16x32_bf16 v[36:39], a[104:107], v[104:107], v[36:39]
    s_waitcnt vmcnt(27)
    v_mfma_f32_16x16x32_bf16 v[40:43], a[8:11], v[108:111], v[40:43]
    v_mfma_f32_16x16x32_bf16 v[44:47], a[40:43], v[108:111], v[44:47]
    v_mfma_f32_16x16x32_bf16 v[48:51], a[72:75], v[108:111], v[48:51]
    v_mfma_f32_16x16x32_bf16 v[52:55], a[104:107], v[108:111], v[52:55]
    s_waitcnt vmcnt(26)
    v_mfma_f32_16x16x32_bf16 v[24:27], a[12:15], v[112:115], v[24:27]
    v_mfma_f32_16x16x32_bf16 v[28:31], a[44:47], v[112:115], v[28:31]
    v_mfma_f32_16x16x32_bf16 v[32:35], a[76:79], v[112:115], v[32:35]
    v_mfma_f32_16x16x32_bf16 v[36:39], a[108:111], v[112:115], v[36:39]
    s_waitcnt vmcnt(25)
    v_mfma_f32_16x16x32_bf16 v[40:43], a[12:15], v[116:119], v[40:43]
    v_mfma_f32_16x16x32_bf16 v[44:47], a[44:47], v[116:119], v[44:47]
    v_mfma_f32_16x16x32_bf16 v[48:51], a[76:79], v[116:119], v[48:51]
    v_mfma_f32_16x16x32_bf16 v[52:55], a[108:111], v[116:119], v[52:55]
    s_waitcnt vmcnt(24)
    v_mfma_f32_16x16x32_bf16 v[24:27], a[16:19], v[120:123], v[24:27]
    v_mfma_f32_16x16x32_bf16 v[28:31], a[48:51], v[120:123], v[28:31]
    v_mfma_f32_16x16x32_bf16 v[32:35], a[80:83], v[120:123], v[32:35]
    v_mfma_f32_16x16x32_bf16 v[36:39], a[112:115], v[120:123], v[36:39]
    s_waitcnt vmcnt(23)
    v_mfma_f32_16x16x32_bf16 v[40:43], a[16:19], v[124:127], v[40:43]
    v_mfma_f32_16x16x32_bf16 v[44:47], a[48:51], v[124:127], v[44:47]
    v_mfma_f32_16x16x32_bf16 v[48:51], a[80:83], v[124:127], v[48:51]
    v_mfma_f32_16x16x32_bf16 v[52:55], a[112:115], v[124:127], v[52:55]
    s_waitcnt vmcnt(22)
    v_mfma_f32_16x16x32_bf16 v[24:27], a[20:23], v[128:131], v[24:27]
    v_mfma_f32_16x16x32_bf16 v[28:31], a[52:55], v[128:131], v[28:31]
    v_mfma_f32_16x16x32_bf16 v[32:35], a[84:87], v[128:131], v[32:35]
    v_mfma_f32_16x16x32_bf16 v[36:39], a[116:119], v[128:131], v[36:39]
    s_waitcnt vmcnt(21)
    v_mfma_f32_16x16x32_bf16 v[40:43], a[20:23], v[132:135], v[40:43]
    v_mfma_f32_16x16x32_bf16 v[44:47], a[52:55], v[132:135], v[44:47]
    v_mfma_f32_16x16x32_bf16 v[48:51], a[84:87], v[132:135], v[48:51]
    v_mfma_f32_16x16x32_bf16 v[52:55], a[116:119], v[132:135], v[52:55]
    s_waitcnt vmcnt(20)
    v_mfma_f32_16x16x32_bf16 v[24:27], a[24:27], v[136:139], v[24:27]
    v_mfma_f32_16x16x32_bf16 v[28:31], a[56:59], v[136:139], v[28:31]
    v_mfma_f32_16x16x32_bf16 v[32:35], a[88:91], v[136:139], v[32:35]
    v_mfma_f32_16x16x32_bf16 v[36:39], a[120:123], v[136:139], v[36:39]
    s_waitcnt vmcnt(19)
    v_mfma_f32_16x16x32_bf16 v[40:43], a[24:27], v[140:143], v[40:43]
    v_mfma_f32_16x16x32_bf16 v[44:47], a[56:59], v[140:143], v[44:47]
    v_mfma_f32_16x16x32_bf16 v[48:51], a[88:91], v[140:143], v[48:51]
    v_mfma_f32_16x16x32_bf16 v[52:55], a[120:123], v[140:143], v[52:55]
    s_waitcnt vmcnt(18)
    v_mfma_f32_16x16x32_bf16 v[24:27], a[28:31], v[144:147], v[24:27]
    v_mfma_f32_16x16x32_bf16 v[28:31], a[60:63], v[144:147], v[28:31]
    v_mfma_f32_16x16x32_bf16 v[32:35], a[92:95], v[144:147], v[32:35]
    v_mfma_f32_16x16x32_bf16 v[36:39], a[124:127], v[144:147], v[36:39]
    s_waitcnt vmcnt(17)
    v_mfma_f32_16x16x32_bf16 v[40:43], a[28:31], v[148:151], v[40:43]
    v_mfma_f32_16x16x32_bf16 v[44:47], a[60:63], v[148:151], v[44:47]
    v_mfma_f32_16x16x32_bf16 v[48:51], a[92:95], v[148:151], v[48:51]
    v_mfma_f32_16x16x32_bf16 v[52:55], a[124:127], v[148:151], v[52:55]
    s_waitcnt vmcnt(12)
    v_mfma_f32_16x16x32_bf16 v[24:27], v[168:171], v[152:155], v[24:27]
    v_mfma_f32_16x16x32_bf16 v[40:43], v[168:171], v[156:159], v[40:43]
    s_waitcnt vmcnt(11)
    v_mfma_f32_16x16x32_bf16 v[24:27], v[172:175], v[160:163], v[24:27]
    v_mfma_f32_16x16x32_bf16 v[40:43], v[172:175], v[164:167], v[40:43]
    s_waitcnt vmcnt(10)
    v_mfma_f32_16x16x32_bf16 v[28:31], v[176:179], v[152:155], v[28:31]
    v_mfma_f32_16x16x32_bf16 v[44:47], v[176:179], v[156:159], v[44:47]
    s_waitcnt vmcnt(9)
    v_mfma_f32_16x16x32_bf16 v[28:31], v[180:183], v[160:163], v[28:31]
    v_mfma_f32_16x16x32_bf16 v[44:47], v[180:183], v[164:167], v[44:47]
    s_waitcnt vmcnt(8)
    v_mfma_f32_16x16x32_bf16 v[32:35], v[184:187], v[152:155], v[32:35]
    v_mfma_f32_16x16x32_bf16 v[48:51], v[184:187], v[156:159], v[48:51]
    s_waitcnt vmcnt(7)
    v_mfma_f32_16x16x32_bf16 v[32:35], v[188:191], v[160:163], v[32:35]
    v_mfma_f32_16x16x32_bf16 v[48:51], v[188:191], v[164:167], v[48:51]
    s_waitcnt vmcnt(6)
    v_mfma_f32_16x16x32_bf16 v[36:39], v[192:195], v[152:155], v[36:39]
    v_mfma_f32_16x16x32_bf16 v[52:55], v[192:195], v[156:159], v[52:55]
    s_waitcnt vmcnt(5)
    v_mfma_f32_16x16x32_bf16 v[36:39], v[196:199], v[160:163], v[36:39]
    v_mfma_f32_16x16x32_bf16 v[52:55], v[196:199], v[164:167], v[52:55]
    ds_write_b128 v6, v[24:27] offset:0
    ds_write_b128 v6, v[28:31] offset:1024
    ds_write_b128 v6, v[32:35] offset:2048
    s_nop 3
    ds_write_b128 v6, v[36:39] offset:3072
    ds_write_b128 v6, v[40:43] offset:4096
    ds_write_b128 v6, v[44:47] offset:5120
    ds_write_b128 v6, v[48:51] offset:6144
    ds_write_b128 v6, v[52:55] offset:7168
    s_waitcnt vmcnt(1)
    s_cmp_lg_u32 s3, 0
    s_cbranch_scc1 Lxk_166
    s_mov_b64 exec, 1
    ds_write_b32 v19, v17
    s_mov_b64 exec, -1
Lxk_166:
    s_waitcnt vmcnt(0)
    v_min_u32 v21, v20, v21
    v_min3_u32 v21, v21, v22, v23
    v_max_u32 v20, 1, v20
    v_add_u32 v20, -1, v20
    v_cndmask_b32 v20, v20, v21, s[46:47]
    s_nop 1
    v_min_u32_dpp v20, v20, v20 row_ror:8 row_mask:0xf bank_mask:0xf
    s_nop 1
    v_min_u32_dpp v20, v20, v20 row_ror:4 row_mask:0xf bank_mask:0xf
    s_nop 1
    v_min_u32_dpp v20, v20, v20 row_ror:2 row_mask:0xf bank_mask:0xf
    s_nop 1
    v_min_u32_dpp v20, v20, v20 row_ror:1 row_mask:0xf bank_mask:0xf
    s_nop 0
    v_readlane_b32 s58, v20, 0
    v_readlane_b32 s30, v20, 16
    s_nop 0
    s_min_u32 s58, s58, s30
    s_min_u32 s58, s58, 62
    s_waitcnt lgkmcnt(0)
    s_barrier
    ds_read_b128 v[24:27], v7 offset:0
    ds_read_b128 v[28:31], v7 offset:8192
    ds_read_b128 v[32:35], v7 offset:16384
    ds_read_b128 v[36:39], v7 offset:24576
    ds_read_b128 v[40:43], v7 offset:1024
    ds_read_b128 v[44:47], v7 offset:9216
    ds_read_b128 v[48:51], v7 offset:17408
    ds_read_b128 v[52:55], v7 offset:25600
    s_waitcnt lgkmcnt(6)
    v_add_f32 v24, v24, v28
    v_add_f32 v25, v25, v29
    v_add_f32 v26, v26, v30
    v_add_f32 v27, v27, v31
    s_waitcnt lgkmcnt(4)
    v_add_f32 v32, v32, v36
    v_add_f32 v33, v33, v37
    v_add_f32 v34, v34, v38
    v_add_f32 v35, v35, v39
    v_add_f32 v24, v24, v32
    v_add_f32 v25, v25, v33
    v_add_f32 v26, v26, v34
    v_add_f32 v27, v27, v35
    v_cvt_pk_bf16_f32 v32, v24, v25
    v_lshlrev_b32 v24, 16, v32
    v_and_b32 v25, s44, v32
    v_mul_f32 v24, v24, v248
    v_mul_f32 v25, v25, v248
    v_cvt_pk_bf16_f32 v32, v24, v25
    v_lshlrev_b32 v24, 16, v32
    v_and_b32 v25, s44, v32
    v_lshlrev_b32 v28, 16, v232
    v_and_b32 v29, s44, v232
    v_lshlrev_b32 v30, 16, v240
    v_and_b32 v31, s44, v240
    v_mul_f32 v28, v28, v30
    v_mul_f32 v29, v29, v31
    v_cvt_pk_bf16_f32 v32, v28, v29
    v_lshlrev_b32 v28, 16, v32
    v_and_b32 v29, s44, v32
    v_add_f32 v28, v28, v200
    v_add_f32 v29, v29, v201
    v_mul_f32 v28, v28, v249
    v_mul_f32 v29, v29, v249
    v_add_f32 v24, v24, v28
    v_add_f32 v25, v25, v29
    v_cvt_pk_bf16_f32 v32, v26, v27
    v_lshlrev_b32 v26, 16, v32
    v_and_b32 v27, s44, v32
    v_mul_f32 v26, v26, v248
    v_mul_f32 v27, v27, v248
    v_cvt_pk_bf16_f32 v32, v26, v27
    v_lshlrev_b32 v26, 16, v32
    v_and_b32 v27, s44, v32
    v_lshlrev_b32 v28, 16, v233
    v_and_b32 v29, s44, v233
    v_lshlrev_b32 v30, 16, v241
    v_and_b32 v31, s44, v241
    v_mul_f32 v28, v28, v30
    v_mul_f32 v29, v29, v31
    v_cvt_pk_bf16_f32 v32, v28, v29
    v_lshlrev_b32 v28, 16, v32
    v_and_b32 v29, s44, v32
    v_add_f32 v28, v28, v202
    v_add_f32 v29, v29, v203
    v_mul_f32 v28, v28, v249
    v_mul_f32 v29, v29, v249
    v_add_f32 v26, v26, v28
    v_add_f32 v27, v27, v29
    buffer_store_dwordx4 v[24:27], v10, s[12:15], 0 offen offset:0
    s_waitcnt lgkmcnt(2)
    v_add_f32 v40, v40, v44
    v_add_f32 v41, v41, v45
    v_add_f32 v42, v42, v46
    v_add_f32 v43, v43, v47
    s_waitcnt lgkmcnt(0)
    v_add_f32 v48, v48, v52
    v_add_f32 v49, v49, v53
    v_add_f32 v50, v50, v54
    v_add_f32 v51, v51, v55
    v_add_f32 v40, v40, v48
    v_add_f32 v41, v41, v49
    v_add_f32 v42, v42, v50
    v_add_f32 v43, v43, v51
    v_cvt_pk_bf16_f32 v48, v40, v41
    v_lshlrev_b32 v40, 16, v48
    v_and_b32 v41, s44, v48
    v_mul_f32 v40, v40, v248
    v_mul_f32 v41, v41, v248
    v_cvt_pk_bf16_f32 v48, v40, v41
    v_lshlrev_b32 v40, 16, v48
    v_and_b32 v41, s44, v48
    v_lshlrev_b32 v44, 16, v234
    v_and_b32 v45, s44, v234
    v_lshlrev_b32 v46, 16, v242
    v_and_b32 v47, s44, v242
    v_mul_f32 v44, v44, v46
    v_mul_f32 v45, v45, v47
    v_cvt_pk_bf16_f32 v48, v44, v45
    v_lshlrev_b32 v44, 16, v48
    v_and_b32 v45, s44, v48
    v_add_f32 v44, v44, v204
    v_add_f32 v45, v45, v205
    v_mul_f32 v44, v44, v249
    v_mul_f32 v45, v45, v249
    v_add_f32 v40, v40, v44
    v_add_f32 v41, v41, v45
    v_cvt_pk_bf16_f32 v48, v42, v43
    v_lshlrev_b32 v42, 16, v48
    v_and_b32 v43, s44, v48
    v_mul_f32 v42, v42, v248
    v_mul_f32 v43, v43, v248
    v_cvt_pk_bf16_f32 v48, v42, v43
    v_lshlrev_b32 v42, 16, v48
    v_and_b32 v43, s44, v48
    v_lshlrev_b32 v44, 16, v235
    v_and_b32 v45, s44, v235
    v_lshlrev_b32 v46, 16, v243
    v_and_b32 v47, s44, v243
    v_mul_f32 v44, v44, v46
    v_mul_f32 v45, v45, v47
    v_cvt_pk_bf16_f32 v48, v44, v45
    v_lshlrev_b32 v44, 16, v48
    v_and_b32 v45, s44, v48
    v_add_f32 v44, v44, v206
    v_add_f32 v45, v45, v207
    v_mul_f32 v44, v44, v249
    v_mul_f32 v45, v45, v249
    v_add_f32 v42, v42, v44
    v_add_f32 v43, v43, v45
    buffer_store_dwordx4 v[40:43], v10, s[12:15], 0 offen offset:64
    s_nop 0
    s_branch L_xc_loop
    s_branch L_end
L_abort:
    s_waitcnt vmcnt(0) lgkmcnt(0)
    v_mov_b32 v2, 4
    v_mov_b32 v3, 1
    s_mov_b64 exec, 1
    buffer_atomic_add v3, v2, s[24:27], 0 offen sc1
    v_mov_b32 v2, 8
    v_mov_b32 v3, s2
    buffer_store_dword v3, v2, s[24:27], 0 offen sc1
    s_nop 0
L_end:
    s_endpgm
.section .rodata,"a"
.p2align 6
.amdhsa_kernel gated_mix__memory_aug_recurrent_mem_tr__ssm_conv_s5__prompt_kernel
  .amdhsa_next_free_vgpr 512
  .amdhsa_next_free_sgpr 102
  .amdhsa_accum_offset 256
  .amdhsa_group_segment_fixed_size 0
  .amdhsa_kernarg_size 160
  .amdhsa_user_sgpr_count 2
  .amdhsa_user_sgpr_kernarg_segment_ptr 1
  .amdhsa_system_sgpr_workgroup_id_x 1
  .amdhsa_float_denorm_mode_32 3
.end_amdhsa_kernel
```
